```python
import torch

def _softmax(x, axis=-1):
    return torch.softmax(x, dim=axis)
def _gelu(x):
    return torch.nn.functional.gelu(x, approximate="tanh")
def _silu(x):
    return torch.nn.functional.silu(x)
def _sigmoid(x):
    return torch.sigmoid(x)
def _layernorm(x, axis=-1, eps=1e-5):
    m = x.mean(dim=axis, keepdim=True)
    v = x.var(dim=axis, keepdim=True, unbiased=False)
    return (x - m) / torch.sqrt(v + eps)
def _scatter_add(tgt, idx, src, axis=0):
    return tgt.clone().index_add_(axis, idx, src)
def _segment_sum(src, seg, n):
    out = torch.zeros((n,) + src.shape[1:], dtype=src.dtype)
    return out.index_add_(0, seg, src)
def _pad(x, pw):
    flat = tuple(v for pair in reversed(pw) for v in pair)
    return torch.nn.functional.pad(x, flat)

kernel_name = 'gated_mix__spectral_gfnet__linear_attn_block__prompt'

def setup_inputs():

    _w = (lambda a: (lambda t: t.to(torch.bfloat16) if t.is_floating_point() else t)(torch.as_tensor(a)))
    def _A_setup():
        B, S, D = 1, 2048, 640
        Df = D // 2 + 1
        return {
            "x": _w((lambda *s: torch.randn(*s, dtype=torch.bfloat16) * 0.05)(B, S, D)),
            "w_r": _w((lambda *s: torch.randn(*s, dtype=torch.bfloat16) * 1.6)(S, Df) * 0.02),
            "w_i": _w((lambda *s: torch.randn(*s, dtype=torch.bfloat16) * 1.6)(S, Df) * 0.02),
        }
    _A_in = _A_setup()

    def _B_setup():
        B, S, D = 1, 2048, 640
        return {
            "x": _w((lambda *s: torch.randn(*s, dtype=torch.bfloat16) * 0.05)(B, S, D)),
            "wqkv": _w((lambda *s: torch.randn(*s, dtype=torch.bfloat16) * 0.4)(D, 3 * D)),
            "wo": _w((lambda *s: torch.randn(*s, dtype=torch.bfloat16) * 0.05)(D, D)),
        }
    _B_in = _B_setup()

    return {
        "A_x": _A_in["x"],
        "A_w_r": _A_in["w_r"],
        "A_w_i": _A_in["w_i"],
        "B_x": _B_in["x"],
        "B_wqkv": _B_in["wqkv"],
        "B_wo": _B_in["wo"],
        "gate_w": _w((lambda *s: torch.randn(*s, dtype=torch.bfloat16) * 0.05)(640) * 16.0),
    }

def reference(A_x, A_w_r, A_w_i, B_x, B_wqkv, B_wo, gate_w):
    def _A_ref(x, w_r, w_i):
        B, S, D = x.shape
        X = (lambda x, axes=(-2,-1): torch.fft.rfft2(x.float(), dim=axes))(x, axes=(-2, -1))
        W = w_r + 1j * w_i
        X = X * W
        y = (lambda x, s, axes=(-2,-1): torch.fft.irfft2(x, s=s, dim=axes).to(torch.bfloat16))(X, (S, D), axes=(-2, -1))
        return y

    def _B_ref(x, wqkv, wo):
        B, S, D = x.shape
        H = 32; Dh = D // H
        qkv = (lambda x, *d: x.permute(*d))((x @ wqkv).reshape(B, S, 3, H, Dh), 2, 0, 3, 1, 4)
        q, k, v = qkv[0], qkv[1], qkv[2]
        phi = lambda t: torch.where(t > 0, t + 1, torch.exp(t)) + 1e-6
        pq, pk = phi(q), phi(k)
        kv = torch.einsum("bhsd,bhse->bhde", pk, v)
        z = torch.einsum("bhsd->bhd", pk)
        num = torch.einsum("bhqd,bhde->bhqe", pq, kv)
        den = torch.einsum("bhqd,bhd->bhq", pq, z)[..., None] + 1e-6
        o = num / den
        return (lambda x, *d: x.permute(*d))(o, 0, 2, 1, 3).reshape(B, S, D) @ wo

    x = A_x
    g = _sigmoid((x * gate_w).sum(-1, keepdims=True))
    a = _A_ref(x, A_w_r, A_w_i)
    b = _B_ref(x, B_wqkv, B_wo)
    return g * a + (1 - g) * b
```

```asm
; @launch grid=(256,1,1) block=(512,1,1) lds=163840
.amdgcn_target "amdgcn-amd-amdhsa--gfx950"
.text
.globl gated_mix__spectral_gfnet__linear_attn_block__prompt_kernel
.p2align 8
.type gated_mix__spectral_gfnet__linear_attn_block__prompt_kernel,@function
gated_mix__spectral_gfnet__linear_attn_block__prompt_kernel:
  s_getpc_b64 s[34:35]
L_pc:
  s_mov_b32 s52, s34
  s_mov_b32 s53, s35
  s_mov_b32 s54, L_end-L_pc
  s_mov_b32 s55, 0x20000
  s_lshr_b32 s64, s2, 3
  s_lshl_b32 s74, s64, 7
  v_lshl_add_u32 v10, v0, 12, s74
  s_cmp_ge_u32 s2, 256
  s_cbranch_scc1 L_end
  buffer_load_dword v100, v10, s[52:55], 0 offen
  s_load_dwordx4 s[84:87], s[0:1], 0
  s_load_dwordx8 s[88:95], s[0:1], 32
  s_load_dwordx2 s[100:101], s[0:1], 16
  s_load_dwordx4 s[96:99], s[0:1], 64
  v_lshrrev_b32 v4, 6, v0
  v_and_b32 v1, 63, v0
  v_readfirstlane_b32 s60, v4
  s_and_b32 s65, s2, 7
  s_and_b32 s63, s64, 3
  s_lshr_b32 s74, s64, 2
  s_mul_i32 s75, s63, 5
  s_lshr_b32 s75, s75, 1
  s_add_u32 s66, s74, s75
  s_cmp_ge_u32 s66, 10
  s_cselect_b32 s75, 10, 0
  s_sub_u32 s66, s66, s75
  v_lshrrev_b32 v2, 4, v1
  v_lshlrev_b32 v16, 4, v1
  s_and_b32 s61, s60, 3
  s_lshl_b32 s76, s2, 3
  s_add_u32 s76, s76, s60
  s_lshl_b32 s76, s76, 7
  s_add_u32 s78, s34, stab-L_pc
  s_addc_u32 s79, s35, 0
  s_add_u32 s78, s78, s76
  s_addc_u32 s79, s79, 0
  s_lshr_b32 s62, s60, 2
  s_cbranch_scc0 L_M
  s_lshr_b32 s75, s65, 2
  s_lshl_b32 s75, s75, 3
  s_add_u32 s75, s75, s74
  s_lshl_b32 s75, s75, 2
  s_add_u32 s75, s75, s61
  s_mul_i32 s75, s75, 1280
  v_lshrrev_b32 v4, 3, v1
  v_mul_u32_u24 v4, 81920, v4
  v_add_u32 v4, s75, v4
  v_and_b32 v5, 7, v1
  v_xor_b32 v5, v5, v2
  v_lshl_add_u32 v17, v5, 4, v4
  v_xor_b32 v5, 4, v5
  v_lshl_add_u32 v18, v5, 4, v4
  v_add_u32 v18, 654336, v18
  v_add_u32 v19, 1308672, v17
  v_add_u32 v20, 1308672, v18
  s_lshl_b32 s3, s61, 12
  s_mul_i32 s69, s61, 5120
  s_and_b32 s77, s65, 3
  s_lshl_b32 s2, s66, 7
  s_mov_b32 m0, s3
  s_waitcnt lgkmcnt(0)
  s_mov_b32 s48, s86
  s_mov_b32 s49, s87
  s_mov_b32 s86, 2621440
  s_mov_b32 s87, 0x20000
  buffer_load_dwordx4 v17, s[84:87], s2 offen offset:0 lds
  buffer_load_dwordx4 v18, s[84:87], s2 offen offset:1024 lds
  buffer_load_dwordx4 v19, s[84:87], s2 offen offset:2048 lds
  buffer_load_dwordx4 v20, s[84:87], s2 offen offset:3072 lds
  s_cmp_lg_u32 s63, 0
  s_cbranch_scc1 L_pq
  s_movk_i32 s68, 20480
  s_mul_i32 s74, s77, 204800
  s_add_u32 s74, s74, s69
  v_add_u32 v21, s74, v16
  v_mov_b32 v22, v21
  v_mov_b32 v23, v21
  v_mov_b32 v24, v21
  v_add_u32 v25, 4096, v21
  s_add_u32 s36, s34, ftab-L_pc
  s_addc_u32 s37, s35, 0
  s_mov_b32 s38, 819200
  s_mov_b32 s39, 0x20000
  s_and_b32 s75, s61, 1
  s_lshl_b32 s74, s75, 10
  v_add_u32 v4, s74, v16
  s_lshr_b32 s76, s61, 1
  s_mul_i32 s76, s76, 1280
  s_add_u32 s74, s74, s76
  s_add_u32 m0, s74, 147456
  s_mov_b32 s52, s92
  s_mov_b32 s53, s93
  s_mov_b32 s54, 1280
  s_mov_b32 s55, 0x20000
  s_cmp_eq_u32 s75, 0
  s_cselect_b64 exec, -1, 0xffff
  buffer_load_dwordx4 v4, s[52:55], 0 offen lds
  s_mov_b64 exec, -1
  s_branch L_pw2
L_pq:
  s_mov_b32 s68, 245760
  s_mul_i32 s74, s77, 320
  s_mul_i32 s75, s63, 160
  s_add_u32 s75, s75, 960
  s_cmp_eq_u32 s63, 1
  s_cselect_b32 s75, 0, s75
  s_cselect_b32 s76, 0, 1120
  s_add_u32 s74, s74, s75
  s_mul_i32 s75, s61, 61440
  s_add_u32 s75, s75, s74
  v_mov_b32 v8, s76
  v_add_u32 v4, 0, v1
  v_mul_u32_u24 v5, 3277, v4
  v_lshrrev_b32 v5, 16, v5
  v_mul_u32_u24 v6, 20, v5
  v_sub_u32 v6, v4, v6
  v_cmp_le_u32 vcc, 10, v6
  v_mul_u32_u24 v5, 3840, v5
  v_lshl_add_u32 v5, v6, 4, v5
  v_cndmask_b32 v7, 0, v8, vcc
  v_add3_u32 v21, v5, v7, s75
  s_sub_u32 s75, s75, 1024
  v_add_u32 v4, 64, v1
  v_mul_u32_u24 v5, 3277, v4
  v_lshrrev_b32 v5, 16, v5
  v_mul_u32_u24 v6, 20, v5
  v_sub_u32 v6, v4, v6
  v_cmp_le_u32 vcc, 10, v6
  v_mul_u32_u24 v5, 3840, v5
  v_lshl_add_u32 v5, v6, 4, v5
  v_cndmask_b32 v7, 0, v8, vcc
  v_add3_u32 v22, v5, v7, s75
  s_sub_u32 s75, s75, 1024
  v_add_u32 v4, 128, v1
  v_mul_u32_u24 v5, 3277, v4
  v_lshrrev_b32 v5, 16, v5
  v_mul_u32_u24 v6, 20, v5
  v_sub_u32 v6, v4, v6
  v_lshrrev_b32 v7, 2, v5
  v_and_b32 v7, 2, v7
  v_xor_b32 v6, v6, v7
  v_cmp_le_u32 vcc, 10, v6
  v_mul_u32_u24 v5, 3840, v5
  v_lshl_add_u32 v5, v6, 4, v5
  v_cndmask_b32 v7, 0, v8, vcc
  v_add3_u32 v23, v5, v7, s75
  s_sub_u32 s75, s75, 1024
  v_add_u32 v4, 192, v1
  v_mul_u32_u24 v5, 3277, v4
  v_lshrrev_b32 v5, 16, v5
  v_mul_u32_u24 v6, 20, v5
  v_sub_u32 v6, v4, v6
  v_xor_b32 v6, 2, v6
  v_cmp_le_u32 vcc, 10, v6
  v_mul_u32_u24 v5, 3840, v5
  v_lshl_add_u32 v5, v6, 4, v5
  v_cndmask_b32 v7, 0, v8, vcc
  v_add3_u32 v24, v5, v7, s75
  s_add_u32 s75, s75, 3072
  v_add_u32 v4, 256, v1
  v_mul_u32_u24 v5, 3277, v4
  v_lshrrev_b32 v5, 16, v5
  v_mul_u32_u24 v6, 20, v5
  v_sub_u32 v6, v4, v6
  v_xor_b32 v6, 2, v6
  v_cmp_le_u32 vcc, 10, v6
  v_mul_u32_u24 v5, 3840, v5
  v_lshl_add_u32 v5, v6, 4, v5
  v_cndmask_b32 v7, 0, v8, vcc
  v_add3_u32 v25, v5, v7, s75
  s_mov_b32 s36, s88
  s_mov_b32 s37, s89
  s_mov_b32 s38, 2457600
  s_mov_b32 s39, 0x20000
L_pw2:
  s_add_u32 s69, s69, 16384
  s_mul_i32 s67, s68, s66
  s_add_u32 m0, s69, 0
  s_nop 0
  buffer_load_dwordx4 v21, s[36:39], s67 offen lds
  buffer_load_dwordx4 v22, s[36:39], s67 offen offset:1024 lds
  buffer_load_dwordx4 v23, s[36:39], s67 offen offset:2048 lds
  buffer_load_dwordx4 v24, s[36:39], s67 offen offset:3072 lds
  s_add_u32 m0, s69, 4096
  s_add_u32 s66, s66, 1
  buffer_load_dwordx4 v25, s[36:39], s67 offen lds
  s_cmp_eq_u32 s66, 10
  s_cselect_b32 s66, 0, s66
  s_load_dwordx16 s[4:19], s[78:79], 0
  s_load_dwordx16 s[20:35], s[78:79], 64
  s_mov_b32 s40, s98
  s_mov_b32 s41, s99
  s_mov_b32 s42, 10485760
  s_mov_b32 s43, 0x20000
  s_mov_b32 s44, s94
  s_mov_b32 s45, s95
  s_mov_b32 s46, 2621440
  s_mov_b32 s47, 0x20000
  s_mov_b32 s56, s96
  s_mov_b32 s57, s97
  s_mov_b32 s58, 256
  s_mov_b32 s59, 0x20000
  v_and_b32 v3, 15, v1
  v_mov_b32 v44, 163776
  v_mov_b32 v45, 1
  s_mov_b32 s71, 0
  s_mul_i32 s74, s61, 80
  v_lshl_add_u32 v5, v2, 2, s74
  v_cvt_f32_u32 v47, v5
  s_cmp_eq_u32 s63, 1
  s_cselect_b32 s73, 0, 1
  s_xor_b32 s73, s73, s62
  v_lshrrev_b32 v46, 2, v3
  v_mul_u32_u24 v46, 20, v46
  v_and_b32 v5, 3, v3
  v_add_u32 v46, v46, v5
  v_and_b32 v31, 1, v1
  v_lshlrev_b32 v31, 7, v31
  v_mov_b32 v8, 0
  v_mov_b32 v9, 0
  v_mov_b32 v10, 0
  v_mov_b32 v11, 0
  ds_write_b128 v44, v[8:11]
  ds_write_b128 v44, v[8:11] offset:16
  s_cmp_eq_u32 s63, 1
  s_cbranch_scc1 L_HQ
  s_mov_b32 s50, 1314816
  s_mov_b32 s51, 0x20000
  s_mov_b32 s52, s100
  s_mov_b32 s53, s101
  s_mov_b32 s54, 1314816
  s_mov_b32 s55, 0x20000
  s_lshl_b32 s74, s61, 4
  s_lshl_b32 s2, s66, 7
  s_add_u32 m0, s3, 36864
  s_mul_i32 s67, s68, s66
  buffer_load_dwordx4 v17, s[84:87], s2 offen lds
  v_add_u32 v4, s74, v3
  v_cvt_f32_u32 v4, v4
  v_lshlrev_b32 v6, 2, v2
  v_cvt_f32_u32 v6, v6
  v_mul_f32 v4, 0x3c800000, v4
  v_mul_f32 v5, v4, v6
  v_fmamk_f32 v8, v4, 0x0, v5
  v_cos_f32 v9, v8
  v_sin_f32 v10, v8
  buffer_load_dwordx4 v18, s[84:87], s2 offen offset:1024 lds
  v_cvt_pk_bf16_f32 v224, v9, v10
  v_cvt_pk_bf16_f32 v240, -v10, v9
  v_fmamk_f32 v11, v4, 0x3f800000, v5
  v_cos_f32 v12, v11
  v_sin_f32 v13, v11
  s_nop 0
  v_cvt_pk_bf16_f32 v225, v12, v13
  v_cvt_pk_bf16_f32 v241, -v13, v12
  v_fmamk_f32 v8, v4, 0x40000000, v5
  v_cos_f32 v9, v8
  v_sin_f32 v10, v8
  buffer_load_dwordx4 v19, s[84:87], s2 offen offset:2048 lds
  v_cvt_pk_bf16_f32 v226, v9, v10
  v_cvt_pk_bf16_f32 v242, -v10, v9
  v_fmamk_f32 v11, v4, 0x40400000, v5
  v_cos_f32 v12, v11
  v_sin_f32 v13, v11
  s_nop 0
  v_cvt_pk_bf16_f32 v227, v12, v13
  v_cvt_pk_bf16_f32 v243, -v13, v12
  v_fmamk_f32 v8, v4, 0x41800000, v5
  v_cos_f32 v9, v8
  v_sin_f32 v10, v8
  buffer_load_dwordx4 v20, s[84:87], s2 offen offset:3072 lds
  v_cvt_pk_bf16_f32 v228, v9, v10
  v_cvt_pk_bf16_f32 v244, -v10, v9
  v_fmamk_f32 v11, v4, 0x41880000, v5
  v_cos_f32 v12, v11
  v_sin_f32 v13, v11
  s_nop 0
  v_cvt_pk_bf16_f32 v229, v12, v13
  v_cvt_pk_bf16_f32 v245, -v13, v12
  v_fmamk_f32 v8, v4, 0x41900000, v5
  v_cos_f32 v9, v8
  s_add_u32 m0, s69, 36864
  s_nop 0
  buffer_load_dwordx4 v21, s[36:39], s67 offen lds
  v_sin_f32 v10, v8
  s_nop 0
  v_cvt_pk_bf16_f32 v230, v9, v10
  v_cvt_pk_bf16_f32 v246, -v10, v9
  v_fmamk_f32 v11, v4, 0x41980000, v5
  v_cos_f32 v12, v11
  v_sin_f32 v13, v11
  s_nop 0
  v_cvt_pk_bf16_f32 v231, v12, v13
  v_cvt_pk_bf16_f32 v247, -v13, v12
  v_fmamk_f32 v8, v4, 0x42000000, v5
  v_cos_f32 v9, v8
  buffer_load_dwordx4 v22, s[36:39], s67 offen offset:1024 lds
  v_sin_f32 v10, v8
  s_nop 0
  v_cvt_pk_bf16_f32 v232, v9, v10
  v_cvt_pk_bf16_f32 v248, -v10, v9
  v_fmamk_f32 v11, v4, 0x42040000, v5
  v_cos_f32 v12, v11
  v_sin_f32 v13, v11
  s_nop 0
  v_cvt_pk_bf16_f32 v233, v12, v13
  v_cvt_pk_bf16_f32 v249, -v13, v12
  v_fmamk_f32 v8, v4, 0x42080000, v5
  v_cos_f32 v9, v8
  buffer_load_dwordx4 v23, s[36:39], s67 offen offset:2048 lds
  v_sin_f32 v10, v8
  s_nop 0
  v_cvt_pk_bf16_f32 v234, v9, v10
  v_cvt_pk_bf16_f32 v250, -v10, v9
  v_fmamk_f32 v11, v4, 0x420c0000, v5
  v_cos_f32 v12, v11
  v_sin_f32 v13, v11
  s_nop 0
  v_cvt_pk_bf16_f32 v235, v12, v13
  v_cvt_pk_bf16_f32 v251, -v13, v12
  v_fmamk_f32 v8, v4, 0x42400000, v5
  buffer_load_dwordx4 v24, s[36:39], s67 offen offset:3072 lds
  v_cos_f32 v9, v8
  v_sin_f32 v10, v8
  s_nop 0
  v_cvt_pk_bf16_f32 v236, v9, v10
  v_cvt_pk_bf16_f32 v252, -v10, v9
  v_fmamk_f32 v11, v4, 0x42440000, v5
  v_cos_f32 v12, v11
  v_sin_f32 v13, v11
  s_nop 0
  v_cvt_pk_bf16_f32 v237, v12, v13
  v_cvt_pk_bf16_f32 v253, -v13, v12
  v_fmamk_f32 v8, v4, 0x42480000, v5
  s_add_u32 m0, s69, 40960
  s_add_u32 s66, s66, 1
  buffer_load_dwordx4 v25, s[36:39], s67 offen lds
  s_cmp_eq_u32 s66, 10
  s_cselect_b32 s66, 0, s66
  v_cos_f32 v9, v8
  v_sin_f32 v10, v8
  s_nop 0
  v_cvt_pk_bf16_f32 v238, v9, v10
  v_cvt_pk_bf16_f32 v254, -v10, v9
  v_fmamk_f32 v11, v4, 0x424c0000, v5
  v_cos_f32 v12, v11
  v_sin_f32 v13, v11
  s_nop 0
  v_cvt_pk_bf16_f32 v239, v12, v13
  v_cvt_pk_bf16_f32 v255, -v13, v12
  s_waitcnt vmcnt(9) lgkmcnt(0)
  s_barrier
  s_lshl_b32 s2, s66, 7
  s_add_u32 m0, s3, 73728
  s_mul_i32 s67, s68, s66
  buffer_load_dwordx4 v17, s[84:87], s2 offen lds
  buffer_load_dwordx4 v18, s[84:87], s2 offen offset:1024 lds
  buffer_load_dwordx4 v19, s[84:87], s2 offen offset:2048 lds
  buffer_load_dwordx4 v20, s[84:87], s2 offen offset:3072 lds
  s_add_u32 m0, s69, 73728
  s_nop 0
  buffer_load_dwordx4 v21, s[36:39], s67 offen lds
  buffer_load_dwordx4 v22, s[36:39], s67 offen offset:1024 lds
  buffer_load_dwordx4 v23, s[36:39], s67 offen offset:2048 lds
  buffer_load_dwordx4 v24, s[36:39], s67 offen offset:3072 lds
  s_add_u32 m0, s69, 77824
  s_add_u32 s66, s66, 1
  buffer_load_dwordx4 v25, s[36:39], s67 offen lds
  s_cmp_eq_u32 s66, 10
  s_cselect_b32 s66, 0, s66
  s_waitcnt vmcnt(9)
  s_barrier
  v_add_u32 v46, s34, v46
  s_lshl_b32 s2, s66, 7
  s_add_u32 m0, s3, 110592
  s_mul_i32 s67, s68, s66
  buffer_load_dwordx4 v17, s[84:87], s2 offen lds
  v_cvt_f32_i32 v46, v46
  v_add_u32 v31, s28, v31
  s_lshl_b32 s75, s9, 1
  s_lshl_b32 s76, s61, 9
  s_lshl_b32 s77, s10, 5
  v_add_u32 v4, 0, v1
  v_mul_u32_u24 v5, 171, v4
  buffer_load_dwordx4 v18, s[84:87], s2 offen offset:1024 lds
  v_lshrrev_b32 v5, 9, v5
  v_mul_u32_u24 v6, 3, v5
  v_sub_u32 v6, v4, v6
  v_bfe_u32 v7, v5, 1, 1
  v_add_u32 v7, s75, v7
  v_sub_u32 v8, 0, v7
  v_cmp_eq_u32 vcc, 0, v7
  s_nop 1
  v_cndmask_b32 v8, v8, 16, vcc
  buffer_load_dwordx4 v19, s[84:87], s2 offen offset:2048 lds
  v_and_b32 v9, 1, v5
  v_cmp_eq_u32 vcc, 1, v9
  s_nop 1
  v_cndmask_b32 v7, v7, v8, vcc
  v_lshrrev_b32 v5, 2, v5
  v_lshl_add_u32 v7, v5, 5, v7
  v_add_u32 v7, s76, v7
  v_and_b32 v7, 0x7ff, v7
  v_mul_u32_u24 v7, 642, v7
  buffer_load_dwordx4 v20, s[84:87], s2 offen offset:3072 lds
  v_add_u32 v7, s77, v7
  v_and_b32 v7, -4, v7
  v_lshl_add_u32 v48, v6, 4, v7
  v_add_u32 v4, 64, v1
  v_mul_u32_u24 v5, 171, v4
  v_lshrrev_b32 v5, 9, v5
  v_mul_u32_u24 v6, 3, v5
  s_add_u32 m0, s69, 110592
  s_nop 0
  buffer_load_dwordx4 v21, s[36:39], s67 offen lds
  v_sub_u32 v6, v4, v6
  v_bfe_u32 v7, v5, 1, 1
  v_add_u32 v7, s75, v7
  v_sub_u32 v8, 0, v7
  v_cmp_eq_u32 vcc, 0, v7
  s_nop 1
  v_cndmask_b32 v8, v8, 16, vcc
  v_and_b32 v9, 1, v5
  v_cmp_eq_u32 vcc, 1, v9
  buffer_load_dwordx4 v22, s[36:39], s67 offen offset:1024 lds
  s_nop 0
  v_cndmask_b32 v7, v7, v8, vcc
  v_lshrrev_b32 v5, 2, v5
  v_lshl_add_u32 v7, v5, 5, v7
  v_add_u32 v7, s76, v7
  v_and_b32 v7, 0x7ff, v7
  v_mul_u32_u24 v7, 642, v7
  v_add_u32 v7, s77, v7
  v_and_b32 v7, -4, v7
  buffer_load_dwordx4 v23, s[36:39], s67 offen offset:2048 lds
  v_lshl_add_u32 v49, v6, 4, v7
  v_add_u32 v4, 128, v1
  v_mul_u32_u24 v5, 171, v4
  v_lshrrev_b32 v5, 9, v5
  v_mul_u32_u24 v6, 3, v5
  v_sub_u32 v6, v4, v6
  v_bfe_u32 v7, v5, 1, 1
  buffer_load_dwordx4 v24, s[36:39], s67 offen offset:3072 lds
  v_add_u32 v7, s75, v7
  v_sub_u32 v8, 0, v7
  v_cmp_eq_u32 vcc, 0, v7
  s_nop 1
  v_cndmask_b32 v8, v8, 16, vcc
  v_and_b32 v9, 1, v5
  v_cmp_eq_u32 vcc, 1, v9
  s_nop 1
  v_cndmask_b32 v7, v7, v8, vcc
  v_lshrrev_b32 v5, 2, v5
  s_add_u32 m0, s69, 114688
  s_add_u32 s66, s66, 1
  buffer_load_dwordx4 v25, s[36:39], s67 offen lds
  s_cmp_eq_u32 s66, 10
  s_cselect_b32 s66, 0, s66
  v_lshl_add_u32 v7, v5, 5, v7
  v_add_u32 v7, s76, v7
  v_and_b32 v7, 0x7ff, v7
  v_mul_u32_u24 v7, 642, v7
  v_add_u32 v7, s77, v7
  v_and_b32 v7, -4, v7
  v_lshl_add_u32 v50, v6, 4, v7
  s_waitcnt vmcnt(9)
  s_barrier
  v_mul_u32_u24 v42, 768, v2
  s_lshl_b32 s2, s66, 7
  s_add_u32 m0, s3, 0
  s_mul_i32 s67, s68, s66
  buffer_load_dwordx4 v17, s[84:87], s2 offen lds
  v_lshl_add_u32 v42, v3, 1, v42
  v_add_u32 v42, s15, v42
  v_lshl_add_u32 v36, v3, 7, s11
  v_mul_u32_u24 v37, 20480, v2
  v_lshl_add_u32 v37, v3, 4, v37
  v_add_u32 v38, s17, v16
  v_lshlrev_b32 v4, 2, v2
  v_xor_b32 v4, v4, v3
  buffer_load_dwordx4 v18, s[84:87], s2 offen offset:1024 lds
  v_lshlrev_b32 v4, 4, v4
  v_lshl_add_u32 v4, v3, 8, v4
  v_add_u32 v39, s18, v4
  v_xor_b32 v4, v2, v3
  v_lshlrev_b32 v4, 4, v4
  v_lshl_add_u32 v4, v2, 8, v4
  v_add_u32 v40, s18, v4
  v_mul_u32_u24 v41, 40960, v2
  buffer_load_dwordx4 v19, s[84:87], s2 offen offset:2048 lds
  v_lshl_add_u32 v41, v3, 4, v41
  v_xor_b32 v97, 16, v39
  v_xor_b32 v52, 64, v40
  v_xor_b32 v98, 32, v39
  v_xor_b32 v53, 128, v40
  v_xor_b32 v99, 48, v39
  v_xor_b32 v54, 192, v40
  v_mov_b32 v64, 0
  v_mov_b32 v65, 0
  buffer_load_dwordx4 v20, s[84:87], s2 offen offset:3072 lds
  v_mov_b32 v66, 0
  v_mov_b32 v67, 0
  v_mov_b32 v68, 0
  v_mov_b32 v69, 0
  v_mov_b32 v70, 0
  v_mov_b32 v71, 0
  v_mov_b32 v72, 0
  v_mov_b32 v73, 0
  s_add_u32 m0, s69, 0
  s_nop 0
  buffer_load_dwordx4 v21, s[36:39], s67 offen lds
  v_mov_b32 v74, 0
  v_mov_b32 v75, 0
  v_mov_b32 v76, 0
  v_mov_b32 v77, 0
  v_mov_b32 v78, 0
  v_mov_b32 v79, 0
  v_mov_b32 v80, 0
  v_mov_b32 v81, 0
  v_mov_b32 v82, 0
  buffer_load_dwordx4 v22, s[36:39], s67 offen offset:1024 lds
  v_mov_b32 v83, 0
  v_mov_b32 v84, 0
  v_mov_b32 v85, 0
  v_mov_b32 v86, 0
  v_mov_b32 v87, 0
  v_mov_b32 v88, 0
  v_mov_b32 v89, 0
  v_mov_b32 v90, 0
  buffer_load_dwordx4 v23, s[36:39], s67 offen offset:2048 lds
  v_mov_b32 v91, 0
  v_mov_b32 v92, 0
  v_mov_b32 v93, 0
  v_mov_b32 v94, 0
  v_mov_b32 v95, 0
  s_lshl_b32 s74, s61, 4
  v_lshl_add_u32 v4, v2, 2, s74
  v_cvt_f32_u32 v4, v4
  v_mul_f32 v4, 0x3c000000, v4
  buffer_load_dwordx4 v24, s[36:39], s67 offen offset:3072 lds
  v_add_u32 v5, s74, v3
  v_cvt_f32_u32 v5, v5
  v_mul_f32 v5, 0x3c000000, v5
  v_cos_f32 v34, v5
  v_sin_f32 v35, v5
  v_cos_f32 v26, v4
  v_sin_f32 v30, v4
  v_add_f32 v4, 0x3c000000, v4
  s_add_u32 m0, s69, 4096
  s_add_u32 s66, s66, 1
  buffer_load_dwordx4 v25, s[36:39], s67 offen lds
  s_cmp_eq_u32 s66, 10
  s_cselect_b32 s66, 0, s66
  v_cos_f32 v27, v4
  v_sin_f32 v31, v4
  v_add_f32 v4, 0x3c000000, v4
  v_cos_f32 v28, v4
  v_sin_f32 v32, v4
  v_add_f32 v4, 0x3c000000, v4
  v_cos_f32 v29, v4
  v_sin_f32 v33, v4
  s_waitcnt vmcnt(9)
  s_barrier
  s_lshl_b32 s2, s66, 7
  s_add_u32 m0, s3, 36864
  s_mul_i32 s67, s68, s66
  buffer_load_dwordx4 v17, s[84:87], s2 offen lds
  buffer_load_dwordx4 v18, s[84:87], s2 offen offset:1024 lds
  buffer_load_dwordx4 v19, s[84:87], s2 offen offset:2048 lds
  buffer_load_dwordx4 v20, s[84:87], s2 offen offset:3072 lds
  s_add_u32 m0, s69, 36864
  s_nop 0
  buffer_load_dwordx4 v21, s[36:39], s67 offen lds
  buffer_load_dwordx4 v22, s[36:39], s67 offen offset:1024 lds
  buffer_load_dwordx4 v23, s[36:39], s67 offen offset:2048 lds
  buffer_load_dwordx4 v24, s[36:39], s67 offen offset:3072 lds
  s_add_u32 m0, s69, 40960
  s_add_u32 s66, s66, 1
  buffer_load_dwordx4 v25, s[36:39], s67 offen lds
  s_cmp_eq_u32 s66, 10
  s_cselect_b32 s66, 0, s66
  s_waitcnt vmcnt(9)
  s_barrier
  s_lshl_b32 s2, s66, 7
  s_add_u32 m0, s3, 73728
  s_mul_i32 s67, s68, s66
  buffer_load_dwordx4 v17, s[84:87], s2 offen lds
  buffer_load_dwordx4 v18, s[84:87], s2 offen offset:1024 lds
  buffer_load_dwordx4 v19, s[84:87], s2 offen offset:2048 lds
  buffer_load_dwordx4 v20, s[84:87], s2 offen offset:3072 lds
  s_add_u32 m0, s69, 73728
  s_nop 0
  buffer_load_dwordx4 v21, s[36:39], s67 offen lds
  buffer_load_dwordx4 v22, s[36:39], s67 offen offset:1024 lds
  buffer_load_dwordx4 v23, s[36:39], s67 offen offset:2048 lds
  buffer_load_dwordx4 v24, s[36:39], s67 offen offset:3072 lds
  s_add_u32 m0, s69, 77824
  s_add_u32 s66, s66, 1
  buffer_load_dwordx4 v25, s[36:39], s67 offen lds
  s_cmp_eq_u32 s66, 10
  s_cselect_b32 s66, 0, s66
  s_waitcnt vmcnt(9)
  s_barrier
  s_lshl_b32 s2, s66, 7
  s_add_u32 m0, s3, 110592
  s_mul_i32 s67, s68, s66
  buffer_load_dwordx4 v17, s[84:87], s2 offen lds
  buffer_load_dwordx4 v18, s[84:87], s2 offen offset:1024 lds
  buffer_load_dwordx4 v19, s[84:87], s2 offen offset:2048 lds
  buffer_load_dwordx4 v20, s[84:87], s2 offen offset:3072 lds
  s_add_u32 m0, s69, 110592
  s_nop 0
  buffer_load_dwordx4 v21, s[36:39], s67 offen lds
  buffer_load_dwordx4 v22, s[36:39], s67 offen offset:1024 lds
  buffer_load_dwordx4 v23, s[36:39], s67 offen offset:2048 lds
  buffer_load_dwordx4 v24, s[36:39], s67 offen offset:3072 lds
  s_add_u32 m0, s69, 114688
  s_add_u32 s66, s66, 1
  buffer_load_dwordx4 v25, s[36:39], s67 offen lds
  s_cmp_eq_u32 s66, 10
  s_cselect_b32 s66, 0, s66
  s_waitcnt vmcnt(9)
  s_barrier
  s_lshl_b32 s2, s66, 7
  s_add_u32 m0, s3, 0
  s_mul_i32 s67, s68, s66
  buffer_load_dwordx4 v17, s[84:87], s2 offen lds
  buffer_load_dwordx4 v18, s[84:87], s2 offen offset:1024 lds
  buffer_load_dwordx4 v19, s[84:87], s2 offen offset:2048 lds
  buffer_load_dwordx4 v20, s[84:87], s2 offen offset:3072 lds
  s_add_u32 m0, s69, 0
  s_nop 0
  buffer_load_dwordx4 v21, s[36:39], s67 offen lds
  buffer_load_dwordx4 v22, s[36:39], s67 offen offset:1024 lds
  buffer_load_dwordx4 v23, s[36:39], s67 offen offset:2048 lds
  buffer_load_dwordx4 v24, s[36:39], s67 offen offset:3072 lds
  s_add_u32 m0, s69, 4096
  s_add_u32 s66, s66, 1
  buffer_load_dwordx4 v25, s[36:39], s67 offen lds
  s_cmp_eq_u32 s66, 10
  s_cselect_b32 s66, 0, s66
  s_waitcnt vmcnt(9)
  s_barrier
  s_lshl_b32 s2, s66, 7
  s_add_u32 m0, s3, 36864
  s_mul_i32 s67, s68, s66
  buffer_load_dwordx4 v17, s[84:87], s2 offen lds
  buffer_load_dwordx4 v18, s[84:87], s2 offen offset:1024 lds
  buffer_load_dwordx4 v19, s[84:87], s2 offen offset:2048 lds
  buffer_load_dwordx4 v20, s[84:87], s2 offen offset:3072 lds
  s_add_u32 m0, s69, 36864
  s_nop 0
  buffer_load_dwordx4 v21, s[36:39], s67 offen lds
  buffer_load_dwordx4 v22, s[36:39], s67 offen offset:1024 lds
  buffer_load_dwordx4 v23, s[36:39], s67 offen offset:2048 lds
  buffer_load_dwordx4 v24, s[36:39], s67 offen offset:3072 lds
  s_add_u32 m0, s69, 40960
  s_add_u32 s66, s66, 1
  buffer_load_dwordx4 v25, s[36:39], s67 offen lds
  s_cmp_eq_u32 s66, 10
  s_cselect_b32 s66, 0, s66
  buffer_load_dword v15, off, s[56:59], 0 sc1
  s_waitcnt vmcnt(10)
  s_barrier
  s_cmp_eq_u32 s63, 0
  s_cbranch_scc1 L_H7
  s_add_u32 m0, s15, 0
  s_nop 0
  buffer_load_dwordx4 v48, s[48:51], 0 offen  lds
  s_add_u32 m0, s15, 1024
  s_nop 0
  buffer_load_dwordx4 v49, s[48:51], 0 offen  lds
  s_add_u32 m0, s15, 2048
  s_nop 0
  buffer_load_dwordx4 v50, s[48:51], 0 offen  lds
  s_add_u32 m0, s15, 3072
  s_nop 0
  buffer_load_dwordx4 v48, s[52:55], 0 offen  lds
  s_add_u32 m0, s15, 4096
  s_nop 0
  buffer_load_dwordx4 v49, s[52:55], 0 offen  lds
  s_add_u32 m0, s15, 5120
  s_nop 0
  buffer_load_dwordx4 v50, s[52:55], 0 offen  lds
  s_branch L_H7b
L_H7:
  s_waitcnt vmcnt(0)
L_H7b:
  s_waitcnt vmcnt(6)
  v_cmp_gt_u32 vcc, 64, v15
  s_cbranch_vccz L_icd_hf
  s_mov_b32 s72, 0x10000
L_ic_hf:
  buffer_load_dword v15, off, s[56:59], 0 sc1
  s_waitcnt vmcnt(0)
  v_cmp_gt_u32 vcc, 64, v15
  s_cbranch_vccz L_icd_hf
  s_sub_u32 s72, s72, 1
  s_cmp_lg_u32 s72, 0
  s_cbranch_scc1 L_ic_hf
L_icd_hf:
  s_barrier
  s_cmp_ge_u32 s8, 21
  s_cbranch_scc1 L_Hnone
  s_cmp_lg_u32 s63, 0
  s_cbranch_scc1 L_H8
  s_mov_b32 s72, 0x100000
L_aw1:
  s_sleep 2
  ds_read_b32 v4, v44 offset:4
  s_sub_u32 s72, s72, 1
  s_cbranch_scc1 L_ax1
  s_waitcnt lgkmcnt(0)
  v_cmp_gt_u32 vcc, 4, v4
  s_cbranch_vccnz L_aw1
L_ax1:
  s_add_u32 m0, s15, 0
  s_nop 0
  buffer_load_dwordx4 v48, s[48:51], 0 offen  lds
  s_add_u32 m0, s15, 1024
  s_nop 0
  buffer_load_dwordx4 v49, s[48:51], 0 offen  lds
  s_add_u32 m0, s15, 2048
  s_nop 0
  buffer_load_dwordx4 v50, s[48:51], 0 offen  lds
  s_add_u32 m0, s15, 3072
  s_nop 0
  buffer_load_dwordx4 v48, s[52:55], 0 offen  lds
  s_add_u32 m0, s15, 4096
  s_nop 0
  buffer_load_dwordx4 v49, s[52:55], 0 offen  lds
  s_add_u32 m0, s15, 5120
  s_nop 0
  buffer_load_dwordx4 v50, s[52:55], 0 offen  lds
L_H8:
  s_waitcnt vmcnt(0)
  ds_read_u16_d16_hi v64, v42 offset:0
  ds_read_u16_d16_hi v65, v42 offset:192
  ds_read_u16_d16_hi v66, v42 offset:384
  ds_read_u16_d16_hi v67, v42 offset:576
  ds_read_u16_d16_hi v68, v42 offset:3072
  ds_read_u16_d16_hi v69, v42 offset:3264
  ds_read_u16_d16_hi v70, v42 offset:3456
  ds_read_u16_d16_hi v71, v42 offset:3648
  ds_read_u16_d16_hi v72, v42 offset:48
  ds_read_u16_d16_hi v73, v42 offset:240
  ds_read_u16_d16_hi v74, v42 offset:432
  ds_read_u16_d16_hi v75, v42 offset:624
  ds_read_u16_d16_hi v76, v42 offset:3120
  ds_read_u16_d16_hi v77, v42 offset:3312
  ds_read_u16_d16_hi v78, v42 offset:3504
  ds_read_u16_d16_hi v79, v42 offset:3696
  ds_read_u16_d16_hi v80, v42 offset:98
  ds_read_u16_d16_hi v81, v42 offset:290
  ds_read_u16_d16_hi v82, v42 offset:482
  ds_read_u16_d16_hi v83, v42 offset:674
  ds_read_u16_d16_hi v84, v42 offset:3170
  ds_read_u16_d16_hi v85, v42 offset:3362
  ds_read_u16_d16_hi v86, v42 offset:3554
  ds_read_u16_d16_hi v87, v42 offset:3746
  ds_read_u16_d16_hi v88, v42 offset:146
  ds_read_u16_d16_hi v89, v42 offset:338
  ds_read_u16_d16_hi v90, v42 offset:530
  ds_read_u16_d16_hi v91, v42 offset:722
  ds_read_u16_d16_hi v92, v42 offset:3218
  ds_read_u16_d16_hi v93, v42 offset:3410
  ds_read_u16_d16_hi v94, v42 offset:3602
  ds_read_u16_d16_hi v95, v42 offset:3794
  s_waitcnt lgkmcnt(0)
  s_mov_b64 exec, 1
  ds_add_u32 v44, v45 offset:16
  s_mov_b64 exec, -1
  s_mov_b32 s72, 0x10000
  s_mov_b64 s[0:1], -1
L_pl_z:
  s_mov_b64 exec, s[0:1]
  buffer_load_dword v15, v36, s[40:43], 0 offen sc1
  s_mov_b64 exec, -1
  s_waitcnt vmcnt(0)
  v_cmp_eq_u32 vcc, 0, v15
  s_cbranch_vccz L_pd_z
  s_mov_b64 s[0:1], vcc
  s_sub_u32 s72, s72, 1
  s_cmp_lg_u32 s72, 0
  s_cbranch_scc1 L_pl_z
L_pd_z:
  s_setprio 2
  buffer_load_dwordx4 v[128:131], v37, s[40:43], s12 offen sc1
  s_add_u32 s12, s12, 5120
  buffer_load_dwordx4 v[132:135], v37, s[40:43], s12 offen sc1
  s_add_u32 s12, s12, 5120
  buffer_load_dwordx4 v[136:139], v37, s[40:43], s12 offen sc1
  s_add_u32 s12, s12, 5120
  buffer_load_dwordx4 v[140:143], v37, s[40:43], s12 offen sc1
  s_mov_b32 s72, 0x100000
L_aw2:
  ds_read_b32 v4, v44 offset:4
  s_sub_u32 s72, s72, 1
  s_cbranch_scc1 L_ax2
  s_waitcnt lgkmcnt(0)
  v_cmp_gt_u32 vcc, 4, v4
  s_cbranch_vccnz L_aw2
L_ax2:
  v_add_u32 v55, 106496, v16
  s_waitcnt vmcnt(0)
  v_swap_b32 v129, v132
  v_swap_b32 v130, v136
  v_swap_b32 v131, v140
  v_swap_b32 v134, v137
  v_swap_b32 v135, v141
  v_swap_b32 v139, v142
  s_cmp_eq_u32 s10, 0
  s_cbranch_scc1 L_P2_dc
  s_cmp_lg_u32 s10, 20
  s_cbranch_scc1 L_P2_x
  v_lshrrev_b32 v128, 16, v128
  v_lshrrev_b32 v129, 16, v129
  v_lshrrev_b32 v130, 16, v130
  v_lshrrev_b32 v131, 16, v131
  v_lshrrev_b32 v132, 16, v132
  v_lshrrev_b32 v133, 16, v133
  v_lshrrev_b32 v134, 16, v134
  v_lshrrev_b32 v135, 16, v135
  v_lshrrev_b32 v136, 16, v136
  v_lshrrev_b32 v137, 16, v137
  v_lshrrev_b32 v138, 16, v138
  v_lshrrev_b32 v139, 16, v139
  v_lshrrev_b32 v140, 16, v140
  v_lshrrev_b32 v141, 16, v141
  v_lshrrev_b32 v142, 16, v142
  v_lshrrev_b32 v143, 16, v143
  s_branch L_P2_x
L_P2_dc:
  v_cmp_eq_u32 vcc, 0, v3
  v_mov_b32 v4, 0xffff
  s_nop 0
  v_cndmask_b32 v4, -1, v4, vcc
  v_and_b32 v128, v4, v128
  v_and_b32 v129, v4, v129
  v_and_b32 v130, v4, v130
  v_and_b32 v131, v4, v131
  v_and_b32 v132, v4, v132
  v_and_b32 v133, v4, v133
  v_and_b32 v134, v4, v134
  v_and_b32 v135, v4, v135
  v_and_b32 v136, v4, v136
  v_and_b32 v137, v4, v137
  v_and_b32 v138, v4, v138
  v_and_b32 v139, v4, v139
  v_and_b32 v140, v4, v140
  v_and_b32 v141, v4, v141
  v_and_b32 v142, v4, v142
  v_and_b32 v143, v4, v143
L_P2_x:
  ds_write_b128 v38, v[136:139] offset:8192
  ds_write_b128 v38, v[140:143] offset:12288
  ds_write_b128 v38, v[128:131] offset:0
  s_cmp_lg_u32 s9, 0
  s_cbranch_scc1 L_P2_r1
  v_lshlrev_b32 v4, 16, v132
  v_and_b32 v5, 0xffff0000, v132
  v_mul_f32 v6, v5, v30
  v_mul_f32 v7, v4, v30
  v_fma_f32 v6, v4, v26, v6
  v_fma_f32 v7, v5, v26, -v7
  v_cvt_pk_bf16_f32 v132, v6, v7
  v_lshlrev_b32 v4, 16, v133
  v_and_b32 v5, 0xffff0000, v133
  v_mul_f32 v6, v5, v31
  v_mul_f32 v7, v4, v31
  v_fma_f32 v6, v4, v27, v6
  v_fma_f32 v7, v5, v27, -v7
  v_cvt_pk_bf16_f32 v133, v6, v7
  v_lshlrev_b32 v4, 16, v134
  v_and_b32 v5, 0xffff0000, v134
  v_mul_f32 v6, v5, v32
  v_mul_f32 v7, v4, v32
  v_fma_f32 v6, v4, v28, v6
  v_fma_f32 v7, v5, v28, -v7
  v_cvt_pk_bf16_f32 v134, v6, v7
  v_lshlrev_b32 v4, 16, v135
  v_and_b32 v5, 0xffff0000, v135
  v_mul_f32 v6, v5, v33
  v_mul_f32 v7, v4, v33
  v_fma_f32 v6, v4, v29, v6
  v_fma_f32 v7, v5, v29, -v7
  v_cvt_pk_bf16_f32 v135, v6, v7
L_P2_r1:
  ds_write_b128 v38, v[132:135] offset:4096
  s_waitcnt lgkmcnt(0)
  s_mov_b64 exec, 1
  ds_add_u32 v44, v45 offset:8
  s_mov_b64 exec, -1
  s_mov_b32 s72, 0x100000
L_aw3:
  ds_read_b32 v4, v44 offset:8
  s_sub_u32 s72, s72, 1
  s_cbranch_scc1 L_ax3
  s_waitcnt lgkmcnt(0)
  v_cmp_gt_u32 vcc, 4, v4
  s_cbranch_vccnz L_aw3
L_ax3:
  ds_read_b128 v[208:211], v55 offset:8192
  ds_read_b128 v[212:215], v55 offset:9216
  ds_read_b128 v[216:219], v55 offset:10240
  ds_read_b128 v[220:223], v55 offset:11264
  ds_read_b128 v[120:123], v55 offset:12288
  ds_read_b128 v[124:127], v55 offset:13312
  ds_read_b128 v[56:59], v55 offset:14336
  ds_read_b128 v[60:63], v55 offset:15360
  ds_read_b128 v[176:179], v55 offset:0
  ds_read_b128 v[180:183], v55 offset:1024
  ds_read_b128 v[184:187], v55 offset:2048
  ds_read_b128 v[188:191], v55 offset:3072
  ds_read_b128 v[192:195], v55 offset:4096
  ds_read_b128 v[196:199], v55 offset:5120
  ds_read_b128 v[200:203], v55 offset:6144
  ds_read_b128 v[204:207], v55 offset:7168
  s_waitcnt lgkmcnt(12)
  v_mfma_f32_16x16x32_bf16 v[144:147], v[224:227], v[208:211], 0
  v_mfma_f32_16x16x32_bf16 v[148:151], v[240:243], v[208:211], 0
  v_mfma_f32_16x16x32_bf16 v[144:147], v[228:231], v[212:215], v[144:147]
  v_mfma_f32_16x16x32_bf16 v[148:151], v[244:247], v[212:215], v[148:151]
  v_mfma_f32_16x16x32_bf16 v[144:147], v[232:235], v[216:219], v[144:147]
  v_mfma_f32_16x16x32_bf16 v[148:151], v[248:251], v[216:219], v[148:151]
  v_mfma_f32_16x16x32_bf16 v[144:147], v[236:239], v[220:223], v[144:147]
  v_mfma_f32_16x16x32_bf16 v[148:151], v[252:255], v[220:223], v[148:151]
  s_waitcnt lgkmcnt(8)
  v_mfma_f32_16x16x32_bf16 v[152:155], v[224:227], v[120:123], 0
  v_mfma_f32_16x16x32_bf16 v[156:159], v[240:243], v[120:123], 0
  v_mfma_f32_16x16x32_bf16 v[152:155], v[228:231], v[124:127], v[152:155]
  v_mfma_f32_16x16x32_bf16 v[156:159], v[244:247], v[124:127], v[156:159]
  v_mfma_f32_16x16x32_bf16 v[152:155], v[232:235], v[56:59], v[152:155]
  v_mfma_f32_16x16x32_bf16 v[156:159], v[248:251], v[56:59], v[156:159]
  v_mfma_f32_16x16x32_bf16 v[152:155], v[236:239], v[60:63], v[152:155]
  v_mfma_f32_16x16x32_bf16 v[156:159], v[252:255], v[60:63], v[156:159]
  s_waitcnt lgkmcnt(4)
  v_mfma_f32_16x16x32_bf16 v[128:131], v[224:227], v[176:179], 0
  v_mfma_f32_16x16x32_bf16 v[132:135], v[240:243], v[176:179], 0
  v_mfma_f32_16x16x32_bf16 v[128:131], v[228:231], v[180:183], v[128:131]
  v_mfma_f32_16x16x32_bf16 v[132:135], v[244:247], v[180:183], v[132:135]
  s_nop 2
  v_pk_add_f32 v[104:105], v[144:145], v[156:157]
  v_pk_add_f32 v[106:107], v[148:149], v[152:153] neg_lo:[0,1] neg_hi:[0,1]
  v_mfma_f32_16x16x32_bf16 v[128:131], v[232:235], v[184:187], v[128:131]
  v_pk_add_f32 v[108:109], v[144:145], v[156:157] neg_lo:[0,1] neg_hi:[0,1]
  v_pk_add_f32 v[110:111], v[148:149], v[152:153]
  v_mfma_f32_16x16x32_bf16 v[132:135], v[248:251], v[184:187], v[132:135]
  v_pk_mul_f32 v[144:145], v[84:85], v[106:107]
  v_pk_mul_f32 v[148:149], v[84:85], v[104:105]
  v_mfma_f32_16x16x32_bf16 v[128:131], v[236:239], v[188:191], v[128:131]
  v_pk_fma_f32 v[144:145], v[80:81], v[104:105], v[144:145] neg_lo:[0,0,1] neg_hi:[0,0,1]
  v_pk_fma_f32 v[148:149], v[80:81], v[106:107], v[148:149]
  v_mfma_f32_16x16x32_bf16 v[132:135], v[252:255], v[188:191], v[132:135]
  v_pk_mul_f32 v[152:153], v[92:93], v[110:111]
  v_pk_mul_f32 v[156:157], v[92:93], v[108:109]
  s_waitcnt lgkmcnt(0)
  v_pk_fma_f32 v[152:153], v[88:89], v[108:109], v[152:153] neg_lo:[0,0,1] neg_hi:[0,0,1]
  v_pk_fma_f32 v[156:157], v[88:89], v[110:111], v[156:157]
  v_mfma_f32_16x16x32_bf16 v[136:139], v[224:227], v[192:195], 0
  v_pk_add_f32 v[104:105], v[144:145], v[152:153]
  v_pk_add_f32 v[106:107], v[148:149], v[156:157]
  v_mfma_f32_16x16x32_bf16 v[140:143], v[240:243], v[192:195], 0
  v_pk_add_f32 v[108:109], v[156:157], v[148:149] neg_lo:[0,1] neg_hi:[0,1]
  v_pk_add_f32 v[110:111], v[152:153], v[144:145] neg_lo:[0,1] neg_hi:[0,1]
  v_mfma_f32_16x16x32_bf16 v[136:139], v[228:231], v[196:199], v[136:139]
  v_cvt_pk_bf16_f32 v168, v104, -v106
  v_cvt_pk_bf16_f32 v172, v108, v110
  v_mfma_f32_16x16x32_bf16 v[140:143], v[244:247], v[196:199], v[140:143]
  v_cvt_pk_bf16_f32 v169, v105, -v107
  v_cvt_pk_bf16_f32 v173, v109, v111
  v_mfma_f32_16x16x32_bf16 v[136:139], v[232:235], v[200:203], v[136:139]
  v_pk_add_f32 v[112:113], v[146:147], v[158:159]
  v_pk_add_f32 v[114:115], v[150:151], v[154:155] neg_lo:[0,1] neg_hi:[0,1]
  v_mfma_f32_16x16x32_bf16 v[140:143], v[248:251], v[200:203], v[140:143]
  v_pk_add_f32 v[116:117], v[146:147], v[158:159] neg_lo:[0,1] neg_hi:[0,1]
  v_pk_add_f32 v[118:119], v[150:151], v[154:155]
  v_mfma_f32_16x16x32_bf16 v[136:139], v[236:239], v[204:207], v[136:139]
  v_pk_mul_f32 v[146:147], v[86:87], v[114:115]
  v_pk_mul_f32 v[150:151], v[86:87], v[112:113]
  v_mfma_f32_16x16x32_bf16 v[140:143], v[252:255], v[204:207], v[140:143]
  v_pk_fma_f32 v[146:147], v[82:83], v[112:113], v[146:147] neg_lo:[0,0,1] neg_hi:[0,0,1]
  v_pk_fma_f32 v[150:151], v[82:83], v[114:115], v[150:151]
  v_pk_mul_f32 v[154:155], v[94:95], v[118:119]
  v_pk_mul_f32 v[158:159], v[94:95], v[116:117]
  v_pk_fma_f32 v[154:155], v[90:91], v[116:117], v[154:155] neg_lo:[0,0,1] neg_hi:[0,0,1]
  v_pk_fma_f32 v[158:159], v[90:91], v[118:119], v[158:159]
  v_pk_add_f32 v[112:113], v[146:147], v[154:155]
  v_pk_add_f32 v[114:115], v[150:151], v[158:159]
  v_pk_add_f32 v[116:117], v[158:159], v[150:151] neg_lo:[0,1] neg_hi:[0,1]
  v_pk_add_f32 v[118:119], v[154:155], v[146:147] neg_lo:[0,1] neg_hi:[0,1]
  v_cvt_pk_bf16_f32 v170, v112, -v114
  v_cvt_pk_bf16_f32 v174, v116, v118
  v_cvt_pk_bf16_f32 v171, v113, -v115
  v_cvt_pk_bf16_f32 v175, v117, v119
  ds_write_b128 v38, v[168:171] offset:24576
  ds_write_b128 v38, v[172:175] offset:28672
  s_cmp_eq_u32 s9, 0
  s_cbranch_scc1 L_P2_sp
  v_pk_add_f32 v[104:105], v[128:129], v[140:141]
  v_pk_add_f32 v[106:107], v[132:133], v[136:137] neg_lo:[0,1] neg_hi:[0,1]
  v_pk_add_f32 v[108:109], v[128:129], v[140:141] neg_lo:[0,1] neg_hi:[0,1]
  v_pk_add_f32 v[110:111], v[132:133], v[136:137]
  v_pk_mul_f32 v[128:129], v[68:69], v[106:107]
  v_pk_mul_f32 v[132:133], v[68:69], v[104:105]
  v_pk_fma_f32 v[128:129], v[64:65], v[104:105], v[128:129] neg_lo:[0,0,1] neg_hi:[0,0,1]
  v_pk_fma_f32 v[132:133], v[64:65], v[106:107], v[132:133]
  v_pk_mul_f32 v[136:137], v[76:77], v[110:111]
  v_pk_mul_f32 v[140:141], v[76:77], v[108:109]
  v_pk_fma_f32 v[136:137], v[72:73], v[108:109], v[136:137] neg_lo:[0,0,1] neg_hi:[0,0,1]
  v_pk_fma_f32 v[140:141], v[72:73], v[110:111], v[140:141]
  v_pk_add_f32 v[104:105], v[128:129], v[136:137]
  v_pk_add_f32 v[106:107], v[132:133], v[140:141]
  v_pk_add_f32 v[108:109], v[140:141], v[132:133] neg_lo:[0,1] neg_hi:[0,1]
  v_pk_add_f32 v[110:111], v[136:137], v[128:129] neg_lo:[0,1] neg_hi:[0,1]
  v_cvt_pk_bf16_f32 v160, v104, -v106
  v_cvt_pk_bf16_f32 v164, v108, v110
  v_cvt_pk_bf16_f32 v161, v105, -v107
  v_cvt_pk_bf16_f32 v165, v109, v111
  v_pk_add_f32 v[112:113], v[130:131], v[142:143]
  v_pk_add_f32 v[114:115], v[134:135], v[138:139] neg_lo:[0,1] neg_hi:[0,1]
  v_pk_add_f32 v[116:117], v[130:131], v[142:143] neg_lo:[0,1] neg_hi:[0,1]
  v_pk_add_f32 v[118:119], v[134:135], v[138:139]
  v_pk_mul_f32 v[130:131], v[70:71], v[114:115]
  v_pk_mul_f32 v[134:135], v[70:71], v[112:113]
  v_pk_fma_f32 v[130:131], v[66:67], v[112:113], v[130:131] neg_lo:[0,0,1] neg_hi:[0,0,1]
  v_pk_fma_f32 v[134:135], v[66:67], v[114:115], v[134:135]
  v_pk_mul_f32 v[138:139], v[78:79], v[118:119]
  v_pk_mul_f32 v[142:143], v[78:79], v[116:117]
  v_pk_fma_f32 v[138:139], v[74:75], v[116:117], v[138:139] neg_lo:[0,0,1] neg_hi:[0,0,1]
  v_pk_fma_f32 v[142:143], v[74:75], v[118:119], v[142:143]
  v_pk_add_f32 v[112:113], v[130:131], v[138:139]
  v_pk_add_f32 v[114:115], v[134:135], v[142:143]
  v_pk_add_f32 v[116:117], v[142:143], v[134:135] neg_lo:[0,1] neg_hi:[0,1]
  v_pk_add_f32 v[118:119], v[138:139], v[130:131] neg_lo:[0,1] neg_hi:[0,1]
  v_cvt_pk_bf16_f32 v162, v112, -v114
  v_cvt_pk_bf16_f32 v166, v116, v118
  v_cvt_pk_bf16_f32 v163, v113, -v115
  v_cvt_pk_bf16_f32 v167, v117, v119
  s_branch L_P2_sq
L_P2_sp:
  v_pk_mul_f32 v[104:105], v[68:69], v[132:133]
  v_pk_mul_f32 v[106:107], v[68:69], v[128:129]
  v_pk_fma_f32 v[104:105], v[64:65], v[128:129], v[104:105] neg_lo:[0,0,1] neg_hi:[0,0,1]
  v_pk_fma_f32 v[106:107], v[64:65], v[132:133], v[106:107]
  v_pk_mul_f32 v[108:109], v[76:77], v[140:141]
  v_pk_mul_f32 v[110:111], v[76:77], v[136:137]
  v_pk_fma_f32 v[108:109], v[72:73], v[136:137], v[108:109] neg_lo:[0,0,1] neg_hi:[0,0,1]
  v_pk_fma_f32 v[110:111], v[72:73], v[140:141], v[110:111]
  v_cvt_pk_bf16_f32 v160, v104, -v106
  v_cvt_pk_bf16_f32 v164, v108, -v110
  v_cvt_pk_bf16_f32 v161, v105, -v107
  v_cvt_pk_bf16_f32 v165, v109, -v111
  v_pk_mul_f32 v[112:113], v[70:71], v[134:135]
  v_pk_mul_f32 v[114:115], v[70:71], v[130:131]
  v_pk_fma_f32 v[112:113], v[66:67], v[130:131], v[112:113] neg_lo:[0,0,1] neg_hi:[0,0,1]
  v_pk_fma_f32 v[114:115], v[66:67], v[134:135], v[114:115]
  v_pk_mul_f32 v[116:117], v[78:79], v[142:143]
  v_pk_mul_f32 v[118:119], v[78:79], v[138:139]
  v_pk_fma_f32 v[116:117], v[74:75], v[138:139], v[116:117] neg_lo:[0,0,1] neg_hi:[0,0,1]
  v_pk_fma_f32 v[118:119], v[74:75], v[142:143], v[118:119]
  v_cvt_pk_bf16_f32 v162, v112, -v114
  v_cvt_pk_bf16_f32 v166, v116, -v118
  v_cvt_pk_bf16_f32 v163, v113, -v115
  v_cvt_pk_bf16_f32 v167, v117, -v119
L_P2_sq:
  ds_write_b128 v38, v[160:163] offset:16384
  ds_write_b128 v38, v[164:167] offset:20480
  s_waitcnt lgkmcnt(0)
  s_mov_b64 exec, 1
  ds_add_u32 v44, v45 offset:12
  s_mov_b64 exec, -1
  s_mov_b32 s72, 0x100000
L_aw4:
  ds_read_b32 v4, v44 offset:12
  s_sub_u32 s72, s72, 1
  s_cbranch_scc1 L_ax4
  s_waitcnt lgkmcnt(0)
  v_cmp_gt_u32 vcc, 4, v4
  s_cbranch_vccnz L_aw4
L_ax4:
  ds_read_b128 v[208:211], v55 offset:24576
  ds_read_b128 v[212:215], v55 offset:25600
  ds_read_b128 v[216:219], v55 offset:26624
  ds_read_b128 v[220:223], v55 offset:27648
  ds_read_b128 v[120:123], v55 offset:28672
  ds_read_b128 v[124:127], v55 offset:29696
  ds_read_b128 v[56:59], v55 offset:30720
  ds_read_b128 v[60:63], v55 offset:31744
  ds_read_b128 v[176:179], v55 offset:16384
  ds_read_b128 v[180:183], v55 offset:17408
  ds_read_b128 v[184:187], v55 offset:18432
  ds_read_b128 v[188:191], v55 offset:19456
  ds_read_b128 v[192:195], v55 offset:20480
  ds_read_b128 v[196:199], v55 offset:21504
  ds_read_b128 v[200:203], v55 offset:22528
  ds_read_b128 v[204:207], v55 offset:23552
  s_waitcnt lgkmcnt(12)
  v_mfma_f32_16x16x32_bf16 v[144:147], v[208:211], v[224:227], 0
  v_mfma_f32_16x16x32_bf16 v[148:151], v[208:211], v[240:243], 0
  v_mfma_f32_16x16x32_bf16 v[144:147], v[212:215], v[228:231], v[144:147]
  v_mfma_f32_16x16x32_bf16 v[148:151], v[212:215], v[244:247], v[148:151]
  v_mfma_f32_16x16x32_bf16 v[144:147], v[216:219], v[232:235], v[144:147]
  v_mfma_f32_16x16x32_bf16 v[148:151], v[216:219], v[248:251], v[148:151]
  v_mfma_f32_16x16x32_bf16 v[144:147], v[220:223], v[236:239], v[144:147]
  v_mfma_f32_16x16x32_bf16 v[148:151], v[220:223], v[252:255], v[148:151]
  s_waitcnt lgkmcnt(8)
  v_mfma_f32_16x16x32_bf16 v[152:155], v[120:123], v[224:227], 0
  v_mfma_f32_16x16x32_bf16 v[156:159], v[120:123], v[240:243], 0
  v_mfma_f32_16x16x32_bf16 v[152:155], v[124:127], v[228:231], v[152:155]
  v_mfma_f32_16x16x32_bf16 v[156:159], v[124:127], v[244:247], v[156:159]
  v_mfma_f32_16x16x32_bf16 v[152:155], v[56:59], v[232:235], v[152:155]
  v_mfma_f32_16x16x32_bf16 v[156:159], v[56:59], v[248:251], v[156:159]
  v_mfma_f32_16x16x32_bf16 v[152:155], v[60:63], v[236:239], v[152:155]
  v_mfma_f32_16x16x32_bf16 v[156:159], v[60:63], v[252:255], v[156:159]
  s_waitcnt lgkmcnt(4)
  v_mfma_f32_16x16x32_bf16 v[128:131], v[176:179], v[224:227], 0
  v_mfma_f32_16x16x32_bf16 v[132:135], v[176:179], v[240:243], 0
  v_mfma_f32_16x16x32_bf16 v[128:131], v[180:183], v[228:231], v[128:131]
  v_mfma_f32_16x16x32_bf16 v[132:135], v[180:183], v[244:247], v[132:135]
  v_cvt_pk_bf16_f32 v168, v144, v148
  v_mfma_f32_16x16x32_bf16 v[128:131], v[184:187], v[232:235], v[128:131]
  v_cvt_pk_bf16_f32 v169, v145, v149
  v_mfma_f32_16x16x32_bf16 v[132:135], v[184:187], v[248:251], v[132:135]
  v_mfma_f32_16x16x32_bf16 v[128:131], v[188:191], v[236:239], v[128:131]
  v_cvt_pk_bf16_f32 v170, v146, v150
  v_mfma_f32_16x16x32_bf16 v[132:135], v[188:191], v[252:255], v[132:135]
  s_waitcnt lgkmcnt(0)
  v_cvt_pk_bf16_f32 v171, v147, v151
  v_mfma_f32_16x16x32_bf16 v[136:139], v[192:195], v[224:227], 0
  v_mfma_f32_16x16x32_bf16 v[140:143], v[192:195], v[240:243], 0
  v_cvt_pk_bf16_f32 v172, v152, v156
  v_mfma_f32_16x16x32_bf16 v[136:139], v[196:199], v[228:231], v[136:139]
  v_cvt_pk_bf16_f32 v173, v153, v157
  v_mfma_f32_16x16x32_bf16 v[140:143], v[196:199], v[244:247], v[140:143]
  v_mfma_f32_16x16x32_bf16 v[136:139], v[200:203], v[232:235], v[136:139]
  v_cvt_pk_bf16_f32 v174, v154, v158
  v_mfma_f32_16x16x32_bf16 v[140:143], v[200:203], v[248:251], v[140:143]
  v_mfma_f32_16x16x32_bf16 v[136:139], v[204:207], v[236:239], v[136:139]
  v_cvt_pk_bf16_f32 v175, v155, v159
  v_mfma_f32_16x16x32_bf16 v[140:143], v[204:207], v[252:255], v[140:143]
  s_cmp_lg_u32 s9, 0
  s_cbranch_scc1 L_P2_r2
  s_nop 5
  v_mul_f32 v4, v140, v35
  v_mul_f32 v5, v136, v35
  v_fma_f32 v4, v136, v34, v4
  v_fma_f32 v5, v140, v34, -v5
  v_mov_b32 v136, v4
  v_mov_b32 v140, v5
  v_mul_f32 v4, v141, v35
  v_mul_f32 v5, v137, v35
  v_fma_f32 v4, v137, v34, v4
  v_fma_f32 v5, v141, v34, -v5
  v_mov_b32 v137, v4
  v_mov_b32 v141, v5
  v_mul_f32 v4, v142, v35
  v_mul_f32 v5, v138, v35
  v_fma_f32 v4, v138, v34, v4
  v_fma_f32 v5, v142, v34, -v5
  v_mov_b32 v138, v4
  v_mov_b32 v142, v5
  v_mul_f32 v4, v143, v35
  v_mul_f32 v5, v139, v35
  v_fma_f32 v4, v139, v34, v4
  v_fma_f32 v5, v143, v34, -v5
  v_mov_b32 v139, v4
  v_mov_b32 v143, v5
L_P2_r2:
  s_cmp_eq_u32 s10, 20
  s_cbranch_scc1 L_P2_ny
  ds_write_b128 v98, v[168:171]
  ds_write_b128 v99, v[172:175]
  v_cvt_pk_bf16_f32 v160, v128, v132
  v_cvt_pk_bf16_f32 v161, v129, v133
  v_cvt_pk_bf16_f32 v162, v130, v134
  v_cvt_pk_bf16_f32 v163, v131, v135
  ds_write_b128 v39, v[160:163]
  v_cvt_pk_bf16_f32 v164, v136, v140
  v_cvt_pk_bf16_f32 v165, v137, v141
  v_cvt_pk_bf16_f32 v166, v138, v142
  v_cvt_pk_bf16_f32 v167, v139, v143
  ds_write_b128 v97, v[164:167]
  s_waitcnt lgkmcnt(0)
  ds_read_b128 v[64:67], v40 offset:0
  ds_read_b128 v[68:71], v52 offset:1024
  ds_read_b128 v[72:75], v53 offset:2048
  ds_read_b128 v[76:79], v54 offset:3072
  s_waitcnt lgkmcnt(3)
  buffer_store_dwordx4 v[64:67], v41, s[40:43], s13 offen sc1
  s_add_u32 s13, s13, 163840
  s_waitcnt lgkmcnt(2)
  buffer_store_dwordx4 v[68:71], v41, s[40:43], s13 offen sc1
  s_add_u32 s13, s13, 163840
  s_waitcnt lgkmcnt(1)
  buffer_store_dwordx4 v[72:75], v41, s[40:43], s13 offen sc1
  s_add_u32 s13, s13, 163840
  s_waitcnt lgkmcnt(0)
  buffer_store_dwordx4 v[76:79], v41, s[40:43], s13 offen sc1
  s_branch L_P2_fl
L_P2_ny:
  v_mov_b32 v160, v128
  s_nop 0
  v_mov_b32 v161, v136
  v_mov_b32 v162, v144
  v_mov_b32 v163, v152
  v_lshlrev_b32 v4, 7, v3
  s_mov_b64 exec, 0xffff
  buffer_store_dwordx4 v[160:163], v4, s[40:43], s13 offen sc1
  s_mov_b64 exec, -1
L_P2_fl:
  s_waitcnt lgkmcnt(0)
  s_mov_b64 exec, 1
  ds_add_u32 v44, v45 offset:20
  s_mov_b64 exec, -1
  s_setprio 0
  s_waitcnt vmcnt(0)
  v_mov_b32 v4, 1
  s_mov_b64 exec, 1
  buffer_store_dword v4, off, s[40:43], s14 sc1
  s_mov_b64 exec, -1
  s_branch L_P3
L_Hnone:
  s_waitcnt vmcnt(0)
  s_waitcnt lgkmcnt(0)
  s_mov_b64 exec, 1
  ds_add_u32 v44, v45 offset:16
  s_mov_b64 exec, -1
  s_waitcnt lgkmcnt(0)
  s_mov_b64 exec, 1
  ds_add_u32 v44, v45 offset:8
  s_mov_b64 exec, -1
  s_waitcnt lgkmcnt(0)
  s_mov_b64 exec, 1
  ds_add_u32 v44, v45 offset:20
  s_mov_b64 exec, -1
  s_branch L_P3
L_M:
  s_waitcnt lgkmcnt(0)
  s_load_dwordx16 s[4:19], s[78:79], 0
  s_load_dwordx16 s[20:35], s[78:79], 64
  s_mov_b32 s40, s98
  s_mov_b32 s41, s99
  s_mov_b32 s42, 10485760
  s_mov_b32 s43, 0x20000
  s_mov_b32 s44, s94
  s_mov_b32 s45, s95
  s_mov_b32 s46, 2621440
  s_mov_b32 s47, 0x20000
  s_mov_b32 s56, s96
  s_mov_b32 s57, s97
  s_mov_b32 s58, 256
  s_mov_b32 s59, 0x20000
  v_and_b32 v3, 15, v1
  v_mov_b32 v44, 163776
  v_mov_b32 v45, 1
  s_mov_b32 s71, 0
  s_mul_i32 s74, s61, 80
  v_lshl_add_u32 v5, v2, 2, s74
  v_cvt_f32_u32 v47, v5
  s_cmp_eq_u32 s63, 1
  s_cselect_b32 s73, 0, 1
  s_xor_b32 s73, s73, s62
  v_lshrrev_b32 v46, 2, v3
  v_mul_u32_u24 v46, 20, v46
  v_and_b32 v5, 3, v3
  v_add_u32 v46, v46, v5
  v_and_b32 v31, 1, v1
  v_lshlrev_b32 v31, 7, v31
  s_mov_b32 s80, 0x3fb8aa3b
  s_mov_b32 s81, 0x3fb8aa3b
  s_mov_b32 s82, 0x358637bd
  s_mov_b32 s83, 0x358637bd
  s_and_b32 s74, s61, 2
  s_cmp_eq_u32 s63, 0
  s_cselect_b32 s74, s61, s74
  s_lshl_b32 s74, s74, 12
  v_lshrrev_b32 v4, 1, v3
  v_xor_b32 v4, v4, v2
  v_lshlrev_b32 v5, 7, v3
  v_add_u32 v5, s74, v5
  v_lshl_add_u32 v17, v4, 4, v5
  v_xor_b32 v18, 64, v17
  s_waitcnt vmcnt(0) lgkmcnt(0)
  v_add_u32 v46, s34, v46
  v_cvt_f32_i32 v46, v46
  v_add_u32 v31, s28, v31
  s_cmp_eq_u32 s63, 0
  s_cbranch_scc1 L_F
  s_cmp_eq_u32 s63, 1
  s_cbranch_scc1 L_Q
  v_bfe_u32 v4, v1, 2, 2
  v_lshl_add_u32 v4, v2, 3, v4
  v_mul_u32_u24 v4, 320, v4
  v_add_u32 v4, 16384, v4
  v_and_b32 v5, 3, v1
  v_and_b32 v6, 1, v2
  v_lshlrev_b32 v6, 2, v6
  s_and_b32 s75, s61, 1
  s_mul_i32 s74, s75, 10
  v_cmp_le_u32 vcc, 2, v5
  s_nop 1
  v_cndmask_b32 v8, 8, 18, vcc
  v_add_u32 v5, s74, v5
  v_add_u32 v7, 0, v5
  v_xor_b32 v7, v7, v6
  v_lshl_add_u32 v19, v7, 3, v4
  v_add_u32 v7, 4, v5
  v_xor_b32 v7, v7, v6
  v_lshl_add_u32 v20, v7, 3, v4
  v_add_u32 v7, v8, v5
  v_xor_b32 v7, v7, v6
  v_lshl_add_u32 v21, v7, 3, v4
  v_add_u32 v7, 22, v5
  v_xor_b32 v7, v7, v6
  v_lshl_add_u32 v22, v7, 3, v4
  v_add_u32 v7, 26, v5
  v_xor_b32 v7, v7, v6
  v_lshl_add_u32 v23, v7, 3, v4
  v_add_u32 v24, 73728, v17
  v_add_u32 v25, 73728, v18
  v_add_u32 v26, 73728, v19
  v_add_u32 v27, 73728, v20
  v_add_u32 v28, 73728, v21
  v_add_u32 v29, 73728, v22
  v_add_u32 v30, 73728, v23
  s_lshl_b32 s74, s75, 2
  s_lshl_b32 s75, s61, 11
  s_add_u32 s75, s75, 147456
  s_add_u32 s76, s74, 8
  v_lshlrev_b32 v4, 2, v2
  v_subrev_u32 v4, s76, v4
  v_subrev_u32 v5, s74, v3
  v_mov_b32 v10, 155648
  v_lshl_add_u32 v10, v1, 2, v10
  v_add_u32 v6, 0, v5
  v_cmp_gt_u32 s[0:1], 20, v6
  v_lshl_add_u32 v6, v6, 2, s75
  v_add_u32 v7, 0, v4
  v_cmp_gt_u32 vcc, 20, v7
  s_nop 0
  s_and_b64 vcc, vcc, s[0:1]
  v_mul_u32_u24 v8, 80, v7
  v_add_u32 v8, v8, v6
  v_cndmask_b32 v34, v10, v8, vcc
  v_add_u32 v7, 16, v4
  v_cmp_gt_u32 vcc, 20, v7
  s_nop 0
  s_and_b64 vcc, vcc, s[0:1]
  v_mul_u32_u24 v8, 80, v7
  v_add_u32 v8, v8, v6
  v_cndmask_b32 v36, v10, v8, vcc
  v_cmp_eq_u32 vcc, 0, v2
  s_nop 0
  s_and_b64 vcc, vcc, s[0:1]
  v_cndmask_b32 v38, v10, v6, vcc
  v_add_u32 v6, 16, v5
  v_cmp_gt_u32 s[0:1], 20, v6
  v_lshl_add_u32 v6, v6, 2, s75
  v_add_u32 v7, 0, v4
  v_cmp_gt_u32 vcc, 20, v7
  s_nop 0
  s_and_b64 vcc, vcc, s[0:1]
  v_mul_u32_u24 v8, 80, v7
  v_add_u32 v8, v8, v6
  v_cndmask_b32 v35, v10, v8, vcc
  v_add_u32 v7, 16, v4
  v_cmp_gt_u32 vcc, 20, v7
  s_nop 0
  s_and_b64 vcc, vcc, s[0:1]
  v_mul_u32_u24 v8, 80, v7
  v_add_u32 v8, v8, v6
  v_cndmask_b32 v37, v10, v8, vcc
  v_cmp_eq_u32 vcc, 0, v2
  s_nop 0
  s_and_b64 vcc, vcc, s[0:1]
  v_cndmask_b32 v39, v10, v6, vcc
  v_lshl_add_u32 v40, v1, 2, s75
  v_add_u32 v41, s6, v16
  v_add_u32 v33, s5, v16
  v_lshlrev_b32 v32, 2, v1
  v_mov_b32 v252, 0x3f803f80
  v_mov_b32 v253, 0x3f803f80
  v_mov_b32 v254, 0x3f803f80
  v_mov_b32 v255, 0x3f803f80
  s_waitcnt lgkmcnt(0)
  s_barrier
  ds_read_b128 v[128:131], v17 offset:0
  ds_read_b128 v[132:135], v17 offset:2048
  ds_read_b128 v[136:139], v17 offset:4096
  ds_read_b128 v[140:143], v17 offset:6144
  ds_read_b64_tr_b16 v[176:177], v19 offset:0
  ds_read_b64_tr_b16 v[178:179], v19 offset:1280
  ds_read_b64_tr_b16 v[180:181], v20 offset:0
  ds_read_b64_tr_b16 v[182:183], v20 offset:1280
  ds_read_b64_tr_b16 v[184:185], v21 offset:0
  ds_read_b64_tr_b16 v[186:187], v21 offset:1280
  ds_read_b64_tr_b16 v[188:189], v22 offset:0
  ds_read_b64_tr_b16 v[190:191], v22 offset:1280
  ds_read_b64_tr_b16 v[192:193], v23 offset:0
  ds_read_b64_tr_b16 v[194:195], v23 offset:1280
  s_waitcnt lgkmcnt(6)
  v_mfma_f32_16x16x32_bf16 v[48:51], v[128:131], v[176:179], 0
  ds_read_b128 v[144:147], v18 offset:0
  v_mfma_f32_16x16x32_bf16 v[68:71], v[132:135], v[176:179], 0
  ds_read_b128 v[148:151], v18 offset:2048
  v_mfma_f32_16x16x32_bf16 v[88:91], v[136:139], v[176:179], 0
  ds_read_b128 v[152:155], v18 offset:4096
  v_mfma_f32_16x16x32_bf16 v[108:111], v[140:143], v[176:179], 0
  ds_read_b128 v[156:159], v18 offset:6144
  v_mfma_f32_16x16x32_bf16 v[52:55], v[128:131], v[180:183], 0
  ds_read_b64_tr_b16 v[196:197], v19 offset:10240
  v_mfma_f32_16x16x32_bf16 v[72:75], v[132:135], v[180:183], 0
  ds_read_b64_tr_b16 v[198:199], v19 offset:11520
  v_mfma_f32_16x16x32_bf16 v[92:95], v[136:139], v[180:183], 0
  ds_read_b64_tr_b16 v[200:201], v20 offset:10240
  v_mfma_f32_16x16x32_bf16 v[112:115], v[140:143], v[180:183], 0
  ds_read_b64_tr_b16 v[202:203], v20 offset:11520
  s_waitcnt lgkmcnt(8)
  v_mfma_f32_16x16x32_bf16 v[56:59], v[128:131], v[184:187], 0
  ds_read_b64_tr_b16 v[204:205], v21 offset:10240
  v_mfma_f32_16x16x32_bf16 v[76:79], v[132:135], v[184:187], 0
  ds_read_b64_tr_b16 v[206:207], v21 offset:11520
  v_mfma_f32_16x16x32_bf16 v[96:99], v[136:139], v[184:187], 0
  ds_read_b64_tr_b16 v[208:209], v22 offset:10240
  v_mfma_f32_16x16x32_bf16 v[116:119], v[140:143], v[184:187], 0
  ds_read_b64_tr_b16 v[210:211], v22 offset:11520
  v_mfma_f32_16x16x32_bf16 v[60:63], v[128:131], v[188:191], 0
  ds_read_b64_tr_b16 v[212:213], v23 offset:10240
  v_mfma_f32_16x16x32_bf16 v[80:83], v[132:135], v[188:191], 0
  ds_read_b64_tr_b16 v[214:215], v23 offset:11520
  v_mfma_f32_16x16x32_bf16 v[100:103], v[136:139], v[188:191], 0
  v_mfma_f32_16x16x32_bf16 v[120:123], v[140:143], v[188:191], 0
  v_mfma_f32_16x16x32_bf16 v[64:67], v[128:131], v[192:195], 0
  v_mfma_f32_16x16x32_bf16 v[84:87], v[132:135], v[192:195], 0
  v_mfma_f32_16x16x32_bf16 v[104:107], v[136:139], v[192:195], 0
  v_mfma_f32_16x16x32_bf16 v[124:127], v[140:143], v[192:195], 0
  s_barrier
  s_waitcnt lgkmcnt(6)
  v_mfma_f32_16x16x32_bf16 v[48:51], v[144:147], v[196:199], v[48:51]
  ds_read_b128 v[128:131], v17 offset:36864
  v_mfma_f32_16x16x32_bf16 v[68:71], v[148:151], v[196:199], v[68:71]
  ds_read_b128 v[132:135], v17 offset:38912
  v_mfma_f32_16x16x32_bf16 v[88:91], v[152:155], v[196:199], v[88:91]
  ds_read_b128 v[136:139], v17 offset:40960
  v_mfma_f32_16x16x32_bf16 v[108:111], v[156:159], v[196:199], v[108:111]
  ds_read_b128 v[140:143], v17 offset:43008
  v_mfma_f32_16x16x32_bf16 v[52:55], v[144:147], v[200:203], v[52:55]
  ds_read_b64_tr_b16 v[176:177], v19 offset:36864
  v_mfma_f32_16x16x32_bf16 v[72:75], v[148:151], v[200:203], v[72:75]
  ds_read_b64_tr_b16 v[178:179], v19 offset:38144
  v_mfma_f32_16x16x32_bf16 v[92:95], v[152:155], v[200:203], v[92:95]
  ds_read_b64_tr_b16 v[180:181], v20 offset:36864
  v_mfma_f32_16x16x32_bf16 v[112:115], v[156:159], v[200:203], v[112:115]
  ds_read_b64_tr_b16 v[182:183], v20 offset:38144
  s_waitcnt lgkmcnt(8)
  v_mfma_f32_16x16x32_bf16 v[56:59], v[144:147], v[204:207], v[56:59]
  ds_read_b64_tr_b16 v[184:185], v21 offset:36864
  v_mfma_f32_16x16x32_bf16 v[76:79], v[148:151], v[204:207], v[76:79]
  ds_read_b64_tr_b16 v[186:187], v21 offset:38144
  v_mfma_f32_16x16x32_bf16 v[96:99], v[152:155], v[204:207], v[96:99]
  ds_read_b64_tr_b16 v[188:189], v22 offset:36864
  v_mfma_f32_16x16x32_bf16 v[116:119], v[156:159], v[204:207], v[116:119]
  ds_read_b64_tr_b16 v[190:191], v22 offset:38144
  v_mfma_f32_16x16x32_bf16 v[60:63], v[144:147], v[208:211], v[60:63]
  ds_read_b64_tr_b16 v[192:193], v23 offset:36864
  v_mfma_f32_16x16x32_bf16 v[80:83], v[148:151], v[208:211], v[80:83]
  ds_read_b64_tr_b16 v[194:195], v23 offset:38144
  v_mfma_f32_16x16x32_bf16 v[100:103], v[152:155], v[208:211], v[100:103]
  v_mfma_f32_16x16x32_bf16 v[120:123], v[156:159], v[208:211], v[120:123]
  v_mfma_f32_16x16x32_bf16 v[64:67], v[144:147], v[212:215], v[64:67]
  v_mfma_f32_16x16x32_bf16 v[84:87], v[148:151], v[212:215], v[84:87]
  v_mfma_f32_16x16x32_bf16 v[104:107], v[152:155], v[212:215], v[104:107]
  v_mfma_f32_16x16x32_bf16 v[124:127], v[156:159], v[212:215], v[124:127]
  s_waitcnt lgkmcnt(6)
  v_mfma_f32_16x16x32_bf16 v[48:51], v[128:131], v[176:179], v[48:51]
  ds_read_b128 v[144:147], v18 offset:36864
  v_mfma_f32_16x16x32_bf16 v[68:71], v[132:135], v[176:179], v[68:71]
  ds_read_b128 v[148:151], v18 offset:38912
  v_mfma_f32_16x16x32_bf16 v[88:91], v[136:139], v[176:179], v[88:91]
  ds_read_b128 v[152:155], v18 offset:40960
  v_mfma_f32_16x16x32_bf16 v[108:111], v[140:143], v[176:179], v[108:111]
  ds_read_b128 v[156:159], v18 offset:43008
  v_mfma_f32_16x16x32_bf16 v[52:55], v[128:131], v[180:183], v[52:55]
  ds_read_b64_tr_b16 v[196:197], v19 offset:47104
  v_mfma_f32_16x16x32_bf16 v[72:75], v[132:135], v[180:183], v[72:75]
  ds_read_b64_tr_b16 v[198:199], v19 offset:48384
  v_mfma_f32_16x16x32_bf16 v[92:95], v[136:139], v[180:183], v[92:95]
  ds_read_b64_tr_b16 v[200:201], v20 offset:47104
  v_mfma_f32_16x16x32_bf16 v[112:115], v[140:143], v[180:183], v[112:115]
  ds_read_b64_tr_b16 v[202:203], v20 offset:48384
  s_waitcnt lgkmcnt(8)
  v_mfma_f32_16x16x32_bf16 v[56:59], v[128:131], v[184:187], v[56:59]
  ds_read_b64_tr_b16 v[204:205], v21 offset:47104
  v_mfma_f32_16x16x32_bf16 v[76:79], v[132:135], v[184:187], v[76:79]
  ds_read_b64_tr_b16 v[206:207], v21 offset:48384
  v_mfma_f32_16x16x32_bf16 v[96:99], v[136:139], v[184:187], v[96:99]
  ds_read_b64_tr_b16 v[208:209], v22 offset:47104
  v_mfma_f32_16x16x32_bf16 v[116:119], v[140:143], v[184:187], v[116:119]
  ds_read_b64_tr_b16 v[210:211], v22 offset:48384
  v_mfma_f32_16x16x32_bf16 v[60:63], v[128:131], v[188:191], v[60:63]
  ds_read_b64_tr_b16 v[212:213], v23 offset:47104
  v_mfma_f32_16x16x32_bf16 v[80:83], v[132:135], v[188:191], v[80:83]
  ds_read_b64_tr_b16 v[214:215], v23 offset:48384
  v_mfma_f32_16x16x32_bf16 v[100:103], v[136:139], v[188:191], v[100:103]
  v_mfma_f32_16x16x32_bf16 v[120:123], v[140:143], v[188:191], v[120:123]
  v_mfma_f32_16x16x32_bf16 v[64:67], v[128:131], v[192:195], v[64:67]
  v_mfma_f32_16x16x32_bf16 v[84:87], v[132:135], v[192:195], v[84:87]
  v_mfma_f32_16x16x32_bf16 v[104:107], v[136:139], v[192:195], v[104:107]
  v_mfma_f32_16x16x32_bf16 v[124:127], v[140:143], v[192:195], v[124:127]
  s_barrier
  s_waitcnt lgkmcnt(6)
  v_mfma_f32_16x16x32_bf16 v[48:51], v[144:147], v[196:199], v[48:51]
  ds_read_b128 v[128:131], v24 offset:0
  v_mfma_f32_16x16x32_bf16 v[68:71], v[148:151], v[196:199], v[68:71]
  ds_read_b128 v[132:135], v24 offset:2048
  v_mfma_f32_16x16x32_bf16 v[88:91], v[152:155], v[196:199], v[88:91]
  ds_read_b128 v[136:139], v24 offset:4096
  v_mfma_f32_16x16x32_bf16 v[108:111], v[156:159], v[196:199], v[108:111]
  ds_read_b128 v[140:143], v24 offset:6144
  v_mfma_f32_16x16x32_bf16 v[52:55], v[144:147], v[200:203], v[52:55]
  ds_read_b64_tr_b16 v[176:177], v26 offset:0
  v_mfma_f32_16x16x32_bf16 v[72:75], v[148:151], v[200:203], v[72:75]
  ds_read_b64_tr_b16 v[178:179], v26 offset:1280
  v_mfma_f32_16x16x32_bf16 v[92:95], v[152:155], v[200:203], v[92:95]
  ds_read_b64_tr_b16 v[180:181], v27 offset:0
  v_mfma_f32_16x16x32_bf16 v[112:115], v[156:159], v[200:203], v[112:115]
  ds_read_b64_tr_b16 v[182:183], v27 offset:1280
  s_waitcnt lgkmcnt(8)
  v_mfma_f32_16x16x32_bf16 v[56:59], v[144:147], v[204:207], v[56:59]
  ds_read_b64_tr_b16 v[184:185], v28 offset:0
  v_mfma_f32_16x16x32_bf16 v[76:79], v[148:151], v[204:207], v[76:79]
  ds_read_b64_tr_b16 v[186:187], v28 offset:1280
  v_mfma_f32_16x16x32_bf16 v[96:99], v[152:155], v[204:207], v[96:99]
  ds_read_b64_tr_b16 v[188:189], v29 offset:0
  v_mfma_f32_16x16x32_bf16 v[116:119], v[156:159], v[204:207], v[116:119]
  ds_read_b64_tr_b16 v[190:191], v29 offset:1280
  v_mfma_f32_16x16x32_bf16 v[60:63], v[144:147], v[208:211], v[60:63]
  ds_read_b64_tr_b16 v[192:193], v30 offset:0
  v_mfma_f32_16x16x32_bf16 v[80:83], v[148:151], v[208:211], v[80:83]
  ds_read_b64_tr_b16 v[194:195], v30 offset:1280
  v_mfma_f32_16x16x32_bf16 v[100:103], v[152:155], v[208:211], v[100:103]
  v_mfma_f32_16x16x32_bf16 v[120:123], v[156:159], v[208:211], v[120:123]
  v_mfma_f32_16x16x32_bf16 v[64:67], v[144:147], v[212:215], v[64:67]
  v_mfma_f32_16x16x32_bf16 v[84:87], v[148:151], v[212:215], v[84:87]
  v_mfma_f32_16x16x32_bf16 v[104:107], v[152:155], v[212:215], v[104:107]
  v_mfma_f32_16x16x32_bf16 v[124:127], v[156:159], v[212:215], v[124:127]
  s_waitcnt lgkmcnt(6)
  v_mfma_f32_16x16x32_bf16 v[48:51], v[128:131], v[176:179], v[48:51]
  ds_read_b128 v[144:147], v25 offset:0
  v_mfma_f32_16x16x32_bf16 v[68:71], v[132:135], v[176:179], v[68:71]
  ds_read_b128 v[148:151], v25 offset:2048
  v_mfma_f32_16x16x32_bf16 v[88:91], v[136:139], v[176:179], v[88:91]
  ds_read_b128 v[152:155], v25 offset:4096
  v_mfma_f32_16x16x32_bf16 v[108:111], v[140:143], v[176:179], v[108:111]
  ds_read_b128 v[156:159], v25 offset:6144
  v_mfma_f32_16x16x32_bf16 v[52:55], v[128:131], v[180:183], v[52:55]
  ds_read_b64_tr_b16 v[196:197], v26 offset:10240
  v_mfma_f32_16x16x32_bf16 v[72:75], v[132:135], v[180:183], v[72:75]
  ds_read_b64_tr_b16 v[198:199], v26 offset:11520
  v_mfma_f32_16x16x32_bf16 v[92:95], v[136:139], v[180:183], v[92:95]
  ds_read_b64_tr_b16 v[200:201], v27 offset:10240
  v_mfma_f32_16x16x32_bf16 v[112:115], v[140:143], v[180:183], v[112:115]
  ds_read_b64_tr_b16 v[202:203], v27 offset:11520
  s_waitcnt lgkmcnt(8)
  v_mfma_f32_16x16x32_bf16 v[56:59], v[128:131], v[184:187], v[56:59]
  ds_read_b64_tr_b16 v[204:205], v28 offset:10240
  v_mfma_f32_16x16x32_bf16 v[76:79], v[132:135], v[184:187], v[76:79]
  ds_read_b64_tr_b16 v[206:207], v28 offset:11520
  v_mfma_f32_16x16x32_bf16 v[96:99], v[136:139], v[184:187], v[96:99]
  ds_read_b64_tr_b16 v[208:209], v29 offset:10240
  v_mfma_f32_16x16x32_bf16 v[116:119], v[140:143], v[184:187], v[116:119]
  ds_read_b64_tr_b16 v[210:211], v29 offset:11520
  v_mfma_f32_16x16x32_bf16 v[60:63], v[128:131], v[188:191], v[60:63]
  ds_read_b64_tr_b16 v[212:213], v30 offset:10240
  v_mfma_f32_16x16x32_bf16 v[80:83], v[132:135], v[188:191], v[80:83]
  ds_read_b64_tr_b16 v[214:215], v30 offset:11520
  v_mfma_f32_16x16x32_bf16 v[100:103], v[136:139], v[188:191], v[100:103]
  v_mfma_f32_16x16x32_bf16 v[120:123], v[140:143], v[188:191], v[120:123]
  v_mfma_f32_16x16x32_bf16 v[64:67], v[128:131], v[192:195], v[64:67]
  v_mfma_f32_16x16x32_bf16 v[84:87], v[132:135], v[192:195], v[84:87]
  v_mfma_f32_16x16x32_bf16 v[104:107], v[136:139], v[192:195], v[104:107]
  v_mfma_f32_16x16x32_bf16 v[124:127], v[140:143], v[192:195], v[124:127]
  s_barrier
  s_waitcnt lgkmcnt(6)
  v_mfma_f32_16x16x32_bf16 v[48:51], v[144:147], v[196:199], v[48:51]
  ds_read_b128 v[128:131], v24 offset:36864
  v_mfma_f32_16x16x32_bf16 v[68:71], v[148:151], v[196:199], v[68:71]
  ds_read_b128 v[132:135], v24 offset:38912
  v_mfma_f32_16x16x32_bf16 v[88:91], v[152:155], v[196:199], v[88:91]
  ds_read_b128 v[136:139], v24 offset:40960
  v_mfma_f32_16x16x32_bf16 v[108:111], v[156:159], v[196:199], v[108:111]
  ds_read_b128 v[140:143], v24 offset:43008
  v_mfma_f32_16x16x32_bf16 v[52:55], v[144:147], v[200:203], v[52:55]
  ds_read_b64_tr_b16 v[176:177], v26 offset:36864
  v_mfma_f32_16x16x32_bf16 v[72:75], v[148:151], v[200:203], v[72:75]
  ds_read_b64_tr_b16 v[178:179], v26 offset:38144
  v_mfma_f32_16x16x32_bf16 v[92:95], v[152:155], v[200:203], v[92:95]
  ds_read_b64_tr_b16 v[180:181], v27 offset:36864
  v_mfma_f32_16x16x32_bf16 v[112:115], v[156:159], v[200:203], v[112:115]
  ds_read_b64_tr_b16 v[182:183], v27 offset:38144
  s_waitcnt lgkmcnt(8)
  v_mfma_f32_16x16x32_bf16 v[56:59], v[144:147], v[204:207], v[56:59]
  ds_read_b64_tr_b16 v[184:185], v28 offset:36864
  v_mfma_f32_16x16x32_bf16 v[76:79], v[148:151], v[204:207], v[76:79]
  ds_read_b64_tr_b16 v[186:187], v28 offset:38144
  v_mfma_f32_16x16x32_bf16 v[96:99], v[152:155], v[204:207], v[96:99]
  ds_read_b64_tr_b16 v[188:189], v29 offset:36864
  v_mfma_f32_16x16x32_bf16 v[116:119], v[156:159], v[204:207], v[116:119]
  ds_read_b64_tr_b16 v[190:191], v29 offset:38144
  v_mfma_f32_16x16x32_bf16 v[60:63], v[144:147], v[208:211], v[60:63]
  ds_read_b64_tr_b16 v[192:193], v30 offset:36864
  v_mfma_f32_16x16x32_bf16 v[80:83], v[148:151], v[208:211], v[80:83]
  ds_read_b64_tr_b16 v[194:195], v30 offset:38144
  v_mfma_f32_16x16x32_bf16 v[100:103], v[152:155], v[208:211], v[100:103]
  v_mfma_f32_16x16x32_bf16 v[120:123], v[156:159], v[208:211], v[120:123]
  v_mfma_f32_16x16x32_bf16 v[64:67], v[144:147], v[212:215], v[64:67]
  v_mfma_f32_16x16x32_bf16 v[84:87], v[148:151], v[212:215], v[84:87]
  v_mfma_f32_16x16x32_bf16 v[104:107], v[152:155], v[212:215], v[104:107]
  v_mfma_f32_16x16x32_bf16 v[124:127], v[156:159], v[212:215], v[124:127]
  s_waitcnt lgkmcnt(6)
  v_mfma_f32_16x16x32_bf16 v[48:51], v[128:131], v[176:179], v[48:51]
  ds_read_b128 v[144:147], v25 offset:36864
  v_mfma_f32_16x16x32_bf16 v[68:71], v[132:135], v[176:179], v[68:71]
  ds_read_b128 v[148:151], v25 offset:38912
  v_mfma_f32_16x16x32_bf16 v[88:91], v[136:139], v[176:179], v[88:91]
  ds_read_b128 v[152:155], v25 offset:40960
  v_mfma_f32_16x16x32_bf16 v[108:111], v[140:143], v[176:179], v[108:111]
  ds_read_b128 v[156:159], v25 offset:43008
  v_mfma_f32_16x16x32_bf16 v[52:55], v[128:131], v[180:183], v[52:55]
  ds_read_b64_tr_b16 v[196:197], v26 offset:47104
  v_mfma_f32_16x16x32_bf16 v[72:75], v[132:135], v[180:183], v[72:75]
  ds_read_b64_tr_b16 v[198:199], v26 offset:48384
  v_mfma_f32_16x16x32_bf16 v[92:95], v[136:139], v[180:183], v[92:95]
  ds_read_b64_tr_b16 v[200:201], v27 offset:47104
  v_mfma_f32_16x16x32_bf16 v[112:115], v[140:143], v[180:183], v[112:115]
  ds_read_b64_tr_b16 v[202:203], v27 offset:48384
  s_waitcnt lgkmcnt(8)
  v_mfma_f32_16x16x32_bf16 v[56:59], v[128:131], v[184:187], v[56:59]
  ds_read_b64_tr_b16 v[204:205], v28 offset:47104
  v_mfma_f32_16x16x32_bf16 v[76:79], v[132:135], v[184:187], v[76:79]
  ds_read_b64_tr_b16 v[206:207], v28 offset:48384
  v_mfma_f32_16x16x32_bf16 v[96:99], v[136:139], v[184:187], v[96:99]
  ds_read_b64_tr_b16 v[208:209], v29 offset:47104
  v_mfma_f32_16x16x32_bf16 v[116:119], v[140:143], v[184:187], v[116:119]
  ds_read_b64_tr_b16 v[210:211], v29 offset:48384
  v_mfma_f32_16x16x32_bf16 v[60:63], v[128:131], v[188:191], v[60:63]
  ds_read_b64_tr_b16 v[212:213], v30 offset:47104
  v_mfma_f32_16x16x32_bf16 v[80:83], v[132:135], v[188:191], v[80:83]
  ds_read_b64_tr_b16 v[214:215], v30 offset:48384
  v_mfma_f32_16x16x32_bf16 v[100:103], v[136:139], v[188:191], v[100:103]
  v_mfma_f32_16x16x32_bf16 v[120:123], v[140:143], v[188:191], v[120:123]
  v_mfma_f32_16x16x32_bf16 v[64:67], v[128:131], v[192:195], v[64:67]
  v_mfma_f32_16x16x32_bf16 v[84:87], v[132:135], v[192:195], v[84:87]
  v_mfma_f32_16x16x32_bf16 v[104:107], v[136:139], v[192:195], v[104:107]
  v_mfma_f32_16x16x32_bf16 v[124:127], v[140:143], v[192:195], v[124:127]
  s_barrier
  s_waitcnt lgkmcnt(6)
  v_mfma_f32_16x16x32_bf16 v[48:51], v[144:147], v[196:199], v[48:51]
  ds_read_b128 v[128:131], v17 offset:0
  v_mfma_f32_16x16x32_bf16 v[68:71], v[148:151], v[196:199], v[68:71]
  ds_read_b128 v[132:135], v17 offset:2048
  v_mfma_f32_16x16x32_bf16 v[88:91], v[152:155], v[196:199], v[88:91]
  ds_read_b128 v[136:139], v17 offset:4096
  v_mfma_f32_16x16x32_bf16 v[108:111], v[156:159], v[196:199], v[108:111]
  ds_read_b128 v[140:143], v17 offset:6144
  v_mfma_f32_16x16x32_bf16 v[52:55], v[144:147], v[200:203], v[52:55]
  ds_read_b64_tr_b16 v[176:177], v19 offset:0
  v_mfma_f32_16x16x32_bf16 v[72:75], v[148:151], v[200:203], v[72:75]
  ds_read_b64_tr_b16 v[178:179], v19 offset:1280
  v_mfma_f32_16x16x32_bf16 v[92:95], v[152:155], v[200:203], v[92:95]
  ds_read_b64_tr_b16 v[180:181], v20 offset:0
  v_mfma_f32_16x16x32_bf16 v[112:115], v[156:159], v[200:203], v[112:115]
  ds_read_b64_tr_b16 v[182:183], v20 offset:1280
  s_waitcnt lgkmcnt(8)
  v_mfma_f32_16x16x32_bf16 v[56:59], v[144:147], v[204:207], v[56:59]
  ds_read_b64_tr_b16 v[184:185], v21 offset:0
  v_mfma_f32_16x16x32_bf16 v[76:79], v[148:151], v[204:207], v[76:79]
  ds_read_b64_tr_b16 v[186:187], v21 offset:1280
  v_mfma_f32_16x16x32_bf16 v[96:99], v[152:155], v[204:207], v[96:99]
  ds_read_b64_tr_b16 v[188:189], v22 offset:0
  v_mfma_f32_16x16x32_bf16 v[116:119], v[156:159], v[204:207], v[116:119]
  ds_read_b64_tr_b16 v[190:191], v22 offset:1280
  v_mfma_f32_16x16x32_bf16 v[60:63], v[144:147], v[208:211], v[60:63]
  ds_read_b64_tr_b16 v[192:193], v23 offset:0
  v_mfma_f32_16x16x32_bf16 v[80:83], v[148:151], v[208:211], v[80:83]
  ds_read_b64_tr_b16 v[194:195], v23 offset:1280
  v_mfma_f32_16x16x32_bf16 v[100:103], v[152:155], v[208:211], v[100:103]
  v_mfma_f32_16x16x32_bf16 v[120:123], v[156:159], v[208:211], v[120:123]
  v_mfma_f32_16x16x32_bf16 v[64:67], v[144:147], v[212:215], v[64:67]
  v_mfma_f32_16x16x32_bf16 v[84:87], v[148:151], v[212:215], v[84:87]
  v_mfma_f32_16x16x32_bf16 v[104:107], v[152:155], v[212:215], v[104:107]
  v_mfma_f32_16x16x32_bf16 v[124:127], v[156:159], v[212:215], v[124:127]
  s_waitcnt lgkmcnt(6)
  v_mfma_f32_16x16x32_bf16 v[48:51], v[128:131], v[176:179], v[48:51]
  ds_read_b128 v[144:147], v18 offset:0
  v_mfma_f32_16x16x32_bf16 v[68:71], v[132:135], v[176:179], v[68:71]
  ds_read_b128 v[148:151], v18 offset:2048
  v_mfma_f32_16x16x32_bf16 v[88:91], v[136:139], v[176:179], v[88:91]
  ds_read_b128 v[152:155], v18 offset:4096
  v_mfma_f32_16x16x32_bf16 v[108:111], v[140:143], v[176:179], v[108:111]
  ds_read_b128 v[156:159], v18 offset:6144
  v_mfma_f32_16x16x32_bf16 v[52:55], v[128:131], v[180:183], v[52:55]
  ds_read_b64_tr_b16 v[196:197], v19 offset:10240
  v_mfma_f32_16x16x32_bf16 v[72:75], v[132:135], v[180:183], v[72:75]
  ds_read_b64_tr_b16 v[198:199], v19 offset:11520
  v_mfma_f32_16x16x32_bf16 v[92:95], v[136:139], v[180:183], v[92:95]
  ds_read_b64_tr_b16 v[200:201], v20 offset:10240
  v_mfma_f32_16x16x32_bf16 v[112:115], v[140:143], v[180:183], v[112:115]
  ds_read_b64_tr_b16 v[202:203], v20 offset:11520
  s_waitcnt lgkmcnt(8)
  v_mfma_f32_16x16x32_bf16 v[56:59], v[128:131], v[184:187], v[56:59]
  ds_read_b64_tr_b16 v[204:205], v21 offset:10240
  v_mfma_f32_16x16x32_bf16 v[76:79], v[132:135], v[184:187], v[76:79]
  ds_read_b64_tr_b16 v[206:207], v21 offset:11520
  v_mfma_f32_16x16x32_bf16 v[96:99], v[136:139], v[184:187], v[96:99]
  ds_read_b64_tr_b16 v[208:209], v22 offset:10240
  v_mfma_f32_16x16x32_bf16 v[116:119], v[140:143], v[184:187], v[116:119]
  ds_read_b64_tr_b16 v[210:211], v22 offset:11520
  v_mfma_f32_16x16x32_bf16 v[60:63], v[128:131], v[188:191], v[60:63]
  ds_read_b64_tr_b16 v[212:213], v23 offset:10240
  v_mfma_f32_16x16x32_bf16 v[80:83], v[132:135], v[188:191], v[80:83]
  ds_read_b64_tr_b16 v[214:215], v23 offset:11520
  v_mfma_f32_16x16x32_bf16 v[100:103], v[136:139], v[188:191], v[100:103]
  v_mfma_f32_16x16x32_bf16 v[120:123], v[140:143], v[188:191], v[120:123]
  v_mfma_f32_16x16x32_bf16 v[64:67], v[128:131], v[192:195], v[64:67]
  v_mfma_f32_16x16x32_bf16 v[84:87], v[132:135], v[192:195], v[84:87]
  v_mfma_f32_16x16x32_bf16 v[104:107], v[136:139], v[192:195], v[104:107]
  v_mfma_f32_16x16x32_bf16 v[124:127], v[140:143], v[192:195], v[124:127]
  s_barrier
  s_waitcnt lgkmcnt(6)
  v_mfma_f32_16x16x32_bf16 v[48:51], v[144:147], v[196:199], v[48:51]
  ds_read_b128 v[128:131], v17 offset:36864
  v_mfma_f32_16x16x32_bf16 v[68:71], v[148:151], v[196:199], v[68:71]
  ds_read_b128 v[132:135], v17 offset:38912
  v_mfma_f32_16x16x32_bf16 v[88:91], v[152:155], v[196:199], v[88:91]
  ds_read_b128 v[136:139], v17 offset:40960
  v_mfma_f32_16x16x32_bf16 v[108:111], v[156:159], v[196:199], v[108:111]
  ds_read_b128 v[140:143], v17 offset:43008
  v_mfma_f32_16x16x32_bf16 v[52:55], v[144:147], v[200:203], v[52:55]
  ds_read_b64_tr_b16 v[176:177], v19 offset:36864
  v_mfma_f32_16x16x32_bf16 v[72:75], v[148:151], v[200:203], v[72:75]
  ds_read_b64_tr_b16 v[178:179], v19 offset:38144
  v_mfma_f32_16x16x32_bf16 v[92:95], v[152:155], v[200:203], v[92:95]
  ds_read_b64_tr_b16 v[180:181], v20 offset:36864
  v_mfma_f32_16x16x32_bf16 v[112:115], v[156:159], v[200:203], v[112:115]
  ds_read_b64_tr_b16 v[182:183], v20 offset:38144
  s_waitcnt lgkmcnt(8)
  v_mfma_f32_16x16x32_bf16 v[56:59], v[144:147], v[204:207], v[56:59]
  ds_read_b64_tr_b16 v[184:185], v21 offset:36864
  v_mfma_f32_16x16x32_bf16 v[76:79], v[148:151], v[204:207], v[76:79]
  ds_read_b64_tr_b16 v[186:187], v21 offset:38144
  v_mfma_f32_16x16x32_bf16 v[96:99], v[152:155], v[204:207], v[96:99]
  ds_read_b64_tr_b16 v[188:189], v22 offset:36864
  v_mfma_f32_16x16x32_bf16 v[116:119], v[156:159], v[204:207], v[116:119]
  ds_read_b64_tr_b16 v[190:191], v22 offset:38144
  v_mfma_f32_16x16x32_bf16 v[60:63], v[144:147], v[208:211], v[60:63]
  ds_read_b64_tr_b16 v[192:193], v23 offset:36864
  v_mfma_f32_16x16x32_bf16 v[80:83], v[148:151], v[208:211], v[80:83]
  ds_read_b64_tr_b16 v[194:195], v23 offset:38144
  v_mfma_f32_16x16x32_bf16 v[100:103], v[152:155], v[208:211], v[100:103]
  v_mfma_f32_16x16x32_bf16 v[120:123], v[156:159], v[208:211], v[120:123]
  v_mfma_f32_16x16x32_bf16 v[64:67], v[144:147], v[212:215], v[64:67]
  v_mfma_f32_16x16x32_bf16 v[84:87], v[148:151], v[212:215], v[84:87]
  v_mfma_f32_16x16x32_bf16 v[104:107], v[152:155], v[212:215], v[104:107]
  v_mfma_f32_16x16x32_bf16 v[124:127], v[156:159], v[212:215], v[124:127]
  s_waitcnt lgkmcnt(6)
  v_mfma_f32_16x16x32_bf16 v[48:51], v[128:131], v[176:179], v[48:51]
  ds_read_b128 v[144:147], v18 offset:36864
  v_mfma_f32_16x16x32_bf16 v[68:71], v[132:135], v[176:179], v[68:71]
  ds_read_b128 v[148:151], v18 offset:38912
  v_mfma_f32_16x16x32_bf16 v[88:91], v[136:139], v[176:179], v[88:91]
  ds_read_b128 v[152:155], v18 offset:40960
  v_mfma_f32_16x16x32_bf16 v[108:111], v[140:143], v[176:179], v[108:111]
  ds_read_b128 v[156:159], v18 offset:43008
  v_mfma_f32_16x16x32_bf16 v[52:55], v[128:131], v[180:183], v[52:55]
  ds_read_b64_tr_b16 v[196:197], v19 offset:47104
  v_mfma_f32_16x16x32_bf16 v[72:75], v[132:135], v[180:183], v[72:75]
  ds_read_b64_tr_b16 v[198:199], v19 offset:48384
  v_mfma_f32_16x16x32_bf16 v[92:95], v[136:139], v[180:183], v[92:95]
  ds_read_b64_tr_b16 v[200:201], v20 offset:47104
  v_mfma_f32_16x16x32_bf16 v[112:115], v[140:143], v[180:183], v[112:115]
  ds_read_b64_tr_b16 v[202:203], v20 offset:48384
  s_waitcnt lgkmcnt(8)
  v_mfma_f32_16x16x32_bf16 v[56:59], v[128:131], v[184:187], v[56:59]
  ds_read_b64_tr_b16 v[204:205], v21 offset:47104
  v_mfma_f32_16x16x32_bf16 v[76:79], v[132:135], v[184:187], v[76:79]
  ds_read_b64_tr_b16 v[206:207], v21 offset:48384
  v_mfma_f32_16x16x32_bf16 v[96:99], v[136:139], v[184:187], v[96:99]
  ds_read_b64_tr_b16 v[208:209], v22 offset:47104
  v_mfma_f32_16x16x32_bf16 v[116:119], v[140:143], v[184:187], v[116:119]
  ds_read_b64_tr_b16 v[210:211], v22 offset:48384
  v_mfma_f32_16x16x32_bf16 v[60:63], v[128:131], v[188:191], v[60:63]
  ds_read_b64_tr_b16 v[212:213], v23 offset:47104
  v_mfma_f32_16x16x32_bf16 v[80:83], v[132:135], v[188:191], v[80:83]
  ds_read_b64_tr_b16 v[214:215], v23 offset:48384
  v_mfma_f32_16x16x32_bf16 v[100:103], v[136:139], v[188:191], v[100:103]
  v_mfma_f32_16x16x32_bf16 v[120:123], v[140:143], v[188:191], v[120:123]
  v_mfma_f32_16x16x32_bf16 v[64:67], v[128:131], v[192:195], v[64:67]
  v_mfma_f32_16x16x32_bf16 v[84:87], v[132:135], v[192:195], v[84:87]
  v_mfma_f32_16x16x32_bf16 v[104:107], v[136:139], v[192:195], v[104:107]
  v_mfma_f32_16x16x32_bf16 v[124:127], v[140:143], v[192:195], v[124:127]
  s_barrier
  s_waitcnt lgkmcnt(6)
  v_mfma_f32_16x16x32_bf16 v[48:51], v[144:147], v[196:199], v[48:51]
  ds_read_b128 v[128:131], v24 offset:0
  v_mfma_f32_16x16x32_bf16 v[68:71], v[148:151], v[196:199], v[68:71]
  ds_read_b128 v[132:135], v24 offset:2048
  v_mfma_f32_16x16x32_bf16 v[88:91], v[152:155], v[196:199], v[88:91]
  ds_read_b128 v[136:139], v24 offset:4096
  v_mfma_f32_16x16x32_bf16 v[108:111], v[156:159], v[196:199], v[108:111]
  ds_read_b128 v[140:143], v24 offset:6144
  v_mfma_f32_16x16x32_bf16 v[52:55], v[144:147], v[200:203], v[52:55]
  ds_read_b64_tr_b16 v[176:177], v26 offset:0
  v_mfma_f32_16x16x32_bf16 v[72:75], v[148:151], v[200:203], v[72:75]
  ds_read_b64_tr_b16 v[178:179], v26 offset:1280
  v_mfma_f32_16x16x32_bf16 v[92:95], v[152:155], v[200:203], v[92:95]
  ds_read_b64_tr_b16 v[180:181], v27 offset:0
  v_mfma_f32_16x16x32_bf16 v[112:115], v[156:159], v[200:203], v[112:115]
  ds_read_b64_tr_b16 v[182:183], v27 offset:1280
  s_waitcnt lgkmcnt(8)
  v_mfma_f32_16x16x32_bf16 v[56:59], v[144:147], v[204:207], v[56:59]
  ds_read_b64_tr_b16 v[184:185], v28 offset:0
  v_mfma_f32_16x16x32_bf16 v[76:79], v[148:151], v[204:207], v[76:79]
  ds_read_b64_tr_b16 v[186:187], v28 offset:1280
  v_mfma_f32_16x16x32_bf16 v[96:99], v[152:155], v[204:207], v[96:99]
  ds_read_b64_tr_b16 v[188:189], v29 offset:0
  v_mfma_f32_16x16x32_bf16 v[116:119], v[156:159], v[204:207], v[116:119]
  ds_read_b64_tr_b16 v[190:191], v29 offset:1280
  v_mfma_f32_16x16x32_bf16 v[60:63], v[144:147], v[208:211], v[60:63]
  ds_read_b64_tr_b16 v[192:193], v30 offset:0
  v_mfma_f32_16x16x32_bf16 v[80:83], v[148:151], v[208:211], v[80:83]
  ds_read_b64_tr_b16 v[194:195], v30 offset:1280
  v_mfma_f32_16x16x32_bf16 v[100:103], v[152:155], v[208:211], v[100:103]
  v_mfma_f32_16x16x32_bf16 v[120:123], v[156:159], v[208:211], v[120:123]
  v_mfma_f32_16x16x32_bf16 v[64:67], v[144:147], v[212:215], v[64:67]
  v_mfma_f32_16x16x32_bf16 v[84:87], v[148:151], v[212:215], v[84:87]
  v_mfma_f32_16x16x32_bf16 v[104:107], v[152:155], v[212:215], v[104:107]
  v_mfma_f32_16x16x32_bf16 v[124:127], v[156:159], v[212:215], v[124:127]
  s_waitcnt lgkmcnt(6)
  v_mfma_f32_16x16x32_bf16 v[48:51], v[128:131], v[176:179], v[48:51]
  ds_read_b128 v[144:147], v25 offset:0
  v_mfma_f32_16x16x32_bf16 v[68:71], v[132:135], v[176:179], v[68:71]
  ds_read_b128 v[148:151], v25 offset:2048
  v_mfma_f32_16x16x32_bf16 v[88:91], v[136:139], v[176:179], v[88:91]
  ds_read_b128 v[152:155], v25 offset:4096
  v_mfma_f32_16x16x32_bf16 v[108:111], v[140:143], v[176:179], v[108:111]
  ds_read_b128 v[156:159], v25 offset:6144
  v_mfma_f32_16x16x32_bf16 v[52:55], v[128:131], v[180:183], v[52:55]
  ds_read_b64_tr_b16 v[196:197], v26 offset:10240
  v_mfma_f32_16x16x32_bf16 v[72:75], v[132:135], v[180:183], v[72:75]
  ds_read_b64_tr_b16 v[198:199], v26 offset:11520
  v_mfma_f32_16x16x32_bf16 v[92:95], v[136:139], v[180:183], v[92:95]
  ds_read_b64_tr_b16 v[200:201], v27 offset:10240
  v_mfma_f32_16x16x32_bf16 v[112:115], v[140:143], v[180:183], v[112:115]
  ds_read_b64_tr_b16 v[202:203], v27 offset:11520
  s_waitcnt lgkmcnt(8)
  v_mfma_f32_16x16x32_bf16 v[56:59], v[128:131], v[184:187], v[56:59]
  ds_read_b64_tr_b16 v[204:205], v28 offset:10240
  v_mfma_f32_16x16x32_bf16 v[76:79], v[132:135], v[184:187], v[76:79]
  ds_read_b64_tr_b16 v[206:207], v28 offset:11520
  v_mfma_f32_16x16x32_bf16 v[96:99], v[136:139], v[184:187], v[96:99]
  ds_read_b64_tr_b16 v[208:209], v29 offset:10240
  v_mfma_f32_16x16x32_bf16 v[116:119], v[140:143], v[184:187], v[116:119]
  ds_read_b64_tr_b16 v[210:211], v29 offset:11520
  v_mfma_f32_16x16x32_bf16 v[60:63], v[128:131], v[188:191], v[60:63]
  ds_read_b64_tr_b16 v[212:213], v30 offset:10240
  v_mfma_f32_16x16x32_bf16 v[80:83], v[132:135], v[188:191], v[80:83]
  ds_read_b64_tr_b16 v[214:215], v30 offset:11520
  v_mfma_f32_16x16x32_bf16 v[100:103], v[136:139], v[188:191], v[100:103]
  v_mfma_f32_16x16x32_bf16 v[120:123], v[140:143], v[188:191], v[120:123]
  v_mfma_f32_16x16x32_bf16 v[64:67], v[128:131], v[192:195], v[64:67]
  v_mfma_f32_16x16x32_bf16 v[84:87], v[132:135], v[192:195], v[84:87]
  v_mfma_f32_16x16x32_bf16 v[104:107], v[136:139], v[192:195], v[104:107]
  v_mfma_f32_16x16x32_bf16 v[124:127], v[140:143], v[192:195], v[124:127]
  s_barrier
  s_waitcnt lgkmcnt(6)
  v_mfma_f32_16x16x32_bf16 v[48:51], v[144:147], v[196:199], v[48:51]
  ds_read_b128 v[128:131], v24 offset:36864
  v_mfma_f32_16x16x32_bf16 v[68:71], v[148:151], v[196:199], v[68:71]
  ds_read_b128 v[132:135], v24 offset:38912
  v_mfma_f32_16x16x32_bf16 v[88:91], v[152:155], v[196:199], v[88:91]
  ds_read_b128 v[136:139], v24 offset:40960
  v_mfma_f32_16x16x32_bf16 v[108:111], v[156:159], v[196:199], v[108:111]
  ds_read_b128 v[140:143], v24 offset:43008
  v_mfma_f32_16x16x32_bf16 v[52:55], v[144:147], v[200:203], v[52:55]
  ds_read_b64_tr_b16 v[176:177], v26 offset:36864
  v_mfma_f32_16x16x32_bf16 v[72:75], v[148:151], v[200:203], v[72:75]
  ds_read_b64_tr_b16 v[178:179], v26 offset:38144
  v_mfma_f32_16x16x32_bf16 v[92:95], v[152:155], v[200:203], v[92:95]
  ds_read_b64_tr_b16 v[180:181], v27 offset:36864
  v_mfma_f32_16x16x32_bf16 v[112:115], v[156:159], v[200:203], v[112:115]
  ds_read_b64_tr_b16 v[182:183], v27 offset:38144
  s_waitcnt lgkmcnt(8)
  v_mfma_f32_16x16x32_bf16 v[56:59], v[144:147], v[204:207], v[56:59]
  ds_read_b64_tr_b16 v[184:185], v28 offset:36864
  v_mfma_f32_16x16x32_bf16 v[76:79], v[148:151], v[204:207], v[76:79]
  ds_read_b64_tr_b16 v[186:187], v28 offset:38144
  v_mfma_f32_16x16x32_bf16 v[96:99], v[152:155], v[204:207], v[96:99]
  ds_read_b64_tr_b16 v[188:189], v29 offset:36864
  v_mfma_f32_16x16x32_bf16 v[116:119], v[156:159], v[204:207], v[116:119]
  ds_read_b64_tr_b16 v[190:191], v29 offset:38144
  v_mfma_f32_16x16x32_bf16 v[60:63], v[144:147], v[208:211], v[60:63]
  ds_read_b64_tr_b16 v[192:193], v30 offset:36864
  v_mfma_f32_16x16x32_bf16 v[80:83], v[148:151], v[208:211], v[80:83]
  ds_read_b64_tr_b16 v[194:195], v30 offset:38144
  v_mfma_f32_16x16x32_bf16 v[100:103], v[152:155], v[208:211], v[100:103]
  v_mfma_f32_16x16x32_bf16 v[120:123], v[156:159], v[208:211], v[120:123]
  v_mfma_f32_16x16x32_bf16 v[64:67], v[144:147], v[212:215], v[64:67]
  v_mfma_f32_16x16x32_bf16 v[84:87], v[148:151], v[212:215], v[84:87]
  v_mfma_f32_16x16x32_bf16 v[104:107], v[152:155], v[212:215], v[104:107]
  v_mfma_f32_16x16x32_bf16 v[124:127], v[156:159], v[212:215], v[124:127]
  s_waitcnt lgkmcnt(6)
  v_mfma_f32_16x16x32_bf16 v[48:51], v[128:131], v[176:179], v[48:51]
  ds_read_b128 v[144:147], v25 offset:36864
  v_mfma_f32_16x16x32_bf16 v[68:71], v[132:135], v[176:179], v[68:71]
  ds_read_b128 v[148:151], v25 offset:38912
  v_mfma_f32_16x16x32_bf16 v[88:91], v[136:139], v[176:179], v[88:91]
  ds_read_b128 v[152:155], v25 offset:40960
  v_mfma_f32_16x16x32_bf16 v[108:111], v[140:143], v[176:179], v[108:111]
  ds_read_b128 v[156:159], v25 offset:43008
  v_mfma_f32_16x16x32_bf16 v[52:55], v[128:131], v[180:183], v[52:55]
  ds_read_b64_tr_b16 v[196:197], v26 offset:47104
  v_mfma_f32_16x16x32_bf16 v[72:75], v[132:135], v[180:183], v[72:75]
  ds_read_b64_tr_b16 v[198:199], v26 offset:48384
  v_mfma_f32_16x16x32_bf16 v[92:95], v[136:139], v[180:183], v[92:95]
  ds_read_b64_tr_b16 v[200:201], v27 offset:47104
  v_mfma_f32_16x16x32_bf16 v[112:115], v[140:143], v[180:183], v[112:115]
  ds_read_b64_tr_b16 v[202:203], v27 offset:48384
  s_waitcnt lgkmcnt(8)
  v_mfma_f32_16x16x32_bf16 v[56:59], v[128:131], v[184:187], v[56:59]
  ds_read_b64_tr_b16 v[204:205], v28 offset:47104
  v_mfma_f32_16x16x32_bf16 v[76:79], v[132:135], v[184:187], v[76:79]
  ds_read_b64_tr_b16 v[206:207], v28 offset:48384
  v_mfma_f32_16x16x32_bf16 v[96:99], v[136:139], v[184:187], v[96:99]
  ds_read_b64_tr_b16 v[208:209], v29 offset:47104
  v_mfma_f32_16x16x32_bf16 v[116:119], v[140:143], v[184:187], v[116:119]
  ds_read_b64_tr_b16 v[210:211], v29 offset:48384
  v_mfma_f32_16x16x32_bf16 v[60:63], v[128:131], v[188:191], v[60:63]
  ds_read_b64_tr_b16 v[212:213], v30 offset:47104
  v_mfma_f32_16x16x32_bf16 v[80:83], v[132:135], v[188:191], v[80:83]
  ds_read_b64_tr_b16 v[214:215], v30 offset:48384
  v_mfma_f32_16x16x32_bf16 v[100:103], v[136:139], v[188:191], v[100:103]
  v_mfma_f32_16x16x32_bf16 v[120:123], v[140:143], v[188:191], v[120:123]
  v_mfma_f32_16x16x32_bf16 v[64:67], v[128:131], v[192:195], v[64:67]
  v_mfma_f32_16x16x32_bf16 v[84:87], v[132:135], v[192:195], v[84:87]
  v_mfma_f32_16x16x32_bf16 v[104:107], v[136:139], v[192:195], v[104:107]
  v_mfma_f32_16x16x32_bf16 v[124:127], v[140:143], v[192:195], v[124:127]
  s_barrier
  s_waitcnt lgkmcnt(6)
  v_mfma_f32_16x16x32_bf16 v[48:51], v[144:147], v[196:199], v[48:51]
  ds_read_b128 v[128:131], v17 offset:0
  v_mfma_f32_16x16x32_bf16 v[68:71], v[148:151], v[196:199], v[68:71]
  ds_read_b128 v[132:135], v17 offset:2048
  v_mfma_f32_16x16x32_bf16 v[88:91], v[152:155], v[196:199], v[88:91]
  ds_read_b128 v[136:139], v17 offset:4096
  v_mfma_f32_16x16x32_bf16 v[108:111], v[156:159], v[196:199], v[108:111]
  ds_read_b128 v[140:143], v17 offset:6144
  v_mfma_f32_16x16x32_bf16 v[52:55], v[144:147], v[200:203], v[52:55]
  ds_read_b64_tr_b16 v[176:177], v19 offset:0
  v_mfma_f32_16x16x32_bf16 v[72:75], v[148:151], v[200:203], v[72:75]
  ds_read_b64_tr_b16 v[178:179], v19 offset:1280
  v_mfma_f32_16x16x32_bf16 v[92:95], v[152:155], v[200:203], v[92:95]
  ds_read_b64_tr_b16 v[180:181], v20 offset:0
  v_mfma_f32_16x16x32_bf16 v[112:115], v[156:159], v[200:203], v[112:115]
  ds_read_b64_tr_b16 v[182:183], v20 offset:1280
  s_waitcnt lgkmcnt(8)
  v_mfma_f32_16x16x32_bf16 v[56:59], v[144:147], v[204:207], v[56:59]
  ds_read_b64_tr_b16 v[184:185], v21 offset:0
  v_mfma_f32_16x16x32_bf16 v[76:79], v[148:151], v[204:207], v[76:79]
  ds_read_b64_tr_b16 v[186:187], v21 offset:1280
  v_mfma_f32_16x16x32_bf16 v[96:99], v[152:155], v[204:207], v[96:99]
  ds_read_b64_tr_b16 v[188:189], v22 offset:0
  v_mfma_f32_16x16x32_bf16 v[116:119], v[156:159], v[204:207], v[116:119]
  ds_read_b64_tr_b16 v[190:191], v22 offset:1280
  v_mfma_f32_16x16x32_bf16 v[60:63], v[144:147], v[208:211], v[60:63]
  ds_read_b64_tr_b16 v[192:193], v23 offset:0
  v_mfma_f32_16x16x32_bf16 v[80:83], v[148:151], v[208:211], v[80:83]
  ds_read_b64_tr_b16 v[194:195], v23 offset:1280
  v_mfma_f32_16x16x32_bf16 v[100:103], v[152:155], v[208:211], v[100:103]
  v_mfma_f32_16x16x32_bf16 v[120:123], v[156:159], v[208:211], v[120:123]
  v_mfma_f32_16x16x32_bf16 v[64:67], v[144:147], v[212:215], v[64:67]
  v_mfma_f32_16x16x32_bf16 v[84:87], v[148:151], v[212:215], v[84:87]
  v_mfma_f32_16x16x32_bf16 v[104:107], v[152:155], v[212:215], v[104:107]
  v_mfma_f32_16x16x32_bf16 v[124:127], v[156:159], v[212:215], v[124:127]
  s_waitcnt lgkmcnt(6)
  v_mfma_f32_16x16x32_bf16 v[48:51], v[128:131], v[176:179], v[48:51]
  ds_read_b128 v[144:147], v18 offset:0
  v_mfma_f32_16x16x32_bf16 v[68:71], v[132:135], v[176:179], v[68:71]
  ds_read_b128 v[148:151], v18 offset:2048
  v_mfma_f32_16x16x32_bf16 v[88:91], v[136:139], v[176:179], v[88:91]
  ds_read_b128 v[152:155], v18 offset:4096
  v_mfma_f32_16x16x32_bf16 v[108:111], v[140:143], v[176:179], v[108:111]
  ds_read_b128 v[156:159], v18 offset:6144
  v_mfma_f32_16x16x32_bf16 v[52:55], v[128:131], v[180:183], v[52:55]
  ds_read_b64_tr_b16 v[196:197], v19 offset:10240
  v_mfma_f32_16x16x32_bf16 v[72:75], v[132:135], v[180:183], v[72:75]
  ds_read_b64_tr_b16 v[198:199], v19 offset:11520
  v_mfma_f32_16x16x32_bf16 v[92:95], v[136:139], v[180:183], v[92:95]
  ds_read_b64_tr_b16 v[200:201], v20 offset:10240
  v_mfma_f32_16x16x32_bf16 v[112:115], v[140:143], v[180:183], v[112:115]
  ds_read_b64_tr_b16 v[202:203], v20 offset:11520
  s_waitcnt lgkmcnt(8)
  v_mfma_f32_16x16x32_bf16 v[56:59], v[128:131], v[184:187], v[56:59]
  ds_read_b64_tr_b16 v[204:205], v21 offset:10240
  v_mfma_f32_16x16x32_bf16 v[76:79], v[132:135], v[184:187], v[76:79]
  ds_read_b64_tr_b16 v[206:207], v21 offset:11520
  v_mfma_f32_16x16x32_bf16 v[96:99], v[136:139], v[184:187], v[96:99]
  ds_read_b64_tr_b16 v[208:209], v22 offset:10240
  v_mfma_f32_16x16x32_bf16 v[116:119], v[140:143], v[184:187], v[116:119]
  ds_read_b64_tr_b16 v[210:211], v22 offset:11520
  v_mfma_f32_16x16x32_bf16 v[60:63], v[128:131], v[188:191], v[60:63]
  ds_read_b64_tr_b16 v[212:213], v23 offset:10240
  v_mfma_f32_16x16x32_bf16 v[80:83], v[132:135], v[188:191], v[80:83]
  ds_read_b64_tr_b16 v[214:215], v23 offset:11520
  v_mfma_f32_16x16x32_bf16 v[100:103], v[136:139], v[188:191], v[100:103]
  v_mfma_f32_16x16x32_bf16 v[120:123], v[140:143], v[188:191], v[120:123]
  v_mfma_f32_16x16x32_bf16 v[64:67], v[128:131], v[192:195], v[64:67]
  v_mfma_f32_16x16x32_bf16 v[84:87], v[132:135], v[192:195], v[84:87]
  v_mfma_f32_16x16x32_bf16 v[104:107], v[136:139], v[192:195], v[104:107]
  v_mfma_f32_16x16x32_bf16 v[124:127], v[140:143], v[192:195], v[124:127]
  s_barrier
  s_waitcnt lgkmcnt(0)
  ds_read_b128 v[128:131], v17 offset:36864
  ds_read_b128 v[132:135], v17 offset:38912
  ds_read_b128 v[136:139], v17 offset:40960
  ds_read_b128 v[140:143], v17 offset:43008
  ds_read_b128 v[160:163], v18 offset:36864
  ds_read_b128 v[164:167], v18 offset:38912
  ds_read_b128 v[168:171], v18 offset:40960
  ds_read_b128 v[172:175], v18 offset:43008
  v_mfma_f32_16x16x32_bf16 v[48:51], v[144:147], v[196:199], v[48:51]
  ds_read_b64_tr_b16 v[176:177], v19 offset:36864
  v_mfma_f32_16x16x32_bf16 v[68:71], v[148:151], v[196:199], v[68:71]
  ds_read_b64_tr_b16 v[178:179], v19 offset:38144
  v_mfma_f32_16x16x32_bf16 v[88:91], v[152:155], v[196:199], v[88:91]
  ds_read_b64_tr_b16 v[216:217], v19 offset:47104
  v_mfma_f32_16x16x32_bf16 v[108:111], v[156:159], v[196:199], v[108:111]
  ds_read_b64_tr_b16 v[218:219], v19 offset:48384
  v_mfma_f32_16x16x32_bf16 v[52:55], v[144:147], v[200:203], v[52:55]
  ds_read_b64_tr_b16 v[180:181], v20 offset:36864
  v_mfma_f32_16x16x32_bf16 v[72:75], v[148:151], v[200:203], v[72:75]
  ds_read_b64_tr_b16 v[182:183], v20 offset:38144
  v_mfma_f32_16x16x32_bf16 v[92:95], v[152:155], v[200:203], v[92:95]
  ds_read_b64_tr_b16 v[220:221], v20 offset:47104
  v_mfma_f32_16x16x32_bf16 v[112:115], v[156:159], v[200:203], v[112:115]
  ds_read_b64_tr_b16 v[222:223], v20 offset:48384
  v_mfma_f32_16x16x32_bf16 v[56:59], v[144:147], v[204:207], v[56:59]
  ds_read_b64_tr_b16 v[184:185], v21 offset:36864
  v_mfma_f32_16x16x32_bf16 v[76:79], v[148:151], v[204:207], v[76:79]
  ds_read_b64_tr_b16 v[186:187], v21 offset:38144
  v_mfma_f32_16x16x32_bf16 v[96:99], v[152:155], v[204:207], v[96:99]
  ds_read_b64_tr_b16 v[224:225], v21 offset:47104
  v_mfma_f32_16x16x32_bf16 v[116:119], v[156:159], v[204:207], v[116:119]
  ds_read_b64_tr_b16 v[226:227], v21 offset:48384
  v_mfma_f32_16x16x32_bf16 v[60:63], v[144:147], v[208:211], v[60:63]
  ds_read_b64_tr_b16 v[188:189], v22 offset:36864
  v_mfma_f32_16x16x32_bf16 v[80:83], v[148:151], v[208:211], v[80:83]
  ds_read_b64_tr_b16 v[190:191], v22 offset:38144
  v_mfma_f32_16x16x32_bf16 v[100:103], v[152:155], v[208:211], v[100:103]
  ds_read_b64_tr_b16 v[228:229], v22 offset:47104
  v_mfma_f32_16x16x32_bf16 v[120:123], v[156:159], v[208:211], v[120:123]
  ds_read_b64_tr_b16 v[230:231], v22 offset:48384
  v_mfma_f32_16x16x32_bf16 v[64:67], v[144:147], v[212:215], v[64:67]
  ds_read_b64_tr_b16 v[192:193], v23 offset:36864
  v_mfma_f32_16x16x32_bf16 v[84:87], v[148:151], v[212:215], v[84:87]
  ds_read_b64_tr_b16 v[194:195], v23 offset:38144
  v_mfma_f32_16x16x32_bf16 v[104:107], v[152:155], v[212:215], v[104:107]
  ds_read_b64_tr_b16 v[232:233], v23 offset:47104
  v_mfma_f32_16x16x32_bf16 v[124:127], v[156:159], v[212:215], v[124:127]
  ds_read_b64_tr_b16 v[234:235], v23 offset:48384
  s_waitcnt lgkmcnt(0)
  v_mfma_f32_16x16x32_bf16 v[48:51], v[128:131], v[176:179], v[48:51]
  v_mfma_f32_16x16x32_bf16 v[68:71], v[132:135], v[176:179], v[68:71]
  v_mfma_f32_16x16x32_bf16 v[88:91], v[136:139], v[176:179], v[88:91]
  v_mfma_f32_16x16x32_bf16 v[108:111], v[140:143], v[176:179], v[108:111]
  v_mfma_f32_16x16x32_bf16 v[48:51], v[160:163], v[216:219], v[48:51]
  v_mfma_f32_16x16x32_bf16 v[68:71], v[164:167], v[216:219], v[68:71]
  v_mfma_f32_16x16x32_bf16 v[88:91], v[168:171], v[216:219], v[88:91]
  v_mfma_f32_16x16x32_bf16 v[108:111], v[172:175], v[216:219], v[108:111]
  v_mfma_f32_16x16x32_bf16 v[52:55], v[128:131], v[180:183], v[52:55]
  v_mfma_f32_16x16x32_bf16 v[72:75], v[132:135], v[180:183], v[72:75]
  v_mfma_f32_16x16x32_bf16 v[92:95], v[136:139], v[180:183], v[92:95]
  s_nop 1
  v_pk_mul_f32 v[4:5], v[48:49], s[80:81]
  v_pk_mul_f32 v[6:7], v[50:51], s[80:81]
  v_exp_f32 v4, v4 clamp
  v_mfma_f32_16x16x32_bf16 v[112:115], v[140:143], v[180:183], v[112:115]
  v_exp_f32 v6, v6 clamp
  v_exp_f32 v5, v5 clamp
  v_exp_f32 v7, v7 clamp
  v_mfma_f32_16x16x32_bf16 v[52:55], v[160:163], v[220:223], v[52:55]
  v_pk_add_f32 v[4:5], v[4:5], s[82:83]
  v_pk_add_f32 v[6:7], v[6:7], s[82:83]
  v_mfma_f32_16x16x32_bf16 v[72:75], v[164:167], v[220:223], v[72:75]
  v_pk_add_f32 v[48:49], v[48:49], v[4:5]
  v_pk_add_f32 v[50:51], v[50:51], v[6:7]
  v_max_f32 v48, v48, v4
  v_mfma_f32_16x16x32_bf16 v[92:95], v[168:171], v[220:223], v[92:95]
  v_max_f32 v50, v50, v6
  v_max_f32 v49, v49, v5
  v_max_f32 v51, v51, v7
  v_mfma_f32_16x16x32_bf16 v[112:115], v[172:175], v[220:223], v[112:115]
  v_pk_mul_f32 v[4:5], v[68:69], s[80:81]
  v_pk_mul_f32 v[6:7], v[70:71], s[80:81]
  v_mfma_f32_16x16x32_bf16 v[56:59], v[128:131], v[184:187], v[56:59]
  v_mfma_f32_16x16x32_bf16 v[76:79], v[132:135], v[184:187], v[76:79]
  v_mfma_f32_16x16x32_bf16 v[96:99], v[136:139], v[184:187], v[96:99]
  v_exp_f32 v4, v4 clamp
  v_exp_f32 v6, v6 clamp
  v_exp_f32 v5, v5 clamp
  v_mfma_f32_16x16x32_bf16 v[116:119], v[140:143], v[184:187], v[116:119]
  v_exp_f32 v7, v7 clamp
  v_pk_add_f32 v[4:5], v[4:5], s[82:83]
  v_pk_add_f32 v[6:7], v[6:7], s[82:83]
  v_mfma_f32_16x16x32_bf16 v[56:59], v[160:163], v[224:227], v[56:59]
  v_pk_add_f32 v[68:69], v[68:69], v[4:5]
  v_pk_add_f32 v[70:71], v[70:71], v[6:7]
  v_mfma_f32_16x16x32_bf16 v[76:79], v[164:167], v[224:227], v[76:79]
  v_max_f32 v68, v68, v4
  v_max_f32 v70, v70, v6
  v_max_f32 v69, v69, v5
  v_mfma_f32_16x16x32_bf16 v[96:99], v[168:171], v[224:227], v[96:99]
  v_max_f32 v71, v71, v7
  v_pk_mul_f32 v[4:5], v[88:89], s[80:81]
  v_pk_mul_f32 v[6:7], v[90:91], s[80:81]
  v_mfma_f32_16x16x32_bf16 v[116:119], v[172:175], v[224:227], v[116:119]
  v_exp_f32 v4, v4 clamp
  v_exp_f32 v6, v6 clamp
  v_mfma_f32_16x16x32_bf16 v[60:63], v[128:131], v[188:191], v[60:63]
  v_mfma_f32_16x16x32_bf16 v[80:83], v[132:135], v[188:191], v[80:83]
  v_mfma_f32_16x16x32_bf16 v[100:103], v[136:139], v[188:191], v[100:103]
  v_exp_f32 v5, v5 clamp
  v_exp_f32 v7, v7 clamp
  v_pk_add_f32 v[4:5], v[4:5], s[82:83]
  v_mfma_f32_16x16x32_bf16 v[120:123], v[140:143], v[188:191], v[120:123]
  v_pk_add_f32 v[6:7], v[6:7], s[82:83]
  v_pk_add_f32 v[88:89], v[88:89], v[4:5]
  v_pk_add_f32 v[90:91], v[90:91], v[6:7]
  v_mfma_f32_16x16x32_bf16 v[60:63], v[160:163], v[228:231], v[60:63]
  v_max_f32 v88, v88, v4
  v_max_f32 v90, v90, v6
  v_mfma_f32_16x16x32_bf16 v[80:83], v[164:167], v[228:231], v[80:83]
  v_max_f32 v89, v89, v5
  v_max_f32 v91, v91, v7
  v_pk_mul_f32 v[4:5], v[108:109], s[80:81]
  v_mfma_f32_16x16x32_bf16 v[100:103], v[168:171], v[228:231], v[100:103]
  v_pk_mul_f32 v[6:7], v[110:111], s[80:81]
  v_exp_f32 v4, v4 clamp
  v_exp_f32 v6, v6 clamp
  v_mfma_f32_16x16x32_bf16 v[120:123], v[172:175], v[228:231], v[120:123]
  v_exp_f32 v5, v5 clamp
  v_exp_f32 v7, v7 clamp
  v_mfma_f32_16x16x32_bf16 v[64:67], v[128:131], v[192:195], v[64:67]
  v_mfma_f32_16x16x32_bf16 v[84:87], v[132:135], v[192:195], v[84:87]
  v_mfma_f32_16x16x32_bf16 v[104:107], v[136:139], v[192:195], v[104:107]
  v_pk_add_f32 v[4:5], v[4:5], s[82:83]
  v_pk_add_f32 v[6:7], v[6:7], s[82:83]
  v_pk_add_f32 v[108:109], v[108:109], v[4:5]
  v_mfma_f32_16x16x32_bf16 v[124:127], v[140:143], v[192:195], v[124:127]
  v_pk_add_f32 v[110:111], v[110:111], v[6:7]
  v_max_f32 v108, v108, v4
  v_max_f32 v110, v110, v6
  v_mfma_f32_16x16x32_bf16 v[64:67], v[160:163], v[232:235], v[64:67]
  v_max_f32 v109, v109, v5
  v_max_f32 v111, v111, v7
  v_mfma_f32_16x16x32_bf16 v[84:87], v[164:167], v[232:235], v[84:87]
  v_cvt_pk_bf16_f32 v236, v48, v49
  v_cvt_pk_bf16_f32 v237, v50, v51
  v_cvt_pk_bf16_f32 v238, v68, v69
  v_mfma_f32_16x16x32_bf16 v[104:107], v[168:171], v[232:235], v[104:107]
  v_cvt_pk_bf16_f32 v239, v70, v71
  ds_write_b128 v33, v[236:239] offset:0
  v_cvt_pk_bf16_f32 v240, v88, v89
  v_mfma_f32_16x16x32_bf16 v[124:127], v[172:175], v[232:235], v[124:127]
  v_cvt_pk_bf16_f32 v241, v90, v91
  v_cvt_pk_bf16_f32 v242, v108, v109
  v_cvt_pk_bf16_f32 v243, v110, v111
  ds_write_b128 v33, v[240:243] offset:1024
  v_pk_mul_f32 v[4:5], v[52:53], s[80:81]
  v_pk_mul_f32 v[6:7], v[54:55], s[80:81]
  v_exp_f32 v4, v4 clamp
  v_exp_f32 v6, v6 clamp
  v_exp_f32 v5, v5 clamp
  v_exp_f32 v7, v7 clamp
  v_pk_add_f32 v[4:5], v[4:5], s[82:83]
  v_pk_add_f32 v[6:7], v[6:7], s[82:83]
  v_pk_add_f32 v[52:53], v[52:53], v[4:5]
  v_pk_add_f32 v[54:55], v[54:55], v[6:7]
  v_max_f32 v52, v52, v4
  v_max_f32 v54, v54, v6
  v_max_f32 v53, v53, v5
  v_max_f32 v55, v55, v7
  v_pk_mul_f32 v[4:5], v[72:73], s[80:81]
  v_pk_mul_f32 v[6:7], v[74:75], s[80:81]
  v_exp_f32 v4, v4 clamp
  v_exp_f32 v6, v6 clamp
  v_exp_f32 v5, v5 clamp
  v_exp_f32 v7, v7 clamp
  v_pk_add_f32 v[4:5], v[4:5], s[82:83]
  v_pk_add_f32 v[6:7], v[6:7], s[82:83]
  v_pk_add_f32 v[72:73], v[72:73], v[4:5]
  v_pk_add_f32 v[74:75], v[74:75], v[6:7]
  v_max_f32 v72, v72, v4
  v_max_f32 v74, v74, v6
  v_max_f32 v73, v73, v5
  v_max_f32 v75, v75, v7
  v_pk_mul_f32 v[4:5], v[92:93], s[80:81]
  v_pk_mul_f32 v[6:7], v[94:95], s[80:81]
  v_exp_f32 v4, v4 clamp
  v_exp_f32 v6, v6 clamp
  v_exp_f32 v5, v5 clamp
  v_exp_f32 v7, v7 clamp
  v_pk_add_f32 v[4:5], v[4:5], s[82:83]
  v_pk_add_f32 v[6:7], v[6:7], s[82:83]
  v_pk_add_f32 v[92:93], v[92:93], v[4:5]
  v_pk_add_f32 v[94:95], v[94:95], v[6:7]
  v_max_f32 v92, v92, v4
  v_max_f32 v94, v94, v6
  v_max_f32 v93, v93, v5
  v_max_f32 v95, v95, v7
  v_pk_mul_f32 v[4:5], v[112:113], s[80:81]
  v_pk_mul_f32 v[6:7], v[114:115], s[80:81]
  v_exp_f32 v4, v4 clamp
  v_exp_f32 v6, v6 clamp
  v_exp_f32 v5, v5 clamp
  v_exp_f32 v7, v7 clamp
  v_pk_add_f32 v[4:5], v[4:5], s[82:83]
  v_pk_add_f32 v[6:7], v[6:7], s[82:83]
  v_pk_add_f32 v[112:113], v[112:113], v[4:5]
  v_pk_add_f32 v[114:115], v[114:115], v[6:7]
  v_max_f32 v112, v112, v4
  v_max_f32 v114, v114, v6
  v_max_f32 v113, v113, v5
  v_max_f32 v115, v115, v7
  v_cvt_pk_bf16_f32 v244, v52, v53
  v_cvt_pk_bf16_f32 v245, v54, v55
  v_cvt_pk_bf16_f32 v246, v72, v73
  v_cvt_pk_bf16_f32 v247, v74, v75
  ds_write_b128 v33, v[244:247] offset:4096
  v_cvt_pk_bf16_f32 v248, v92, v93
  v_cvt_pk_bf16_f32 v249, v94, v95
  v_cvt_pk_bf16_f32 v250, v112, v113
  v_cvt_pk_bf16_f32 v251, v114, v115
  ds_write_b128 v33, v[248:251] offset:5120
  v_cvt_pk_bf16_f32 v236, v60, v61
  v_cvt_pk_bf16_f32 v237, v62, v63
  v_cvt_pk_bf16_f32 v238, v80, v81
  v_cvt_pk_bf16_f32 v239, v82, v83
  ds_write_b128 v33, v[236:239] offset:12288
  v_cvt_pk_bf16_f32 v240, v100, v101
  v_cvt_pk_bf16_f32 v241, v102, v103
  v_cvt_pk_bf16_f32 v242, v120, v121
  v_cvt_pk_bf16_f32 v243, v122, v123
  ds_write_b128 v33, v[240:243] offset:13312
  v_cvt_pk_bf16_f32 v244, v64, v65
  v_cvt_pk_bf16_f32 v245, v66, v67
  v_cvt_pk_bf16_f32 v246, v84, v85
  v_cvt_pk_bf16_f32 v247, v86, v87
  ds_write_b128 v33, v[244:247] offset:16384
  v_cvt_pk_bf16_f32 v248, v104, v105
  v_cvt_pk_bf16_f32 v249, v106, v107
  v_cvt_pk_bf16_f32 v250, v124, v125
  v_cvt_pk_bf16_f32 v251, v126, v127
  ds_write_b128 v33, v[248:251] offset:17408
  s_mov_b32 exec_lo, 0x00ff00ff
  s_mov_b32 exec_hi, 0x00ff00ff
  v_pk_mul_f32 v[4:5], v[56:57], s[80:81]
  v_pk_mul_f32 v[6:7], v[58:59], s[80:81]
  v_exp_f32 v4, v4 clamp
  v_exp_f32 v6, v6 clamp
  v_exp_f32 v5, v5 clamp
  v_exp_f32 v7, v7 clamp
  v_pk_add_f32 v[4:5], v[4:5], s[82:83]
  v_pk_add_f32 v[6:7], v[6:7], s[82:83]
  v_pk_add_f32 v[56:57], v[56:57], v[4:5]
  v_pk_add_f32 v[58:59], v[58:59], v[6:7]
  v_max_f32 v56, v56, v4
  v_max_f32 v58, v58, v6
  v_max_f32 v57, v57, v5
  v_max_f32 v59, v59, v7
  v_pk_mul_f32 v[4:5], v[76:77], s[80:81]
  v_pk_mul_f32 v[6:7], v[78:79], s[80:81]
  v_exp_f32 v4, v4 clamp
  v_exp_f32 v6, v6 clamp
  v_exp_f32 v5, v5 clamp
  v_exp_f32 v7, v7 clamp
  v_pk_add_f32 v[4:5], v[4:5], s[82:83]
  v_pk_add_f32 v[6:7], v[6:7], s[82:83]
  v_pk_add_f32 v[76:77], v[76:77], v[4:5]
  v_pk_add_f32 v[78:79], v[78:79], v[6:7]
  v_max_f32 v76, v76, v4
  v_max_f32 v78, v78, v6
  v_max_f32 v77, v77, v5
  v_max_f32 v79, v79, v7
  v_pk_mul_f32 v[4:5], v[96:97], s[80:81]
  v_pk_mul_f32 v[6:7], v[98:99], s[80:81]
  v_exp_f32 v4, v4 clamp
  v_exp_f32 v6, v6 clamp
  v_exp_f32 v5, v5 clamp
  v_exp_f32 v7, v7 clamp
  v_pk_add_f32 v[4:5], v[4:5], s[82:83]
  v_pk_add_f32 v[6:7], v[6:7], s[82:83]
  v_pk_add_f32 v[96:97], v[96:97], v[4:5]
  v_pk_add_f32 v[98:99], v[98:99], v[6:7]
  v_max_f32 v96, v96, v4
  v_max_f32 v98, v98, v6
  v_max_f32 v97, v97, v5
  v_max_f32 v99, v99, v7
  v_pk_mul_f32 v[4:5], v[116:117], s[80:81]
  v_pk_mul_f32 v[6:7], v[118:119], s[80:81]
  v_exp_f32 v4, v4 clamp
  v_exp_f32 v6, v6 clamp
  v_exp_f32 v5, v5 clamp
  v_exp_f32 v7, v7 clamp
  v_pk_add_f32 v[4:5], v[4:5], s[82:83]
  v_pk_add_f32 v[6:7], v[6:7], s[82:83]
  v_pk_add_f32 v[116:117], v[116:117], v[4:5]
  v_pk_add_f32 v[118:119], v[118:119], v[6:7]
  v_max_f32 v116, v116, v4
  v_max_f32 v118, v118, v6
  v_max_f32 v117, v117, v5
  v_max_f32 v119, v119, v7
  s_mov_b64 exec, -1
  v_cvt_pk_bf16_f32 v236, v56, v57
  v_cvt_pk_bf16_f32 v237, v58, v59
  v_cvt_pk_bf16_f32 v238, v76, v77
  v_cvt_pk_bf16_f32 v239, v78, v79
  ds_write_b128 v33, v[236:239] offset:8192
  v_cvt_pk_bf16_f32 v240, v96, v97
  v_cvt_pk_bf16_f32 v241, v98, v99
  v_cvt_pk_bf16_f32 v242, v116, v117
  v_cvt_pk_bf16_f32 v243, v118, v119
  ds_write_b128 v33, v[240:243] offset:9216
  s_waitcnt lgkmcnt(0)
  s_mov_b64 exec, 1
  ds_add_u32 v44, v45 offset:0
  s_mov_b64 exec, -1
  s_mov_b32 s72, 0x100000
L_aw5:
  ds_read_b32 v4, v44 offset:0
  s_sub_u32 s72, s72, 1
  s_cbranch_scc1 L_ax5
  s_waitcnt lgkmcnt(0)
  v_cmp_gt_u32 vcc, 4, v4
  s_cbranch_vccnz L_aw5
L_ax5:
  ds_read_b128 v[48:51], v41 offset:0
  ds_read_b128 v[52:55], v41 offset:4096
  ds_read_b128 v[56:59], v41 offset:8192
  ds_read_b128 v[60:63], v41 offset:12288
  ds_read_b128 v[64:67], v41 offset:1024
  ds_read_b128 v[68:71], v41 offset:5120
  ds_read_b128 v[72:75], v41 offset:9216
  ds_read_b128 v[76:79], v41 offset:13312
  ds_read_b128 v[80:83], v41 offset:2048
  ds_read_b128 v[84:87], v41 offset:6144
  ds_read_b128 v[88:91], v41 offset:10240
  ds_read_b128 v[92:95], v41 offset:14336
  ds_read_b128 v[96:99], v41 offset:3072
  ds_read_b128 v[100:103], v41 offset:7168
  ds_read_b128 v[104:107], v41 offset:11264
  ds_read_b128 v[108:111], v41 offset:15360
  s_waitcnt lgkmcnt(12)
  v_mfma_f32_16x16x32_bf16 v[112:115], v[56:59], v[48:51], 0
  v_mfma_f32_16x16x32_bf16 v[116:119], v[56:59], v[52:55], 0
  v_mfma_f32_16x16x32_bf16 v[120:123], v[60:63], v[48:51], 0
  v_mfma_f32_16x16x32_bf16 v[124:127], v[60:63], v[52:55], 0
  v_mfma_f32_16x16x32_bf16 v[128:131], v[252:255], v[48:51], 0
  v_mfma_f32_16x16x32_bf16 v[132:135], v[252:255], v[52:55], 0
  s_waitcnt lgkmcnt(8)
  v_mfma_f32_16x16x32_bf16 v[112:115], v[72:75], v[64:67], v[112:115]
  v_mfma_f32_16x16x32_bf16 v[116:119], v[72:75], v[68:71], v[116:119]
  v_mfma_f32_16x16x32_bf16 v[120:123], v[76:79], v[64:67], v[120:123]
  v_mfma_f32_16x16x32_bf16 v[124:127], v[76:79], v[68:71], v[124:127]
  v_mfma_f32_16x16x32_bf16 v[128:131], v[252:255], v[64:67], v[128:131]
  v_mfma_f32_16x16x32_bf16 v[132:135], v[252:255], v[68:71], v[132:135]
  s_waitcnt lgkmcnt(4)
  v_mfma_f32_16x16x32_bf16 v[112:115], v[88:91], v[80:83], v[112:115]
  v_mfma_f32_16x16x32_bf16 v[116:119], v[88:91], v[84:87], v[116:119]
  v_mfma_f32_16x16x32_bf16 v[120:123], v[92:95], v[80:83], v[120:123]
  v_mfma_f32_16x16x32_bf16 v[124:127], v[92:95], v[84:87], v[124:127]
  v_mfma_f32_16x16x32_bf16 v[128:131], v[252:255], v[80:83], v[128:131]
  v_mfma_f32_16x16x32_bf16 v[132:135], v[252:255], v[84:87], v[132:135]
  s_waitcnt lgkmcnt(0)
  v_mfma_f32_16x16x32_bf16 v[112:115], v[104:107], v[96:99], v[112:115]
  v_mfma_f32_16x16x32_bf16 v[116:119], v[104:107], v[100:103], v[116:119]
  v_mfma_f32_16x16x32_bf16 v[120:123], v[108:111], v[96:99], v[120:123]
  v_mfma_f32_16x16x32_bf16 v[124:127], v[108:111], v[100:103], v[124:127]
  v_mfma_f32_16x16x32_bf16 v[128:131], v[252:255], v[96:99], v[128:131]
  v_mfma_f32_16x16x32_bf16 v[132:135], v[252:255], v[100:103], v[132:135]
  s_waitcnt lgkmcnt(0)
  s_mov_b64 exec, 1
  ds_add_u32 v44, v45 offset:4
  s_mov_b64 exec, -1
  ds_write2_b32 v34, v112, v113 offset0:0 offset1:20
  ds_write2_b32 v34, v114, v115 offset0:40 offset1:60
  ds_write2_b32 v35, v116, v117 offset0:0 offset1:20
  ds_write2_b32 v35, v118, v119 offset0:40 offset1:60
  ds_write2_b32 v36, v120, v121 offset0:0 offset1:20
  ds_write2_b32 v36, v122, v123 offset0:40 offset1:60
  ds_write2_b32 v37, v124, v125 offset0:0 offset1:20
  ds_write2_b32 v37, v126, v127 offset0:40 offset1:60
  ds_write_b32 v38, v128 offset:1600
  ds_write_b32 v39, v132 offset:1600
  s_waitcnt lgkmcnt(0)
  ds_read_b32 v48, v40 offset:0
  ds_read_b32 v49, v40 offset:256
  ds_read_b32 v50, v40 offset:512
  ds_read_b32 v51, v40 offset:768
  ds_read_b32 v52, v40 offset:1024
  ds_read_b32 v53, v40 offset:1280
  ds_read_b32 v54, v40 offset:1536
  s_waitcnt lgkmcnt(6)
  buffer_atomic_add_f32 v48, v32, s[40:43], s4 offen offset:0
  s_waitcnt lgkmcnt(5)
  buffer_atomic_add_f32 v49, v32, s[40:43], s4 offen offset:256
  s_waitcnt lgkmcnt(4)
  buffer_atomic_add_f32 v50, v32, s[40:43], s4 offen offset:512
  s_waitcnt lgkmcnt(3)
  buffer_atomic_add_f32 v51, v32, s[40:43], s4 offen offset:768
  s_waitcnt lgkmcnt(2)
  buffer_atomic_add_f32 v52, v32, s[40:43], s4 offen offset:1024
  s_waitcnt lgkmcnt(1)
  buffer_atomic_add_f32 v53, v32, s[40:43], s4 offen offset:1280
  s_mov_b32 exec_hi, 15
  s_waitcnt lgkmcnt(0)
  buffer_atomic_add_f32 v54, v32, s[40:43], s4 offen offset:1536
  s_mov_b64 exec, -1
L_MB:
  v_mul_f32 v6, 0x3acccccd, v46
  v_add_f32 v46, 4.0, v46
  v_cmp_eq_f32 vcc, 0, v47
  v_mov_b32 v4, 0x3f00
  v_mul_f32 v7, v6, v47
  s_lshl_b32 s74, s71, 2
  s_lshr_b32 s74, 0x43021, s74
  s_and_b32 s74, s74, 15
  s_lshl_b32 s74, s74, 2
  s_add_u32 s74, s74, s61
  s_mul_i32 s74, s74, 5120
  v_add_u32 v5, s74, v16
  s_add_u32 s71, s71, 1
  v_mul_f32 v12, 0x41800000, v6
  v_cos_f32 v8, v12
  v_sin_f32 v9, v12
  v_fmamk_f32 v12, v6, 0x0, v7
  v_cos_f32 v18, v12
  v_sin_f32 v19, v12
  v_fmamk_f32 v13, v6, 0x3f800000, v7
  v_cos_f32 v20, v13
  v_sin_f32 v21, v13
  v_fmamk_f32 v12, v6, 0x40000000, v7
  v_cos_f32 v22, v12
  v_sin_f32 v23, v12
  v_fmamk_f32 v13, v6, 0x40400000, v7
  v_cos_f32 v24, v13
  v_sin_f32 v25, v13
  v_cvt_pk_bf16_f32 v26, v18, v19
  v_cvt_pk_bf16_f32 v27, v20, v21
  v_cvt_pk_bf16_f32 v28, v22, v23
  v_cvt_pk_bf16_f32 v29, v24, v25
  v_cndmask_b32 v26, v26, v4, vcc
  ds_write_b128 v5, v[26:29] offset:0
  v_pk_mul_f32 v[10:11], v[18:19], v[8:9] op_sel:[0,0] op_sel_hi:[1,0]
  v_pk_mul_f32 v[12:13], v[20:21], v[8:9] op_sel:[0,0] op_sel_hi:[1,0]
  v_pk_fma_f32 v[18:19], v[18:19], v[8:9], v[10:11] op_sel:[1,1,0] op_sel_hi:[0,1,1] neg_lo:[0,1,0]
  v_pk_fma_f32 v[20:21], v[20:21], v[8:9], v[12:13] op_sel:[1,1,0] op_sel_hi:[0,1,1] neg_lo:[0,1,0]
  v_pk_mul_f32 v[10:11], v[22:23], v[8:9] op_sel:[0,0] op_sel_hi:[1,0]
  v_pk_mul_f32 v[12:13], v[24:25], v[8:9] op_sel:[0,0] op_sel_hi:[1,0]
  v_pk_fma_f32 v[22:23], v[22:23], v[8:9], v[10:11] op_sel:[1,1,0] op_sel_hi:[0,1,1] neg_lo:[0,1,0]
  v_pk_fma_f32 v[24:25], v[24:25], v[8:9], v[12:13] op_sel:[1,1,0] op_sel_hi:[0,1,1] neg_lo:[0,1,0]
  v_cvt_pk_bf16_f32 v26, v18, v19
  v_cvt_pk_bf16_f32 v27, v20, v21
  v_cvt_pk_bf16_f32 v28, v22, v23
  v_cvt_pk_bf16_f32 v29, v24, v25
  ds_write_b128 v5, v[26:29] offset:1024
  v_pk_mul_f32 v[10:11], v[18:19], v[8:9] op_sel:[0,0] op_sel_hi:[1,0]
  v_pk_mul_f32 v[12:13], v[20:21], v[8:9] op_sel:[0,0] op_sel_hi:[1,0]
  v_pk_fma_f32 v[18:19], v[18:19], v[8:9], v[10:11] op_sel:[1,1,0] op_sel_hi:[0,1,1] neg_lo:[0,1,0]
  v_pk_fma_f32 v[20:21], v[20:21], v[8:9], v[12:13] op_sel:[1,1,0] op_sel_hi:[0,1,1] neg_lo:[0,1,0]
  v_pk_mul_f32 v[10:11], v[22:23], v[8:9] op_sel:[0,0] op_sel_hi:[1,0]
  v_pk_mul_f32 v[12:13], v[24:25], v[8:9] op_sel:[0,0] op_sel_hi:[1,0]
  v_pk_fma_f32 v[22:23], v[22:23], v[8:9], v[10:11] op_sel:[1,1,0] op_sel_hi:[0,1,1] neg_lo:[0,1,0]
  v_pk_fma_f32 v[24:25], v[24:25], v[8:9], v[12:13] op_sel:[1,1,0] op_sel_hi:[0,1,1] neg_lo:[0,1,0]
  v_cvt_pk_bf16_f32 v26, v18, v19
  v_cvt_pk_bf16_f32 v27, v20, v21
  v_cvt_pk_bf16_f32 v28, v22, v23
  v_cvt_pk_bf16_f32 v29, v24, v25
  ds_write_b128 v5, v[26:29] offset:2048
  v_pk_mul_f32 v[10:11], v[18:19], v[8:9] op_sel:[0,0] op_sel_hi:[1,0]
  v_pk_mul_f32 v[12:13], v[20:21], v[8:9] op_sel:[0,0] op_sel_hi:[1,0]
  v_pk_fma_f32 v[18:19], v[18:19], v[8:9], v[10:11] op_sel:[1,1,0] op_sel_hi:[0,1,1] neg_lo:[0,1,0]
  v_pk_fma_f32 v[20:21], v[20:21], v[8:9], v[12:13] op_sel:[1,1,0] op_sel_hi:[0,1,1] neg_lo:[0,1,0]
  v_pk_mul_f32 v[10:11], v[22:23], v[8:9] op_sel:[0,0] op_sel_hi:[1,0]
  v_pk_mul_f32 v[12:13], v[24:25], v[8:9] op_sel:[0,0] op_sel_hi:[1,0]
  v_pk_fma_f32 v[22:23], v[22:23], v[8:9], v[10:11] op_sel:[1,1,0] op_sel_hi:[0,1,1] neg_lo:[0,1,0]
  v_pk_fma_f32 v[24:25], v[24:25], v[8:9], v[12:13] op_sel:[1,1,0] op_sel_hi:[0,1,1] neg_lo:[0,1,0]
  v_cvt_pk_bf16_f32 v26, v18, v19
  v_cvt_pk_bf16_f32 v27, v20, v21
  v_cvt_pk_bf16_f32 v28, v22, v23
  v_cvt_pk_bf16_f32 v29, v24, v25
  ds_write_b128 v5, v[26:29] offset:3072
  v_pk_mul_f32 v[10:11], v[18:19], v[8:9] op_sel:[0,0] op_sel_hi:[1,0]
  v_pk_mul_f32 v[12:13], v[20:21], v[8:9] op_sel:[0,0] op_sel_hi:[1,0]
  v_pk_fma_f32 v[18:19], v[18:19], v[8:9], v[10:11] op_sel:[1,1,0] op_sel_hi:[0,1,1] neg_lo:[0,1,0]
  v_pk_fma_f32 v[20:21], v[20:21], v[8:9], v[12:13] op_sel:[1,1,0] op_sel_hi:[0,1,1] neg_lo:[0,1,0]
  v_pk_mul_f32 v[10:11], v[22:23], v[8:9] op_sel:[0,0] op_sel_hi:[1,0]
  v_pk_mul_f32 v[12:13], v[24:25], v[8:9] op_sel:[0,0] op_sel_hi:[1,0]
  v_pk_fma_f32 v[22:23], v[22:23], v[8:9], v[10:11] op_sel:[1,1,0] op_sel_hi:[0,1,1] neg_lo:[0,1,0]
  v_pk_fma_f32 v[24:25], v[24:25], v[8:9], v[12:13] op_sel:[1,1,0] op_sel_hi:[0,1,1] neg_lo:[0,1,0]
  v_cvt_pk_bf16_f32 v26, v18, v19
  v_cvt_pk_bf16_f32 v27, v20, v21
  v_cvt_pk_bf16_f32 v28, v22, v23
  v_cvt_pk_bf16_f32 v29, v24, v25
  ds_write_b128 v5, v[26:29] offset:4096
  s_waitcnt vmcnt(0)
  v_mov_b32 v4, 1
  s_mov_b64 exec, 1
  buffer_store_dword v4, off, s[40:43], s7 sc1
  s_mov_b64 exec, -1
  s_cmp_lg_u32 s63, 0
  s_cbranch_scc1 L_MB2
  s_waitcnt lgkmcnt(0)
  s_mov_b64 exec, 1
  ds_add_u32 v44, v45 offset:4
  s_mov_b64 exec, -1
L_MB2:
  s_cmp_ge_u32 s71, 2
  s_cbranch_scc1 L_ifd6
L_if6:
  v_mul_f32 v6, 0x3acccccd, v46
  v_add_f32 v46, 4.0, v46
  v_cmp_eq_f32 vcc, 0, v47
  v_mov_b32 v4, 0x3f00
  v_mul_f32 v7, v6, v47
  s_lshl_b32 s74, s71, 2
  s_lshr_b32 s74, 0x43021, s74
  s_and_b32 s74, s74, 15
  s_lshl_b32 s74, s74, 2
  s_add_u32 s74, s74, s61
  s_mul_i32 s74, s74, 5120
  v_add_u32 v5, s74, v16
  s_add_u32 s71, s71, 1
  v_mul_f32 v12, 0x41800000, v6
  v_cos_f32 v8, v12
  v_sin_f32 v9, v12
  v_fmamk_f32 v12, v6, 0x0, v7
  v_cos_f32 v18, v12
  v_sin_f32 v19, v12
  v_fmamk_f32 v13, v6, 0x3f800000, v7
  v_cos_f32 v20, v13
  v_sin_f32 v21, v13
  v_fmamk_f32 v12, v6, 0x40000000, v7
  v_cos_f32 v22, v12
  v_sin_f32 v23, v12
  v_fmamk_f32 v13, v6, 0x40400000, v7
  v_cos_f32 v24, v13
  v_sin_f32 v25, v13
  v_cvt_pk_bf16_f32 v26, v18, v19
  v_cvt_pk_bf16_f32 v27, v20, v21
  v_cvt_pk_bf16_f32 v28, v22, v23
  v_cvt_pk_bf16_f32 v29, v24, v25
  v_cndmask_b32 v26, v26, v4, vcc
  ds_write_b128 v5, v[26:29] offset:0
  v_pk_mul_f32 v[10:11], v[18:19], v[8:9] op_sel:[0,0] op_sel_hi:[1,0]
  v_pk_mul_f32 v[12:13], v[20:21], v[8:9] op_sel:[0,0] op_sel_hi:[1,0]
  v_pk_fma_f32 v[18:19], v[18:19], v[8:9], v[10:11] op_sel:[1,1,0] op_sel_hi:[0,1,1] neg_lo:[0,1,0]
  v_pk_fma_f32 v[20:21], v[20:21], v[8:9], v[12:13] op_sel:[1,1,0] op_sel_hi:[0,1,1] neg_lo:[0,1,0]
  v_pk_mul_f32 v[10:11], v[22:23], v[8:9] op_sel:[0,0] op_sel_hi:[1,0]
  v_pk_mul_f32 v[12:13], v[24:25], v[8:9] op_sel:[0,0] op_sel_hi:[1,0]
  v_pk_fma_f32 v[22:23], v[22:23], v[8:9], v[10:11] op_sel:[1,1,0] op_sel_hi:[0,1,1] neg_lo:[0,1,0]
  v_pk_fma_f32 v[24:25], v[24:25], v[8:9], v[12:13] op_sel:[1,1,0] op_sel_hi:[0,1,1] neg_lo:[0,1,0]
  v_cvt_pk_bf16_f32 v26, v18, v19
  v_cvt_pk_bf16_f32 v27, v20, v21
  v_cvt_pk_bf16_f32 v28, v22, v23
  v_cvt_pk_bf16_f32 v29, v24, v25
  ds_write_b128 v5, v[26:29] offset:1024
  v_pk_mul_f32 v[10:11], v[18:19], v[8:9] op_sel:[0,0] op_sel_hi:[1,0]
  v_pk_mul_f32 v[12:13], v[20:21], v[8:9] op_sel:[0,0] op_sel_hi:[1,0]
  v_pk_fma_f32 v[18:19], v[18:19], v[8:9], v[10:11] op_sel:[1,1,0] op_sel_hi:[0,1,1] neg_lo:[0,1,0]
  v_pk_fma_f32 v[20:21], v[20:21], v[8:9], v[12:13] op_sel:[1,1,0] op_sel_hi:[0,1,1] neg_lo:[0,1,0]
  v_pk_mul_f32 v[10:11], v[22:23], v[8:9] op_sel:[0,0] op_sel_hi:[1,0]
  v_pk_mul_f32 v[12:13], v[24:25], v[8:9] op_sel:[0,0] op_sel_hi:[1,0]
  v_pk_fma_f32 v[22:23], v[22:23], v[8:9], v[10:11] op_sel:[1,1,0] op_sel_hi:[0,1,1] neg_lo:[0,1,0]
  v_pk_fma_f32 v[24:25], v[24:25], v[8:9], v[12:13] op_sel:[1,1,0] op_sel_hi:[0,1,1] neg_lo:[0,1,0]
  v_cvt_pk_bf16_f32 v26, v18, v19
  v_cvt_pk_bf16_f32 v27, v20, v21
  v_cvt_pk_bf16_f32 v28, v22, v23
  v_cvt_pk_bf16_f32 v29, v24, v25
  ds_write_b128 v5, v[26:29] offset:2048
  v_pk_mul_f32 v[10:11], v[18:19], v[8:9] op_sel:[0,0] op_sel_hi:[1,0]
  v_pk_mul_f32 v[12:13], v[20:21], v[8:9] op_sel:[0,0] op_sel_hi:[1,0]
  v_pk_fma_f32 v[18:19], v[18:19], v[8:9], v[10:11] op_sel:[1,1,0] op_sel_hi:[0,1,1] neg_lo:[0,1,0]
  v_pk_fma_f32 v[20:21], v[20:21], v[8:9], v[12:13] op_sel:[1,1,0] op_sel_hi:[0,1,1] neg_lo:[0,1,0]
  v_pk_mul_f32 v[10:11], v[22:23], v[8:9] op_sel:[0,0] op_sel_hi:[1,0]
  v_pk_mul_f32 v[12:13], v[24:25], v[8:9] op_sel:[0,0] op_sel_hi:[1,0]
  v_pk_fma_f32 v[22:23], v[22:23], v[8:9], v[10:11] op_sel:[1,1,0] op_sel_hi:[0,1,1] neg_lo:[0,1,0]
  v_pk_fma_f32 v[24:25], v[24:25], v[8:9], v[12:13] op_sel:[1,1,0] op_sel_hi:[0,1,1] neg_lo:[0,1,0]
  v_cvt_pk_bf16_f32 v26, v18, v19
  v_cvt_pk_bf16_f32 v27, v20, v21
  v_cvt_pk_bf16_f32 v28, v22, v23
  v_cvt_pk_bf16_f32 v29, v24, v25
  ds_write_b128 v5, v[26:29] offset:3072
  v_pk_mul_f32 v[10:11], v[18:19], v[8:9] op_sel:[0,0] op_sel_hi:[1,0]
  v_pk_mul_f32 v[12:13], v[20:21], v[8:9] op_sel:[0,0] op_sel_hi:[1,0]
  v_pk_fma_f32 v[18:19], v[18:19], v[8:9], v[10:11] op_sel:[1,1,0] op_sel_hi:[0,1,1] neg_lo:[0,1,0]
  v_pk_fma_f32 v[20:21], v[20:21], v[8:9], v[12:13] op_sel:[1,1,0] op_sel_hi:[0,1,1] neg_lo:[0,1,0]
  v_pk_mul_f32 v[10:11], v[22:23], v[8:9] op_sel:[0,0] op_sel_hi:[1,0]
  v_pk_mul_f32 v[12:13], v[24:25], v[8:9] op_sel:[0,0] op_sel_hi:[1,0]
  v_pk_fma_f32 v[22:23], v[22:23], v[8:9], v[10:11] op_sel:[1,1,0] op_sel_hi:[0,1,1] neg_lo:[0,1,0]
  v_pk_fma_f32 v[24:25], v[24:25], v[8:9], v[12:13] op_sel:[1,1,0] op_sel_hi:[0,1,1] neg_lo:[0,1,0]
  v_cvt_pk_bf16_f32 v26, v18, v19
  v_cvt_pk_bf16_f32 v27, v20, v21
  v_cvt_pk_bf16_f32 v28, v22, v23
  v_cvt_pk_bf16_f32 v29, v24, v25
  ds_write_b128 v5, v[26:29] offset:4096
  s_cmp_lt_u32 s71, 2
  s_cbranch_scc1 L_if6
L_ifd6:
  s_mov_b32 s72, 0x10000
  s_mov_b64 s[0:1], -1
L_pl_pm:
  s_mov_b64 exec, s[0:1]
  buffer_load_dword v15, v31, s[40:43], 0 offen sc1
  s_mov_b64 exec, -1
  s_waitcnt vmcnt(0)
  v_cmp_eq_u32 vcc, 0, v15
  s_cbranch_vccz L_pd_pm
  s_mov_b64 s[0:1], vcc
  s_sub_u32 s72, s72, 1
  s_cmp_lg_u32 s72, 0
  s_cbranch_scc1 L_pl_pm
L_pd_pm:
  s_mov_b32 s72, 0x100000
L_aw7:
  s_sleep 2
  ds_read_b32 v4, v44 offset:8
  s_sub_u32 s72, s72, 1
  s_cbranch_scc1 L_ax7
  s_waitcnt lgkmcnt(0)
  v_cmp_gt_u32 vcc, 4, v4
  s_cbranch_vccnz L_aw7
L_ax7:
  s_add_u32 s79, s33, 0
  s_add_u32 s78, s33, 4096
  buffer_load_dwordx4 v[156:159], v16, s[40:43], s79 offen offset:0 sc1
  buffer_load_dwordx4 v[160:163], v16, s[40:43], s79 offen offset:1024 sc1
  buffer_load_dwordx4 v[164:167], v16, s[40:43], s79 offen offset:2048 sc1
  buffer_load_dwordx4 v[168:171], v16, s[40:43], s79 offen offset:3072 sc1
  buffer_load_dwordx4 v[172:175], v16, s[40:43], s78 offen offset:0 sc1
  s_add_u32 s79, s33, 5120
  s_add_u32 s78, s33, 9216
  buffer_load_dwordx4 v[176:179], v16, s[40:43], s79 offen offset:0 sc1
  buffer_load_dwordx4 v[180:183], v16, s[40:43], s79 offen offset:1024 sc1
  buffer_load_dwordx4 v[184:187], v16, s[40:43], s79 offen offset:2048 sc1
  buffer_load_dwordx4 v[188:191], v16, s[40:43], s79 offen offset:3072 sc1
  buffer_load_dwordx4 v[192:195], v16, s[40:43], s78 offen offset:0 sc1
  s_add_u32 s79, s33, 10240
  s_add_u32 s78, s33, 14336
  buffer_load_dwordx4 v[196:199], v16, s[40:43], s79 offen offset:0 sc1
  buffer_load_dwordx4 v[200:203], v16, s[40:43], s79 offen offset:1024 sc1
  buffer_load_dwordx4 v[204:207], v16, s[40:43], s79 offen offset:2048 sc1
  buffer_load_dwordx4 v[208:211], v16, s[40:43], s79 offen offset:3072 sc1
  buffer_load_dwordx4 v[212:215], v16, s[40:43], s78 offen offset:0 sc1
  s_add_u32 s79, s33, 15360
  s_add_u32 s78, s33, 19456
  buffer_load_dwordx4 v[216:219], v16, s[40:43], s79 offen offset:0 sc1
  buffer_load_dwordx4 v[220:223], v16, s[40:43], s79 offen offset:1024 sc1
  buffer_load_dwordx4 v[224:227], v16, s[40:43], s79 offen offset:2048 sc1
  buffer_load_dwordx4 v[228:231], v16, s[40:43], s79 offen offset:3072 sc1
  buffer_load_dwordx4 v[232:235], v16, s[40:43], s78 offen offset:0 sc1
  s_add_u32 s79, s33, 20480
  s_add_u32 s78, s33, 24576
  buffer_load_dwordx4 v[236:239], v16, s[40:43], s79 offen offset:0 sc1
  buffer_load_dwordx4 v[240:243], v16, s[40:43], s79 offen offset:1024 sc1
  buffer_load_dwordx4 v[244:247], v16, s[40:43], s79 offen offset:2048 sc1
  buffer_load_dwordx4 v[248:251], v16, s[40:43], s79 offen offset:3072 sc1
  buffer_load_dwordx4 v[252:255], v16, s[40:43], s78 offen offset:0 sc1
  s_mov_b32 s72, 0x100000
L_aw8:
  s_sleep 2
  ds_read_b32 v4, v44 offset:20
  s_sub_u32 s72, s72, 1
  s_cbranch_scc1 L_ax8
  s_waitcnt lgkmcnt(0)
  v_cmp_gt_u32 vcc, 4, v4
  s_cbranch_vccnz L_aw8
L_ax8:
  s_cmp_ge_u32 s71, 5
  s_cbranch_scc1 L_ifd9
L_if9:
  v_mul_f32 v6, 0x3acccccd, v46
  v_add_f32 v46, 4.0, v46
  v_cmp_eq_f32 vcc, 0, v47
  v_mov_b32 v4, 0x3f00
  v_mul_f32 v7, v6, v47
  s_lshl_b32 s74, s71, 2
  s_lshr_b32 s74, 0x43021, s74
  s_and_b32 s74, s74, 15
  s_lshl_b32 s74, s74, 2
  s_add_u32 s74, s74, s61
  s_mul_i32 s74, s74, 5120
  v_add_u32 v5, s74, v16
  s_add_u32 s71, s71, 1
  v_mul_f32 v12, 0x41800000, v6
  v_cos_f32 v8, v12
  v_sin_f32 v9, v12
  v_fmamk_f32 v12, v6, 0x0, v7
  v_cos_f32 v18, v12
  v_sin_f32 v19, v12
  v_fmamk_f32 v13, v6, 0x3f800000, v7
  v_cos_f32 v20, v13
  v_sin_f32 v21, v13
  v_fmamk_f32 v12, v6, 0x40000000, v7
  v_cos_f32 v22, v12
  v_sin_f32 v23, v12
  v_fmamk_f32 v13, v6, 0x40400000, v7
  v_cos_f32 v24, v13
  v_sin_f32 v25, v13
  v_cvt_pk_bf16_f32 v26, v18, v19
  v_cvt_pk_bf16_f32 v27, v20, v21
  v_cvt_pk_bf16_f32 v28, v22, v23
  v_cvt_pk_bf16_f32 v29, v24, v25
  v_cndmask_b32 v26, v26, v4, vcc
  ds_write_b128 v5, v[26:29] offset:0
  v_pk_mul_f32 v[10:11], v[18:19], v[8:9] op_sel:[0,0] op_sel_hi:[1,0]
  v_pk_mul_f32 v[12:13], v[20:21], v[8:9] op_sel:[0,0] op_sel_hi:[1,0]
  v_pk_fma_f32 v[18:19], v[18:19], v[8:9], v[10:11] op_sel:[1,1,0] op_sel_hi:[0,1,1] neg_lo:[0,1,0]
  v_pk_fma_f32 v[20:21], v[20:21], v[8:9], v[12:13] op_sel:[1,1,0] op_sel_hi:[0,1,1] neg_lo:[0,1,0]
  v_pk_mul_f32 v[10:11], v[22:23], v[8:9] op_sel:[0,0] op_sel_hi:[1,0]
  v_pk_mul_f32 v[12:13], v[24:25], v[8:9] op_sel:[0,0] op_sel_hi:[1,0]
  v_pk_fma_f32 v[22:23], v[22:23], v[8:9], v[10:11] op_sel:[1,1,0] op_sel_hi:[0,1,1] neg_lo:[0,1,0]
  v_pk_fma_f32 v[24:25], v[24:25], v[8:9], v[12:13] op_sel:[1,1,0] op_sel_hi:[0,1,1] neg_lo:[0,1,0]
  v_cvt_pk_bf16_f32 v26, v18, v19
  v_cvt_pk_bf16_f32 v27, v20, v21
  v_cvt_pk_bf16_f32 v28, v22, v23
  v_cvt_pk_bf16_f32 v29, v24, v25
  ds_write_b128 v5, v[26:29] offset:1024
  v_pk_mul_f32 v[10:11], v[18:19], v[8:9] op_sel:[0,0] op_sel_hi:[1,0]
  v_pk_mul_f32 v[12:13], v[20:21], v[8:9] op_sel:[0,0] op_sel_hi:[1,0]
  v_pk_fma_f32 v[18:19], v[18:19], v[8:9], v[10:11] op_sel:[1,1,0] op_sel_hi:[0,1,1] neg_lo:[0,1,0]
  v_pk_fma_f32 v[20:21], v[20:21], v[8:9], v[12:13] op_sel:[1,1,0] op_sel_hi:[0,1,1] neg_lo:[0,1,0]
  v_pk_mul_f32 v[10:11], v[22:23], v[8:9] op_sel:[0,0] op_sel_hi:[1,0]
  v_pk_mul_f32 v[12:13], v[24:25], v[8:9] op_sel:[0,0] op_sel_hi:[1,0]
  v_pk_fma_f32 v[22:23], v[22:23], v[8:9], v[10:11] op_sel:[1,1,0] op_sel_hi:[0,1,1] neg_lo:[0,1,0]
  v_pk_fma_f32 v[24:25], v[24:25], v[8:9], v[12:13] op_sel:[1,1,0] op_sel_hi:[0,1,1] neg_lo:[0,1,0]
  v_cvt_pk_bf16_f32 v26, v18, v19
  v_cvt_pk_bf16_f32 v27, v20, v21
  v_cvt_pk_bf16_f32 v28, v22, v23
  v_cvt_pk_bf16_f32 v29, v24, v25
  ds_write_b128 v5, v[26:29] offset:2048
  v_pk_mul_f32 v[10:11], v[18:19], v[8:9] op_sel:[0,0] op_sel_hi:[1,0]
  v_pk_mul_f32 v[12:13], v[20:21], v[8:9] op_sel:[0,0] op_sel_hi:[1,0]
  v_pk_fma_f32 v[18:19], v[18:19], v[8:9], v[10:11] op_sel:[1,1,0] op_sel_hi:[0,1,1] neg_lo:[0,1,0]
  v_pk_fma_f32 v[20:21], v[20:21], v[8:9], v[12:13] op_sel:[1,1,0] op_sel_hi:[0,1,1] neg_lo:[0,1,0]
  v_pk_mul_f32 v[10:11], v[22:23], v[8:9] op_sel:[0,0] op_sel_hi:[1,0]
  v_pk_mul_f32 v[12:13], v[24:25], v[8:9] op_sel:[0,0] op_sel_hi:[1,0]
  v_pk_fma_f32 v[22:23], v[22:23], v[8:9], v[10:11] op_sel:[1,1,0] op_sel_hi:[0,1,1] neg_lo:[0,1,0]
  v_pk_fma_f32 v[24:25], v[24:25], v[8:9], v[12:13] op_sel:[1,1,0] op_sel_hi:[0,1,1] neg_lo:[0,1,0]
  v_cvt_pk_bf16_f32 v26, v18, v19
  v_cvt_pk_bf16_f32 v27, v20, v21
  v_cvt_pk_bf16_f32 v28, v22, v23
  v_cvt_pk_bf16_f32 v29, v24, v25
  ds_write_b128 v5, v[26:29] offset:3072
  v_pk_mul_f32 v[10:11], v[18:19], v[8:9] op_sel:[0,0] op_sel_hi:[1,0]
  v_pk_mul_f32 v[12:13], v[20:21], v[8:9] op_sel:[0,0] op_sel_hi:[1,0]
  v_pk_fma_f32 v[18:19], v[18:19], v[8:9], v[10:11] op_sel:[1,1,0] op_sel_hi:[0,1,1] neg_lo:[0,1,0]
  v_pk_fma_f32 v[20:21], v[20:21], v[8:9], v[12:13] op_sel:[1,1,0] op_sel_hi:[0,1,1] neg_lo:[0,1,0]
  v_pk_mul_f32 v[10:11], v[22:23], v[8:9] op_sel:[0,0] op_sel_hi:[1,0]
  v_pk_mul_f32 v[12:13], v[24:25], v[8:9] op_sel:[0,0] op_sel_hi:[1,0]
  v_pk_fma_f32 v[22:23], v[22:23], v[8:9], v[10:11] op_sel:[1,1,0] op_sel_hi:[0,1,1] neg_lo:[0,1,0]
  v_pk_fma_f32 v[24:25], v[24:25], v[8:9], v[12:13] op_sel:[1,1,0] op_sel_hi:[0,1,1] neg_lo:[0,1,0]
  v_cvt_pk_bf16_f32 v26, v18, v19
  v_cvt_pk_bf16_f32 v27, v20, v21
  v_cvt_pk_bf16_f32 v28, v22, v23
  v_cvt_pk_bf16_f32 v29, v24, v25
  ds_write_b128 v5, v[26:29] offset:4096
  s_cmp_lt_u32 s71, 5
  s_cbranch_scc1 L_if9
L_ifd9:
  s_waitcnt lgkmcnt(0)
  s_mov_b64 exec, 1
  ds_add_u32 v44, v45 offset:24
  s_mov_b64 exec, -1
L_P3:
  s_cmp_lg_u32 s73, 0
  s_cbranch_scc1 L_P3B
  v_lshl_add_u32 v17, v1, 7, s29
  v_min_u32 v6, 19, v1
  v_add_u32 v6, 64, v6
  v_lshl_add_u32 v18, v6, 7, s29
  v_and_b32 v6, 3, v1
  v_lshrrev_b32 v5, 2, v3
  v_lshlrev_b32 v5, 8, v5
  v_lshl_add_u32 v5, v2, 6, v5
  v_lshl_add_u32 v30, v6, 4, v5
  v_add_u32 v31, 4096, v30
  v_add_u32 v32, 8192, v30
  v_lshlrev_b32 v19, 4, v2
  v_add_u32 v20, s24, v16
  v_add_u32 v21, 61440, v20
  v_and_b32 v5, 1, v1
  v_lshlrev_b32 v5, 31, v5
  v_xor_b32 v5, 0.5, v5
  s_add_u32 s74, s19, 0
  s_and_b32 s74, s74, 3
  s_mul_i32 s74, s74, 5120
  v_add_u32 v22, s74, v16
  v_add_u32 v23, 61440, v22
  s_add_u32 s74, s19, 1
  s_and_b32 s74, s74, 3
  s_mul_i32 s74, s74, 5120
  v_add_u32 v24, s74, v16
  v_add_u32 v25, 61440, v24
  s_add_u32 s74, s19, 2
  s_and_b32 s74, s74, 3
  s_mul_i32 s74, s74, 5120
  v_add_u32 v26, s74, v16
  v_add_u32 v27, 61440, v26
  s_add_u32 s74, s19, 3
  s_and_b32 s74, s74, 3
  s_mul_i32 s74, s74, 5120
  v_add_u32 v28, s74, v16
  v_add_u32 v29, 61440, v28
  s_cmp_lg_u32 s63, 1
  s_cbranch_scc1 L_P3V
  buffer_load_dword v15, v17, s[40:43], 0 offen sc1
  buffer_load_dword v14, v18, s[40:43], 0 offen sc1
  s_waitcnt vmcnt(2)
  v_mov_b32 v4, 1
  s_mov_b64 exec, 1
  buffer_store_dword v4, off, s[40:43], s7 sc1
  s_mov_b64 exec, -1
L_P3V:
  s_mov_b32 s72, 0x100000
L_aw10:
  s_sleep 2
  ds_read_b32 v4, v44 offset:24
  s_sub_u32 s72, s72, 1
  s_cbranch_scc1 L_ax10
  s_waitcnt lgkmcnt(0)
  v_cmp_gt_u32 vcc, 4, v4
  s_cbranch_vccnz L_aw10
L_ax10:
  ds_read_b128 v[128:131], v22 offset:20480
  ds_read_b128 v[132:135], v22 offset:40960
  ds_read_b128 v[136:139], v22 offset:0
  ds_read_b128 v[140:143], v23 offset:0
  ds_read_b128 v[144:147], v23 offset:20480
  ds_read_b128 v[148:151], v22 offset:21504
  ds_read_b128 v[152:155], v22 offset:41984
  ds_read_b128 v[156:159], v22 offset:1024
  ds_read_b128 v[160:163], v23 offset:1024
  ds_read_b128 v[164:167], v23 offset:21504
  s_cmp_lg_u32 s63, 1
  s_cbranch_scc1 L_P3W
  s_waitcnt vmcnt(1)
  v_min_u32 v15, v15, v14
  v_cmp_eq_u32 vcc, 0, v15
  s_cbranch_vccz L_pd_v
L_P3W:
  s_mov_b32 s72, 0x10000
  s_mov_b64 s[0:1], -1
L_pl_v:
  s_mov_b64 exec, s[0:1]
  buffer_load_dword v15, v17, s[40:43], 0 offen sc1
  buffer_load_dword v14, v18, s[40:43], 0 offen sc1
  s_mov_b64 exec, -1
  s_waitcnt vmcnt(0)
  v_min_u32 v15, v15, v14
  v_cmp_eq_u32 vcc, 0, v15
  s_cbranch_vccz L_pd_v
  s_mov_b64 s[0:1], vcc
  s_sub_u32 s72, s72, 1
  s_cmp_lg_u32 s72, 0
  s_cbranch_scc1 L_pl_v
L_pd_v:
  buffer_load_dwordx4 v[124:127], v19, s[40:43], s30 offen sc1
  buffer_load_dwordx4 v[84:87], v30, s[40:43], s20 offen offset:0 sc1
  buffer_load_dwordx4 v[88:91], v30, s[40:43], s20 offen offset:2048 sc1
  buffer_load_dwordx4 v[92:95], v31, s[40:43], s20 offen offset:0 sc1
  buffer_load_dwordx4 v[96:99], v31, s[40:43], s20 offen offset:2048 sc1
  buffer_load_dwordx4 v[100:103], v32, s[40:43], s20 offen offset:0 sc1
  buffer_load_dwordx4 v[104:107], v30, s[40:43], s21 offen offset:0 sc1
  s_waitcnt vmcnt(5) lgkmcnt(5)
  v_mfma_f32_16x16x32_bf16 v[64:67], v[84:87], v[128:131], 0
  buffer_load_dwordx4 v[108:111], v30, s[40:43], s21 offen offset:2048 sc1
  ds_read_b128 v[168:171], v22 offset:22528
  v_mfma_f32_16x16x32_bf16 v[68:71], v[84:87], v[132:135], 0
  ds_read_b128 v[172:175], v22 offset:43008
  v_mfma_f32_16x16x32_bf16 v[72:75], v[84:87], v[136:139], 0
  ds_read_b128 v[176:179], v22 offset:2048
  v_mfma_f32_16x16x32_bf16 v[76:79], v[84:87], v[140:143], 0
  ds_read_b128 v[180:183], v23 offset:2048
  v_mfma_f32_16x16x32_bf16 v[80:83], v[84:87], v[144:147], 0
  ds_read_b128 v[184:187], v23 offset:22528
  s_waitcnt vmcnt(5) lgkmcnt(5)
  v_mfma_f32_16x16x32_bf16 v[64:67], v[88:91], v[148:151], v[64:67]
  buffer_load_dwordx4 v[112:115], v31, s[40:43], s21 offen offset:0 sc1
  ds_read_b128 v[128:131], v22 offset:23552
  v_mfma_f32_16x16x32_bf16 v[68:71], v[88:91], v[152:155], v[68:71]
  ds_read_b128 v[132:135], v22 offset:44032
  v_mfma_f32_16x16x32_bf16 v[72:75], v[88:91], v[156:159], v[72:75]
  ds_read_b128 v[136:139], v22 offset:3072
  v_mfma_f32_16x16x32_bf16 v[76:79], v[88:91], v[160:163], v[76:79]
  ds_read_b128 v[140:143], v23 offset:3072
  v_mfma_f32_16x16x32_bf16 v[80:83], v[88:91], v[164:167], v[80:83]
  ds_read_b128 v[144:147], v23 offset:23552
  s_waitcnt vmcnt(5) lgkmcnt(5)
  v_mfma_f32_16x16x32_bf16 v[64:67], v[92:95], v[168:171], v[64:67]
  buffer_load_dwordx4 v[116:119], v31, s[40:43], s21 offen offset:2048 sc1
  ds_read_b128 v[148:151], v22 offset:24576
  v_mfma_f32_16x16x32_bf16 v[68:71], v[92:95], v[172:175], v[68:71]
  ds_read_b128 v[152:155], v22 offset:45056
  v_mfma_f32_16x16x32_bf16 v[72:75], v[92:95], v[176:179], v[72:75]
  ds_read_b128 v[156:159], v22 offset:4096
  v_mfma_f32_16x16x32_bf16 v[76:79], v[92:95], v[180:183], v[76:79]
  ds_read_b128 v[160:163], v23 offset:4096
  v_mfma_f32_16x16x32_bf16 v[80:83], v[92:95], v[184:187], v[80:83]
  ds_read_b128 v[164:167], v23 offset:24576
  s_waitcnt vmcnt(5) lgkmcnt(5)
  v_mfma_f32_16x16x32_bf16 v[64:67], v[96:99], v[128:131], v[64:67]
  buffer_load_dwordx4 v[120:123], v32, s[40:43], s21 offen offset:0 sc1
  ds_read_b128 v[168:171], v24 offset:20480
  v_mfma_f32_16x16x32_bf16 v[68:71], v[96:99], v[132:135], v[68:71]
  ds_read_b128 v[172:175], v24 offset:40960
  v_mfma_f32_16x16x32_bf16 v[72:75], v[96:99], v[136:139], v[72:75]
  ds_read_b128 v[176:179], v24 offset:0
  v_mfma_f32_16x16x32_bf16 v[76:79], v[96:99], v[140:143], v[76:79]
  ds_read_b128 v[180:183], v25 offset:0
  v_mfma_f32_16x16x32_bf16 v[80:83], v[96:99], v[144:147], v[80:83]
  ds_read_b128 v[184:187], v25 offset:20480
  s_waitcnt vmcnt(5) lgkmcnt(5)
  v_mfma_f32_16x16x32_bf16 v[64:67], v[100:103], v[148:151], v[64:67]
  buffer_load_dwordx4 v[84:87], v30, s[40:43], s22 offen offset:0 sc1
  ds_read_b128 v[128:131], v24 offset:21504
  v_mfma_f32_16x16x32_bf16 v[68:71], v[100:103], v[152:155], v[68:71]
  ds_read_b128 v[132:135], v24 offset:41984
  v_mfma_f32_16x16x32_bf16 v[72:75], v[100:103], v[156:159], v[72:75]
  ds_read_b128 v[136:139], v24 offset:1024
  v_mfma_f32_16x16x32_bf16 v[76:79], v[100:103], v[160:163], v[76:79]
  ds_read_b128 v[140:143], v25 offset:1024
  v_mfma_f32_16x16x32_bf16 v[80:83], v[100:103], v[164:167], v[80:83]
  ds_read_b128 v[144:147], v25 offset:21504
  s_waitcnt vmcnt(5) lgkmcnt(5)
  v_mfma_f32_16x16x32_bf16 v[64:67], v[104:107], v[168:171], v[64:67]
  buffer_load_dwordx4 v[88:91], v30, s[40:43], s22 offen offset:2048 sc1
  ds_read_b128 v[148:151], v24 offset:22528
  v_mfma_f32_16x16x32_bf16 v[68:71], v[104:107], v[172:175], v[68:71]
  ds_read_b128 v[152:155], v24 offset:43008
  v_mfma_f32_16x16x32_bf16 v[72:75], v[104:107], v[176:179], v[72:75]
  ds_read_b128 v[156:159], v24 offset:2048
  v_mfma_f32_16x16x32_bf16 v[76:79], v[104:107], v[180:183], v[76:79]
  ds_read_b128 v[160:163], v25 offset:2048
  v_mfma_f32_16x16x32_bf16 v[80:83], v[104:107], v[184:187], v[80:83]
  ds_read_b128 v[164:167], v25 offset:22528
  s_waitcnt vmcnt(5) lgkmcnt(5)
  v_mfma_f32_16x16x32_bf16 v[64:67], v[108:111], v[128:131], v[64:67]
  buffer_load_dwordx4 v[92:95], v31, s[40:43], s22 offen offset:0 sc1
  ds_read_b128 v[168:171], v24 offset:23552
  v_mfma_f32_16x16x32_bf16 v[68:71], v[108:111], v[132:135], v[68:71]
  ds_read_b128 v[172:175], v24 offset:44032
  v_mfma_f32_16x16x32_bf16 v[72:75], v[108:111], v[136:139], v[72:75]
  ds_read_b128 v[176:179], v24 offset:3072
  v_mfma_f32_16x16x32_bf16 v[76:79], v[108:111], v[140:143], v[76:79]
  ds_read_b128 v[180:183], v25 offset:3072
  v_mfma_f32_16x16x32_bf16 v[80:83], v[108:111], v[144:147], v[80:83]
  ds_read_b128 v[184:187], v25 offset:23552
  s_waitcnt vmcnt(5) lgkmcnt(5)
  v_mfma_f32_16x16x32_bf16 v[64:67], v[112:115], v[148:151], v[64:67]
  buffer_load_dwordx4 v[96:99], v31, s[40:43], s22 offen offset:2048 sc1
  ds_read_b128 v[128:131], v24 offset:24576
  v_mfma_f32_16x16x32_bf16 v[68:71], v[112:115], v[152:155], v[68:71]
  ds_read_b128 v[132:135], v24 offset:45056
  v_mfma_f32_16x16x32_bf16 v[72:75], v[112:115], v[156:159], v[72:75]
  ds_read_b128 v[136:139], v24 offset:4096
  v_mfma_f32_16x16x32_bf16 v[76:79], v[112:115], v[160:163], v[76:79]
  ds_read_b128 v[140:143], v25 offset:4096
  v_mfma_f32_16x16x32_bf16 v[80:83], v[112:115], v[164:167], v[80:83]
  ds_read_b128 v[144:147], v25 offset:24576
  s_waitcnt vmcnt(5) lgkmcnt(5)
  v_mfma_f32_16x16x32_bf16 v[64:67], v[116:119], v[168:171], v[64:67]
  buffer_load_dwordx4 v[100:103], v32, s[40:43], s22 offen offset:0 sc1
  ds_read_b128 v[148:151], v26 offset:20480
  v_mfma_f32_16x16x32_bf16 v[68:71], v[116:119], v[172:175], v[68:71]
  ds_read_b128 v[152:155], v26 offset:40960
  v_mfma_f32_16x16x32_bf16 v[72:75], v[116:119], v[176:179], v[72:75]
  ds_read_b128 v[156:159], v26 offset:0
  v_mfma_f32_16x16x32_bf16 v[76:79], v[116:119], v[180:183], v[76:79]
  ds_read_b128 v[160:163], v27 offset:0
  v_mfma_f32_16x16x32_bf16 v[80:83], v[116:119], v[184:187], v[80:83]
  ds_read_b128 v[164:167], v27 offset:20480
  s_waitcnt vmcnt(5) lgkmcnt(5)
  v_mfma_f32_16x16x32_bf16 v[64:67], v[120:123], v[128:131], v[64:67]
  buffer_load_dwordx4 v[104:107], v30, s[40:43], s23 offen offset:0 sc1
  ds_read_b128 v[168:171], v26 offset:21504
  v_mfma_f32_16x16x32_bf16 v[68:71], v[120:123], v[132:135], v[68:71]
  ds_read_b128 v[172:175], v26 offset:41984
  v_mfma_f32_16x16x32_bf16 v[72:75], v[120:123], v[136:139], v[72:75]
  ds_read_b128 v[176:179], v26 offset:1024
  v_mfma_f32_16x16x32_bf16 v[76:79], v[120:123], v[140:143], v[76:79]
  ds_read_b128 v[180:183], v27 offset:1024
  v_mfma_f32_16x16x32_bf16 v[80:83], v[120:123], v[144:147], v[80:83]
  ds_read_b128 v[184:187], v27 offset:21504
  s_waitcnt vmcnt(5) lgkmcnt(5)
  v_mfma_f32_16x16x32_bf16 v[64:67], v[84:87], v[148:151], v[64:67]
  buffer_load_dwordx4 v[108:111], v30, s[40:43], s23 offen offset:2048 sc1
  ds_read_b128 v[128:131], v26 offset:22528
  v_mfma_f32_16x16x32_bf16 v[68:71], v[84:87], v[152:155], v[68:71]
  ds_read_b128 v[132:135], v26 offset:43008
  v_mfma_f32_16x16x32_bf16 v[72:75], v[84:87], v[156:159], v[72:75]
  ds_read_b128 v[136:139], v26 offset:2048
  v_mfma_f32_16x16x32_bf16 v[76:79], v[84:87], v[160:163], v[76:79]
  ds_read_b128 v[140:143], v27 offset:2048
  v_mfma_f32_16x16x32_bf16 v[80:83], v[84:87], v[164:167], v[80:83]
  ds_read_b128 v[144:147], v27 offset:22528
  s_waitcnt vmcnt(5) lgkmcnt(5)
  v_mfma_f32_16x16x32_bf16 v[64:67], v[88:91], v[168:171], v[64:67]
  buffer_load_dwordx4 v[112:115], v31, s[40:43], s23 offen offset:0 sc1
  ds_read_b128 v[148:151], v26 offset:23552
  v_mfma_f32_16x16x32_bf16 v[68:71], v[88:91], v[172:175], v[68:71]
  ds_read_b128 v[152:155], v26 offset:44032
  v_mfma_f32_16x16x32_bf16 v[72:75], v[88:91], v[176:179], v[72:75]
  ds_read_b128 v[156:159], v26 offset:3072
  v_mfma_f32_16x16x32_bf16 v[76:79], v[88:91], v[180:183], v[76:79]
  ds_read_b128 v[160:163], v27 offset:3072
  v_mfma_f32_16x16x32_bf16 v[80:83], v[88:91], v[184:187], v[80:83]
  ds_read_b128 v[164:167], v27 offset:23552
  s_waitcnt vmcnt(5) lgkmcnt(5)
  v_mfma_f32_16x16x32_bf16 v[64:67], v[92:95], v[128:131], v[64:67]
  buffer_load_dwordx4 v[116:119], v31, s[40:43], s23 offen offset:2048 sc1
  ds_read_b128 v[168:171], v26 offset:24576
  v_mfma_f32_16x16x32_bf16 v[68:71], v[92:95], v[132:135], v[68:71]
  ds_read_b128 v[172:175], v26 offset:45056
  v_mfma_f32_16x16x32_bf16 v[72:75], v[92:95], v[136:139], v[72:75]
  ds_read_b128 v[176:179], v26 offset:4096
  v_mfma_f32_16x16x32_bf16 v[76:79], v[92:95], v[140:143], v[76:79]
  ds_read_b128 v[180:183], v27 offset:4096
  v_mfma_f32_16x16x32_bf16 v[80:83], v[92:95], v[144:147], v[80:83]
  ds_read_b128 v[184:187], v27 offset:24576
  s_waitcnt vmcnt(5) lgkmcnt(5)
  v_mfma_f32_16x16x32_bf16 v[64:67], v[96:99], v[148:151], v[64:67]
  buffer_load_dwordx4 v[120:123], v32, s[40:43], s23 offen offset:0 sc1
  ds_read_b128 v[128:131], v28 offset:20480
  v_mfma_f32_16x16x32_bf16 v[68:71], v[96:99], v[152:155], v[68:71]
  ds_read_b128 v[132:135], v28 offset:40960
  v_mfma_f32_16x16x32_bf16 v[72:75], v[96:99], v[156:159], v[72:75]
  ds_read_b128 v[136:139], v28 offset:0
  v_mfma_f32_16x16x32_bf16 v[76:79], v[96:99], v[160:163], v[76:79]
  ds_read_b128 v[140:143], v29 offset:0
  v_mfma_f32_16x16x32_bf16 v[80:83], v[96:99], v[164:167], v[80:83]
  ds_read_b128 v[144:147], v29 offset:20480
  s_waitcnt vmcnt(5) lgkmcnt(5)
  v_mfma_f32_16x16x32_bf16 v[64:67], v[100:103], v[168:171], v[64:67]
  ds_read_b128 v[148:151], v28 offset:21504
  v_mfma_f32_16x16x32_bf16 v[68:71], v[100:103], v[172:175], v[68:71]
  ds_read_b128 v[152:155], v28 offset:41984
  v_mfma_f32_16x16x32_bf16 v[72:75], v[100:103], v[176:179], v[72:75]
  ds_read_b128 v[156:159], v28 offset:1024
  v_mfma_f32_16x16x32_bf16 v[76:79], v[100:103], v[180:183], v[76:79]
  ds_read_b128 v[160:163], v29 offset:1024
  v_mfma_f32_16x16x32_bf16 v[80:83], v[100:103], v[184:187], v[80:83]
  ds_read_b128 v[164:167], v29 offset:21504
  s_barrier
  s_waitcnt vmcnt(4) lgkmcnt(5)
  v_mfma_f32_16x16x32_bf16 v[64:67], v[104:107], v[128:131], v[64:67]
  ds_read_b128 v[168:171], v28 offset:22528
  v_mfma_f32_16x16x32_bf16 v[68:71], v[104:107], v[132:135], v[68:71]
  ds_read_b128 v[172:175], v28 offset:43008
  v_mfma_f32_16x16x32_bf16 v[72:75], v[104:107], v[136:139], v[72:75]
  ds_read_b128 v[176:179], v28 offset:2048
  v_mfma_f32_16x16x32_bf16 v[76:79], v[104:107], v[140:143], v[76:79]
  ds_read_b128 v[180:183], v29 offset:2048
  v_mfma_f32_16x16x32_bf16 v[80:83], v[104:107], v[144:147], v[80:83]
  ds_read_b128 v[184:187], v29 offset:22528
  s_waitcnt vmcnt(3) lgkmcnt(5)
  v_mfma_f32_16x16x32_bf16 v[64:67], v[108:111], v[148:151], v[64:67]
  ds_read_b128 v[128:131], v28 offset:23552
  v_mfma_f32_16x16x32_bf16 v[68:71], v[108:111], v[152:155], v[68:71]
  ds_read_b128 v[132:135], v28 offset:44032
  v_mfma_f32_16x16x32_bf16 v[72:75], v[108:111], v[156:159], v[72:75]
  ds_read_b128 v[136:139], v28 offset:3072
  v_mfma_f32_16x16x32_bf16 v[76:79], v[108:111], v[160:163], v[76:79]
  ds_read_b128 v[140:143], v29 offset:3072
  v_mfma_f32_16x16x32_bf16 v[80:83], v[108:111], v[164:167], v[80:83]
  ds_read_b128 v[144:147], v29 offset:23552
  s_waitcnt vmcnt(2) lgkmcnt(5)
  v_mfma_f32_16x16x32_bf16 v[64:67], v[112:115], v[168:171], v[64:67]
  ds_read_b128 v[148:151], v28 offset:24576
  v_mfma_f32_16x16x32_bf16 v[68:71], v[112:115], v[172:175], v[68:71]
  ds_read_b128 v[152:155], v28 offset:45056
  v_mfma_f32_16x16x32_bf16 v[72:75], v[112:115], v[176:179], v[72:75]
  ds_read_b128 v[156:159], v28 offset:4096
  v_mfma_f32_16x16x32_bf16 v[76:79], v[112:115], v[180:183], v[76:79]
  ds_read_b128 v[160:163], v29 offset:4096
  v_mfma_f32_16x16x32_bf16 v[80:83], v[112:115], v[184:187], v[80:83]
  ds_read_b128 v[164:167], v29 offset:24576
  v_mul_f32 v124, v5, v124
  v_mul_f32 v125, v5, v125
  v_mul_f32 v126, v5, v126
  v_mul_f32 v127, v5, v127
  s_waitcnt vmcnt(1) lgkmcnt(5)
  v_mfma_f32_16x16x32_bf16 v[64:67], v[116:119], v[128:131], v[64:67]
  v_mfma_f32_16x16x32_bf16 v[68:71], v[116:119], v[132:135], v[68:71]
  v_mfma_f32_16x16x32_bf16 v[72:75], v[116:119], v[136:139], v[72:75]
  v_mfma_f32_16x16x32_bf16 v[76:79], v[116:119], v[140:143], v[76:79]
  v_mfma_f32_16x16x32_bf16 v[80:83], v[116:119], v[144:147], v[80:83]
  s_waitcnt vmcnt(0) lgkmcnt(0)
  v_mfma_f32_16x16x32_bf16 v[64:67], v[120:123], v[148:151], v[64:67]
  v_mfma_f32_16x16x32_bf16 v[68:71], v[120:123], v[152:155], v[68:71]
  v_mfma_f32_16x16x32_bf16 v[72:75], v[120:123], v[156:159], v[72:75]
  v_mfma_f32_16x16x32_bf16 v[76:79], v[120:123], v[160:163], v[76:79]
  v_mfma_f32_16x16x32_bf16 v[80:83], v[120:123], v[164:167], v[80:83]
  s_nop 3
  v_pk_add_f32 v[64:65], v[64:65], v[124:125]
  v_cvt_pk_bf16_f32 v84, v64, v65
  v_pk_add_f32 v[66:67], v[66:67], v[126:127]
  v_cvt_pk_bf16_f32 v85, v66, v67
  ds_write_b64 v20, v[84:85] offset:20480
  v_pk_add_f32 v[68:69], v[68:69], v[124:125]
  v_cvt_pk_bf16_f32 v86, v68, v69
  v_pk_add_f32 v[70:71], v[70:71], v[126:127]
  v_cvt_pk_bf16_f32 v87, v70, v71
  ds_write_b64 v20, v[86:87] offset:40960
  v_pk_add_f32 v[72:73], v[72:73], v[124:125]
  v_cvt_pk_bf16_f32 v88, v72, v73
  v_pk_add_f32 v[74:75], v[74:75], v[126:127]
  v_cvt_pk_bf16_f32 v89, v74, v75
  ds_write_b64 v20, v[88:89] offset:0
  v_pk_add_f32 v[76:77], v[76:77], v[124:125]
  v_cvt_pk_bf16_f32 v90, v76, v77
  v_pk_add_f32 v[78:79], v[78:79], v[126:127]
  v_cvt_pk_bf16_f32 v91, v78, v79
  ds_write_b64 v21, v[90:91] offset:0
  v_pk_add_f32 v[80:81], v[80:81], v[124:125]
  v_cvt_pk_bf16_f32 v92, v80, v81
  v_pk_add_f32 v[82:83], v[82:83], v[126:127]
  v_cvt_pk_bf16_f32 v93, v82, v83
  ds_write_b64 v21, v[92:93] offset:20480
  s_waitcnt lgkmcnt(0)
  s_barrier
  s_endpgm
L_P3B:
  v_and_b32 v4, 1, v1
  v_lshl_add_u32 v17, v4, 7, s35
  v_add_u32 v18, 4096, v16
  v_lshlrev_b32 v19, 2, v3
  v_add_u32 v20, s24, v16
  v_add_u32 v21, s25, v16
  v_add_u32 v22, s26, v16
  v_add_u32 v23, s27, v16
  v_add_u32 v24, s29, v16
  v_add_u32 v25, 61440, v24
  v_mul_u32_u24 v26, 81920, v3
  v_mul_u32_u24 v4, 40, v2
  v_add_u32 v26, v26, v4
  v_lshl_add_u32 v4, v3, 6, s32
  v_cvt_f32_u32 v4, v4
  v_mul_f32 v4, 0x3a000000, v4
  v_cvt_f32_u32 v5, v2
  v_add_f32 v5, v5, v5
  v_mul_f32 v5, v5, v4
  v_add_f32 v6, 0xbe800000, v5
  v_cvt_f32_u32 v7, v3
  v_mul_f32 v7, 0.5, v7
  v_cmp_eq_u32 vcc, 0, v2
  v_fmamk_f32 v8, v4, 0x0, v5
  v_cos_f32 v9, v8
  v_fmamk_f32 v8, v4, 0x0, v6
  v_cndmask_b32 v8, v8, v7, vcc
  v_cos_f32 v10, v8
  s_nop 0
  v_cvt_pk_bf16_f32 v32, v9, v10
  v_fmamk_f32 v8, v4, 0x3f800000, v5
  v_cos_f32 v9, v8
  v_fmamk_f32 v8, v4, 0x3f800000, v6
  v_cos_f32 v10, v8
  s_nop 0
  v_cvt_pk_bf16_f32 v33, v9, v10
  v_fmamk_f32 v8, v4, 0x41000000, v5
  v_cos_f32 v9, v8
  v_fmamk_f32 v8, v4, 0x41000000, v6
  v_cos_f32 v10, v8
  s_nop 0
  v_cvt_pk_bf16_f32 v34, v9, v10
  v_fmamk_f32 v8, v4, 0x41100000, v5
  v_cos_f32 v9, v8
  v_fmamk_f32 v8, v4, 0x41100000, v6
  v_cos_f32 v10, v8
  s_nop 0
  v_cvt_pk_bf16_f32 v35, v9, v10
  s_mov_b32 s72, 0x10000
  s_mov_b64 s[0:1], -1
L_pl_o:
  s_mov_b64 exec, s[0:1]
  buffer_load_dword v15, v17, s[40:43], 0 offen sc1
  s_mov_b64 exec, -1
  s_waitcnt vmcnt(0)
  v_cmp_eq_u32 vcc, 0, v15
  s_cbranch_vccz L_pd_o
  s_mov_b64 s[0:1], vcc
  s_sub_u32 s72, s72, 1
  s_cmp_lg_u32 s72, 0
  s_cbranch_scc1 L_pl_o
L_pd_o:
  buffer_load_dwordx4 v[36:39], v16, s[40:43], s21 offen offset:0 sc1
  buffer_load_dwordx4 v[40:43], v16, s[40:43], s21 offen offset:1024 sc1
  buffer_load_dwordx4 v[44:47], v16, s[40:43], s21 offen offset:2048 sc1
  buffer_load_dwordx4 v[48:51], v16, s[40:43], s21 offen offset:3072 sc1
  buffer_load_dwordx4 v[52:55], v18, s[40:43], s21 offen offset:0 sc1
  buffer_load_dwordx4 v[56:59], v16, s[40:43], s22 offen offset:0 sc1
  s_waitcnt vmcnt(5)
  v_mfma_f32_16x16x32_bf16 v[96:99], v[156:159], v[36:39], 0
  buffer_load_dwordx4 v[60:63], v16, s[40:43], s22 offen offset:1024 sc1
  v_mfma_f32_16x16x32_bf16 v[100:103], v[160:163], v[36:39], 0
  v_mfma_f32_16x16x32_bf16 v[104:107], v[164:167], v[36:39], 0
  v_mfma_f32_16x16x32_bf16 v[108:111], v[168:171], v[36:39], 0
  v_mfma_f32_16x16x32_bf16 v[112:115], v[172:175], v[36:39], 0
  s_waitcnt vmcnt(5)
  v_mfma_f32_16x16x32_bf16 v[96:99], v[176:179], v[40:43], v[96:99]
  buffer_load_dwordx4 v[64:67], v16, s[40:43], s22 offen offset:2048 sc1
  v_mfma_f32_16x16x32_bf16 v[100:103], v[180:183], v[40:43], v[100:103]
  v_mfma_f32_16x16x32_bf16 v[104:107], v[184:187], v[40:43], v[104:107]
  v_mfma_f32_16x16x32_bf16 v[108:111], v[188:191], v[40:43], v[108:111]
  v_mfma_f32_16x16x32_bf16 v[112:115], v[192:195], v[40:43], v[112:115]
  s_waitcnt vmcnt(5)
  v_mfma_f32_16x16x32_bf16 v[96:99], v[196:199], v[44:47], v[96:99]
  buffer_load_dwordx4 v[68:71], v16, s[40:43], s22 offen offset:3072 sc1
  v_mfma_f32_16x16x32_bf16 v[100:103], v[200:203], v[44:47], v[100:103]
  v_mfma_f32_16x16x32_bf16 v[104:107], v[204:207], v[44:47], v[104:107]
  v_mfma_f32_16x16x32_bf16 v[108:111], v[208:211], v[44:47], v[108:111]
  v_mfma_f32_16x16x32_bf16 v[112:115], v[212:215], v[44:47], v[112:115]
  s_waitcnt vmcnt(5)
  v_mfma_f32_16x16x32_bf16 v[96:99], v[216:219], v[48:51], v[96:99]
  buffer_load_dwordx4 v[72:75], v18, s[40:43], s22 offen offset:0 sc1
  v_mfma_f32_16x16x32_bf16 v[100:103], v[220:223], v[48:51], v[100:103]
  v_mfma_f32_16x16x32_bf16 v[104:107], v[224:227], v[48:51], v[104:107]
  v_mfma_f32_16x16x32_bf16 v[108:111], v[228:231], v[48:51], v[108:111]
  v_mfma_f32_16x16x32_bf16 v[112:115], v[232:235], v[48:51], v[112:115]
  s_waitcnt vmcnt(5)
  v_mfma_f32_16x16x32_bf16 v[96:99], v[236:239], v[52:55], v[96:99]
  buffer_load_dwordx4 v[36:39], v16, s[40:43], s23 offen offset:0 sc1
  v_mfma_f32_16x16x32_bf16 v[100:103], v[240:243], v[52:55], v[100:103]
  v_mfma_f32_16x16x32_bf16 v[104:107], v[244:247], v[52:55], v[104:107]
  v_mfma_f32_16x16x32_bf16 v[108:111], v[248:251], v[52:55], v[108:111]
  v_mfma_f32_16x16x32_bf16 v[112:115], v[252:255], v[52:55], v[112:115]
  s_waitcnt vmcnt(5)
  v_mfma_f32_16x16x32_bf16 v[116:119], v[156:159], v[56:59], 0
  buffer_load_dwordx4 v[40:43], v16, s[40:43], s23 offen offset:1024 sc1
  v_mfma_f32_16x16x32_bf16 v[120:123], v[160:163], v[56:59], 0
  v_mfma_f32_16x16x32_bf16 v[124:127], v[164:167], v[56:59], 0
  ds_write_b128 v20, v[96:99] offset:0
  v_mfma_f32_16x16x32_bf16 v[128:131], v[168:171], v[56:59], 0
  v_mfma_f32_16x16x32_bf16 v[132:135], v[172:175], v[56:59], 0
  s_waitcnt vmcnt(5)
  v_mfma_f32_16x16x32_bf16 v[116:119], v[176:179], v[60:63], v[116:119]
  buffer_load_dwordx4 v[44:47], v16, s[40:43], s23 offen offset:2048 sc1
  v_mfma_f32_16x16x32_bf16 v[120:123], v[180:183], v[60:63], v[120:123]
  v_mfma_f32_16x16x32_bf16 v[124:127], v[184:187], v[60:63], v[124:127]
  ds_write_b128 v20, v[100:103] offset:1024
  v_mfma_f32_16x16x32_bf16 v[128:131], v[188:191], v[60:63], v[128:131]
  v_mfma_f32_16x16x32_bf16 v[132:135], v[192:195], v[60:63], v[132:135]
  s_waitcnt vmcnt(5)
  v_mfma_f32_16x16x32_bf16 v[116:119], v[196:199], v[64:67], v[116:119]
  buffer_load_dwordx4 v[48:51], v16, s[40:43], s23 offen offset:3072 sc1
  v_mfma_f32_16x16x32_bf16 v[120:123], v[200:203], v[64:67], v[120:123]
  v_mfma_f32_16x16x32_bf16 v[124:127], v[204:207], v[64:67], v[124:127]
  ds_write_b128 v20, v[104:107] offset:2048
  v_mfma_f32_16x16x32_bf16 v[128:131], v[208:211], v[64:67], v[128:131]
  v_mfma_f32_16x16x32_bf16 v[132:135], v[212:215], v[64:67], v[132:135]
  s_waitcnt vmcnt(5)
  v_mfma_f32_16x16x32_bf16 v[116:119], v[216:219], v[68:71], v[116:119]
  buffer_load_dwordx4 v[52:55], v18, s[40:43], s23 offen offset:0 sc1
  v_mfma_f32_16x16x32_bf16 v[120:123], v[220:223], v[68:71], v[120:123]
  v_mfma_f32_16x16x32_bf16 v[124:127], v[224:227], v[68:71], v[124:127]
  ds_write_b128 v20, v[108:111] offset:3072
  v_mfma_f32_16x16x32_bf16 v[128:131], v[228:231], v[68:71], v[128:131]
  v_mfma_f32_16x16x32_bf16 v[132:135], v[232:235], v[68:71], v[132:135]
  s_waitcnt vmcnt(5)
  v_mfma_f32_16x16x32_bf16 v[116:119], v[236:239], v[72:75], v[116:119]
  buffer_load_dwordx4 v[56:59], v16, s[40:43], s20 offen offset:0 sc1
  v_mfma_f32_16x16x32_bf16 v[120:123], v[240:243], v[72:75], v[120:123]
  v_mfma_f32_16x16x32_bf16 v[124:127], v[244:247], v[72:75], v[124:127]
  ds_write_b128 v20, v[112:115] offset:4096
  v_mfma_f32_16x16x32_bf16 v[128:131], v[248:251], v[72:75], v[128:131]
  v_mfma_f32_16x16x32_bf16 v[132:135], v[252:255], v[72:75], v[132:135]
  s_waitcnt vmcnt(5)
  v_mfma_f32_16x16x32_bf16 v[136:139], v[156:159], v[36:39], 0
  buffer_load_dwordx4 v[60:63], v16, s[40:43], s20 offen offset:1024 sc1
  v_mfma_f32_16x16x32_bf16 v[140:143], v[160:163], v[36:39], 0
  v_mfma_f32_16x16x32_bf16 v[144:147], v[164:167], v[36:39], 0
  ds_write_b128 v21, v[116:119] offset:0
  v_mfma_f32_16x16x32_bf16 v[148:151], v[168:171], v[36:39], 0
  v_mfma_f32_16x16x32_bf16 v[152:155], v[172:175], v[36:39], 0
  s_waitcnt vmcnt(5)
  v_mfma_f32_16x16x32_bf16 v[136:139], v[176:179], v[40:43], v[136:139]
  buffer_load_dwordx4 v[64:67], v16, s[40:43], s20 offen offset:2048 sc1
  v_mfma_f32_16x16x32_bf16 v[140:143], v[180:183], v[40:43], v[140:143]
  v_mfma_f32_16x16x32_bf16 v[144:147], v[184:187], v[40:43], v[144:147]
  ds_write_b128 v21, v[120:123] offset:1024
  v_mfma_f32_16x16x32_bf16 v[148:151], v[188:191], v[40:43], v[148:151]
  v_mfma_f32_16x16x32_bf16 v[152:155], v[192:195], v[40:43], v[152:155]
  s_waitcnt vmcnt(5)
  v_mfma_f32_16x16x32_bf16 v[136:139], v[196:199], v[44:47], v[136:139]
  buffer_load_dwordx4 v[68:71], v16, s[40:43], s20 offen offset:3072 sc1
  v_mfma_f32_16x16x32_bf16 v[140:143], v[200:203], v[44:47], v[140:143]
  v_mfma_f32_16x16x32_bf16 v[144:147], v[204:207], v[44:47], v[144:147]
  ds_write_b128 v21, v[124:127] offset:2048
  v_mfma_f32_16x16x32_bf16 v[148:151], v[208:211], v[44:47], v[148:151]
  v_mfma_f32_16x16x32_bf16 v[152:155], v[212:215], v[44:47], v[152:155]
  s_waitcnt vmcnt(5)
  v_mfma_f32_16x16x32_bf16 v[136:139], v[216:219], v[48:51], v[136:139]
  buffer_load_dwordx4 v[72:75], v18, s[40:43], s20 offen offset:0 sc1
  v_mfma_f32_16x16x32_bf16 v[140:143], v[220:223], v[48:51], v[140:143]
  v_mfma_f32_16x16x32_bf16 v[144:147], v[224:227], v[48:51], v[144:147]
  ds_write_b128 v21, v[128:131] offset:3072
  v_mfma_f32_16x16x32_bf16 v[148:151], v[228:231], v[48:51], v[148:151]
  v_mfma_f32_16x16x32_bf16 v[152:155], v[232:235], v[48:51], v[152:155]
  s_waitcnt vmcnt(5)
  v_mfma_f32_16x16x32_bf16 v[136:139], v[236:239], v[52:55], v[136:139]
  v_mfma_f32_16x16x32_bf16 v[140:143], v[240:243], v[52:55], v[140:143]
  v_mfma_f32_16x16x32_bf16 v[144:147], v[244:247], v[52:55], v[144:147]
  ds_write_b128 v21, v[132:135] offset:4096
  v_mfma_f32_16x16x32_bf16 v[148:151], v[248:251], v[52:55], v[148:151]
  v_mfma_f32_16x16x32_bf16 v[152:155], v[252:255], v[52:55], v[152:155]
  s_barrier
  buffer_load_dword v28, v19, s[40:43], s30 offen sc1
  s_waitcnt vmcnt(5)
  v_mfma_f32_16x16x32_bf16 v[76:79], v[156:159], v[56:59], 0
  v_mfma_f32_16x16x32_bf16 v[80:83], v[160:163], v[56:59], 0
  v_mfma_f32_16x16x32_bf16 v[84:87], v[164:167], v[56:59], 0
  ds_write_b128 v22, v[136:139] offset:0
  v_mfma_f32_16x16x32_bf16 v[88:91], v[168:171], v[56:59], 0
  v_mfma_f32_16x16x32_bf16 v[92:95], v[172:175], v[56:59], 0
  s_waitcnt vmcnt(4)
  v_mfma_f32_16x16x32_bf16 v[76:79], v[176:179], v[60:63], v[76:79]
  v_mfma_f32_16x16x32_bf16 v[80:83], v[180:183], v[60:63], v[80:83]
  v_mfma_f32_16x16x32_bf16 v[84:87], v[184:187], v[60:63], v[84:87]
  ds_write_b128 v22, v[140:143] offset:1024
  v_mfma_f32_16x16x32_bf16 v[88:91], v[188:191], v[60:63], v[88:91]
  v_mfma_f32_16x16x32_bf16 v[92:95], v[192:195], v[60:63], v[92:95]
  s_waitcnt vmcnt(3)
  v_mfma_f32_16x16x32_bf16 v[76:79], v[196:199], v[64:67], v[76:79]
  v_mfma_f32_16x16x32_bf16 v[80:83], v[200:203], v[64:67], v[80:83]
  v_mfma_f32_16x16x32_bf16 v[84:87], v[204:207], v[64:67], v[84:87]
  ds_write_b128 v22, v[144:147] offset:2048
  v_mfma_f32_16x16x32_bf16 v[88:91], v[208:211], v[64:67], v[88:91]
  v_mfma_f32_16x16x32_bf16 v[92:95], v[212:215], v[64:67], v[92:95]
  s_waitcnt vmcnt(2)
  v_mfma_f32_16x16x32_bf16 v[76:79], v[216:219], v[68:71], v[76:79]
  v_mfma_f32_16x16x32_bf16 v[80:83], v[220:223], v[68:71], v[80:83]
  v_mfma_f32_16x16x32_bf16 v[84:87], v[224:227], v[68:71], v[84:87]
  ds_write_b128 v22, v[148:151] offset:3072
  v_mfma_f32_16x16x32_bf16 v[88:91], v[228:231], v[68:71], v[88:91]
  v_mfma_f32_16x16x32_bf16 v[92:95], v[232:235], v[68:71], v[92:95]
  s_waitcnt vmcnt(1)
  v_mfma_f32_16x16x32_bf16 v[76:79], v[236:239], v[72:75], v[76:79]
  v_mfma_f32_16x16x32_bf16 v[80:83], v[240:243], v[72:75], v[80:83]
  v_mfma_f32_16x16x32_bf16 v[84:87], v[244:247], v[72:75], v[84:87]
  ds_write_b128 v22, v[152:155] offset:4096
  v_mfma_f32_16x16x32_bf16 v[88:91], v[248:251], v[72:75], v[88:91]
  v_mfma_f32_16x16x32_bf16 v[92:95], v[252:255], v[72:75], v[92:95]
  s_waitcnt lgkmcnt(0)
  s_barrier
  ds_read_b128 v[36:39], v24 offset:20480
  ds_read_b128 v[40:43], v24 offset:40960
  ds_read_b128 v[44:47], v24 offset:0
  ds_read_b128 v[48:51], v25 offset:0
  ds_read_b128 v[52:55], v25 offset:20480
  ds_read_b128 v[96:99], v23 offset:0
  ds_read_b128 v[100:103], v23 offset:1024
  ds_read_b128 v[104:107], v23 offset:2048
  ds_read_b128 v[108:111], v23 offset:3072
  ds_read_b128 v[112:115], v23 offset:4096
  ds_read_b128 v[116:119], v23 offset:5120
  ds_read_b128 v[120:123], v23 offset:6144
  ds_read_b128 v[124:127], v23 offset:7168
  ds_read_b128 v[128:131], v23 offset:8192
  ds_read_b128 v[132:135], v23 offset:9216
  ds_read_b128 v[136:139], v23 offset:10240
  ds_read_b128 v[140:143], v23 offset:11264
  ds_read_b128 v[144:147], v23 offset:12288
  ds_read_b128 v[148:151], v23 offset:13312
  ds_read_b128 v[152:155], v23 offset:14336
  s_waitcnt lgkmcnt(15)
  v_mfma_f32_16x16x32_bf16 v[56:59], v[36:39], v[32:35], 0
  v_mfma_f32_16x16x32_bf16 v[60:63], v[40:43], v[32:35], 0
  v_mfma_f32_16x16x32_bf16 v[64:67], v[44:47], v[32:35], 0
  v_mfma_f32_16x16x32_bf16 v[68:71], v[48:51], v[32:35], 0
  v_mfma_f32_16x16x32_bf16 v[72:75], v[52:55], v[32:35], 0
  s_waitcnt vmcnt(0)
  v_mul_f32 v30, 0x35cccccd, v28
  v_sub_f32 v28, 1.0, v28
  v_mov_b32 v31, v30
  v_cvt_pk_bf16_f32 v28, v28, v28
  v_and_b32 v28, 0xffff0000, v28
  v_mov_b32 v29, v28
  s_waitcnt lgkmcnt(10)
  v_pk_add_f32 v[76:77], v[76:77], v[96:97]
  v_pk_add_f32 v[78:79], v[78:79], v[98:99]
  v_pk_add_f32 v[80:81], v[80:81], v[100:101]
  v_pk_add_f32 v[82:83], v[82:83], v[102:103]
  v_pk_add_f32 v[84:85], v[84:85], v[104:105]
  v_pk_add_f32 v[86:87], v[86:87], v[106:107]
  v_pk_add_f32 v[88:89], v[88:89], v[108:109]
  v_pk_add_f32 v[90:91], v[90:91], v[110:111]
  v_pk_add_f32 v[92:93], v[92:93], v[112:113]
  v_pk_add_f32 v[94:95], v[94:95], v[114:115]
  v_pk_mul_f32 v[56:57], v[56:57], v[30:31]
  v_pk_mul_f32 v[58:59], v[58:59], v[30:31]
  v_pk_mul_f32 v[60:61], v[60:61], v[30:31]
  v_pk_mul_f32 v[62:63], v[62:63], v[30:31]
  v_pk_mul_f32 v[64:65], v[64:65], v[30:31]
  v_pk_mul_f32 v[66:67], v[66:67], v[30:31]
  v_pk_mul_f32 v[68:69], v[68:69], v[30:31]
  v_pk_mul_f32 v[70:71], v[70:71], v[30:31]
  v_pk_mul_f32 v[72:73], v[72:73], v[30:31]
  v_pk_mul_f32 v[74:75], v[74:75], v[30:31]
  s_waitcnt lgkmcnt(5)
  v_pk_add_f32 v[76:77], v[76:77], v[116:117]
  v_pk_add_f32 v[78:79], v[78:79], v[118:119]
  v_pk_add_f32 v[80:81], v[80:81], v[120:121]
  v_pk_add_f32 v[82:83], v[82:83], v[122:123]
  v_pk_add_f32 v[84:85], v[84:85], v[124:125]
  v_pk_add_f32 v[86:87], v[86:87], v[126:127]
  v_pk_add_f32 v[88:89], v[88:89], v[128:129]
  v_pk_add_f32 v[90:91], v[90:91], v[130:131]
  v_pk_add_f32 v[92:93], v[92:93], v[132:133]
  v_pk_add_f32 v[94:95], v[94:95], v[134:135]
  s_waitcnt lgkmcnt(0)
  v_pk_add_f32 v[76:77], v[76:77], v[136:137]
  v_pk_add_f32 v[78:79], v[78:79], v[138:139]
  v_pk_add_f32 v[80:81], v[80:81], v[140:141]
  v_pk_add_f32 v[82:83], v[82:83], v[142:143]
  v_pk_add_f32 v[84:85], v[84:85], v[144:145]
  v_pk_add_f32 v[86:87], v[86:87], v[146:147]
  v_pk_add_f32 v[88:89], v[88:89], v[148:149]
  v_pk_add_f32 v[90:91], v[90:91], v[150:151]
  v_pk_add_f32 v[92:93], v[92:93], v[152:153]
  v_pk_add_f32 v[94:95], v[94:95], v[154:155]
  v_pk_fma_f32 v[76:77], v[76:77], v[28:29], v[56:57]
  v_cvt_pk_bf16_f32 v36, v76, v77
  v_pk_fma_f32 v[78:79], v[78:79], v[28:29], v[58:59]
  v_cvt_pk_bf16_f32 v37, v78, v79
  v_pk_fma_f32 v[80:81], v[80:81], v[28:29], v[60:61]
  v_cvt_pk_bf16_f32 v38, v80, v81
  v_pk_fma_f32 v[82:83], v[82:83], v[28:29], v[62:63]
  v_cvt_pk_bf16_f32 v39, v82, v83
  buffer_store_dwordx4 v[36:39], v26, s[44:47], s31 offen
  v_pk_fma_f32 v[84:85], v[84:85], v[28:29], v[64:65]
  v_cvt_pk_bf16_f32 v40, v84, v85
  v_pk_fma_f32 v[86:87], v[86:87], v[28:29], v[66:67]
  v_cvt_pk_bf16_f32 v41, v86, v87
  v_pk_fma_f32 v[88:89], v[88:89], v[28:29], v[68:69]
  v_cvt_pk_bf16_f32 v42, v88, v89
  v_pk_fma_f32 v[90:91], v[90:91], v[28:29], v[70:71]
  v_cvt_pk_bf16_f32 v43, v90, v91
  buffer_store_dwordx4 v[40:43], v26, s[44:47], s31 offen offset:16
  v_pk_fma_f32 v[92:93], v[92:93], v[28:29], v[72:73]
  v_cvt_pk_bf16_f32 v44, v92, v93
  v_pk_fma_f32 v[94:95], v[94:95], v[28:29], v[74:75]
  v_cvt_pk_bf16_f32 v45, v94, v95
  buffer_store_dwordx2 v[44:45], v26, s[44:47], s31 offen offset:32
  s_endpgm
L_F:
  s_lshl_b32 s74, s66, 7
  s_add_u32 s74, s74, 147456
  v_lshl_add_u32 v34, v2, 4, s74
  v_add_u32 v19, 16384, v16
  v_add_u32 v24, 73728, v17
  v_add_u32 v25, 73728, v18
  v_add_u32 v26, 73728, v19
  v_add_u32 v4, 0, v3
  v_lshrrev_b32 v5, 1, v4
  v_and_b32 v6, 1, v4
  v_lshlrev_b32 v6, 9, v6
  v_mov_b32 v7, s16
  v_cmp_eq_u32 vcc, 1, v4
  s_nop 1
  v_cndmask_b32 v5, v5, 16, vcc
  v_cndmask_b32 v6, v6, 0, vcc
  v_cndmask_b32 v7, v7, 0, vcc
  v_lshl_add_u32 v7, v2, 8, v7
  v_mul_u32_u24 v7, v7, v5
  v_sub_u32 v7, v7, v6
  v_cvt_f32_i32 v7, v7
  v_mul_f32 v7, 0x3a000000, v7
  v_cvt_f32_u32 v5, v5
  v_fmamk_f32 v8, v5, 0x0, v7
  v_cos_f32 v9, v8
  v_fmamk_f32 v8, v5, 0x3d000000, v7
  v_cos_f32 v10, v8
  s_nop 0
  v_cvt_pk_bf16_f32 v240, v9, v10
  v_fmamk_f32 v8, v5, 0x3d800000, v7
  v_cos_f32 v9, v8
  v_fmamk_f32 v8, v5, 0x3dc00000, v7
  v_cos_f32 v10, v8
  s_nop 0
  v_cvt_pk_bf16_f32 v241, v9, v10
  v_fmamk_f32 v8, v5, 0x3f000000, v7
  v_cos_f32 v9, v8
  v_fmamk_f32 v8, v5, 0x3f080000, v7
  v_cos_f32 v10, v8
  s_nop 0
  v_cvt_pk_bf16_f32 v242, v9, v10
  v_fmamk_f32 v8, v5, 0x3f100000, v7
  v_cos_f32 v9, v8
  v_fmamk_f32 v8, v5, 0x3f180000, v7
  v_cos_f32 v10, v8
  s_nop 0
  v_cvt_pk_bf16_f32 v243, v9, v10
  v_add_u32 v4, 16, v3
  v_lshrrev_b32 v5, 1, v4
  v_and_b32 v6, 1, v4
  v_lshlrev_b32 v6, 9, v6
  v_mov_b32 v7, s16
  v_lshl_add_u32 v7, v2, 8, v7
  v_mul_u32_u24 v7, v7, v5
  v_sub_u32 v7, v7, v6
  v_cvt_f32_i32 v7, v7
  v_mul_f32 v7, 0x3a000000, v7
  v_cvt_f32_u32 v5, v5
  v_fmamk_f32 v8, v5, 0x0, v7
  v_cos_f32 v9, v8
  v_fmamk_f32 v8, v5, 0x3d000000, v7
  v_cos_f32 v10, v8
  s_nop 0
  v_cvt_pk_bf16_f32 v244, v9, v10
  v_fmamk_f32 v8, v5, 0x3d800000, v7
  v_cos_f32 v9, v8
  v_fmamk_f32 v8, v5, 0x3dc00000, v7
  v_cos_f32 v10, v8
  s_nop 0
  v_cvt_pk_bf16_f32 v245, v9, v10
  v_fmamk_f32 v8, v5, 0x3f000000, v7
  v_cos_f32 v9, v8
  v_fmamk_f32 v8, v5, 0x3f080000, v7
  v_cos_f32 v10, v8
  s_nop 0
  v_cvt_pk_bf16_f32 v246, v9, v10
  v_fmamk_f32 v8, v5, 0x3f100000, v7
  v_cos_f32 v9, v8
  v_fmamk_f32 v8, v5, 0x3f180000, v7
  v_cos_f32 v10, v8
  s_nop 0
  v_cvt_pk_bf16_f32 v247, v9, v10
  v_mul_u32_u24 v32, 327680, v2
  v_lshl_add_u32 v32, v3, 4, v32
  v_lshl_add_u32 v33, v2, 4, s6
  s_waitcnt lgkmcnt(0)
  s_barrier
  ds_read_b128 v[136:139], v17 offset:0
  ds_read_b128 v[140:143], v17 offset:2048
  ds_read_b128 v[152:155], v34 offset:0
  ds_read_b128 v[160:163], v19 offset:0
  ds_read_b128 v[164:167], v19 offset:1024
  ds_read_b128 v[168:171], v19 offset:2048
  ds_read_b128 v[172:175], v19 offset:3072
  ds_read_b128 v[176:179], v19 offset:4096
  ds_read_b128 v[180:183], v19 offset:5120
  ds_read_b128 v[184:187], v19 offset:6144
  ds_read_b128 v[188:191], v19 offset:7168
  ds_read_b128 v[192:195], v19 offset:8192
  ds_read_b128 v[196:199], v19 offset:9216
  s_waitcnt lgkmcnt(5)
  v_mfma_f32_16x16x32_bf16 v[48:51], v[136:139], v[160:163], 0
  ds_read_b128 v[144:147], v18 offset:0
  v_mfma_f32_16x16x32_bf16 v[88:91], v[140:143], v[160:163], 0
  ds_read_b128 v[148:151], v18 offset:2048
  v_mfma_f32_16x16x32_bf16 v[52:55], v[136:139], v[164:167], 0
  ds_read_b128 v[156:159], v34 offset:64
  v_mfma_f32_16x16x32_bf16 v[92:95], v[140:143], v[164:167], 0
  ds_read_b128 v[200:203], v19 offset:10240
  v_mfma_f32_16x16x32_bf16 v[56:59], v[136:139], v[168:171], 0
  ds_read_b128 v[204:207], v19 offset:11264
  v_mfma_f32_16x16x32_bf16 v[96:99], v[140:143], v[168:171], 0
  ds_read_b128 v[208:211], v19 offset:12288
  v_mfma_f32_16x16x32_bf16 v[60:63], v[136:139], v[172:175], 0
  ds_read_b128 v[212:215], v19 offset:13312
  v_mfma_f32_16x16x32_bf16 v[100:103], v[140:143], v[172:175], 0
  ds_read_b128 v[216:219], v19 offset:14336
  v_mfma_f32_16x16x32_bf16 v[64:67], v[136:139], v[176:179], 0
  v_mfma_f32_16x16x32_bf16 v[104:107], v[140:143], v[176:179], 0
  v_mfma_f32_16x16x32_bf16 v[132:135], v[140:143], v[152:155], 0
  v_mfma_f32_16x16x32_bf16 v[128:131], v[136:139], v[152:155], 0
  s_waitcnt lgkmcnt(8)
  v_mfma_f32_16x16x32_bf16 v[68:71], v[136:139], v[180:183], 0
  ds_read_b128 v[220:223], v19 offset:15360
  v_mfma_f32_16x16x32_bf16 v[108:111], v[140:143], v[180:183], 0
  ds_read_b128 v[224:227], v19 offset:16384
  v_mfma_f32_16x16x32_bf16 v[72:75], v[136:139], v[184:187], 0
  ds_read_b128 v[228:231], v19 offset:17408
  v_mfma_f32_16x16x32_bf16 v[112:115], v[140:143], v[184:187], 0
  ds_read_b128 v[232:235], v19 offset:18432
  v_mfma_f32_16x16x32_bf16 v[76:79], v[136:139], v[188:191], 0
  ds_read_b128 v[236:239], v19 offset:19456
  v_mfma_f32_16x16x32_bf16 v[116:119], v[140:143], v[188:191], 0
  v_mfma_f32_16x16x32_bf16 v[80:83], v[136:139], v[192:195], 0
  v_mfma_f32_16x16x32_bf16 v[120:123], v[140:143], v[192:195], 0
  v_mfma_f32_16x16x32_bf16 v[84:87], v[136:139], v[196:199], 0
  v_mfma_f32_16x16x32_bf16 v[124:127], v[140:143], v[196:199], 0
  s_barrier
  s_waitcnt lgkmcnt(5)
  v_mfma_f32_16x16x32_bf16 v[48:51], v[144:147], v[200:203], v[48:51]
  ds_read_b128 v[136:139], v17 offset:36864
  v_mfma_f32_16x16x32_bf16 v[88:91], v[148:151], v[200:203], v[88:91]
  ds_read_b128 v[140:143], v17 offset:38912
  v_mfma_f32_16x16x32_bf16 v[52:55], v[144:147], v[204:207], v[52:55]
  ds_read_b128 v[152:155], v34 offset:128
  v_mfma_f32_16x16x32_bf16 v[92:95], v[148:151], v[204:207], v[92:95]
  ds_read_b128 v[160:163], v19 offset:36864
  v_mfma_f32_16x16x32_bf16 v[56:59], v[144:147], v[208:211], v[56:59]
  ds_read_b128 v[164:167], v19 offset:37888
  v_mfma_f32_16x16x32_bf16 v[96:99], v[148:151], v[208:211], v[96:99]
  ds_read_b128 v[168:171], v19 offset:38912
  v_mfma_f32_16x16x32_bf16 v[60:63], v[144:147], v[212:215], v[60:63]
  ds_read_b128 v[172:175], v19 offset:39936
  v_mfma_f32_16x16x32_bf16 v[100:103], v[148:151], v[212:215], v[100:103]
  ds_read_b128 v[176:179], v19 offset:40960
  v_mfma_f32_16x16x32_bf16 v[64:67], v[144:147], v[216:219], v[64:67]
  v_mfma_f32_16x16x32_bf16 v[104:107], v[148:151], v[216:219], v[104:107]
  v_mfma_f32_16x16x32_bf16 v[132:135], v[148:151], v[156:159], v[132:135]
  v_mfma_f32_16x16x32_bf16 v[128:131], v[144:147], v[156:159], v[128:131]
  s_waitcnt lgkmcnt(8)
  v_mfma_f32_16x16x32_bf16 v[68:71], v[144:147], v[220:223], v[68:71]
  ds_read_b128 v[180:183], v19 offset:41984
  v_mfma_f32_16x16x32_bf16 v[108:111], v[148:151], v[220:223], v[108:111]
  ds_read_b128 v[184:187], v19 offset:43008
  v_mfma_f32_16x16x32_bf16 v[72:75], v[144:147], v[224:227], v[72:75]
  ds_read_b128 v[188:191], v19 offset:44032
  v_mfma_f32_16x16x32_bf16 v[112:115], v[148:151], v[224:227], v[112:115]
  ds_read_b128 v[192:195], v19 offset:45056
  v_mfma_f32_16x16x32_bf16 v[76:79], v[144:147], v[228:231], v[76:79]
  ds_read_b128 v[196:199], v19 offset:46080
  v_mfma_f32_16x16x32_bf16 v[116:119], v[148:151], v[228:231], v[116:119]
  v_mfma_f32_16x16x32_bf16 v[80:83], v[144:147], v[232:235], v[80:83]
  v_mfma_f32_16x16x32_bf16 v[120:123], v[148:151], v[232:235], v[120:123]
  v_mfma_f32_16x16x32_bf16 v[84:87], v[144:147], v[236:239], v[84:87]
  v_mfma_f32_16x16x32_bf16 v[124:127], v[148:151], v[236:239], v[124:127]
  s_waitcnt lgkmcnt(5)
  v_mfma_f32_16x16x32_bf16 v[48:51], v[136:139], v[160:163], v[48:51]
  ds_read_b128 v[144:147], v18 offset:36864
  v_mfma_f32_16x16x32_bf16 v[88:91], v[140:143], v[160:163], v[88:91]
  ds_read_b128 v[148:151], v18 offset:38912
  v_mfma_f32_16x16x32_bf16 v[52:55], v[136:139], v[164:167], v[52:55]
  ds_read_b128 v[156:159], v34 offset:192
  v_mfma_f32_16x16x32_bf16 v[92:95], v[140:143], v[164:167], v[92:95]
  ds_read_b128 v[200:203], v19 offset:47104
  v_mfma_f32_16x16x32_bf16 v[56:59], v[136:139], v[168:171], v[56:59]
  ds_read_b128 v[204:207], v19 offset:48128
  v_mfma_f32_16x16x32_bf16 v[96:99], v[140:143], v[168:171], v[96:99]
  ds_read_b128 v[208:211], v19 offset:49152
  v_mfma_f32_16x16x32_bf16 v[60:63], v[136:139], v[172:175], v[60:63]
  ds_read_b128 v[212:215], v19 offset:50176
  v_mfma_f32_16x16x32_bf16 v[100:103], v[140:143], v[172:175], v[100:103]
  ds_read_b128 v[216:219], v19 offset:51200
  v_mfma_f32_16x16x32_bf16 v[64:67], v[136:139], v[176:179], v[64:67]
  v_mfma_f32_16x16x32_bf16 v[104:107], v[140:143], v[176:179], v[104:107]
  v_mfma_f32_16x16x32_bf16 v[132:135], v[140:143], v[152:155], v[132:135]
  v_mfma_f32_16x16x32_bf16 v[128:131], v[136:139], v[152:155], v[128:131]
  s_waitcnt lgkmcnt(8)
  v_mfma_f32_16x16x32_bf16 v[68:71], v[136:139], v[180:183], v[68:71]
  ds_read_b128 v[220:223], v19 offset:52224
  v_mfma_f32_16x16x32_bf16 v[108:111], v[140:143], v[180:183], v[108:111]
  ds_read_b128 v[224:227], v19 offset:53248
  v_mfma_f32_16x16x32_bf16 v[72:75], v[136:139], v[184:187], v[72:75]
  ds_read_b128 v[228:231], v19 offset:54272
  v_mfma_f32_16x16x32_bf16 v[112:115], v[140:143], v[184:187], v[112:115]
  ds_read_b128 v[232:235], v19 offset:55296
  v_mfma_f32_16x16x32_bf16 v[76:79], v[136:139], v[188:191], v[76:79]
  ds_read_b128 v[236:239], v19 offset:56320
  v_mfma_f32_16x16x32_bf16 v[116:119], v[140:143], v[188:191], v[116:119]
  v_mfma_f32_16x16x32_bf16 v[80:83], v[136:139], v[192:195], v[80:83]
  v_mfma_f32_16x16x32_bf16 v[120:123], v[140:143], v[192:195], v[120:123]
  v_mfma_f32_16x16x32_bf16 v[84:87], v[136:139], v[196:199], v[84:87]
  v_mfma_f32_16x16x32_bf16 v[124:127], v[140:143], v[196:199], v[124:127]
  s_barrier
  s_waitcnt lgkmcnt(5)
  v_mfma_f32_16x16x32_bf16 v[48:51], v[144:147], v[200:203], v[48:51]
  ds_read_b128 v[136:139], v24 offset:0
  v_mfma_f32_16x16x32_bf16 v[88:91], v[148:151], v[200:203], v[88:91]
  ds_read_b128 v[140:143], v24 offset:2048
  v_mfma_f32_16x16x32_bf16 v[52:55], v[144:147], v[204:207], v[52:55]
  ds_read_b128 v[152:155], v34 offset:256
  v_mfma_f32_16x16x32_bf16 v[92:95], v[148:151], v[204:207], v[92:95]
  ds_read_b128 v[160:163], v26 offset:0
  v_mfma_f32_16x16x32_bf16 v[56:59], v[144:147], v[208:211], v[56:59]
  ds_read_b128 v[164:167], v26 offset:1024
  v_mfma_f32_16x16x32_bf16 v[96:99], v[148:151], v[208:211], v[96:99]
  ds_read_b128 v[168:171], v26 offset:2048
  v_mfma_f32_16x16x32_bf16 v[60:63], v[144:147], v[212:215], v[60:63]
  ds_read_b128 v[172:175], v26 offset:3072
  v_mfma_f32_16x16x32_bf16 v[100:103], v[148:151], v[212:215], v[100:103]
  ds_read_b128 v[176:179], v26 offset:4096
  v_mfma_f32_16x16x32_bf16 v[64:67], v[144:147], v[216:219], v[64:67]
  v_mfma_f32_16x16x32_bf16 v[104:107], v[148:151], v[216:219], v[104:107]
  v_mfma_f32_16x16x32_bf16 v[132:135], v[148:151], v[156:159], v[132:135]
  v_mfma_f32_16x16x32_bf16 v[128:131], v[144:147], v[156:159], v[128:131]
  s_waitcnt lgkmcnt(8)
  v_mfma_f32_16x16x32_bf16 v[68:71], v[144:147], v[220:223], v[68:71]
  ds_read_b128 v[180:183], v26 offset:5120
  v_mfma_f32_16x16x32_bf16 v[108:111], v[148:151], v[220:223], v[108:111]
  ds_read_b128 v[184:187], v26 offset:6144
  v_mfma_f32_16x16x32_bf16 v[72:75], v[144:147], v[224:227], v[72:75]
  ds_read_b128 v[188:191], v26 offset:7168
  v_mfma_f32_16x16x32_bf16 v[112:115], v[148:151], v[224:227], v[112:115]
  ds_read_b128 v[192:195], v26 offset:8192
  v_mfma_f32_16x16x32_bf16 v[76:79], v[144:147], v[228:231], v[76:79]
  ds_read_b128 v[196:199], v26 offset:9216
  v_mfma_f32_16x16x32_bf16 v[116:119], v[148:151], v[228:231], v[116:119]
  v_mfma_f32_16x16x32_bf16 v[80:83], v[144:147], v[232:235], v[80:83]
  v_mfma_f32_16x16x32_bf16 v[120:123], v[148:151], v[232:235], v[120:123]
  v_mfma_f32_16x16x32_bf16 v[84:87], v[144:147], v[236:239], v[84:87]
  v_mfma_f32_16x16x32_bf16 v[124:127], v[148:151], v[236:239], v[124:127]
  s_waitcnt lgkmcnt(5)
  v_mfma_f32_16x16x32_bf16 v[48:51], v[136:139], v[160:163], v[48:51]
  ds_read_b128 v[144:147], v25 offset:0
  v_mfma_f32_16x16x32_bf16 v[88:91], v[140:143], v[160:163], v[88:91]
  ds_read_b128 v[148:151], v25 offset:2048
  v_mfma_f32_16x16x32_bf16 v[52:55], v[136:139], v[164:167], v[52:55]
  ds_read_b128 v[156:159], v34 offset:320
  v_mfma_f32_16x16x32_bf16 v[92:95], v[140:143], v[164:167], v[92:95]
  ds_read_b128 v[200:203], v26 offset:10240
  v_mfma_f32_16x16x32_bf16 v[56:59], v[136:139], v[168:171], v[56:59]
  ds_read_b128 v[204:207], v26 offset:11264
  v_mfma_f32_16x16x32_bf16 v[96:99], v[140:143], v[168:171], v[96:99]
  ds_read_b128 v[208:211], v26 offset:12288
  v_mfma_f32_16x16x32_bf16 v[60:63], v[136:139], v[172:175], v[60:63]
  ds_read_b128 v[212:215], v26 offset:13312
  v_mfma_f32_16x16x32_bf16 v[100:103], v[140:143], v[172:175], v[100:103]
  ds_read_b128 v[216:219], v26 offset:14336
  v_mfma_f32_16x16x32_bf16 v[64:67], v[136:139], v[176:179], v[64:67]
  v_mfma_f32_16x16x32_bf16 v[104:107], v[140:143], v[176:179], v[104:107]
  v_mfma_f32_16x16x32_bf16 v[132:135], v[140:143], v[152:155], v[132:135]
  v_mfma_f32_16x16x32_bf16 v[128:131], v[136:139], v[152:155], v[128:131]
  s_waitcnt lgkmcnt(8)
  v_mfma_f32_16x16x32_bf16 v[68:71], v[136:139], v[180:183], v[68:71]
  ds_read_b128 v[220:223], v26 offset:15360
  v_mfma_f32_16x16x32_bf16 v[108:111], v[140:143], v[180:183], v[108:111]
  ds_read_b128 v[224:227], v26 offset:16384
  v_mfma_f32_16x16x32_bf16 v[72:75], v[136:139], v[184:187], v[72:75]
  ds_read_b128 v[228:231], v26 offset:17408
  v_mfma_f32_16x16x32_bf16 v[112:115], v[140:143], v[184:187], v[112:115]
  ds_read_b128 v[232:235], v26 offset:18432
  v_mfma_f32_16x16x32_bf16 v[76:79], v[136:139], v[188:191], v[76:79]
  ds_read_b128 v[236:239], v26 offset:19456
  v_mfma_f32_16x16x32_bf16 v[116:119], v[140:143], v[188:191], v[116:119]
  v_mfma_f32_16x16x32_bf16 v[80:83], v[136:139], v[192:195], v[80:83]
  v_mfma_f32_16x16x32_bf16 v[120:123], v[140:143], v[192:195], v[120:123]
  v_mfma_f32_16x16x32_bf16 v[84:87], v[136:139], v[196:199], v[84:87]
  v_mfma_f32_16x16x32_bf16 v[124:127], v[140:143], v[196:199], v[124:127]
  s_barrier
  s_waitcnt lgkmcnt(5)
  v_mfma_f32_16x16x32_bf16 v[48:51], v[144:147], v[200:203], v[48:51]
  ds_read_b128 v[136:139], v24 offset:36864
  v_mfma_f32_16x16x32_bf16 v[88:91], v[148:151], v[200:203], v[88:91]
  ds_read_b128 v[140:143], v24 offset:38912
  v_mfma_f32_16x16x32_bf16 v[52:55], v[144:147], v[204:207], v[52:55]
  ds_read_b128 v[152:155], v34 offset:384
  v_mfma_f32_16x16x32_bf16 v[92:95], v[148:151], v[204:207], v[92:95]
  ds_read_b128 v[160:163], v26 offset:36864
  v_mfma_f32_16x16x32_bf16 v[56:59], v[144:147], v[208:211], v[56:59]
  ds_read_b128 v[164:167], v26 offset:37888
  v_mfma_f32_16x16x32_bf16 v[96:99], v[148:151], v[208:211], v[96:99]
  ds_read_b128 v[168:171], v26 offset:38912
  v_mfma_f32_16x16x32_bf16 v[60:63], v[144:147], v[212:215], v[60:63]
  ds_read_b128 v[172:175], v26 offset:39936
  v_mfma_f32_16x16x32_bf16 v[100:103], v[148:151], v[212:215], v[100:103]
  ds_read_b128 v[176:179], v26 offset:40960
  v_mfma_f32_16x16x32_bf16 v[64:67], v[144:147], v[216:219], v[64:67]
  v_mfma_f32_16x16x32_bf16 v[104:107], v[148:151], v[216:219], v[104:107]
  v_mfma_f32_16x16x32_bf16 v[132:135], v[148:151], v[156:159], v[132:135]
  v_mfma_f32_16x16x32_bf16 v[128:131], v[144:147], v[156:159], v[128:131]
  s_waitcnt lgkmcnt(8)
  v_mfma_f32_16x16x32_bf16 v[68:71], v[144:147], v[220:223], v[68:71]
  ds_read_b128 v[180:183], v26 offset:41984
  v_mfma_f32_16x16x32_bf16 v[108:111], v[148:151], v[220:223], v[108:111]
  ds_read_b128 v[184:187], v26 offset:43008
  v_mfma_f32_16x16x32_bf16 v[72:75], v[144:147], v[224:227], v[72:75]
  ds_read_b128 v[188:191], v26 offset:44032
  v_mfma_f32_16x16x32_bf16 v[112:115], v[148:151], v[224:227], v[112:115]
  ds_read_b128 v[192:195], v26 offset:45056
  v_mfma_f32_16x16x32_bf16 v[76:79], v[144:147], v[228:231], v[76:79]
  ds_read_b128 v[196:199], v26 offset:46080
  v_mfma_f32_16x16x32_bf16 v[116:119], v[148:151], v[228:231], v[116:119]
  v_mfma_f32_16x16x32_bf16 v[80:83], v[144:147], v[232:235], v[80:83]
  v_mfma_f32_16x16x32_bf16 v[120:123], v[148:151], v[232:235], v[120:123]
  v_mfma_f32_16x16x32_bf16 v[84:87], v[144:147], v[236:239], v[84:87]
  v_mfma_f32_16x16x32_bf16 v[124:127], v[148:151], v[236:239], v[124:127]
  s_waitcnt lgkmcnt(5)
  v_mfma_f32_16x16x32_bf16 v[48:51], v[136:139], v[160:163], v[48:51]
  ds_read_b128 v[144:147], v25 offset:36864
  v_mfma_f32_16x16x32_bf16 v[88:91], v[140:143], v[160:163], v[88:91]
  ds_read_b128 v[148:151], v25 offset:38912
  v_mfma_f32_16x16x32_bf16 v[52:55], v[136:139], v[164:167], v[52:55]
  ds_read_b128 v[156:159], v34 offset:448
  v_mfma_f32_16x16x32_bf16 v[92:95], v[140:143], v[164:167], v[92:95]
  ds_read_b128 v[200:203], v26 offset:47104
  v_mfma_f32_16x16x32_bf16 v[56:59], v[136:139], v[168:171], v[56:59]
  ds_read_b128 v[204:207], v26 offset:48128
  v_mfma_f32_16x16x32_bf16 v[96:99], v[140:143], v[168:171], v[96:99]
  ds_read_b128 v[208:211], v26 offset:49152
  v_mfma_f32_16x16x32_bf16 v[60:63], v[136:139], v[172:175], v[60:63]
  ds_read_b128 v[212:215], v26 offset:50176
  v_mfma_f32_16x16x32_bf16 v[100:103], v[140:143], v[172:175], v[100:103]
  ds_read_b128 v[216:219], v26 offset:51200
  v_mfma_f32_16x16x32_bf16 v[64:67], v[136:139], v[176:179], v[64:67]
  v_mfma_f32_16x16x32_bf16 v[104:107], v[140:143], v[176:179], v[104:107]
  v_mfma_f32_16x16x32_bf16 v[132:135], v[140:143], v[152:155], v[132:135]
  v_mfma_f32_16x16x32_bf16 v[128:131], v[136:139], v[152:155], v[128:131]
  s_waitcnt lgkmcnt(8)
  v_mfma_f32_16x16x32_bf16 v[68:71], v[136:139], v[180:183], v[68:71]
  ds_read_b128 v[220:223], v26 offset:52224
  v_mfma_f32_16x16x32_bf16 v[108:111], v[140:143], v[180:183], v[108:111]
  ds_read_b128 v[224:227], v26 offset:53248
  v_mfma_f32_16x16x32_bf16 v[72:75], v[136:139], v[184:187], v[72:75]
  ds_read_b128 v[228:231], v26 offset:54272
  v_mfma_f32_16x16x32_bf16 v[112:115], v[140:143], v[184:187], v[112:115]
  ds_read_b128 v[232:235], v26 offset:55296
  v_mfma_f32_16x16x32_bf16 v[76:79], v[136:139], v[188:191], v[76:79]
  ds_read_b128 v[236:239], v26 offset:56320
  v_mfma_f32_16x16x32_bf16 v[116:119], v[140:143], v[188:191], v[116:119]
  v_mfma_f32_16x16x32_bf16 v[80:83], v[136:139], v[192:195], v[80:83]
  v_mfma_f32_16x16x32_bf16 v[120:123], v[140:143], v[192:195], v[120:123]
  v_mfma_f32_16x16x32_bf16 v[84:87], v[136:139], v[196:199], v[84:87]
  v_mfma_f32_16x16x32_bf16 v[124:127], v[140:143], v[196:199], v[124:127]
  s_barrier
  s_waitcnt lgkmcnt(5)
  v_mfma_f32_16x16x32_bf16 v[48:51], v[144:147], v[200:203], v[48:51]
  ds_read_b128 v[136:139], v17 offset:0
  v_mfma_f32_16x16x32_bf16 v[88:91], v[148:151], v[200:203], v[88:91]
  ds_read_b128 v[140:143], v17 offset:2048
  v_mfma_f32_16x16x32_bf16 v[52:55], v[144:147], v[204:207], v[52:55]
  ds_read_b128 v[152:155], v34 offset:512
  v_mfma_f32_16x16x32_bf16 v[92:95], v[148:151], v[204:207], v[92:95]
  ds_read_b128 v[160:163], v19 offset:0
  v_mfma_f32_16x16x32_bf16 v[56:59], v[144:147], v[208:211], v[56:59]
  ds_read_b128 v[164:167], v19 offset:1024
  v_mfma_f32_16x16x32_bf16 v[96:99], v[148:151], v[208:211], v[96:99]
  ds_read_b128 v[168:171], v19 offset:2048
  v_mfma_f32_16x16x32_bf16 v[60:63], v[144:147], v[212:215], v[60:63]
  ds_read_b128 v[172:175], v19 offset:3072
  v_mfma_f32_16x16x32_bf16 v[100:103], v[148:151], v[212:215], v[100:103]
  ds_read_b128 v[176:179], v19 offset:4096
  v_mfma_f32_16x16x32_bf16 v[64:67], v[144:147], v[216:219], v[64:67]
  v_mfma_f32_16x16x32_bf16 v[104:107], v[148:151], v[216:219], v[104:107]
  v_mfma_f32_16x16x32_bf16 v[132:135], v[148:151], v[156:159], v[132:135]
  v_mfma_f32_16x16x32_bf16 v[128:131], v[144:147], v[156:159], v[128:131]
  s_waitcnt lgkmcnt(8)
  v_mfma_f32_16x16x32_bf16 v[68:71], v[144:147], v[220:223], v[68:71]
  ds_read_b128 v[180:183], v19 offset:5120
  v_mfma_f32_16x16x32_bf16 v[108:111], v[148:151], v[220:223], v[108:111]
  ds_read_b128 v[184:187], v19 offset:6144
  v_mfma_f32_16x16x32_bf16 v[72:75], v[144:147], v[224:227], v[72:75]
  ds_read_b128 v[188:191], v19 offset:7168
  v_mfma_f32_16x16x32_bf16 v[112:115], v[148:151], v[224:227], v[112:115]
  ds_read_b128 v[192:195], v19 offset:8192
  v_mfma_f32_16x16x32_bf16 v[76:79], v[144:147], v[228:231], v[76:79]
  ds_read_b128 v[196:199], v19 offset:9216
  v_mfma_f32_16x16x32_bf16 v[116:119], v[148:151], v[228:231], v[116:119]
  v_mfma_f32_16x16x32_bf16 v[80:83], v[144:147], v[232:235], v[80:83]
  v_mfma_f32_16x16x32_bf16 v[120:123], v[148:151], v[232:235], v[120:123]
  v_mfma_f32_16x16x32_bf16 v[84:87], v[144:147], v[236:239], v[84:87]
  v_mfma_f32_16x16x32_bf16 v[124:127], v[148:151], v[236:239], v[124:127]
  s_waitcnt lgkmcnt(5)
  v_mfma_f32_16x16x32_bf16 v[48:51], v[136:139], v[160:163], v[48:51]
  ds_read_b128 v[144:147], v18 offset:0
  v_mfma_f32_16x16x32_bf16 v[88:91], v[140:143], v[160:163], v[88:91]
  ds_read_b128 v[148:151], v18 offset:2048
  v_mfma_f32_16x16x32_bf16 v[52:55], v[136:139], v[164:167], v[52:55]
  ds_read_b128 v[156:159], v34 offset:576
  v_mfma_f32_16x16x32_bf16 v[92:95], v[140:143], v[164:167], v[92:95]
  ds_read_b128 v[200:203], v19 offset:10240
  v_mfma_f32_16x16x32_bf16 v[56:59], v[136:139], v[168:171], v[56:59]
  ds_read_b128 v[204:207], v19 offset:11264
  v_mfma_f32_16x16x32_bf16 v[96:99], v[140:143], v[168:171], v[96:99]
  ds_read_b128 v[208:211], v19 offset:12288
  v_mfma_f32_16x16x32_bf16 v[60:63], v[136:139], v[172:175], v[60:63]
  ds_read_b128 v[212:215], v19 offset:13312
  v_mfma_f32_16x16x32_bf16 v[100:103], v[140:143], v[172:175], v[100:103]
  ds_read_b128 v[216:219], v19 offset:14336
  v_mfma_f32_16x16x32_bf16 v[64:67], v[136:139], v[176:179], v[64:67]
  v_mfma_f32_16x16x32_bf16 v[104:107], v[140:143], v[176:179], v[104:107]
  v_mfma_f32_16x16x32_bf16 v[132:135], v[140:143], v[152:155], v[132:135]
  v_mfma_f32_16x16x32_bf16 v[128:131], v[136:139], v[152:155], v[128:131]
  s_waitcnt lgkmcnt(8)
  v_mfma_f32_16x16x32_bf16 v[68:71], v[136:139], v[180:183], v[68:71]
  ds_read_b128 v[220:223], v19 offset:15360
  v_mfma_f32_16x16x32_bf16 v[108:111], v[140:143], v[180:183], v[108:111]
  ds_read_b128 v[224:227], v19 offset:16384
  v_mfma_f32_16x16x32_bf16 v[72:75], v[136:139], v[184:187], v[72:75]
  ds_read_b128 v[228:231], v19 offset:17408
  v_mfma_f32_16x16x32_bf16 v[112:115], v[140:143], v[184:187], v[112:115]
  ds_read_b128 v[232:235], v19 offset:18432
  v_mfma_f32_16x16x32_bf16 v[76:79], v[136:139], v[188:191], v[76:79]
  ds_read_b128 v[236:239], v19 offset:19456
  v_mfma_f32_16x16x32_bf16 v[116:119], v[140:143], v[188:191], v[116:119]
  v_mfma_f32_16x16x32_bf16 v[80:83], v[136:139], v[192:195], v[80:83]
  v_mfma_f32_16x16x32_bf16 v[120:123], v[140:143], v[192:195], v[120:123]
  v_mfma_f32_16x16x32_bf16 v[84:87], v[136:139], v[196:199], v[84:87]
  v_mfma_f32_16x16x32_bf16 v[124:127], v[140:143], v[196:199], v[124:127]
  s_barrier
  s_waitcnt lgkmcnt(5)
  v_mfma_f32_16x16x32_bf16 v[48:51], v[144:147], v[200:203], v[48:51]
  ds_read_b128 v[136:139], v17 offset:36864
  v_mfma_f32_16x16x32_bf16 v[88:91], v[148:151], v[200:203], v[88:91]
  ds_read_b128 v[140:143], v17 offset:38912
  v_mfma_f32_16x16x32_bf16 v[52:55], v[144:147], v[204:207], v[52:55]
  ds_read_b128 v[152:155], v34 offset:640
  v_mfma_f32_16x16x32_bf16 v[92:95], v[148:151], v[204:207], v[92:95]
  ds_read_b128 v[160:163], v19 offset:36864
  v_mfma_f32_16x16x32_bf16 v[56:59], v[144:147], v[208:211], v[56:59]
  ds_read_b128 v[164:167], v19 offset:37888
  v_mfma_f32_16x16x32_bf16 v[96:99], v[148:151], v[208:211], v[96:99]
  ds_read_b128 v[168:171], v19 offset:38912
  v_mfma_f32_16x16x32_bf16 v[60:63], v[144:147], v[212:215], v[60:63]
  ds_read_b128 v[172:175], v19 offset:39936
  v_mfma_f32_16x16x32_bf16 v[100:103], v[148:151], v[212:215], v[100:103]
  ds_read_b128 v[176:179], v19 offset:40960
  v_mfma_f32_16x16x32_bf16 v[64:67], v[144:147], v[216:219], v[64:67]
  v_mfma_f32_16x16x32_bf16 v[104:107], v[148:151], v[216:219], v[104:107]
  v_mfma_f32_16x16x32_bf16 v[132:135], v[148:151], v[156:159], v[132:135]
  v_mfma_f32_16x16x32_bf16 v[128:131], v[144:147], v[156:159], v[128:131]
  s_waitcnt lgkmcnt(8)
  v_mfma_f32_16x16x32_bf16 v[68:71], v[144:147], v[220:223], v[68:71]
  ds_read_b128 v[180:183], v19 offset:41984
  v_mfma_f32_16x16x32_bf16 v[108:111], v[148:151], v[220:223], v[108:111]
  ds_read_b128 v[184:187], v19 offset:43008
  v_mfma_f32_16x16x32_bf16 v[72:75], v[144:147], v[224:227], v[72:75]
  ds_read_b128 v[188:191], v19 offset:44032
  v_mfma_f32_16x16x32_bf16 v[112:115], v[148:151], v[224:227], v[112:115]
  ds_read_b128 v[192:195], v19 offset:45056
  v_mfma_f32_16x16x32_bf16 v[76:79], v[144:147], v[228:231], v[76:79]
  ds_read_b128 v[196:199], v19 offset:46080
  v_mfma_f32_16x16x32_bf16 v[116:119], v[148:151], v[228:231], v[116:119]
  v_mfma_f32_16x16x32_bf16 v[80:83], v[144:147], v[232:235], v[80:83]
  v_mfma_f32_16x16x32_bf16 v[120:123], v[148:151], v[232:235], v[120:123]
  v_mfma_f32_16x16x32_bf16 v[84:87], v[144:147], v[236:239], v[84:87]
  v_mfma_f32_16x16x32_bf16 v[124:127], v[148:151], v[236:239], v[124:127]
  s_waitcnt lgkmcnt(5)
  v_mfma_f32_16x16x32_bf16 v[48:51], v[136:139], v[160:163], v[48:51]
  ds_read_b128 v[144:147], v18 offset:36864
  v_mfma_f32_16x16x32_bf16 v[88:91], v[140:143], v[160:163], v[88:91]
  ds_read_b128 v[148:151], v18 offset:38912
  v_mfma_f32_16x16x32_bf16 v[52:55], v[136:139], v[164:167], v[52:55]
  ds_read_b128 v[156:159], v34 offset:704
  v_mfma_f32_16x16x32_bf16 v[92:95], v[140:143], v[164:167], v[92:95]
  ds_read_b128 v[200:203], v19 offset:47104
  v_mfma_f32_16x16x32_bf16 v[56:59], v[136:139], v[168:171], v[56:59]
  ds_read_b128 v[204:207], v19 offset:48128
  v_mfma_f32_16x16x32_bf16 v[96:99], v[140:143], v[168:171], v[96:99]
  ds_read_b128 v[208:211], v19 offset:49152
  v_mfma_f32_16x16x32_bf16 v[60:63], v[136:139], v[172:175], v[60:63]
  ds_read_b128 v[212:215], v19 offset:50176
  v_mfma_f32_16x16x32_bf16 v[100:103], v[140:143], v[172:175], v[100:103]
  ds_read_b128 v[216:219], v19 offset:51200
  v_mfma_f32_16x16x32_bf16 v[64:67], v[136:139], v[176:179], v[64:67]
  v_mfma_f32_16x16x32_bf16 v[104:107], v[140:143], v[176:179], v[104:107]
  v_mfma_f32_16x16x32_bf16 v[132:135], v[140:143], v[152:155], v[132:135]
  v_mfma_f32_16x16x32_bf16 v[128:131], v[136:139], v[152:155], v[128:131]
  s_waitcnt lgkmcnt(8)
  v_mfma_f32_16x16x32_bf16 v[68:71], v[136:139], v[180:183], v[68:71]
  ds_read_b128 v[220:223], v19 offset:52224
  v_mfma_f32_16x16x32_bf16 v[108:111], v[140:143], v[180:183], v[108:111]
  ds_read_b128 v[224:227], v19 offset:53248
  v_mfma_f32_16x16x32_bf16 v[72:75], v[136:139], v[184:187], v[72:75]
  ds_read_b128 v[228:231], v19 offset:54272
  v_mfma_f32_16x16x32_bf16 v[112:115], v[140:143], v[184:187], v[112:115]
  ds_read_b128 v[232:235], v19 offset:55296
  v_mfma_f32_16x16x32_bf16 v[76:79], v[136:139], v[188:191], v[76:79]
  ds_read_b128 v[236:239], v19 offset:56320
  v_mfma_f32_16x16x32_bf16 v[116:119], v[140:143], v[188:191], v[116:119]
  v_mfma_f32_16x16x32_bf16 v[80:83], v[136:139], v[192:195], v[80:83]
  v_mfma_f32_16x16x32_bf16 v[120:123], v[140:143], v[192:195], v[120:123]
  v_mfma_f32_16x16x32_bf16 v[84:87], v[136:139], v[196:199], v[84:87]
  v_mfma_f32_16x16x32_bf16 v[124:127], v[140:143], v[196:199], v[124:127]
  s_barrier
  s_waitcnt lgkmcnt(5)
  v_mfma_f32_16x16x32_bf16 v[48:51], v[144:147], v[200:203], v[48:51]
  ds_read_b128 v[136:139], v24 offset:0
  v_mfma_f32_16x16x32_bf16 v[88:91], v[148:151], v[200:203], v[88:91]
  ds_read_b128 v[140:143], v24 offset:2048
  v_mfma_f32_16x16x32_bf16 v[52:55], v[144:147], v[204:207], v[52:55]
  ds_read_b128 v[152:155], v34 offset:768
  v_mfma_f32_16x16x32_bf16 v[92:95], v[148:151], v[204:207], v[92:95]
  ds_read_b128 v[160:163], v26 offset:0
  v_mfma_f32_16x16x32_bf16 v[56:59], v[144:147], v[208:211], v[56:59]
  ds_read_b128 v[164:167], v26 offset:1024
  v_mfma_f32_16x16x32_bf16 v[96:99], v[148:151], v[208:211], v[96:99]
  ds_read_b128 v[168:171], v26 offset:2048
  v_mfma_f32_16x16x32_bf16 v[60:63], v[144:147], v[212:215], v[60:63]
  ds_read_b128 v[172:175], v26 offset:3072
  v_mfma_f32_16x16x32_bf16 v[100:103], v[148:151], v[212:215], v[100:103]
  ds_read_b128 v[176:179], v26 offset:4096
  v_mfma_f32_16x16x32_bf16 v[64:67], v[144:147], v[216:219], v[64:67]
  v_mfma_f32_16x16x32_bf16 v[104:107], v[148:151], v[216:219], v[104:107]
  v_mfma_f32_16x16x32_bf16 v[132:135], v[148:151], v[156:159], v[132:135]
  v_mfma_f32_16x16x32_bf16 v[128:131], v[144:147], v[156:159], v[128:131]
  s_waitcnt lgkmcnt(8)
  v_mfma_f32_16x16x32_bf16 v[68:71], v[144:147], v[220:223], v[68:71]
  ds_read_b128 v[180:183], v26 offset:5120
  v_mfma_f32_16x16x32_bf16 v[108:111], v[148:151], v[220:223], v[108:111]
  ds_read_b128 v[184:187], v26 offset:6144
  v_mfma_f32_16x16x32_bf16 v[72:75], v[144:147], v[224:227], v[72:75]
  ds_read_b128 v[188:191], v26 offset:7168
  v_mfma_f32_16x16x32_bf16 v[112:115], v[148:151], v[224:227], v[112:115]
  ds_read_b128 v[192:195], v26 offset:8192
  v_mfma_f32_16x16x32_bf16 v[76:79], v[144:147], v[228:231], v[76:79]
  ds_read_b128 v[196:199], v26 offset:9216
  v_mfma_f32_16x16x32_bf16 v[116:119], v[148:151], v[228:231], v[116:119]
  v_mfma_f32_16x16x32_bf16 v[80:83], v[144:147], v[232:235], v[80:83]
  v_mfma_f32_16x16x32_bf16 v[120:123], v[148:151], v[232:235], v[120:123]
  v_mfma_f32_16x16x32_bf16 v[84:87], v[144:147], v[236:239], v[84:87]
  v_mfma_f32_16x16x32_bf16 v[124:127], v[148:151], v[236:239], v[124:127]
  s_waitcnt lgkmcnt(5)
  v_mfma_f32_16x16x32_bf16 v[48:51], v[136:139], v[160:163], v[48:51]
  ds_read_b128 v[144:147], v25 offset:0
  v_mfma_f32_16x16x32_bf16 v[88:91], v[140:143], v[160:163], v[88:91]
  ds_read_b128 v[148:151], v25 offset:2048
  v_mfma_f32_16x16x32_bf16 v[52:55], v[136:139], v[164:167], v[52:55]
  ds_read_b128 v[156:159], v34 offset:832
  v_mfma_f32_16x16x32_bf16 v[92:95], v[140:143], v[164:167], v[92:95]
  ds_read_b128 v[200:203], v26 offset:10240
  v_mfma_f32_16x16x32_bf16 v[56:59], v[136:139], v[168:171], v[56:59]
  ds_read_b128 v[204:207], v26 offset:11264
  v_mfma_f32_16x16x32_bf16 v[96:99], v[140:143], v[168:171], v[96:99]
  ds_read_b128 v[208:211], v26 offset:12288
  v_mfma_f32_16x16x32_bf16 v[60:63], v[136:139], v[172:175], v[60:63]
  ds_read_b128 v[212:215], v26 offset:13312
  v_mfma_f32_16x16x32_bf16 v[100:103], v[140:143], v[172:175], v[100:103]
  ds_read_b128 v[216:219], v26 offset:14336
  v_mfma_f32_16x16x32_bf16 v[64:67], v[136:139], v[176:179], v[64:67]
  v_mfma_f32_16x16x32_bf16 v[104:107], v[140:143], v[176:179], v[104:107]
  v_mfma_f32_16x16x32_bf16 v[132:135], v[140:143], v[152:155], v[132:135]
  v_mfma_f32_16x16x32_bf16 v[128:131], v[136:139], v[152:155], v[128:131]
  s_waitcnt lgkmcnt(8)
  v_mfma_f32_16x16x32_bf16 v[68:71], v[136:139], v[180:183], v[68:71]
  ds_read_b128 v[220:223], v26 offset:15360
  v_mfma_f32_16x16x32_bf16 v[108:111], v[140:143], v[180:183], v[108:111]
  ds_read_b128 v[224:227], v26 offset:16384
  v_mfma_f32_16x16x32_bf16 v[72:75], v[136:139], v[184:187], v[72:75]
  ds_read_b128 v[228:231], v26 offset:17408
  v_mfma_f32_16x16x32_bf16 v[112:115], v[140:143], v[184:187], v[112:115]
  ds_read_b128 v[232:235], v26 offset:18432
  v_mfma_f32_16x16x32_bf16 v[76:79], v[136:139], v[188:191], v[76:79]
  ds_read_b128 v[236:239], v26 offset:19456
  v_mfma_f32_16x16x32_bf16 v[116:119], v[140:143], v[188:191], v[116:119]
  v_mfma_f32_16x16x32_bf16 v[80:83], v[136:139], v[192:195], v[80:83]
  v_mfma_f32_16x16x32_bf16 v[120:123], v[140:143], v[192:195], v[120:123]
  v_mfma_f32_16x16x32_bf16 v[84:87], v[136:139], v[196:199], v[84:87]
  v_mfma_f32_16x16x32_bf16 v[124:127], v[140:143], v[196:199], v[124:127]
  s_barrier
  s_waitcnt lgkmcnt(5)
  v_mfma_f32_16x16x32_bf16 v[48:51], v[144:147], v[200:203], v[48:51]
  ds_read_b128 v[136:139], v24 offset:36864
  v_mfma_f32_16x16x32_bf16 v[88:91], v[148:151], v[200:203], v[88:91]
  ds_read_b128 v[140:143], v24 offset:38912
  v_mfma_f32_16x16x32_bf16 v[52:55], v[144:147], v[204:207], v[52:55]
  ds_read_b128 v[152:155], v34 offset:896
  v_mfma_f32_16x16x32_bf16 v[92:95], v[148:151], v[204:207], v[92:95]
  ds_read_b128 v[160:163], v26 offset:36864
  v_mfma_f32_16x16x32_bf16 v[56:59], v[144:147], v[208:211], v[56:59]
  ds_read_b128 v[164:167], v26 offset:37888
  v_mfma_f32_16x16x32_bf16 v[96:99], v[148:151], v[208:211], v[96:99]
  ds_read_b128 v[168:171], v26 offset:38912
  v_mfma_f32_16x16x32_bf16 v[60:63], v[144:147], v[212:215], v[60:63]
  ds_read_b128 v[172:175], v26 offset:39936
  v_mfma_f32_16x16x32_bf16 v[100:103], v[148:151], v[212:215], v[100:103]
  ds_read_b128 v[176:179], v26 offset:40960
  v_mfma_f32_16x16x32_bf16 v[64:67], v[144:147], v[216:219], v[64:67]
  v_mfma_f32_16x16x32_bf16 v[104:107], v[148:151], v[216:219], v[104:107]
  v_mfma_f32_16x16x32_bf16 v[132:135], v[148:151], v[156:159], v[132:135]
  v_mfma_f32_16x16x32_bf16 v[128:131], v[144:147], v[156:159], v[128:131]
  s_waitcnt lgkmcnt(8)
  v_mfma_f32_16x16x32_bf16 v[68:71], v[144:147], v[220:223], v[68:71]
  ds_read_b128 v[180:183], v26 offset:41984
  v_mfma_f32_16x16x32_bf16 v[108:111], v[148:151], v[220:223], v[108:111]
  ds_read_b128 v[184:187], v26 offset:43008
  v_mfma_f32_16x16x32_bf16 v[72:75], v[144:147], v[224:227], v[72:75]
  ds_read_b128 v[188:191], v26 offset:44032
  v_mfma_f32_16x16x32_bf16 v[112:115], v[148:151], v[224:227], v[112:115]
  ds_read_b128 v[192:195], v26 offset:45056
  v_mfma_f32_16x16x32_bf16 v[76:79], v[144:147], v[228:231], v[76:79]
  ds_read_b128 v[196:199], v26 offset:46080
  v_mfma_f32_16x16x32_bf16 v[116:119], v[148:151], v[228:231], v[116:119]
  v_mfma_f32_16x16x32_bf16 v[80:83], v[144:147], v[232:235], v[80:83]
  v_mfma_f32_16x16x32_bf16 v[120:123], v[148:151], v[232:235], v[120:123]
  v_mfma_f32_16x16x32_bf16 v[84:87], v[144:147], v[236:239], v[84:87]
  v_mfma_f32_16x16x32_bf16 v[124:127], v[148:151], v[236:239], v[124:127]
  s_waitcnt lgkmcnt(5)
  v_mfma_f32_16x16x32_bf16 v[48:51], v[136:139], v[160:163], v[48:51]
  ds_read_b128 v[144:147], v25 offset:36864
  v_mfma_f32_16x16x32_bf16 v[88:91], v[140:143], v[160:163], v[88:91]
  ds_read_b128 v[148:151], v25 offset:38912
  v_mfma_f32_16x16x32_bf16 v[52:55], v[136:139], v[164:167], v[52:55]
  ds_read_b128 v[156:159], v34 offset:960
  v_mfma_f32_16x16x32_bf16 v[92:95], v[140:143], v[164:167], v[92:95]
  ds_read_b128 v[200:203], v26 offset:47104
  v_mfma_f32_16x16x32_bf16 v[56:59], v[136:139], v[168:171], v[56:59]
  ds_read_b128 v[204:207], v26 offset:48128
  v_mfma_f32_16x16x32_bf16 v[96:99], v[140:143], v[168:171], v[96:99]
  ds_read_b128 v[208:211], v26 offset:49152
  v_mfma_f32_16x16x32_bf16 v[60:63], v[136:139], v[172:175], v[60:63]
  ds_read_b128 v[212:215], v26 offset:50176
  v_mfma_f32_16x16x32_bf16 v[100:103], v[140:143], v[172:175], v[100:103]
  ds_read_b128 v[216:219], v26 offset:51200
  v_mfma_f32_16x16x32_bf16 v[64:67], v[136:139], v[176:179], v[64:67]
  v_mfma_f32_16x16x32_bf16 v[104:107], v[140:143], v[176:179], v[104:107]
  v_mfma_f32_16x16x32_bf16 v[132:135], v[140:143], v[152:155], v[132:135]
  v_mfma_f32_16x16x32_bf16 v[128:131], v[136:139], v[152:155], v[128:131]
  s_waitcnt lgkmcnt(8)
  v_mfma_f32_16x16x32_bf16 v[68:71], v[136:139], v[180:183], v[68:71]
  ds_read_b128 v[220:223], v26 offset:52224
  v_mfma_f32_16x16x32_bf16 v[108:111], v[140:143], v[180:183], v[108:111]
  ds_read_b128 v[224:227], v26 offset:53248
  v_mfma_f32_16x16x32_bf16 v[72:75], v[136:139], v[184:187], v[72:75]
  ds_read_b128 v[228:231], v26 offset:54272
  v_mfma_f32_16x16x32_bf16 v[112:115], v[140:143], v[184:187], v[112:115]
  ds_read_b128 v[232:235], v26 offset:55296
  v_mfma_f32_16x16x32_bf16 v[76:79], v[136:139], v[188:191], v[76:79]
  ds_read_b128 v[236:239], v26 offset:56320
  v_mfma_f32_16x16x32_bf16 v[116:119], v[140:143], v[188:191], v[116:119]
  v_mfma_f32_16x16x32_bf16 v[80:83], v[136:139], v[192:195], v[80:83]
  v_mfma_f32_16x16x32_bf16 v[120:123], v[140:143], v[192:195], v[120:123]
  v_mfma_f32_16x16x32_bf16 v[84:87], v[136:139], v[196:199], v[84:87]
  v_mfma_f32_16x16x32_bf16 v[124:127], v[140:143], v[196:199], v[124:127]
  s_barrier
  s_waitcnt lgkmcnt(5)
  v_mfma_f32_16x16x32_bf16 v[48:51], v[144:147], v[200:203], v[48:51]
  ds_read_b128 v[136:139], v17 offset:0
  v_mfma_f32_16x16x32_bf16 v[88:91], v[148:151], v[200:203], v[88:91]
  ds_read_b128 v[140:143], v17 offset:2048
  v_mfma_f32_16x16x32_bf16 v[52:55], v[144:147], v[204:207], v[52:55]
  ds_read_b128 v[152:155], v34 offset:1024
  v_mfma_f32_16x16x32_bf16 v[92:95], v[148:151], v[204:207], v[92:95]
  ds_read_b128 v[160:163], v19 offset:0
  v_mfma_f32_16x16x32_bf16 v[56:59], v[144:147], v[208:211], v[56:59]
  ds_read_b128 v[164:167], v19 offset:1024
  v_mfma_f32_16x16x32_bf16 v[96:99], v[148:151], v[208:211], v[96:99]
  ds_read_b128 v[168:171], v19 offset:2048
  v_mfma_f32_16x16x32_bf16 v[60:63], v[144:147], v[212:215], v[60:63]
  ds_read_b128 v[172:175], v19 offset:3072
  v_mfma_f32_16x16x32_bf16 v[100:103], v[148:151], v[212:215], v[100:103]
  ds_read_b128 v[176:179], v19 offset:4096
  v_mfma_f32_16x16x32_bf16 v[64:67], v[144:147], v[216:219], v[64:67]
  v_mfma_f32_16x16x32_bf16 v[104:107], v[148:151], v[216:219], v[104:107]
  v_mfma_f32_16x16x32_bf16 v[132:135], v[148:151], v[156:159], v[132:135]
  v_mfma_f32_16x16x32_bf16 v[128:131], v[144:147], v[156:159], v[128:131]
  s_waitcnt lgkmcnt(8)
  v_mfma_f32_16x16x32_bf16 v[68:71], v[144:147], v[220:223], v[68:71]
  ds_read_b128 v[180:183], v19 offset:5120
  v_mfma_f32_16x16x32_bf16 v[108:111], v[148:151], v[220:223], v[108:111]
  ds_read_b128 v[184:187], v19 offset:6144
  v_mfma_f32_16x16x32_bf16 v[72:75], v[144:147], v[224:227], v[72:75]
  ds_read_b128 v[188:191], v19 offset:7168
  v_mfma_f32_16x16x32_bf16 v[112:115], v[148:151], v[224:227], v[112:115]
  ds_read_b128 v[192:195], v19 offset:8192
  v_mfma_f32_16x16x32_bf16 v[76:79], v[144:147], v[228:231], v[76:79]
  ds_read_b128 v[196:199], v19 offset:9216
  v_mfma_f32_16x16x32_bf16 v[116:119], v[148:151], v[228:231], v[116:119]
  v_mfma_f32_16x16x32_bf16 v[80:83], v[144:147], v[232:235], v[80:83]
  v_mfma_f32_16x16x32_bf16 v[120:123], v[148:151], v[232:235], v[120:123]
  v_mfma_f32_16x16x32_bf16 v[84:87], v[144:147], v[236:239], v[84:87]
  v_mfma_f32_16x16x32_bf16 v[124:127], v[148:151], v[236:239], v[124:127]
  s_waitcnt lgkmcnt(5)
  v_mfma_f32_16x16x32_bf16 v[48:51], v[136:139], v[160:163], v[48:51]
  ds_read_b128 v[144:147], v18 offset:0
  v_mfma_f32_16x16x32_bf16 v[88:91], v[140:143], v[160:163], v[88:91]
  ds_read_b128 v[148:151], v18 offset:2048
  v_mfma_f32_16x16x32_bf16 v[52:55], v[136:139], v[164:167], v[52:55]
  ds_read_b128 v[156:159], v34 offset:1088
  v_mfma_f32_16x16x32_bf16 v[92:95], v[140:143], v[164:167], v[92:95]
  ds_read_b128 v[200:203], v19 offset:10240
  v_mfma_f32_16x16x32_bf16 v[56:59], v[136:139], v[168:171], v[56:59]
  ds_read_b128 v[204:207], v19 offset:11264
  v_mfma_f32_16x16x32_bf16 v[96:99], v[140:143], v[168:171], v[96:99]
  ds_read_b128 v[208:211], v19 offset:12288
  v_mfma_f32_16x16x32_bf16 v[60:63], v[136:139], v[172:175], v[60:63]
  ds_read_b128 v[212:215], v19 offset:13312
  v_mfma_f32_16x16x32_bf16 v[100:103], v[140:143], v[172:175], v[100:103]
  ds_read_b128 v[216:219], v19 offset:14336
  v_mfma_f32_16x16x32_bf16 v[64:67], v[136:139], v[176:179], v[64:67]
  v_mfma_f32_16x16x32_bf16 v[104:107], v[140:143], v[176:179], v[104:107]
  v_mfma_f32_16x16x32_bf16 v[132:135], v[140:143], v[152:155], v[132:135]
  v_mfma_f32_16x16x32_bf16 v[128:131], v[136:139], v[152:155], v[128:131]
  s_waitcnt lgkmcnt(8)
  v_mfma_f32_16x16x32_bf16 v[68:71], v[136:139], v[180:183], v[68:71]
  ds_read_b128 v[220:223], v19 offset:15360
  v_mfma_f32_16x16x32_bf16 v[108:111], v[140:143], v[180:183], v[108:111]
  ds_read_b128 v[224:227], v19 offset:16384
  v_mfma_f32_16x16x32_bf16 v[72:75], v[136:139], v[184:187], v[72:75]
  ds_read_b128 v[228:231], v19 offset:17408
  v_mfma_f32_16x16x32_bf16 v[112:115], v[140:143], v[184:187], v[112:115]
  ds_read_b128 v[232:235], v19 offset:18432
  v_mfma_f32_16x16x32_bf16 v[76:79], v[136:139], v[188:191], v[76:79]
  ds_read_b128 v[236:239], v19 offset:19456
  v_mfma_f32_16x16x32_bf16 v[116:119], v[140:143], v[188:191], v[116:119]
  v_mfma_f32_16x16x32_bf16 v[80:83], v[136:139], v[192:195], v[80:83]
  v_mfma_f32_16x16x32_bf16 v[120:123], v[140:143], v[192:195], v[120:123]
  v_mfma_f32_16x16x32_bf16 v[84:87], v[136:139], v[196:199], v[84:87]
  v_mfma_f32_16x16x32_bf16 v[124:127], v[140:143], v[196:199], v[124:127]
  s_barrier
  s_waitcnt lgkmcnt(5)
  v_mfma_f32_16x16x32_bf16 v[48:51], v[144:147], v[200:203], v[48:51]
  ds_read_b128 v[136:139], v17 offset:36864
  v_mfma_f32_16x16x32_bf16 v[88:91], v[148:151], v[200:203], v[88:91]
  ds_read_b128 v[140:143], v17 offset:38912
  v_mfma_f32_16x16x32_bf16 v[52:55], v[144:147], v[204:207], v[52:55]
  ds_read_b128 v[152:155], v34 offset:1152
  v_mfma_f32_16x16x32_bf16 v[92:95], v[148:151], v[204:207], v[92:95]
  ds_read_b128 v[160:163], v19 offset:36864
  v_mfma_f32_16x16x32_bf16 v[56:59], v[144:147], v[208:211], v[56:59]
  ds_read_b128 v[164:167], v19 offset:37888
  v_mfma_f32_16x16x32_bf16 v[96:99], v[148:151], v[208:211], v[96:99]
  ds_read_b128 v[168:171], v19 offset:38912
  v_mfma_f32_16x16x32_bf16 v[60:63], v[144:147], v[212:215], v[60:63]
  ds_read_b128 v[172:175], v19 offset:39936
  v_mfma_f32_16x16x32_bf16 v[100:103], v[148:151], v[212:215], v[100:103]
  ds_read_b128 v[176:179], v19 offset:40960
  v_mfma_f32_16x16x32_bf16 v[64:67], v[144:147], v[216:219], v[64:67]
  v_mfma_f32_16x16x32_bf16 v[104:107], v[148:151], v[216:219], v[104:107]
  v_mfma_f32_16x16x32_bf16 v[132:135], v[148:151], v[156:159], v[132:135]
  v_mfma_f32_16x16x32_bf16 v[128:131], v[144:147], v[156:159], v[128:131]
  s_waitcnt lgkmcnt(8)
  v_mfma_f32_16x16x32_bf16 v[68:71], v[144:147], v[220:223], v[68:71]
  ds_read_b128 v[180:183], v19 offset:41984
  v_mfma_f32_16x16x32_bf16 v[108:111], v[148:151], v[220:223], v[108:111]
  ds_read_b128 v[184:187], v19 offset:43008
  v_mfma_f32_16x16x32_bf16 v[72:75], v[144:147], v[224:227], v[72:75]
  ds_read_b128 v[188:191], v19 offset:44032
  v_mfma_f32_16x16x32_bf16 v[112:115], v[148:151], v[224:227], v[112:115]
  ds_read_b128 v[192:195], v19 offset:45056
  v_mfma_f32_16x16x32_bf16 v[76:79], v[144:147], v[228:231], v[76:79]
  ds_read_b128 v[196:199], v19 offset:46080
  v_mfma_f32_16x16x32_bf16 v[116:119], v[148:151], v[228:231], v[116:119]
  v_mfma_f32_16x16x32_bf16 v[80:83], v[144:147], v[232:235], v[80:83]
  v_mfma_f32_16x16x32_bf16 v[120:123], v[148:151], v[232:235], v[120:123]
  v_mfma_f32_16x16x32_bf16 v[84:87], v[144:147], v[236:239], v[84:87]
  v_mfma_f32_16x16x32_bf16 v[124:127], v[148:151], v[236:239], v[124:127]
  s_waitcnt lgkmcnt(0)
  ds_read_b128 v[144:147], v18 offset:36864
  ds_read_b128 v[148:151], v18 offset:38912
  ds_read_b128 v[156:159], v34 offset:1216
  ds_read_b128 v[200:203], v19 offset:47104
  ds_read_b128 v[204:207], v19 offset:48128
  ds_read_b128 v[208:211], v19 offset:49152
  ds_read_b128 v[212:215], v19 offset:50176
  ds_read_b128 v[216:219], v19 offset:51200
  ds_read_b128 v[220:223], v19 offset:52224
  ds_read_b128 v[224:227], v19 offset:53248
  ds_read_b128 v[228:231], v19 offset:54272
  ds_read_b128 v[232:235], v19 offset:55296
  ds_read_b128 v[236:239], v19 offset:56320
  v_mfma_f32_16x16x32_bf16 v[48:51], v[136:139], v[160:163], v[48:51]
  v_mfma_f32_16x16x32_bf16 v[88:91], v[140:143], v[160:163], v[88:91]
  v_mfma_f32_16x16x32_bf16 v[52:55], v[136:139], v[164:167], v[52:55]
  v_mfma_f32_16x16x32_bf16 v[92:95], v[140:143], v[164:167], v[92:95]
  s_waitcnt lgkmcnt(8)
  v_mfma_f32_16x16x32_bf16 v[48:51], v[144:147], v[200:203], v[48:51]
  v_mfma_f32_16x16x32_bf16 v[88:91], v[148:151], v[200:203], v[88:91]
  v_mfma_f32_16x16x32_bf16 v[52:55], v[144:147], v[204:207], v[52:55]
  v_mfma_f32_16x16x32_bf16 v[92:95], v[148:151], v[204:207], v[92:95]
  v_mfma_f32_16x16x32_bf16 v[56:59], v[136:139], v[168:171], v[56:59]
  v_mfma_f32_16x16x32_bf16 v[96:99], v[140:143], v[168:171], v[96:99]
  v_mfma_f32_16x16x32_bf16 v[60:63], v[136:139], v[172:175], v[60:63]
  s_nop 1
  v_cvt_pk_bf16_f32 v248, v48, v49
  v_cvt_pk_bf16_f32 v249, v50, v51
  v_mfma_f32_16x16x32_bf16 v[100:103], v[140:143], v[172:175], v[100:103]
  v_cvt_pk_bf16_f32 v250, v88, v89
  v_cvt_pk_bf16_f32 v251, v90, v91
  s_waitcnt lgkmcnt(6)
  v_cvt_pk_bf16_f32 v252, v52, v53
  v_cvt_pk_bf16_f32 v253, v54, v55
  v_mfma_f32_16x16x32_bf16 v[56:59], v[144:147], v[208:211], v[56:59]
  v_cvt_pk_bf16_f32 v254, v92, v93
  v_mfma_f32_16x16x32_bf16 v[96:99], v[148:151], v[208:211], v[96:99]
  v_cvt_pk_bf16_f32 v255, v94, v95
  v_mfma_f32_16x16x32_bf16 v[48:51], v[240:243], v[248:251], 0
  v_mfma_f32_16x16x32_bf16 v[60:63], v[144:147], v[212:215], v[60:63]
  v_mfma_f32_16x16x32_bf16 v[88:91], v[244:247], v[248:251], 0
  v_mfma_f32_16x16x32_bf16 v[52:55], v[240:243], v[252:255], 0
  v_mfma_f32_16x16x32_bf16 v[100:103], v[148:151], v[212:215], v[100:103]
  v_mfma_f32_16x16x32_bf16 v[92:95], v[244:247], v[252:255], 0
  v_mfma_f32_16x16x32_bf16 v[64:67], v[136:139], v[176:179], v[64:67]
  v_mfma_f32_16x16x32_bf16 v[104:107], v[140:143], v[176:179], v[104:107]
  v_mfma_f32_16x16x32_bf16 v[68:71], v[136:139], v[180:183], v[68:71]
  s_nop 2
  v_cvt_pk_bf16_f32 v160, v48, v52
  v_cvt_pk_bf16_f32 v161, v49, v53
  v_cvt_pk_bf16_f32 v162, v50, v54
  v_cvt_pk_bf16_f32 v163, v51, v55
  v_mfma_f32_16x16x32_bf16 v[108:111], v[140:143], v[180:183], v[108:111]
  buffer_store_dwordx4 v[160:163], v32, s[40:43], s4 offen offset:0 sc1
  v_cvt_pk_bf16_f32 v164, v88, v92
  v_cvt_pk_bf16_f32 v165, v89, v93
  s_waitcnt lgkmcnt(4)
  v_cvt_pk_bf16_f32 v166, v90, v94
  v_cvt_pk_bf16_f32 v167, v91, v95
  buffer_store_dwordx4 v[164:167], v32, s[40:43], s5 offen offset:0 sc1
  v_mfma_f32_16x16x32_bf16 v[64:67], v[144:147], v[216:219], v[64:67]
  v_cvt_pk_bf16_f32 v248, v56, v57
  v_cvt_pk_bf16_f32 v249, v58, v59
  v_cvt_pk_bf16_f32 v250, v96, v97
  v_mfma_f32_16x16x32_bf16 v[104:107], v[148:151], v[216:219], v[104:107]
  v_cvt_pk_bf16_f32 v251, v98, v99
  v_cvt_pk_bf16_f32 v252, v60, v61
  v_cvt_pk_bf16_f32 v253, v62, v63
  v_mfma_f32_16x16x32_bf16 v[68:71], v[144:147], v[220:223], v[68:71]
  v_cvt_pk_bf16_f32 v254, v100, v101
  v_cvt_pk_bf16_f32 v255, v102, v103
  v_mfma_f32_16x16x32_bf16 v[56:59], v[240:243], v[248:251], 0
  v_mfma_f32_16x16x32_bf16 v[108:111], v[148:151], v[220:223], v[108:111]
  v_mfma_f32_16x16x32_bf16 v[96:99], v[244:247], v[248:251], 0
  v_mfma_f32_16x16x32_bf16 v[60:63], v[240:243], v[252:255], 0
  v_mfma_f32_16x16x32_bf16 v[100:103], v[244:247], v[252:255], 0
  v_mfma_f32_16x16x32_bf16 v[72:75], v[136:139], v[184:187], v[72:75]
  v_mfma_f32_16x16x32_bf16 v[112:115], v[140:143], v[184:187], v[112:115]
  v_mfma_f32_16x16x32_bf16 v[76:79], v[136:139], v[188:191], v[76:79]
  s_nop 3
  v_cvt_pk_bf16_f32 v160, v56, v60
  v_cvt_pk_bf16_f32 v161, v57, v61
  v_cvt_pk_bf16_f32 v162, v58, v62
  v_cvt_pk_bf16_f32 v163, v59, v63
  v_mfma_f32_16x16x32_bf16 v[116:119], v[140:143], v[188:191], v[116:119]
  buffer_store_dwordx4 v[160:163], v32, s[40:43], s4 offen offset:256 sc1
  v_cvt_pk_bf16_f32 v164, v96, v100
  v_cvt_pk_bf16_f32 v165, v97, v101
  s_waitcnt lgkmcnt(2)
  v_cvt_pk_bf16_f32 v166, v98, v102
  v_cvt_pk_bf16_f32 v167, v99, v103
  buffer_store_dwordx4 v[164:167], v32, s[40:43], s5 offen offset:256 sc1
  v_mfma_f32_16x16x32_bf16 v[72:75], v[144:147], v[224:227], v[72:75]
  v_cvt_pk_bf16_f32 v248, v64, v65
  v_cvt_pk_bf16_f32 v249, v66, v67
  v_cvt_pk_bf16_f32 v250, v104, v105
  v_mfma_f32_16x16x32_bf16 v[112:115], v[148:151], v[224:227], v[112:115]
  v_cvt_pk_bf16_f32 v251, v106, v107
  v_cvt_pk_bf16_f32 v252, v68, v69
  v_cvt_pk_bf16_f32 v253, v70, v71
  v_mfma_f32_16x16x32_bf16 v[76:79], v[144:147], v[228:231], v[76:79]
  v_cvt_pk_bf16_f32 v254, v108, v109
  v_cvt_pk_bf16_f32 v255, v110, v111
  v_mfma_f32_16x16x32_bf16 v[64:67], v[240:243], v[248:251], 0
  v_mfma_f32_16x16x32_bf16 v[116:119], v[148:151], v[228:231], v[116:119]
  v_mfma_f32_16x16x32_bf16 v[104:107], v[244:247], v[248:251], 0
  v_mfma_f32_16x16x32_bf16 v[68:71], v[240:243], v[252:255], 0
  v_mfma_f32_16x16x32_bf16 v[108:111], v[244:247], v[252:255], 0
  v_mfma_f32_16x16x32_bf16 v[80:83], v[136:139], v[192:195], v[80:83]
  v_mfma_f32_16x16x32_bf16 v[120:123], v[140:143], v[192:195], v[120:123]
  v_mfma_f32_16x16x32_bf16 v[84:87], v[136:139], v[196:199], v[84:87]
  s_nop 3
  v_cvt_pk_bf16_f32 v160, v64, v68
  v_cvt_pk_bf16_f32 v161, v65, v69
  v_cvt_pk_bf16_f32 v162, v66, v70
  v_cvt_pk_bf16_f32 v163, v67, v71
  v_mfma_f32_16x16x32_bf16 v[124:127], v[140:143], v[196:199], v[124:127]
  buffer_store_dwordx4 v[160:163], v32, s[40:43], s4 offen offset:512 sc1
  v_cvt_pk_bf16_f32 v164, v104, v108
  v_cvt_pk_bf16_f32 v165, v105, v109
  s_waitcnt lgkmcnt(0)
  v_cvt_pk_bf16_f32 v166, v106, v110
  v_cvt_pk_bf16_f32 v167, v107, v111
  buffer_store_dwordx4 v[164:167], v32, s[40:43], s5 offen offset:512 sc1
  v_mfma_f32_16x16x32_bf16 v[80:83], v[144:147], v[232:235], v[80:83]
  v_cvt_pk_bf16_f32 v248, v72, v73
  v_cvt_pk_bf16_f32 v249, v74, v75
  v_cvt_pk_bf16_f32 v250, v112, v113
  v_mfma_f32_16x16x32_bf16 v[120:123], v[148:151], v[232:235], v[120:123]
  v_cvt_pk_bf16_f32 v251, v114, v115
  v_cvt_pk_bf16_f32 v252, v76, v77
  v_cvt_pk_bf16_f32 v253, v78, v79
  v_mfma_f32_16x16x32_bf16 v[84:87], v[144:147], v[236:239], v[84:87]
  v_cvt_pk_bf16_f32 v254, v116, v117
  v_cvt_pk_bf16_f32 v255, v118, v119
  v_mfma_f32_16x16x32_bf16 v[72:75], v[240:243], v[248:251], 0
  v_mfma_f32_16x16x32_bf16 v[124:127], v[148:151], v[236:239], v[124:127]
  v_mfma_f32_16x16x32_bf16 v[112:115], v[244:247], v[248:251], 0
  v_mfma_f32_16x16x32_bf16 v[76:79], v[240:243], v[252:255], 0
  v_mfma_f32_16x16x32_bf16 v[116:119], v[244:247], v[252:255], 0
  v_mfma_f32_16x16x32_bf16 v[128:131], v[136:139], v[152:155], v[128:131]
  v_mfma_f32_16x16x32_bf16 v[132:135], v[140:143], v[152:155], v[132:135]
  s_waitcnt lgkmcnt(0)
  s_nop 3
  v_cvt_pk_bf16_f32 v160, v72, v76
  v_cvt_pk_bf16_f32 v161, v73, v77
  v_cvt_pk_bf16_f32 v162, v74, v78
  v_cvt_pk_bf16_f32 v163, v75, v79
  buffer_store_dwordx4 v[160:163], v32, s[40:43], s4 offen offset:768 sc1
  v_cvt_pk_bf16_f32 v164, v112, v116
  v_cvt_pk_bf16_f32 v165, v113, v117
  v_cvt_pk_bf16_f32 v166, v114, v118
  v_mfma_f32_16x16x32_bf16 v[128:131], v[144:147], v[156:159], v[128:131]
  v_cvt_pk_bf16_f32 v167, v115, v119
  buffer_store_dwordx4 v[164:167], v32, s[40:43], s5 offen offset:768 sc1
  v_cvt_pk_bf16_f32 v248, v80, v81
  v_cvt_pk_bf16_f32 v249, v82, v83
  v_cvt_pk_bf16_f32 v250, v120, v121
  v_cvt_pk_bf16_f32 v251, v122, v123
  v_cvt_pk_bf16_f32 v252, v84, v85
  v_mfma_f32_16x16x32_bf16 v[132:135], v[148:151], v[156:159], v[132:135]
  v_cvt_pk_bf16_f32 v253, v86, v87
  v_cvt_pk_bf16_f32 v254, v124, v125
  v_cvt_pk_bf16_f32 v255, v126, v127
  v_mfma_f32_16x16x32_bf16 v[80:83], v[240:243], v[248:251], 0
  v_mfma_f32_16x16x32_bf16 v[120:123], v[244:247], v[248:251], 0
  v_mfma_f32_16x16x32_bf16 v[84:87], v[240:243], v[252:255], 0
  v_mfma_f32_16x16x32_bf16 v[124:127], v[244:247], v[252:255], 0
  s_waitcnt lgkmcnt(0)
  s_mov_b64 exec, 1
  ds_add_u32 v44, v45 offset:0
  s_mov_b64 exec, -1
  s_nop 2
  v_cvt_pk_bf16_f32 v160, v80, v84
  v_cvt_pk_bf16_f32 v161, v81, v85
  v_cvt_pk_bf16_f32 v162, v82, v86
  v_cvt_pk_bf16_f32 v163, v83, v87
  buffer_store_dwordx4 v[160:163], v32, s[40:43], s4 offen offset:1024 sc1
  v_cvt_pk_bf16_f32 v164, v120, v124
  v_cvt_pk_bf16_f32 v165, v121, v125
  v_cvt_pk_bf16_f32 v166, v122, v126
  v_cvt_pk_bf16_f32 v167, v123, v127
  buffer_store_dwordx4 v[164:167], v32, s[40:43], s5 offen offset:1024 sc1
  s_mov_b32 s72, 0x100000
L_aw11:
  ds_read_b32 v4, v44 offset:0
  s_sub_u32 s72, s72, 1
  s_cbranch_scc1 L_ax11
  s_waitcnt lgkmcnt(0)
  v_cmp_gt_u32 vcc, 4, v4
  s_cbranch_vccnz L_aw11
L_ax11:
  s_and_b32 s74, s65, 3
  s_cbranch_scc1 L_MB
  v_cvt_pk_bf16_f32 v128, v128, v128
  v_cvt_pk_bf16_f32 v129, v129, v129
  v_cvt_pk_bf16_f32 v130, v130, v130
  v_cvt_pk_bf16_f32 v131, v131, v131
  v_cvt_pk_bf16_f32 v132, v132, v132
  v_cvt_pk_bf16_f32 v133, v133, v133
  v_cvt_pk_bf16_f32 v134, v134, v134
  v_cvt_pk_bf16_f32 v135, v135, v135
  v_and_b32 v128, 0xffff0000, v128
  v_and_b32 v129, 0xffff0000, v129
  v_and_b32 v130, 0xffff0000, v130
  v_and_b32 v131, 0xffff0000, v131
  v_and_b32 v132, 0xffff0000, v132
  v_and_b32 v133, 0xffff0000, v133
  v_and_b32 v134, 0xffff0000, v134
  v_and_b32 v135, 0xffff0000, v135
  v_mul_f32 v128, 0xbfb8aa3b, v128
  v_mul_f32 v129, 0xbfb8aa3b, v129
  v_mul_f32 v130, 0xbfb8aa3b, v130
  v_mul_f32 v131, 0xbfb8aa3b, v131
  v_mul_f32 v132, 0xbfb8aa3b, v132
  v_mul_f32 v133, 0xbfb8aa3b, v133
  v_mul_f32 v134, 0xbfb8aa3b, v134
  v_mul_f32 v135, 0xbfb8aa3b, v135
  v_exp_f32 v128, v128
  v_exp_f32 v129, v129
  v_exp_f32 v130, v130
  v_exp_f32 v131, v131
  v_exp_f32 v132, v132
  v_exp_f32 v133, v133
  v_exp_f32 v134, v134
  v_exp_f32 v135, v135
  v_add_f32 v128, 1.0, v128
  v_add_f32 v129, 1.0, v129
  v_add_f32 v130, 1.0, v130
  v_add_f32 v131, 1.0, v131
  v_add_f32 v132, 1.0, v132
  v_add_f32 v133, 1.0, v133
  v_add_f32 v134, 1.0, v134
  v_add_f32 v135, 1.0, v135
  v_rcp_f32 v128, v128
  v_rcp_f32 v129, v129
  v_rcp_f32 v130, v130
  v_rcp_f32 v131, v131
  v_rcp_f32 v132, v132
  v_rcp_f32 v133, v133
  v_rcp_f32 v134, v134
  v_rcp_f32 v135, v135
  v_cvt_pk_bf16_f32 v128, v128, v128
  v_cvt_pk_bf16_f32 v129, v129, v129
  v_cvt_pk_bf16_f32 v130, v130, v130
  v_cvt_pk_bf16_f32 v131, v131, v131
  v_cvt_pk_bf16_f32 v132, v132, v132
  v_cvt_pk_bf16_f32 v133, v133, v133
  v_cvt_pk_bf16_f32 v134, v134, v134
  v_cvt_pk_bf16_f32 v135, v135, v135
  v_and_b32 v128, 0xffff0000, v128
  v_and_b32 v129, 0xffff0000, v129
  v_and_b32 v130, 0xffff0000, v130
  v_and_b32 v131, 0xffff0000, v131
  v_and_b32 v132, 0xffff0000, v132
  v_and_b32 v133, 0xffff0000, v133
  v_and_b32 v134, 0xffff0000, v134
  v_and_b32 v135, 0xffff0000, v135
  s_mov_b32 exec_lo, 0x00010001
  s_mov_b32 exec_hi, 0x00010001
  buffer_store_dwordx4 v[128:131], v33, s[40:43], 0 offen sc1
  buffer_store_dwordx4 v[132:135], v33, s[40:43], 0 offen offset:64 sc1
  s_mov_b64 exec, -1
  s_branch L_MB
L_Q:
  v_bfe_u32 v4, v1, 2, 2
  v_lshl_add_u32 v4, v2, 3, v4
  v_mul_u32_u24 v4, 320, v4
  v_add_u32 v4, 16384, v4
  v_and_b32 v5, 3, v1
  v_and_b32 v6, 1, v2
  v_lshlrev_b32 v6, 2, v6
  s_and_b32 s75, s61, 1
  s_mul_i32 s74, s75, 20
  v_mul_u32_u24 v5, 5, v5
  v_add_u32 v5, s74, v5
  v_add_u32 v7, 0, v5
  v_xor_b32 v7, v7, v6
  v_lshl_add_u32 v19, v7, 3, v4
  v_add_u32 v7, 1, v5
  v_xor_b32 v7, v7, v6
  v_lshl_add_u32 v20, v7, 3, v4
  v_add_u32 v7, 2, v5
  v_xor_b32 v7, v7, v6
  v_lshl_add_u32 v21, v7, 3, v4
  v_add_u32 v7, 3, v5
  v_xor_b32 v7, v7, v6
  v_lshl_add_u32 v22, v7, 3, v4
  v_add_u32 v7, 4, v5
  v_xor_b32 v7, v7, v6
  v_lshl_add_u32 v23, v7, 3, v4
  v_add_u32 v24, 73728, v17
  v_add_u32 v25, 73728, v18
  v_add_u32 v26, 73728, v19
  v_add_u32 v27, 73728, v20
  v_add_u32 v28, 73728, v21
  v_add_u32 v29, 73728, v22
  v_add_u32 v30, 73728, v23
  v_add_u32 v4, 0, v1
  v_cmp_le_u32 vcc, 105, v4
  s_nop 1
  v_cndmask_b32 v5, 0, 1, vcc
  v_mul_u32_u24 v6, 105, v5
  v_sub_u32 v6, v4, v6
  v_mul_u32_u24 v7, 1728, v5
  v_lshl_add_u32 v7, v6, 4, v7
  v_add_u32 v34, s6, v7
  v_mul_u32_u24 v7, 205, v6
  v_lshrrev_b32 v7, 10, v7
  v_mul_u32_u24 v12, 5, v7
  v_sub_u32 v12, v6, v12
  v_mul_u32_u24 v5, 24, v5
  v_add_u32 v5, v5, v7
  v_mul_u32_u24 v5, 48, v5
  v_lshl_add_u32 v5, v12, 3, v5
  v_add_u32 v38, s16, v5
  v_add_u32 v4, 64, v1
  v_cmp_le_u32 vcc, 105, v4
  s_nop 1
  v_cndmask_b32 v5, 0, 1, vcc
  v_mul_u32_u24 v6, 105, v5
  v_sub_u32 v6, v4, v6
  v_mul_u32_u24 v7, 1728, v5
  v_lshl_add_u32 v7, v6, 4, v7
  v_add_u32 v35, s6, v7
  v_mul_u32_u24 v7, 205, v6
  v_lshrrev_b32 v7, 10, v7
  v_mul_u32_u24 v12, 5, v7
  v_sub_u32 v12, v6, v12
  v_mul_u32_u24 v5, 24, v5
  v_add_u32 v5, v5, v7
  v_mul_u32_u24 v5, 48, v5
  v_lshl_add_u32 v5, v12, 3, v5
  v_add_u32 v39, s16, v5
  v_add_u32 v4, 128, v1
  v_cmp_le_u32 vcc, 105, v4
  s_nop 1
  v_cndmask_b32 v5, 0, 1, vcc
  v_mul_u32_u24 v6, 105, v5
  v_sub_u32 v6, v4, v6
  v_mul_u32_u24 v7, 1728, v5
  v_lshl_add_u32 v7, v6, 4, v7
  v_add_u32 v36, s6, v7
  v_mul_u32_u24 v7, 205, v6
  v_lshrrev_b32 v7, 10, v7
  v_mul_u32_u24 v12, 5, v7
  v_sub_u32 v12, v6, v12
  v_mul_u32_u24 v5, 24, v5
  v_add_u32 v5, v5, v7
  v_mul_u32_u24 v5, 48, v5
  v_lshl_add_u32 v5, v12, 3, v5
  v_add_u32 v40, s16, v5
  v_add_u32 v4, 192, v1
  v_cmp_le_u32 vcc, 105, v4
  s_nop 1
  v_cndmask_b32 v5, 0, 1, vcc
  v_mul_u32_u24 v6, 105, v5
  v_sub_u32 v6, v4, v6
  v_mul_u32_u24 v7, 1728, v5
  v_lshl_add_u32 v7, v6, 4, v7
  v_add_u32 v37, s6, v7
  v_mul_u32_u24 v7, 205, v6
  v_lshrrev_b32 v7, 10, v7
  v_mul_u32_u24 v12, 5, v7
  v_sub_u32 v12, v6, v12
  v_mul_u32_u24 v5, 24, v5
  v_add_u32 v5, v5, v7
  v_mul_u32_u24 v5, 48, v5
  v_lshl_add_u32 v5, v12, 3, v5
  v_add_u32 v41, s16, v5
  v_cmp_le_u32 vcc, 18, v1
  v_mov_b32 v4, 0x7ffffff0
  s_nop 0
  v_cndmask_b32 v37, v37, v4, vcc
  v_mov_b32 v4, 159744
  v_cndmask_b32 v41, v41, v4, vcc
  v_and_b32 v4, 3, v1
  v_mul_u32_u24 v5, 24, v2
  v_add_u32 v4, v4, v5
  v_mul_u32_u24 v4, 48, v4
  v_add_u32 v42, s17, v4
  v_and_b32 v4, 31, v1
  v_lshl_add_u32 v43, v4, 7, s11
  v_and_b32 v4, 1, v2
  v_mul_u32_u24 v4, 20480, v4
  v_lshrrev_b32 v5, 1, v2
  v_lshl_add_u32 v4, v5, 8, v4
  v_lshl_add_u32 v32, v3, 4, v4
  s_waitcnt lgkmcnt(0)
  s_barrier
  ds_read_b128 v[128:131], v17 offset:0
  ds_read_b128 v[132:135], v17 offset:2048
  ds_read_b128 v[136:139], v17 offset:4096
  ds_read_b128 v[140:143], v17 offset:6144
  ds_read_b64_tr_b16 v[176:177], v19 offset:0
  ds_read_b64_tr_b16 v[178:179], v19 offset:1280
  ds_read_b64_tr_b16 v[180:181], v20 offset:0
  ds_read_b64_tr_b16 v[182:183], v20 offset:1280
  ds_read_b64_tr_b16 v[184:185], v21 offset:0
  ds_read_b64_tr_b16 v[186:187], v21 offset:1280
  ds_read_b64_tr_b16 v[188:189], v22 offset:0
  ds_read_b64_tr_b16 v[190:191], v22 offset:1280
  ds_read_b64_tr_b16 v[192:193], v23 offset:0
  ds_read_b64_tr_b16 v[194:195], v23 offset:1280
  s_waitcnt lgkmcnt(6)
  v_mfma_f32_16x16x32_bf16 v[48:51], v[176:179], v[128:131], 0
  ds_read_b128 v[144:147], v18 offset:0
  v_mfma_f32_16x16x32_bf16 v[68:71], v[176:179], v[132:135], 0
  ds_read_b128 v[148:151], v18 offset:2048
  v_mfma_f32_16x16x32_bf16 v[88:91], v[176:179], v[136:139], 0
  ds_read_b128 v[152:155], v18 offset:4096
  v_mfma_f32_16x16x32_bf16 v[108:111], v[176:179], v[140:143], 0
  ds_read_b128 v[156:159], v18 offset:6144
  v_mfma_f32_16x16x32_bf16 v[52:55], v[180:183], v[128:131], 0
  ds_read_b64_tr_b16 v[196:197], v19 offset:10240
  v_mfma_f32_16x16x32_bf16 v[72:75], v[180:183], v[132:135], 0
  ds_read_b64_tr_b16 v[198:199], v19 offset:11520
  v_mfma_f32_16x16x32_bf16 v[92:95], v[180:183], v[136:139], 0
  ds_read_b64_tr_b16 v[200:201], v20 offset:10240
  v_mfma_f32_16x16x32_bf16 v[112:115], v[180:183], v[140:143], 0
  ds_read_b64_tr_b16 v[202:203], v20 offset:11520
  s_waitcnt lgkmcnt(8)
  v_mfma_f32_16x16x32_bf16 v[56:59], v[184:187], v[128:131], 0
  ds_read_b64_tr_b16 v[204:205], v21 offset:10240
  v_mfma_f32_16x16x32_bf16 v[76:79], v[184:187], v[132:135], 0
  ds_read_b64_tr_b16 v[206:207], v21 offset:11520
  v_mfma_f32_16x16x32_bf16 v[96:99], v[184:187], v[136:139], 0
  ds_read_b64_tr_b16 v[208:209], v22 offset:10240
  v_mfma_f32_16x16x32_bf16 v[116:119], v[184:187], v[140:143], 0
  ds_read_b64_tr_b16 v[210:211], v22 offset:11520
  v_mfma_f32_16x16x32_bf16 v[60:63], v[188:191], v[128:131], 0
  ds_read_b64_tr_b16 v[212:213], v23 offset:10240
  v_mfma_f32_16x16x32_bf16 v[80:83], v[188:191], v[132:135], 0
  ds_read_b64_tr_b16 v[214:215], v23 offset:11520
  v_mfma_f32_16x16x32_bf16 v[100:103], v[188:191], v[136:139], 0
  v_mfma_f32_16x16x32_bf16 v[120:123], v[188:191], v[140:143], 0
  v_mfma_f32_16x16x32_bf16 v[64:67], v[192:195], v[128:131], 0
  v_mfma_f32_16x16x32_bf16 v[84:87], v[192:195], v[132:135], 0
  v_mfma_f32_16x16x32_bf16 v[104:107], v[192:195], v[136:139], 0
  v_mfma_f32_16x16x32_bf16 v[124:127], v[192:195], v[140:143], 0
  s_barrier
  s_waitcnt lgkmcnt(6)
  v_mfma_f32_16x16x32_bf16 v[48:51], v[196:199], v[144:147], v[48:51]
  ds_read_b128 v[128:131], v17 offset:36864
  v_mfma_f32_16x16x32_bf16 v[68:71], v[196:199], v[148:151], v[68:71]
  ds_read_b128 v[132:135], v17 offset:38912
  v_mfma_f32_16x16x32_bf16 v[88:91], v[196:199], v[152:155], v[88:91]
  ds_read_b128 v[136:139], v17 offset:40960
  v_mfma_f32_16x16x32_bf16 v[108:111], v[196:199], v[156:159], v[108:111]
  ds_read_b128 v[140:143], v17 offset:43008
  v_mfma_f32_16x16x32_bf16 v[52:55], v[200:203], v[144:147], v[52:55]
  ds_read_b64_tr_b16 v[176:177], v19 offset:36864
  v_mfma_f32_16x16x32_bf16 v[72:75], v[200:203], v[148:151], v[72:75]
  ds_read_b64_tr_b16 v[178:179], v19 offset:38144
  v_mfma_f32_16x16x32_bf16 v[92:95], v[200:203], v[152:155], v[92:95]
  ds_read_b64_tr_b16 v[180:181], v20 offset:36864
  v_mfma_f32_16x16x32_bf16 v[112:115], v[200:203], v[156:159], v[112:115]
  ds_read_b64_tr_b16 v[182:183], v20 offset:38144
  s_waitcnt lgkmcnt(8)
  v_mfma_f32_16x16x32_bf16 v[56:59], v[204:207], v[144:147], v[56:59]
  ds_read_b64_tr_b16 v[184:185], v21 offset:36864
  v_mfma_f32_16x16x32_bf16 v[76:79], v[204:207], v[148:151], v[76:79]
  ds_read_b64_tr_b16 v[186:187], v21 offset:38144
  v_mfma_f32_16x16x32_bf16 v[96:99], v[204:207], v[152:155], v[96:99]
  ds_read_b64_tr_b16 v[188:189], v22 offset:36864
  v_mfma_f32_16x16x32_bf16 v[116:119], v[204:207], v[156:159], v[116:119]
  ds_read_b64_tr_b16 v[190:191], v22 offset:38144
  v_mfma_f32_16x16x32_bf16 v[60:63], v[208:211], v[144:147], v[60:63]
  ds_read_b64_tr_b16 v[192:193], v23 offset:36864
  v_mfma_f32_16x16x32_bf16 v[80:83], v[208:211], v[148:151], v[80:83]
  ds_read_b64_tr_b16 v[194:195], v23 offset:38144
  v_mfma_f32_16x16x32_bf16 v[100:103], v[208:211], v[152:155], v[100:103]
  v_mfma_f32_16x16x32_bf16 v[120:123], v[208:211], v[156:159], v[120:123]
  v_mfma_f32_16x16x32_bf16 v[64:67], v[212:215], v[144:147], v[64:67]
  v_mfma_f32_16x16x32_bf16 v[84:87], v[212:215], v[148:151], v[84:87]
  v_mfma_f32_16x16x32_bf16 v[104:107], v[212:215], v[152:155], v[104:107]
  v_mfma_f32_16x16x32_bf16 v[124:127], v[212:215], v[156:159], v[124:127]
  s_waitcnt lgkmcnt(6)
  v_mfma_f32_16x16x32_bf16 v[48:51], v[176:179], v[128:131], v[48:51]
  ds_read_b128 v[144:147], v18 offset:36864
  v_mfma_f32_16x16x32_bf16 v[68:71], v[176:179], v[132:135], v[68:71]
  ds_read_b128 v[148:151], v18 offset:38912
  v_mfma_f32_16x16x32_bf16 v[88:91], v[176:179], v[136:139], v[88:91]
  ds_read_b128 v[152:155], v18 offset:40960
  v_mfma_f32_16x16x32_bf16 v[108:111], v[176:179], v[140:143], v[108:111]
  ds_read_b128 v[156:159], v18 offset:43008
  v_mfma_f32_16x16x32_bf16 v[52:55], v[180:183], v[128:131], v[52:55]
  ds_read_b64_tr_b16 v[196:197], v19 offset:47104
  v_mfma_f32_16x16x32_bf16 v[72:75], v[180:183], v[132:135], v[72:75]
  ds_read_b64_tr_b16 v[198:199], v19 offset:48384
  v_mfma_f32_16x16x32_bf16 v[92:95], v[180:183], v[136:139], v[92:95]
  ds_read_b64_tr_b16 v[200:201], v20 offset:47104
  v_mfma_f32_16x16x32_bf16 v[112:115], v[180:183], v[140:143], v[112:115]
  ds_read_b64_tr_b16 v[202:203], v20 offset:48384
  s_waitcnt lgkmcnt(8)
  v_mfma_f32_16x16x32_bf16 v[56:59], v[184:187], v[128:131], v[56:59]
  ds_read_b64_tr_b16 v[204:205], v21 offset:47104
  v_mfma_f32_16x16x32_bf16 v[76:79], v[184:187], v[132:135], v[76:79]
  ds_read_b64_tr_b16 v[206:207], v21 offset:48384
  v_mfma_f32_16x16x32_bf16 v[96:99], v[184:187], v[136:139], v[96:99]
  ds_read_b64_tr_b16 v[208:209], v22 offset:47104
  v_mfma_f32_16x16x32_bf16 v[116:119], v[184:187], v[140:143], v[116:119]
  ds_read_b64_tr_b16 v[210:211], v22 offset:48384
  v_mfma_f32_16x16x32_bf16 v[60:63], v[188:191], v[128:131], v[60:63]
  ds_read_b64_tr_b16 v[212:213], v23 offset:47104
  v_mfma_f32_16x16x32_bf16 v[80:83], v[188:191], v[132:135], v[80:83]
  ds_read_b64_tr_b16 v[214:215], v23 offset:48384
  v_mfma_f32_16x16x32_bf16 v[100:103], v[188:191], v[136:139], v[100:103]
  v_mfma_f32_16x16x32_bf16 v[120:123], v[188:191], v[140:143], v[120:123]
  v_mfma_f32_16x16x32_bf16 v[64:67], v[192:195], v[128:131], v[64:67]
  v_mfma_f32_16x16x32_bf16 v[84:87], v[192:195], v[132:135], v[84:87]
  v_mfma_f32_16x16x32_bf16 v[104:107], v[192:195], v[136:139], v[104:107]
  v_mfma_f32_16x16x32_bf16 v[124:127], v[192:195], v[140:143], v[124:127]
  s_barrier
  s_waitcnt lgkmcnt(6)
  v_mfma_f32_16x16x32_bf16 v[48:51], v[196:199], v[144:147], v[48:51]
  ds_read_b128 v[128:131], v24 offset:0
  v_mfma_f32_16x16x32_bf16 v[68:71], v[196:199], v[148:151], v[68:71]
  ds_read_b128 v[132:135], v24 offset:2048
  v_mfma_f32_16x16x32_bf16 v[88:91], v[196:199], v[152:155], v[88:91]
  ds_read_b128 v[136:139], v24 offset:4096
  v_mfma_f32_16x16x32_bf16 v[108:111], v[196:199], v[156:159], v[108:111]
  ds_read_b128 v[140:143], v24 offset:6144
  v_mfma_f32_16x16x32_bf16 v[52:55], v[200:203], v[144:147], v[52:55]
  ds_read_b64_tr_b16 v[176:177], v26 offset:0
  v_mfma_f32_16x16x32_bf16 v[72:75], v[200:203], v[148:151], v[72:75]
  ds_read_b64_tr_b16 v[178:179], v26 offset:1280
  v_mfma_f32_16x16x32_bf16 v[92:95], v[200:203], v[152:155], v[92:95]
  ds_read_b64_tr_b16 v[180:181], v27 offset:0
  v_mfma_f32_16x16x32_bf16 v[112:115], v[200:203], v[156:159], v[112:115]
  ds_read_b64_tr_b16 v[182:183], v27 offset:1280
  s_waitcnt lgkmcnt(8)
  v_mfma_f32_16x16x32_bf16 v[56:59], v[204:207], v[144:147], v[56:59]
  ds_read_b64_tr_b16 v[184:185], v28 offset:0
  v_mfma_f32_16x16x32_bf16 v[76:79], v[204:207], v[148:151], v[76:79]
  ds_read_b64_tr_b16 v[186:187], v28 offset:1280
  v_mfma_f32_16x16x32_bf16 v[96:99], v[204:207], v[152:155], v[96:99]
  ds_read_b64_tr_b16 v[188:189], v29 offset:0
  v_mfma_f32_16x16x32_bf16 v[116:119], v[204:207], v[156:159], v[116:119]
  ds_read_b64_tr_b16 v[190:191], v29 offset:1280
  v_mfma_f32_16x16x32_bf16 v[60:63], v[208:211], v[144:147], v[60:63]
  ds_read_b64_tr_b16 v[192:193], v30 offset:0
  v_mfma_f32_16x16x32_bf16 v[80:83], v[208:211], v[148:151], v[80:83]
  ds_read_b64_tr_b16 v[194:195], v30 offset:1280
  v_mfma_f32_16x16x32_bf16 v[100:103], v[208:211], v[152:155], v[100:103]
  v_mfma_f32_16x16x32_bf16 v[120:123], v[208:211], v[156:159], v[120:123]
  v_mfma_f32_16x16x32_bf16 v[64:67], v[212:215], v[144:147], v[64:67]
  v_mfma_f32_16x16x32_bf16 v[84:87], v[212:215], v[148:151], v[84:87]
  v_mfma_f32_16x16x32_bf16 v[104:107], v[212:215], v[152:155], v[104:107]
  v_mfma_f32_16x16x32_bf16 v[124:127], v[212:215], v[156:159], v[124:127]
  s_waitcnt lgkmcnt(6)
  v_mfma_f32_16x16x32_bf16 v[48:51], v[176:179], v[128:131], v[48:51]
  ds_read_b128 v[144:147], v25 offset:0
  v_mfma_f32_16x16x32_bf16 v[68:71], v[176:179], v[132:135], v[68:71]
  ds_read_b128 v[148:151], v25 offset:2048
  v_mfma_f32_16x16x32_bf16 v[88:91], v[176:179], v[136:139], v[88:91]
  ds_read_b128 v[152:155], v25 offset:4096
  v_mfma_f32_16x16x32_bf16 v[108:111], v[176:179], v[140:143], v[108:111]
  ds_read_b128 v[156:159], v25 offset:6144
  v_mfma_f32_16x16x32_bf16 v[52:55], v[180:183], v[128:131], v[52:55]
  ds_read_b64_tr_b16 v[196:197], v26 offset:10240
  v_mfma_f32_16x16x32_bf16 v[72:75], v[180:183], v[132:135], v[72:75]
  ds_read_b64_tr_b16 v[198:199], v26 offset:11520
  v_mfma_f32_16x16x32_bf16 v[92:95], v[180:183], v[136:139], v[92:95]
  ds_read_b64_tr_b16 v[200:201], v27 offset:10240
  v_mfma_f32_16x16x32_bf16 v[112:115], v[180:183], v[140:143], v[112:115]
  ds_read_b64_tr_b16 v[202:203], v27 offset:11520
  s_waitcnt lgkmcnt(8)
  v_mfma_f32_16x16x32_bf16 v[56:59], v[184:187], v[128:131], v[56:59]
  ds_read_b64_tr_b16 v[204:205], v28 offset:10240
  v_mfma_f32_16x16x32_bf16 v[76:79], v[184:187], v[132:135], v[76:79]
  ds_read_b64_tr_b16 v[206:207], v28 offset:11520
  v_mfma_f32_16x16x32_bf16 v[96:99], v[184:187], v[136:139], v[96:99]
  ds_read_b64_tr_b16 v[208:209], v29 offset:10240
  v_mfma_f32_16x16x32_bf16 v[116:119], v[184:187], v[140:143], v[116:119]
  ds_read_b64_tr_b16 v[210:211], v29 offset:11520
  v_mfma_f32_16x16x32_bf16 v[60:63], v[188:191], v[128:131], v[60:63]
  ds_read_b64_tr_b16 v[212:213], v30 offset:10240
  v_mfma_f32_16x16x32_bf16 v[80:83], v[188:191], v[132:135], v[80:83]
  ds_read_b64_tr_b16 v[214:215], v30 offset:11520
  v_mfma_f32_16x16x32_bf16 v[100:103], v[188:191], v[136:139], v[100:103]
  v_mfma_f32_16x16x32_bf16 v[120:123], v[188:191], v[140:143], v[120:123]
  v_mfma_f32_16x16x32_bf16 v[64:67], v[192:195], v[128:131], v[64:67]
  v_mfma_f32_16x16x32_bf16 v[84:87], v[192:195], v[132:135], v[84:87]
  v_mfma_f32_16x16x32_bf16 v[104:107], v[192:195], v[136:139], v[104:107]
  v_mfma_f32_16x16x32_bf16 v[124:127], v[192:195], v[140:143], v[124:127]
  s_barrier
  s_waitcnt lgkmcnt(6)
  v_mfma_f32_16x16x32_bf16 v[48:51], v[196:199], v[144:147], v[48:51]
  ds_read_b128 v[128:131], v24 offset:36864
  v_mfma_f32_16x16x32_bf16 v[68:71], v[196:199], v[148:151], v[68:71]
  ds_read_b128 v[132:135], v24 offset:38912
  v_mfma_f32_16x16x32_bf16 v[88:91], v[196:199], v[152:155], v[88:91]
  ds_read_b128 v[136:139], v24 offset:40960
  v_mfma_f32_16x16x32_bf16 v[108:111], v[196:199], v[156:159], v[108:111]
  ds_read_b128 v[140:143], v24 offset:43008
  v_mfma_f32_16x16x32_bf16 v[52:55], v[200:203], v[144:147], v[52:55]
  ds_read_b64_tr_b16 v[176:177], v26 offset:36864
  v_mfma_f32_16x16x32_bf16 v[72:75], v[200:203], v[148:151], v[72:75]
  ds_read_b64_tr_b16 v[178:179], v26 offset:38144
  v_mfma_f32_16x16x32_bf16 v[92:95], v[200:203], v[152:155], v[92:95]
  ds_read_b64_tr_b16 v[180:181], v27 offset:36864
  v_mfma_f32_16x16x32_bf16 v[112:115], v[200:203], v[156:159], v[112:115]
  ds_read_b64_tr_b16 v[182:183], v27 offset:38144
  s_waitcnt lgkmcnt(8)
  v_mfma_f32_16x16x32_bf16 v[56:59], v[204:207], v[144:147], v[56:59]
  ds_read_b64_tr_b16 v[184:185], v28 offset:36864
  v_mfma_f32_16x16x32_bf16 v[76:79], v[204:207], v[148:151], v[76:79]
  ds_read_b64_tr_b16 v[186:187], v28 offset:38144
  v_mfma_f32_16x16x32_bf16 v[96:99], v[204:207], v[152:155], v[96:99]
  ds_read_b64_tr_b16 v[188:189], v29 offset:36864
  v_mfma_f32_16x16x32_bf16 v[116:119], v[204:207], v[156:159], v[116:119]
  ds_read_b64_tr_b16 v[190:191], v29 offset:38144
  v_mfma_f32_16x16x32_bf16 v[60:63], v[208:211], v[144:147], v[60:63]
  ds_read_b64_tr_b16 v[192:193], v30 offset:36864
  v_mfma_f32_16x16x32_bf16 v[80:83], v[208:211], v[148:151], v[80:83]
  ds_read_b64_tr_b16 v[194:195], v30 offset:38144
  v_mfma_f32_16x16x32_bf16 v[100:103], v[208:211], v[152:155], v[100:103]
  v_mfma_f32_16x16x32_bf16 v[120:123], v[208:211], v[156:159], v[120:123]
  v_mfma_f32_16x16x32_bf16 v[64:67], v[212:215], v[144:147], v[64:67]
  v_mfma_f32_16x16x32_bf16 v[84:87], v[212:215], v[148:151], v[84:87]
  v_mfma_f32_16x16x32_bf16 v[104:107], v[212:215], v[152:155], v[104:107]
  v_mfma_f32_16x16x32_bf16 v[124:127], v[212:215], v[156:159], v[124:127]
  s_waitcnt lgkmcnt(6)
  v_mfma_f32_16x16x32_bf16 v[48:51], v[176:179], v[128:131], v[48:51]
  ds_read_b128 v[144:147], v25 offset:36864
  v_mfma_f32_16x16x32_bf16 v[68:71], v[176:179], v[132:135], v[68:71]
  ds_read_b128 v[148:151], v25 offset:38912
  v_mfma_f32_16x16x32_bf16 v[88:91], v[176:179], v[136:139], v[88:91]
  ds_read_b128 v[152:155], v25 offset:40960
  v_mfma_f32_16x16x32_bf16 v[108:111], v[176:179], v[140:143], v[108:111]
  ds_read_b128 v[156:159], v25 offset:43008
  v_mfma_f32_16x16x32_bf16 v[52:55], v[180:183], v[128:131], v[52:55]
  ds_read_b64_tr_b16 v[196:197], v26 offset:47104
  v_mfma_f32_16x16x32_bf16 v[72:75], v[180:183], v[132:135], v[72:75]
  ds_read_b64_tr_b16 v[198:199], v26 offset:48384
  v_mfma_f32_16x16x32_bf16 v[92:95], v[180:183], v[136:139], v[92:95]
  ds_read_b64_tr_b16 v[200:201], v27 offset:47104
  v_mfma_f32_16x16x32_bf16 v[112:115], v[180:183], v[140:143], v[112:115]
  ds_read_b64_tr_b16 v[202:203], v27 offset:48384
  s_waitcnt lgkmcnt(8)
  v_mfma_f32_16x16x32_bf16 v[56:59], v[184:187], v[128:131], v[56:59]
  ds_read_b64_tr_b16 v[204:205], v28 offset:47104
  v_mfma_f32_16x16x32_bf16 v[76:79], v[184:187], v[132:135], v[76:79]
  ds_read_b64_tr_b16 v[206:207], v28 offset:48384
  v_mfma_f32_16x16x32_bf16 v[96:99], v[184:187], v[136:139], v[96:99]
  ds_read_b64_tr_b16 v[208:209], v29 offset:47104
  v_mfma_f32_16x16x32_bf16 v[116:119], v[184:187], v[140:143], v[116:119]
  ds_read_b64_tr_b16 v[210:211], v29 offset:48384
  v_mfma_f32_16x16x32_bf16 v[60:63], v[188:191], v[128:131], v[60:63]
  ds_read_b64_tr_b16 v[212:213], v30 offset:47104
  v_mfma_f32_16x16x32_bf16 v[80:83], v[188:191], v[132:135], v[80:83]
  ds_read_b64_tr_b16 v[214:215], v30 offset:48384
  v_mfma_f32_16x16x32_bf16 v[100:103], v[188:191], v[136:139], v[100:103]
  v_mfma_f32_16x16x32_bf16 v[120:123], v[188:191], v[140:143], v[120:123]
  v_mfma_f32_16x16x32_bf16 v[64:67], v[192:195], v[128:131], v[64:67]
  v_mfma_f32_16x16x32_bf16 v[84:87], v[192:195], v[132:135], v[84:87]
  v_mfma_f32_16x16x32_bf16 v[104:107], v[192:195], v[136:139], v[104:107]
  v_mfma_f32_16x16x32_bf16 v[124:127], v[192:195], v[140:143], v[124:127]
  s_barrier
  s_waitcnt lgkmcnt(6)
  v_mfma_f32_16x16x32_bf16 v[48:51], v[196:199], v[144:147], v[48:51]
  ds_read_b128 v[128:131], v17 offset:0
  v_mfma_f32_16x16x32_bf16 v[68:71], v[196:199], v[148:151], v[68:71]
  ds_read_b128 v[132:135], v17 offset:2048
  v_mfma_f32_16x16x32_bf16 v[88:91], v[196:199], v[152:155], v[88:91]
  ds_read_b128 v[136:139], v17 offset:4096
  v_mfma_f32_16x16x32_bf16 v[108:111], v[196:199], v[156:159], v[108:111]
  ds_read_b128 v[140:143], v17 offset:6144
  v_mfma_f32_16x16x32_bf16 v[52:55], v[200:203], v[144:147], v[52:55]
  ds_read_b64_tr_b16 v[176:177], v19 offset:0
  v_mfma_f32_16x16x32_bf16 v[72:75], v[200:203], v[148:151], v[72:75]
  ds_read_b64_tr_b16 v[178:179], v19 offset:1280
  v_mfma_f32_16x16x32_bf16 v[92:95], v[200:203], v[152:155], v[92:95]
  ds_read_b64_tr_b16 v[180:181], v20 offset:0
  v_mfma_f32_16x16x32_bf16 v[112:115], v[200:203], v[156:159], v[112:115]
  ds_read_b64_tr_b16 v[182:183], v20 offset:1280
  s_waitcnt lgkmcnt(8)
  v_mfma_f32_16x16x32_bf16 v[56:59], v[204:207], v[144:147], v[56:59]
  ds_read_b64_tr_b16 v[184:185], v21 offset:0
  v_mfma_f32_16x16x32_bf16 v[76:79], v[204:207], v[148:151], v[76:79]
  ds_read_b64_tr_b16 v[186:187], v21 offset:1280
  v_mfma_f32_16x16x32_bf16 v[96:99], v[204:207], v[152:155], v[96:99]
  ds_read_b64_tr_b16 v[188:189], v22 offset:0
  v_mfma_f32_16x16x32_bf16 v[116:119], v[204:207], v[156:159], v[116:119]
  ds_read_b64_tr_b16 v[190:191], v22 offset:1280
  v_mfma_f32_16x16x32_bf16 v[60:63], v[208:211], v[144:147], v[60:63]
  ds_read_b64_tr_b16 v[192:193], v23 offset:0
  v_mfma_f32_16x16x32_bf16 v[80:83], v[208:211], v[148:151], v[80:83]
  ds_read_b64_tr_b16 v[194:195], v23 offset:1280
  v_mfma_f32_16x16x32_bf16 v[100:103], v[208:211], v[152:155], v[100:103]
  v_mfma_f32_16x16x32_bf16 v[120:123], v[208:211], v[156:159], v[120:123]
  v_mfma_f32_16x16x32_bf16 v[64:67], v[212:215], v[144:147], v[64:67]
  v_mfma_f32_16x16x32_bf16 v[84:87], v[212:215], v[148:151], v[84:87]
  v_mfma_f32_16x16x32_bf16 v[104:107], v[212:215], v[152:155], v[104:107]
  v_mfma_f32_16x16x32_bf16 v[124:127], v[212:215], v[156:159], v[124:127]
  s_waitcnt lgkmcnt(6)
  v_mfma_f32_16x16x32_bf16 v[48:51], v[176:179], v[128:131], v[48:51]
  ds_read_b128 v[144:147], v18 offset:0
  v_mfma_f32_16x16x32_bf16 v[68:71], v[176:179], v[132:135], v[68:71]
  ds_read_b128 v[148:151], v18 offset:2048
  v_mfma_f32_16x16x32_bf16 v[88:91], v[176:179], v[136:139], v[88:91]
  ds_read_b128 v[152:155], v18 offset:4096
  v_mfma_f32_16x16x32_bf16 v[108:111], v[176:179], v[140:143], v[108:111]
  ds_read_b128 v[156:159], v18 offset:6144
  v_mfma_f32_16x16x32_bf16 v[52:55], v[180:183], v[128:131], v[52:55]
  ds_read_b64_tr_b16 v[196:197], v19 offset:10240
  v_mfma_f32_16x16x32_bf16 v[72:75], v[180:183], v[132:135], v[72:75]
  ds_read_b64_tr_b16 v[198:199], v19 offset:11520
  v_mfma_f32_16x16x32_bf16 v[92:95], v[180:183], v[136:139], v[92:95]
  ds_read_b64_tr_b16 v[200:201], v20 offset:10240
  v_mfma_f32_16x16x32_bf16 v[112:115], v[180:183], v[140:143], v[112:115]
  ds_read_b64_tr_b16 v[202:203], v20 offset:11520
  s_waitcnt lgkmcnt(8)
  v_mfma_f32_16x16x32_bf16 v[56:59], v[184:187], v[128:131], v[56:59]
  ds_read_b64_tr_b16 v[204:205], v21 offset:10240
  v_mfma_f32_16x16x32_bf16 v[76:79], v[184:187], v[132:135], v[76:79]
  ds_read_b64_tr_b16 v[206:207], v21 offset:11520
  v_mfma_f32_16x16x32_bf16 v[96:99], v[184:187], v[136:139], v[96:99]
  ds_read_b64_tr_b16 v[208:209], v22 offset:10240
  v_mfma_f32_16x16x32_bf16 v[116:119], v[184:187], v[140:143], v[116:119]
  ds_read_b64_tr_b16 v[210:211], v22 offset:11520
  v_mfma_f32_16x16x32_bf16 v[60:63], v[188:191], v[128:131], v[60:63]
  ds_read_b64_tr_b16 v[212:213], v23 offset:10240
  v_mfma_f32_16x16x32_bf16 v[80:83], v[188:191], v[132:135], v[80:83]
  ds_read_b64_tr_b16 v[214:215], v23 offset:11520
  v_mfma_f32_16x16x32_bf16 v[100:103], v[188:191], v[136:139], v[100:103]
  v_mfma_f32_16x16x32_bf16 v[120:123], v[188:191], v[140:143], v[120:123]
  v_mfma_f32_16x16x32_bf16 v[64:67], v[192:195], v[128:131], v[64:67]
  v_mfma_f32_16x16x32_bf16 v[84:87], v[192:195], v[132:135], v[84:87]
  v_mfma_f32_16x16x32_bf16 v[104:107], v[192:195], v[136:139], v[104:107]
  v_mfma_f32_16x16x32_bf16 v[124:127], v[192:195], v[140:143], v[124:127]
  s_barrier
  s_waitcnt lgkmcnt(6)
  v_mfma_f32_16x16x32_bf16 v[48:51], v[196:199], v[144:147], v[48:51]
  ds_read_b128 v[128:131], v17 offset:36864
  v_mfma_f32_16x16x32_bf16 v[68:71], v[196:199], v[148:151], v[68:71]
  ds_read_b128 v[132:135], v17 offset:38912
  v_mfma_f32_16x16x32_bf16 v[88:91], v[196:199], v[152:155], v[88:91]
  ds_read_b128 v[136:139], v17 offset:40960
  v_mfma_f32_16x16x32_bf16 v[108:111], v[196:199], v[156:159], v[108:111]
  ds_read_b128 v[140:143], v17 offset:43008
  v_mfma_f32_16x16x32_bf16 v[52:55], v[200:203], v[144:147], v[52:55]
  ds_read_b64_tr_b16 v[176:177], v19 offset:36864
  v_mfma_f32_16x16x32_bf16 v[72:75], v[200:203], v[148:151], v[72:75]
  ds_read_b64_tr_b16 v[178:179], v19 offset:38144
  v_mfma_f32_16x16x32_bf16 v[92:95], v[200:203], v[152:155], v[92:95]
  ds_read_b64_tr_b16 v[180:181], v20 offset:36864
  v_mfma_f32_16x16x32_bf16 v[112:115], v[200:203], v[156:159], v[112:115]
  ds_read_b64_tr_b16 v[182:183], v20 offset:38144
  s_waitcnt lgkmcnt(8)
  v_mfma_f32_16x16x32_bf16 v[56:59], v[204:207], v[144:147], v[56:59]
  ds_read_b64_tr_b16 v[184:185], v21 offset:36864
  v_mfma_f32_16x16x32_bf16 v[76:79], v[204:207], v[148:151], v[76:79]
  ds_read_b64_tr_b16 v[186:187], v21 offset:38144
  v_mfma_f32_16x16x32_bf16 v[96:99], v[204:207], v[152:155], v[96:99]
  ds_read_b64_tr_b16 v[188:189], v22 offset:36864
  v_mfma_f32_16x16x32_bf16 v[116:119], v[204:207], v[156:159], v[116:119]
  ds_read_b64_tr_b16 v[190:191], v22 offset:38144
  v_mfma_f32_16x16x32_bf16 v[60:63], v[208:211], v[144:147], v[60:63]
  ds_read_b64_tr_b16 v[192:193], v23 offset:36864
  v_mfma_f32_16x16x32_bf16 v[80:83], v[208:211], v[148:151], v[80:83]
  ds_read_b64_tr_b16 v[194:195], v23 offset:38144
  v_mfma_f32_16x16x32_bf16 v[100:103], v[208:211], v[152:155], v[100:103]
  v_mfma_f32_16x16x32_bf16 v[120:123], v[208:211], v[156:159], v[120:123]
  v_mfma_f32_16x16x32_bf16 v[64:67], v[212:215], v[144:147], v[64:67]
  v_mfma_f32_16x16x32_bf16 v[84:87], v[212:215], v[148:151], v[84:87]
  v_mfma_f32_16x16x32_bf16 v[104:107], v[212:215], v[152:155], v[104:107]
  v_mfma_f32_16x16x32_bf16 v[124:127], v[212:215], v[156:159], v[124:127]
  s_waitcnt lgkmcnt(6)
  v_mfma_f32_16x16x32_bf16 v[48:51], v[176:179], v[128:131], v[48:51]
  ds_read_b128 v[144:147], v18 offset:36864
  v_mfma_f32_16x16x32_bf16 v[68:71], v[176:179], v[132:135], v[68:71]
  ds_read_b128 v[148:151], v18 offset:38912
  v_mfma_f32_16x16x32_bf16 v[88:91], v[176:179], v[136:139], v[88:91]
  ds_read_b128 v[152:155], v18 offset:40960
  v_mfma_f32_16x16x32_bf16 v[108:111], v[176:179], v[140:143], v[108:111]
  ds_read_b128 v[156:159], v18 offset:43008
  v_mfma_f32_16x16x32_bf16 v[52:55], v[180:183], v[128:131], v[52:55]
  ds_read_b64_tr_b16 v[196:197], v19 offset:47104
  v_mfma_f32_16x16x32_bf16 v[72:75], v[180:183], v[132:135], v[72:75]
  ds_read_b64_tr_b16 v[198:199], v19 offset:48384
  v_mfma_f32_16x16x32_bf16 v[92:95], v[180:183], v[136:139], v[92:95]
  ds_read_b64_tr_b16 v[200:201], v20 offset:47104
  v_mfma_f32_16x16x32_bf16 v[112:115], v[180:183], v[140:143], v[112:115]
  ds_read_b64_tr_b16 v[202:203], v20 offset:48384
  s_waitcnt lgkmcnt(8)
  v_mfma_f32_16x16x32_bf16 v[56:59], v[184:187], v[128:131], v[56:59]
  ds_read_b64_tr_b16 v[204:205], v21 offset:47104
  v_mfma_f32_16x16x32_bf16 v[76:79], v[184:187], v[132:135], v[76:79]
  ds_read_b64_tr_b16 v[206:207], v21 offset:48384
  v_mfma_f32_16x16x32_bf16 v[96:99], v[184:187], v[136:139], v[96:99]
  ds_read_b64_tr_b16 v[208:209], v22 offset:47104
  v_mfma_f32_16x16x32_bf16 v[116:119], v[184:187], v[140:143], v[116:119]
  ds_read_b64_tr_b16 v[210:211], v22 offset:48384
  v_mfma_f32_16x16x32_bf16 v[60:63], v[188:191], v[128:131], v[60:63]
  ds_read_b64_tr_b16 v[212:213], v23 offset:47104
  v_mfma_f32_16x16x32_bf16 v[80:83], v[188:191], v[132:135], v[80:83]
  ds_read_b64_tr_b16 v[214:215], v23 offset:48384
  v_mfma_f32_16x16x32_bf16 v[100:103], v[188:191], v[136:139], v[100:103]
  v_mfma_f32_16x16x32_bf16 v[120:123], v[188:191], v[140:143], v[120:123]
  v_mfma_f32_16x16x32_bf16 v[64:67], v[192:195], v[128:131], v[64:67]
  v_mfma_f32_16x16x32_bf16 v[84:87], v[192:195], v[132:135], v[84:87]
  v_mfma_f32_16x16x32_bf16 v[104:107], v[192:195], v[136:139], v[104:107]
  v_mfma_f32_16x16x32_bf16 v[124:127], v[192:195], v[140:143], v[124:127]
  s_barrier
  s_waitcnt lgkmcnt(6)
  v_mfma_f32_16x16x32_bf16 v[48:51], v[196:199], v[144:147], v[48:51]
  ds_read_b128 v[128:131], v24 offset:0
  v_mfma_f32_16x16x32_bf16 v[68:71], v[196:199], v[148:151], v[68:71]
  ds_read_b128 v[132:135], v24 offset:2048
  v_mfma_f32_16x16x32_bf16 v[88:91], v[196:199], v[152:155], v[88:91]
  ds_read_b128 v[136:139], v24 offset:4096
  v_mfma_f32_16x16x32_bf16 v[108:111], v[196:199], v[156:159], v[108:111]
  ds_read_b128 v[140:143], v24 offset:6144
  v_mfma_f32_16x16x32_bf16 v[52:55], v[200:203], v[144:147], v[52:55]
  ds_read_b64_tr_b16 v[176:177], v26 offset:0
  v_mfma_f32_16x16x32_bf16 v[72:75], v[200:203], v[148:151], v[72:75]
  ds_read_b64_tr_b16 v[178:179], v26 offset:1280
  v_mfma_f32_16x16x32_bf16 v[92:95], v[200:203], v[152:155], v[92:95]
  ds_read_b64_tr_b16 v[180:181], v27 offset:0
  v_mfma_f32_16x16x32_bf16 v[112:115], v[200:203], v[156:159], v[112:115]
  ds_read_b64_tr_b16 v[182:183], v27 offset:1280
  s_waitcnt lgkmcnt(8)
  v_mfma_f32_16x16x32_bf16 v[56:59], v[204:207], v[144:147], v[56:59]
  ds_read_b64_tr_b16 v[184:185], v28 offset:0
  v_mfma_f32_16x16x32_bf16 v[76:79], v[204:207], v[148:151], v[76:79]
  ds_read_b64_tr_b16 v[186:187], v28 offset:1280
  v_mfma_f32_16x16x32_bf16 v[96:99], v[204:207], v[152:155], v[96:99]
  ds_read_b64_tr_b16 v[188:189], v29 offset:0
  v_mfma_f32_16x16x32_bf16 v[116:119], v[204:207], v[156:159], v[116:119]
  ds_read_b64_tr_b16 v[190:191], v29 offset:1280
  v_mfma_f32_16x16x32_bf16 v[60:63], v[208:211], v[144:147], v[60:63]
  ds_read_b64_tr_b16 v[192:193], v30 offset:0
  v_mfma_f32_16x16x32_bf16 v[80:83], v[208:211], v[148:151], v[80:83]
  ds_read_b64_tr_b16 v[194:195], v30 offset:1280
  v_mfma_f32_16x16x32_bf16 v[100:103], v[208:211], v[152:155], v[100:103]
  v_mfma_f32_16x16x32_bf16 v[120:123], v[208:211], v[156:159], v[120:123]
  v_mfma_f32_16x16x32_bf16 v[64:67], v[212:215], v[144:147], v[64:67]
  v_mfma_f32_16x16x32_bf16 v[84:87], v[212:215], v[148:151], v[84:87]
  v_mfma_f32_16x16x32_bf16 v[104:107], v[212:215], v[152:155], v[104:107]
  v_mfma_f32_16x16x32_bf16 v[124:127], v[212:215], v[156:159], v[124:127]
  s_waitcnt lgkmcnt(6)
  v_mfma_f32_16x16x32_bf16 v[48:51], v[176:179], v[128:131], v[48:51]
  ds_read_b128 v[144:147], v25 offset:0
  v_mfma_f32_16x16x32_bf16 v[68:71], v[176:179], v[132:135], v[68:71]
  ds_read_b128 v[148:151], v25 offset:2048
  v_mfma_f32_16x16x32_bf16 v[88:91], v[176:179], v[136:139], v[88:91]
  ds_read_b128 v[152:155], v25 offset:4096
  v_mfma_f32_16x16x32_bf16 v[108:111], v[176:179], v[140:143], v[108:111]
  ds_read_b128 v[156:159], v25 offset:6144
  v_mfma_f32_16x16x32_bf16 v[52:55], v[180:183], v[128:131], v[52:55]
  ds_read_b64_tr_b16 v[196:197], v26 offset:10240
  v_mfma_f32_16x16x32_bf16 v[72:75], v[180:183], v[132:135], v[72:75]
  ds_read_b64_tr_b16 v[198:199], v26 offset:11520
  v_mfma_f32_16x16x32_bf16 v[92:95], v[180:183], v[136:139], v[92:95]
  ds_read_b64_tr_b16 v[200:201], v27 offset:10240
  v_mfma_f32_16x16x32_bf16 v[112:115], v[180:183], v[140:143], v[112:115]
  ds_read_b64_tr_b16 v[202:203], v27 offset:11520
  s_waitcnt lgkmcnt(8)
  v_mfma_f32_16x16x32_bf16 v[56:59], v[184:187], v[128:131], v[56:59]
  ds_read_b64_tr_b16 v[204:205], v28 offset:10240
  v_mfma_f32_16x16x32_bf16 v[76:79], v[184:187], v[132:135], v[76:79]
  ds_read_b64_tr_b16 v[206:207], v28 offset:11520
  v_mfma_f32_16x16x32_bf16 v[96:99], v[184:187], v[136:139], v[96:99]
  ds_read_b64_tr_b16 v[208:209], v29 offset:10240
  v_mfma_f32_16x16x32_bf16 v[116:119], v[184:187], v[140:143], v[116:119]
  ds_read_b64_tr_b16 v[210:211], v29 offset:11520
  v_mfma_f32_16x16x32_bf16 v[60:63], v[188:191], v[128:131], v[60:63]
  ds_read_b64_tr_b16 v[212:213], v30 offset:10240
  v_mfma_f32_16x16x32_bf16 v[80:83], v[188:191], v[132:135], v[80:83]
  ds_read_b64_tr_b16 v[214:215], v30 offset:11520
  v_mfma_f32_16x16x32_bf16 v[100:103], v[188:191], v[136:139], v[100:103]
  v_mfma_f32_16x16x32_bf16 v[120:123], v[188:191], v[140:143], v[120:123]
  v_mfma_f32_16x16x32_bf16 v[64:67], v[192:195], v[128:131], v[64:67]
  v_mfma_f32_16x16x32_bf16 v[84:87], v[192:195], v[132:135], v[84:87]
  v_mfma_f32_16x16x32_bf16 v[104:107], v[192:195], v[136:139], v[104:107]
  v_mfma_f32_16x16x32_bf16 v[124:127], v[192:195], v[140:143], v[124:127]
  s_barrier
  s_waitcnt lgkmcnt(6)
  v_mfma_f32_16x16x32_bf16 v[48:51], v[196:199], v[144:147], v[48:51]
  ds_read_b128 v[128:131], v24 offset:36864
  v_mfma_f32_16x16x32_bf16 v[68:71], v[196:199], v[148:151], v[68:71]
  ds_read_b128 v[132:135], v24 offset:38912
  v_mfma_f32_16x16x32_bf16 v[88:91], v[196:199], v[152:155], v[88:91]
  ds_read_b128 v[136:139], v24 offset:40960
  v_mfma_f32_16x16x32_bf16 v[108:111], v[196:199], v[156:159], v[108:111]
  ds_read_b128 v[140:143], v24 offset:43008
  v_mfma_f32_16x16x32_bf16 v[52:55], v[200:203], v[144:147], v[52:55]
  ds_read_b64_tr_b16 v[176:177], v26 offset:36864
  v_mfma_f32_16x16x32_bf16 v[72:75], v[200:203], v[148:151], v[72:75]
  ds_read_b64_tr_b16 v[178:179], v26 offset:38144
  v_mfma_f32_16x16x32_bf16 v[92:95], v[200:203], v[152:155], v[92:95]
  ds_read_b64_tr_b16 v[180:181], v27 offset:36864
  v_mfma_f32_16x16x32_bf16 v[112:115], v[200:203], v[156:159], v[112:115]
  ds_read_b64_tr_b16 v[182:183], v27 offset:38144
  s_waitcnt lgkmcnt(8)
  v_mfma_f32_16x16x32_bf16 v[56:59], v[204:207], v[144:147], v[56:59]
  ds_read_b64_tr_b16 v[184:185], v28 offset:36864
  v_mfma_f32_16x16x32_bf16 v[76:79], v[204:207], v[148:151], v[76:79]
  ds_read_b64_tr_b16 v[186:187], v28 offset:38144
  v_mfma_f32_16x16x32_bf16 v[96:99], v[204:207], v[152:155], v[96:99]
  ds_read_b64_tr_b16 v[188:189], v29 offset:36864
  v_mfma_f32_16x16x32_bf16 v[116:119], v[204:207], v[156:159], v[116:119]
  ds_read_b64_tr_b16 v[190:191], v29 offset:38144
  v_mfma_f32_16x16x32_bf16 v[60:63], v[208:211], v[144:147], v[60:63]
  ds_read_b64_tr_b16 v[192:193], v30 offset:36864
  v_mfma_f32_16x16x32_bf16 v[80:83], v[208:211], v[148:151], v[80:83]
  ds_read_b64_tr_b16 v[194:195], v30 offset:38144
  v_mfma_f32_16x16x32_bf16 v[100:103], v[208:211], v[152:155], v[100:103]
  v_mfma_f32_16x16x32_bf16 v[120:123], v[208:211], v[156:159], v[120:123]
  v_mfma_f32_16x16x32_bf16 v[64:67], v[212:215], v[144:147], v[64:67]
  v_mfma_f32_16x16x32_bf16 v[84:87], v[212:215], v[148:151], v[84:87]
  v_mfma_f32_16x16x32_bf16 v[104:107], v[212:215], v[152:155], v[104:107]
  v_mfma_f32_16x16x32_bf16 v[124:127], v[212:215], v[156:159], v[124:127]
  s_waitcnt lgkmcnt(6)
  v_mfma_f32_16x16x32_bf16 v[48:51], v[176:179], v[128:131], v[48:51]
  ds_read_b128 v[144:147], v25 offset:36864
  v_mfma_f32_16x16x32_bf16 v[68:71], v[176:179], v[132:135], v[68:71]
  ds_read_b128 v[148:151], v25 offset:38912
  v_mfma_f32_16x16x32_bf16 v[88:91], v[176:179], v[136:139], v[88:91]
  ds_read_b128 v[152:155], v25 offset:40960
  v_mfma_f32_16x16x32_bf16 v[108:111], v[176:179], v[140:143], v[108:111]
  ds_read_b128 v[156:159], v25 offset:43008
  v_mfma_f32_16x16x32_bf16 v[52:55], v[180:183], v[128:131], v[52:55]
  ds_read_b64_tr_b16 v[196:197], v26 offset:47104
  v_mfma_f32_16x16x32_bf16 v[72:75], v[180:183], v[132:135], v[72:75]
  ds_read_b64_tr_b16 v[198:199], v26 offset:48384
  v_mfma_f32_16x16x32_bf16 v[92:95], v[180:183], v[136:139], v[92:95]
  ds_read_b64_tr_b16 v[200:201], v27 offset:47104
  v_mfma_f32_16x16x32_bf16 v[112:115], v[180:183], v[140:143], v[112:115]
  ds_read_b64_tr_b16 v[202:203], v27 offset:48384
  s_waitcnt lgkmcnt(8)
  v_mfma_f32_16x16x32_bf16 v[56:59], v[184:187], v[128:131], v[56:59]
  ds_read_b64_tr_b16 v[204:205], v28 offset:47104
  v_mfma_f32_16x16x32_bf16 v[76:79], v[184:187], v[132:135], v[76:79]
  ds_read_b64_tr_b16 v[206:207], v28 offset:48384
  v_mfma_f32_16x16x32_bf16 v[96:99], v[184:187], v[136:139], v[96:99]
  ds_read_b64_tr_b16 v[208:209], v29 offset:47104
  v_mfma_f32_16x16x32_bf16 v[116:119], v[184:187], v[140:143], v[116:119]
  ds_read_b64_tr_b16 v[210:211], v29 offset:48384
  v_mfma_f32_16x16x32_bf16 v[60:63], v[188:191], v[128:131], v[60:63]
  ds_read_b64_tr_b16 v[212:213], v30 offset:47104
  v_mfma_f32_16x16x32_bf16 v[80:83], v[188:191], v[132:135], v[80:83]
  ds_read_b64_tr_b16 v[214:215], v30 offset:48384
  v_mfma_f32_16x16x32_bf16 v[100:103], v[188:191], v[136:139], v[100:103]
  v_mfma_f32_16x16x32_bf16 v[120:123], v[188:191], v[140:143], v[120:123]
  v_mfma_f32_16x16x32_bf16 v[64:67], v[192:195], v[128:131], v[64:67]
  v_mfma_f32_16x16x32_bf16 v[84:87], v[192:195], v[132:135], v[84:87]
  v_mfma_f32_16x16x32_bf16 v[104:107], v[192:195], v[136:139], v[104:107]
  v_mfma_f32_16x16x32_bf16 v[124:127], v[192:195], v[140:143], v[124:127]
  s_barrier
  s_waitcnt lgkmcnt(6)
  v_mfma_f32_16x16x32_bf16 v[48:51], v[196:199], v[144:147], v[48:51]
  ds_read_b128 v[128:131], v17 offset:0
  v_mfma_f32_16x16x32_bf16 v[68:71], v[196:199], v[148:151], v[68:71]
  ds_read_b128 v[132:135], v17 offset:2048
  v_mfma_f32_16x16x32_bf16 v[88:91], v[196:199], v[152:155], v[88:91]
  ds_read_b128 v[136:139], v17 offset:4096
  v_mfma_f32_16x16x32_bf16 v[108:111], v[196:199], v[156:159], v[108:111]
  ds_read_b128 v[140:143], v17 offset:6144
  v_mfma_f32_16x16x32_bf16 v[52:55], v[200:203], v[144:147], v[52:55]
  ds_read_b64_tr_b16 v[176:177], v19 offset:0
  v_mfma_f32_16x16x32_bf16 v[72:75], v[200:203], v[148:151], v[72:75]
  ds_read_b64_tr_b16 v[178:179], v19 offset:1280
  v_mfma_f32_16x16x32_bf16 v[92:95], v[200:203], v[152:155], v[92:95]
  ds_read_b64_tr_b16 v[180:181], v20 offset:0
  v_mfma_f32_16x16x32_bf16 v[112:115], v[200:203], v[156:159], v[112:115]
  ds_read_b64_tr_b16 v[182:183], v20 offset:1280
  s_waitcnt lgkmcnt(8)
  v_mfma_f32_16x16x32_bf16 v[56:59], v[204:207], v[144:147], v[56:59]
  ds_read_b64_tr_b16 v[184:185], v21 offset:0
  v_mfma_f32_16x16x32_bf16 v[76:79], v[204:207], v[148:151], v[76:79]
  ds_read_b64_tr_b16 v[186:187], v21 offset:1280
  v_mfma_f32_16x16x32_bf16 v[96:99], v[204:207], v[152:155], v[96:99]
  ds_read_b64_tr_b16 v[188:189], v22 offset:0
  v_mfma_f32_16x16x32_bf16 v[116:119], v[204:207], v[156:159], v[116:119]
  ds_read_b64_tr_b16 v[190:191], v22 offset:1280
  v_mfma_f32_16x16x32_bf16 v[60:63], v[208:211], v[144:147], v[60:63]
  ds_read_b64_tr_b16 v[192:193], v23 offset:0
  v_mfma_f32_16x16x32_bf16 v[80:83], v[208:211], v[148:151], v[80:83]
  ds_read_b64_tr_b16 v[194:195], v23 offset:1280
  v_mfma_f32_16x16x32_bf16 v[100:103], v[208:211], v[152:155], v[100:103]
  v_mfma_f32_16x16x32_bf16 v[120:123], v[208:211], v[156:159], v[120:123]
  v_mfma_f32_16x16x32_bf16 v[64:67], v[212:215], v[144:147], v[64:67]
  v_mfma_f32_16x16x32_bf16 v[84:87], v[212:215], v[148:151], v[84:87]
  v_mfma_f32_16x16x32_bf16 v[104:107], v[212:215], v[152:155], v[104:107]
  v_mfma_f32_16x16x32_bf16 v[124:127], v[212:215], v[156:159], v[124:127]
  s_waitcnt lgkmcnt(6)
  v_mfma_f32_16x16x32_bf16 v[48:51], v[176:179], v[128:131], v[48:51]
  ds_read_b128 v[144:147], v18 offset:0
  v_mfma_f32_16x16x32_bf16 v[68:71], v[176:179], v[132:135], v[68:71]
  ds_read_b128 v[148:151], v18 offset:2048
  v_mfma_f32_16x16x32_bf16 v[88:91], v[176:179], v[136:139], v[88:91]
  ds_read_b128 v[152:155], v18 offset:4096
  v_mfma_f32_16x16x32_bf16 v[108:111], v[176:179], v[140:143], v[108:111]
  ds_read_b128 v[156:159], v18 offset:6144
  v_mfma_f32_16x16x32_bf16 v[52:55], v[180:183], v[128:131], v[52:55]
  ds_read_b64_tr_b16 v[196:197], v19 offset:10240
  v_mfma_f32_16x16x32_bf16 v[72:75], v[180:183], v[132:135], v[72:75]
  ds_read_b64_tr_b16 v[198:199], v19 offset:11520
  v_mfma_f32_16x16x32_bf16 v[92:95], v[180:183], v[136:139], v[92:95]
  ds_read_b64_tr_b16 v[200:201], v20 offset:10240
  v_mfma_f32_16x16x32_bf16 v[112:115], v[180:183], v[140:143], v[112:115]
  ds_read_b64_tr_b16 v[202:203], v20 offset:11520
  s_waitcnt lgkmcnt(8)
  v_mfma_f32_16x16x32_bf16 v[56:59], v[184:187], v[128:131], v[56:59]
  ds_read_b64_tr_b16 v[204:205], v21 offset:10240
  v_mfma_f32_16x16x32_bf16 v[76:79], v[184:187], v[132:135], v[76:79]
  ds_read_b64_tr_b16 v[206:207], v21 offset:11520
  v_mfma_f32_16x16x32_bf16 v[96:99], v[184:187], v[136:139], v[96:99]
  ds_read_b64_tr_b16 v[208:209], v22 offset:10240
  v_mfma_f32_16x16x32_bf16 v[116:119], v[184:187], v[140:143], v[116:119]
  ds_read_b64_tr_b16 v[210:211], v22 offset:11520
  v_mfma_f32_16x16x32_bf16 v[60:63], v[188:191], v[128:131], v[60:63]
  ds_read_b64_tr_b16 v[212:213], v23 offset:10240
  v_mfma_f32_16x16x32_bf16 v[80:83], v[188:191], v[132:135], v[80:83]
  ds_read_b64_tr_b16 v[214:215], v23 offset:11520
  v_mfma_f32_16x16x32_bf16 v[100:103], v[188:191], v[136:139], v[100:103]
  v_mfma_f32_16x16x32_bf16 v[120:123], v[188:191], v[140:143], v[120:123]
  v_mfma_f32_16x16x32_bf16 v[64:67], v[192:195], v[128:131], v[64:67]
  v_mfma_f32_16x16x32_bf16 v[84:87], v[192:195], v[132:135], v[84:87]
  v_mfma_f32_16x16x32_bf16 v[104:107], v[192:195], v[136:139], v[104:107]
  v_mfma_f32_16x16x32_bf16 v[124:127], v[192:195], v[140:143], v[124:127]
  s_barrier
  s_waitcnt lgkmcnt(6)
  v_mfma_f32_16x16x32_bf16 v[48:51], v[196:199], v[144:147], v[48:51]
  ds_read_b128 v[128:131], v17 offset:36864
  v_mfma_f32_16x16x32_bf16 v[68:71], v[196:199], v[148:151], v[68:71]
  ds_read_b128 v[132:135], v17 offset:38912
  v_mfma_f32_16x16x32_bf16 v[88:91], v[196:199], v[152:155], v[88:91]
  ds_read_b128 v[136:139], v17 offset:40960
  v_mfma_f32_16x16x32_bf16 v[108:111], v[196:199], v[156:159], v[108:111]
  ds_read_b128 v[140:143], v17 offset:43008
  v_mfma_f32_16x16x32_bf16 v[52:55], v[200:203], v[144:147], v[52:55]
  ds_read_b64_tr_b16 v[176:177], v19 offset:36864
  v_mfma_f32_16x16x32_bf16 v[72:75], v[200:203], v[148:151], v[72:75]
  ds_read_b64_tr_b16 v[178:179], v19 offset:38144
  v_mfma_f32_16x16x32_bf16 v[92:95], v[200:203], v[152:155], v[92:95]
  ds_read_b64_tr_b16 v[180:181], v20 offset:36864
  v_mfma_f32_16x16x32_bf16 v[112:115], v[200:203], v[156:159], v[112:115]
  ds_read_b64_tr_b16 v[182:183], v20 offset:38144
  s_waitcnt lgkmcnt(8)
  v_mfma_f32_16x16x32_bf16 v[56:59], v[204:207], v[144:147], v[56:59]
  ds_read_b64_tr_b16 v[184:185], v21 offset:36864
  v_mfma_f32_16x16x32_bf16 v[76:79], v[204:207], v[148:151], v[76:79]
  ds_read_b64_tr_b16 v[186:187], v21 offset:38144
  v_mfma_f32_16x16x32_bf16 v[96:99], v[204:207], v[152:155], v[96:99]
  ds_read_b64_tr_b16 v[188:189], v22 offset:36864
  v_mfma_f32_16x16x32_bf16 v[116:119], v[204:207], v[156:159], v[116:119]
  ds_read_b64_tr_b16 v[190:191], v22 offset:38144
  v_mfma_f32_16x16x32_bf16 v[60:63], v[208:211], v[144:147], v[60:63]
  ds_read_b64_tr_b16 v[192:193], v23 offset:36864
  v_mfma_f32_16x16x32_bf16 v[80:83], v[208:211], v[148:151], v[80:83]
  ds_read_b64_tr_b16 v[194:195], v23 offset:38144
  v_mfma_f32_16x16x32_bf16 v[100:103], v[208:211], v[152:155], v[100:103]
  v_mfma_f32_16x16x32_bf16 v[120:123], v[208:211], v[156:159], v[120:123]
  v_mfma_f32_16x16x32_bf16 v[64:67], v[212:215], v[144:147], v[64:67]
  v_mfma_f32_16x16x32_bf16 v[84:87], v[212:215], v[148:151], v[84:87]
  v_mfma_f32_16x16x32_bf16 v[104:107], v[212:215], v[152:155], v[104:107]
  v_mfma_f32_16x16x32_bf16 v[124:127], v[212:215], v[156:159], v[124:127]
  s_waitcnt lgkmcnt(6)
  v_mfma_f32_16x16x32_bf16 v[48:51], v[176:179], v[128:131], v[48:51]
  ds_read_b128 v[144:147], v18 offset:36864
  v_mfma_f32_16x16x32_bf16 v[68:71], v[176:179], v[132:135], v[68:71]
  ds_read_b128 v[148:151], v18 offset:38912
  v_mfma_f32_16x16x32_bf16 v[88:91], v[176:179], v[136:139], v[88:91]
  ds_read_b128 v[152:155], v18 offset:40960
  v_mfma_f32_16x16x32_bf16 v[108:111], v[176:179], v[140:143], v[108:111]
  ds_read_b128 v[156:159], v18 offset:43008
  v_mfma_f32_16x16x32_bf16 v[52:55], v[180:183], v[128:131], v[52:55]
  ds_read_b64_tr_b16 v[196:197], v19 offset:47104
  v_mfma_f32_16x16x32_bf16 v[72:75], v[180:183], v[132:135], v[72:75]
  ds_read_b64_tr_b16 v[198:199], v19 offset:48384
  v_mfma_f32_16x16x32_bf16 v[92:95], v[180:183], v[136:139], v[92:95]
  ds_read_b64_tr_b16 v[200:201], v20 offset:47104
  v_mfma_f32_16x16x32_bf16 v[112:115], v[180:183], v[140:143], v[112:115]
  ds_read_b64_tr_b16 v[202:203], v20 offset:48384
  s_waitcnt lgkmcnt(8)
  v_mfma_f32_16x16x32_bf16 v[56:59], v[184:187], v[128:131], v[56:59]
  ds_read_b64_tr_b16 v[204:205], v21 offset:47104
  v_mfma_f32_16x16x32_bf16 v[76:79], v[184:187], v[132:135], v[76:79]
  ds_read_b64_tr_b16 v[206:207], v21 offset:48384
  v_mfma_f32_16x16x32_bf16 v[96:99], v[184:187], v[136:139], v[96:99]
  ds_read_b64_tr_b16 v[208:209], v22 offset:47104
  v_mfma_f32_16x16x32_bf16 v[116:119], v[184:187], v[140:143], v[116:119]
  ds_read_b64_tr_b16 v[210:211], v22 offset:48384
  v_mfma_f32_16x16x32_bf16 v[60:63], v[188:191], v[128:131], v[60:63]
  ds_read_b64_tr_b16 v[212:213], v23 offset:47104
  v_mfma_f32_16x16x32_bf16 v[80:83], v[188:191], v[132:135], v[80:83]
  ds_read_b64_tr_b16 v[214:215], v23 offset:48384
  v_mfma_f32_16x16x32_bf16 v[100:103], v[188:191], v[136:139], v[100:103]
  v_mfma_f32_16x16x32_bf16 v[120:123], v[188:191], v[140:143], v[120:123]
  v_mfma_f32_16x16x32_bf16 v[64:67], v[192:195], v[128:131], v[64:67]
  v_mfma_f32_16x16x32_bf16 v[84:87], v[192:195], v[132:135], v[84:87]
  v_mfma_f32_16x16x32_bf16 v[104:107], v[192:195], v[136:139], v[104:107]
  v_mfma_f32_16x16x32_bf16 v[124:127], v[192:195], v[140:143], v[124:127]
  s_waitcnt lgkmcnt(6)
  v_mfma_f32_16x16x32_bf16 v[48:51], v[196:199], v[144:147], v[48:51]
  v_mfma_f32_16x16x32_bf16 v[68:71], v[196:199], v[148:151], v[68:71]
  v_mfma_f32_16x16x32_bf16 v[88:91], v[196:199], v[152:155], v[88:91]
  v_mfma_f32_16x16x32_bf16 v[108:111], v[196:199], v[156:159], v[108:111]
  v_mfma_f32_16x16x32_bf16 v[52:55], v[200:203], v[144:147], v[52:55]
  v_mfma_f32_16x16x32_bf16 v[72:75], v[200:203], v[148:151], v[72:75]
  v_mfma_f32_16x16x32_bf16 v[92:95], v[200:203], v[152:155], v[92:95]
  v_mfma_f32_16x16x32_bf16 v[112:115], v[200:203], v[156:159], v[112:115]
  s_waitcnt lgkmcnt(0)
  v_mfma_f32_16x16x32_bf16 v[56:59], v[204:207], v[144:147], v[56:59]
  v_mfma_f32_16x16x32_bf16 v[76:79], v[204:207], v[148:151], v[76:79]
  v_mfma_f32_16x16x32_bf16 v[96:99], v[204:207], v[152:155], v[96:99]
  v_mfma_f32_16x16x32_bf16 v[116:119], v[204:207], v[156:159], v[116:119]
  v_mfma_f32_16x16x32_bf16 v[60:63], v[208:211], v[144:147], v[60:63]
  v_mfma_f32_16x16x32_bf16 v[80:83], v[208:211], v[148:151], v[80:83]
  v_mfma_f32_16x16x32_bf16 v[100:103], v[208:211], v[152:155], v[100:103]
  v_mfma_f32_16x16x32_bf16 v[120:123], v[208:211], v[156:159], v[120:123]
  v_mfma_f32_16x16x32_bf16 v[64:67], v[212:215], v[144:147], v[64:67]
  v_mfma_f32_16x16x32_bf16 v[84:87], v[212:215], v[148:151], v[84:87]
  v_mfma_f32_16x16x32_bf16 v[104:107], v[212:215], v[152:155], v[104:107]
  v_mfma_f32_16x16x32_bf16 v[124:127], v[212:215], v[156:159], v[124:127]
  s_waitcnt lgkmcnt(0)
  s_mov_b64 exec, 1
  ds_add_u32 v44, v45 offset:0
  s_mov_b64 exec, -1
  s_setprio 2
  v_pk_mul_f32 v[4:5], v[48:49], s[80:81]
  v_pk_mul_f32 v[6:7], v[50:51], s[80:81]
  v_exp_f32 v4, v4 clamp
  v_exp_f32 v6, v6 clamp
  v_exp_f32 v5, v5 clamp
  v_exp_f32 v7, v7 clamp
  v_pk_add_f32 v[4:5], v[4:5], s[82:83]
  v_pk_add_f32 v[6:7], v[6:7], s[82:83]
  v_pk_add_f32 v[48:49], v[48:49], v[4:5]
  v_pk_add_f32 v[50:51], v[50:51], v[6:7]
  v_max_f32 v48, v48, v4
  v_max_f32 v50, v50, v6
  v_max_f32 v49, v49, v5
  v_max_f32 v51, v51, v7
  v_pk_mul_f32 v[4:5], v[52:53], s[80:81]
  v_pk_mul_f32 v[6:7], v[54:55], s[80:81]
  v_exp_f32 v4, v4 clamp
  v_exp_f32 v6, v6 clamp
  v_exp_f32 v5, v5 clamp
  v_exp_f32 v7, v7 clamp
  v_pk_add_f32 v[4:5], v[4:5], s[82:83]
  v_pk_add_f32 v[6:7], v[6:7], s[82:83]
  v_pk_add_f32 v[52:53], v[52:53], v[4:5]
  v_pk_add_f32 v[54:55], v[54:55], v[6:7]
  v_max_f32 v52, v52, v4
  v_max_f32 v54, v54, v6
  v_max_f32 v53, v53, v5
  v_max_f32 v55, v55, v7
  v_pk_mul_f32 v[4:5], v[56:57], s[80:81]
  v_pk_mul_f32 v[6:7], v[58:59], s[80:81]
  v_exp_f32 v4, v4 clamp
  v_exp_f32 v6, v6 clamp
  v_exp_f32 v5, v5 clamp
  v_exp_f32 v7, v7 clamp
  v_pk_add_f32 v[4:5], v[4:5], s[82:83]
  v_pk_add_f32 v[6:7], v[6:7], s[82:83]
  v_pk_add_f32 v[56:57], v[56:57], v[4:5]
  v_pk_add_f32 v[58:59], v[58:59], v[6:7]
  v_max_f32 v56, v56, v4
  v_max_f32 v58, v58, v6
  v_max_f32 v57, v57, v5
  v_max_f32 v59, v59, v7
  v_pk_mul_f32 v[4:5], v[60:61], s[80:81]
  v_pk_mul_f32 v[6:7], v[62:63], s[80:81]
  v_exp_f32 v4, v4 clamp
  v_exp_f32 v6, v6 clamp
  v_exp_f32 v5, v5 clamp
  v_exp_f32 v7, v7 clamp
  v_pk_add_f32 v[4:5], v[4:5], s[82:83]
  v_pk_add_f32 v[6:7], v[6:7], s[82:83]
  v_pk_add_f32 v[60:61], v[60:61], v[4:5]
  v_pk_add_f32 v[62:63], v[62:63], v[6:7]
  v_max_f32 v60, v60, v4
  v_max_f32 v62, v62, v6
  v_max_f32 v61, v61, v5
  v_max_f32 v63, v63, v7
  v_pk_mul_f32 v[4:5], v[64:65], s[80:81]
  v_pk_mul_f32 v[6:7], v[66:67], s[80:81]
  v_exp_f32 v4, v4 clamp
  v_exp_f32 v6, v6 clamp
  v_exp_f32 v5, v5 clamp
  v_exp_f32 v7, v7 clamp
  v_pk_add_f32 v[4:5], v[4:5], s[82:83]
  v_pk_add_f32 v[6:7], v[6:7], s[82:83]
  v_pk_add_f32 v[64:65], v[64:65], v[4:5]
  v_pk_add_f32 v[66:67], v[66:67], v[6:7]
  v_max_f32 v64, v64, v4
  v_max_f32 v66, v66, v6
  v_max_f32 v65, v65, v5
  v_max_f32 v67, v67, v7
  v_cvt_pk_bf16_f32 v128, v48, v49
  v_cvt_pk_bf16_f32 v129, v50, v51
  v_cvt_pk_bf16_f32 v130, v52, v53
  v_cvt_pk_bf16_f32 v131, v54, v55
  v_cvt_pk_bf16_f32 v132, v56, v57
  v_cvt_pk_bf16_f32 v133, v58, v59
  v_cvt_pk_bf16_f32 v134, v60, v61
  v_cvt_pk_bf16_f32 v135, v62, v63
  v_cvt_pk_bf16_f32 v136, v64, v65
  v_cvt_pk_bf16_f32 v137, v66, v67
  v_mov_b32 v138, 0
  v_mov_b32 v139, 0
  v_pk_mul_f32 v[4:5], v[68:69], s[80:81]
  v_pk_mul_f32 v[6:7], v[70:71], s[80:81]
  v_exp_f32 v4, v4 clamp
  v_exp_f32 v6, v6 clamp
  v_exp_f32 v5, v5 clamp
  v_exp_f32 v7, v7 clamp
  v_pk_add_f32 v[4:5], v[4:5], s[82:83]
  v_pk_add_f32 v[6:7], v[6:7], s[82:83]
  v_pk_add_f32 v[68:69], v[68:69], v[4:5]
  v_pk_add_f32 v[70:71], v[70:71], v[6:7]
  v_max_f32 v68, v68, v4
  v_max_f32 v70, v70, v6
  v_max_f32 v69, v69, v5
  v_max_f32 v71, v71, v7
  v_pk_mul_f32 v[4:5], v[72:73], s[80:81]
  v_pk_mul_f32 v[6:7], v[74:75], s[80:81]
  v_exp_f32 v4, v4 clamp
  v_exp_f32 v6, v6 clamp
  v_exp_f32 v5, v5 clamp
  v_exp_f32 v7, v7 clamp
  v_pk_add_f32 v[4:5], v[4:5], s[82:83]
  v_pk_add_f32 v[6:7], v[6:7], s[82:83]
  v_pk_add_f32 v[72:73], v[72:73], v[4:5]
  v_pk_add_f32 v[74:75], v[74:75], v[6:7]
  v_max_f32 v72, v72, v4
  v_max_f32 v74, v74, v6
  v_max_f32 v73, v73, v5
  v_max_f32 v75, v75, v7
  v_pk_mul_f32 v[4:5], v[76:77], s[80:81]
  v_pk_mul_f32 v[6:7], v[78:79], s[80:81]
  v_exp_f32 v4, v4 clamp
  v_exp_f32 v6, v6 clamp
  v_exp_f32 v5, v5 clamp
  v_exp_f32 v7, v7 clamp
  v_pk_add_f32 v[4:5], v[4:5], s[82:83]
  v_pk_add_f32 v[6:7], v[6:7], s[82:83]
  v_pk_add_f32 v[76:77], v[76:77], v[4:5]
  v_pk_add_f32 v[78:79], v[78:79], v[6:7]
  v_max_f32 v76, v76, v4
  v_max_f32 v78, v78, v6
  v_max_f32 v77, v77, v5
  v_max_f32 v79, v79, v7
  v_pk_mul_f32 v[4:5], v[80:81], s[80:81]
  v_pk_mul_f32 v[6:7], v[82:83], s[80:81]
  v_exp_f32 v4, v4 clamp
  v_exp_f32 v6, v6 clamp
  v_exp_f32 v5, v5 clamp
  v_exp_f32 v7, v7 clamp
  v_pk_add_f32 v[4:5], v[4:5], s[82:83]
  v_pk_add_f32 v[6:7], v[6:7], s[82:83]
  v_pk_add_f32 v[80:81], v[80:81], v[4:5]
  v_pk_add_f32 v[82:83], v[82:83], v[6:7]
  v_max_f32 v80, v80, v4
  v_max_f32 v82, v82, v6
  v_max_f32 v81, v81, v5
  v_max_f32 v83, v83, v7
  v_pk_mul_f32 v[4:5], v[84:85], s[80:81]
  v_pk_mul_f32 v[6:7], v[86:87], s[80:81]
  v_exp_f32 v4, v4 clamp
  v_exp_f32 v6, v6 clamp
  v_exp_f32 v5, v5 clamp
  v_exp_f32 v7, v7 clamp
  v_pk_add_f32 v[4:5], v[4:5], s[82:83]
  v_pk_add_f32 v[6:7], v[6:7], s[82:83]
  v_pk_add_f32 v[84:85], v[84:85], v[4:5]
  v_pk_add_f32 v[86:87], v[86:87], v[6:7]
  v_max_f32 v84, v84, v4
  v_max_f32 v86, v86, v6
  v_max_f32 v85, v85, v5
  v_max_f32 v87, v87, v7
  v_cvt_pk_bf16_f32 v140, v68, v69
  v_cvt_pk_bf16_f32 v141, v70, v71
  v_cvt_pk_bf16_f32 v142, v72, v73
  v_cvt_pk_bf16_f32 v143, v74, v75
  v_cvt_pk_bf16_f32 v144, v76, v77
  v_cvt_pk_bf16_f32 v145, v78, v79
  v_cvt_pk_bf16_f32 v146, v80, v81
  v_cvt_pk_bf16_f32 v147, v82, v83
  v_cvt_pk_bf16_f32 v148, v84, v85
  v_cvt_pk_bf16_f32 v149, v86, v87
  v_mov_b32 v150, 0
  v_mov_b32 v151, 0
  v_pk_mul_f32 v[4:5], v[88:89], s[80:81]
  v_pk_mul_f32 v[6:7], v[90:91], s[80:81]
  v_exp_f32 v4, v4 clamp
  v_exp_f32 v6, v6 clamp
  v_exp_f32 v5, v5 clamp
  v_exp_f32 v7, v7 clamp
  v_pk_add_f32 v[4:5], v[4:5], s[82:83]
  v_pk_add_f32 v[6:7], v[6:7], s[82:83]
  v_pk_add_f32 v[88:89], v[88:89], v[4:5]
  v_pk_add_f32 v[90:91], v[90:91], v[6:7]
  v_max_f32 v88, v88, v4
  v_max_f32 v90, v90, v6
  v_max_f32 v89, v89, v5
  v_max_f32 v91, v91, v7
  v_pk_mul_f32 v[4:5], v[92:93], s[80:81]
  v_pk_mul_f32 v[6:7], v[94:95], s[80:81]
  v_exp_f32 v4, v4 clamp
  v_exp_f32 v6, v6 clamp
  v_exp_f32 v5, v5 clamp
  v_exp_f32 v7, v7 clamp
  v_pk_add_f32 v[4:5], v[4:5], s[82:83]
  v_pk_add_f32 v[6:7], v[6:7], s[82:83]
  v_pk_add_f32 v[92:93], v[92:93], v[4:5]
  v_pk_add_f32 v[94:95], v[94:95], v[6:7]
  v_max_f32 v92, v92, v4
  v_max_f32 v94, v94, v6
  v_max_f32 v93, v93, v5
  v_max_f32 v95, v95, v7
  v_pk_mul_f32 v[4:5], v[96:97], s[80:81]
  v_pk_mul_f32 v[6:7], v[98:99], s[80:81]
  v_exp_f32 v4, v4 clamp
  v_exp_f32 v6, v6 clamp
  v_exp_f32 v5, v5 clamp
  v_exp_f32 v7, v7 clamp
  v_pk_add_f32 v[4:5], v[4:5], s[82:83]
  v_pk_add_f32 v[6:7], v[6:7], s[82:83]
  v_pk_add_f32 v[96:97], v[96:97], v[4:5]
  v_pk_add_f32 v[98:99], v[98:99], v[6:7]
  v_max_f32 v96, v96, v4
  v_max_f32 v98, v98, v6
  v_max_f32 v97, v97, v5
  v_max_f32 v99, v99, v7
  v_pk_mul_f32 v[4:5], v[100:101], s[80:81]
  v_pk_mul_f32 v[6:7], v[102:103], s[80:81]
  v_exp_f32 v4, v4 clamp
  v_exp_f32 v6, v6 clamp
  v_exp_f32 v5, v5 clamp
  v_exp_f32 v7, v7 clamp
  v_pk_add_f32 v[4:5], v[4:5], s[82:83]
  v_pk_add_f32 v[6:7], v[6:7], s[82:83]
  v_pk_add_f32 v[100:101], v[100:101], v[4:5]
  v_pk_add_f32 v[102:103], v[102:103], v[6:7]
  v_max_f32 v100, v100, v4
  v_max_f32 v102, v102, v6
  v_max_f32 v101, v101, v5
  v_max_f32 v103, v103, v7
  v_pk_mul_f32 v[4:5], v[104:105], s[80:81]
  v_pk_mul_f32 v[6:7], v[106:107], s[80:81]
  v_exp_f32 v4, v4 clamp
  v_exp_f32 v6, v6 clamp
  v_exp_f32 v5, v5 clamp
  v_exp_f32 v7, v7 clamp
  v_pk_add_f32 v[4:5], v[4:5], s[82:83]
  v_pk_add_f32 v[6:7], v[6:7], s[82:83]
  v_pk_add_f32 v[104:105], v[104:105], v[4:5]
  v_pk_add_f32 v[106:107], v[106:107], v[6:7]
  v_max_f32 v104, v104, v4
  v_max_f32 v106, v106, v6
  v_max_f32 v105, v105, v5
  v_max_f32 v107, v107, v7
  v_cvt_pk_bf16_f32 v152, v88, v89
  v_cvt_pk_bf16_f32 v153, v90, v91
  v_cvt_pk_bf16_f32 v154, v92, v93
  v_cvt_pk_bf16_f32 v155, v94, v95
  v_cvt_pk_bf16_f32 v156, v96, v97
  v_cvt_pk_bf16_f32 v157, v98, v99
  v_cvt_pk_bf16_f32 v158, v100, v101
  v_cvt_pk_bf16_f32 v159, v102, v103
  v_cvt_pk_bf16_f32 v160, v104, v105
  v_cvt_pk_bf16_f32 v161, v106, v107
  v_mov_b32 v162, 0
  v_mov_b32 v163, 0
  v_pk_mul_f32 v[4:5], v[108:109], s[80:81]
  v_pk_mul_f32 v[6:7], v[110:111], s[80:81]
  v_exp_f32 v4, v4 clamp
  v_exp_f32 v6, v6 clamp
  v_exp_f32 v5, v5 clamp
  v_exp_f32 v7, v7 clamp
  v_pk_add_f32 v[4:5], v[4:5], s[82:83]
  v_pk_add_f32 v[6:7], v[6:7], s[82:83]
  v_pk_add_f32 v[108:109], v[108:109], v[4:5]
  v_pk_add_f32 v[110:111], v[110:111], v[6:7]
  v_max_f32 v108, v108, v4
  v_max_f32 v110, v110, v6
  v_max_f32 v109, v109, v5
  v_max_f32 v111, v111, v7
  v_pk_mul_f32 v[4:5], v[112:113], s[80:81]
  v_pk_mul_f32 v[6:7], v[114:115], s[80:81]
  v_exp_f32 v4, v4 clamp
  v_exp_f32 v6, v6 clamp
  v_exp_f32 v5, v5 clamp
  v_exp_f32 v7, v7 clamp
  v_pk_add_f32 v[4:5], v[4:5], s[82:83]
  v_pk_add_f32 v[6:7], v[6:7], s[82:83]
  v_pk_add_f32 v[112:113], v[112:113], v[4:5]
  v_pk_add_f32 v[114:115], v[114:115], v[6:7]
  v_max_f32 v112, v112, v4
  v_max_f32 v114, v114, v6
  v_max_f32 v113, v113, v5
  v_max_f32 v115, v115, v7
  v_pk_mul_f32 v[4:5], v[116:117], s[80:81]
  v_pk_mul_f32 v[6:7], v[118:119], s[80:81]
  v_exp_f32 v4, v4 clamp
  v_exp_f32 v6, v6 clamp
  v_exp_f32 v5, v5 clamp
  v_exp_f32 v7, v7 clamp
  v_pk_add_f32 v[4:5], v[4:5], s[82:83]
  v_pk_add_f32 v[6:7], v[6:7], s[82:83]
  v_pk_add_f32 v[116:117], v[116:117], v[4:5]
  v_pk_add_f32 v[118:119], v[118:119], v[6:7]
  v_max_f32 v116, v116, v4
  v_max_f32 v118, v118, v6
  v_max_f32 v117, v117, v5
  v_max_f32 v119, v119, v7
  v_pk_mul_f32 v[4:5], v[120:121], s[80:81]
  v_pk_mul_f32 v[6:7], v[122:123], s[80:81]
  v_exp_f32 v4, v4 clamp
  v_exp_f32 v6, v6 clamp
  v_exp_f32 v5, v5 clamp
  v_exp_f32 v7, v7 clamp
  v_pk_add_f32 v[4:5], v[4:5], s[82:83]
  v_pk_add_f32 v[6:7], v[6:7], s[82:83]
  v_pk_add_f32 v[120:121], v[120:121], v[4:5]
  v_pk_add_f32 v[122:123], v[122:123], v[6:7]
  v_max_f32 v120, v120, v4
  v_max_f32 v122, v122, v6
  v_max_f32 v121, v121, v5
  v_max_f32 v123, v123, v7
  v_pk_mul_f32 v[4:5], v[124:125], s[80:81]
  v_pk_mul_f32 v[6:7], v[126:127], s[80:81]
  v_exp_f32 v4, v4 clamp
  v_exp_f32 v6, v6 clamp
  v_exp_f32 v5, v5 clamp
  v_exp_f32 v7, v7 clamp
  v_pk_add_f32 v[4:5], v[4:5], s[82:83]
  v_pk_add_f32 v[6:7], v[6:7], s[82:83]
  v_pk_add_f32 v[124:125], v[124:125], v[4:5]
  v_pk_add_f32 v[126:127], v[126:127], v[6:7]
  v_max_f32 v124, v124, v4
  v_max_f32 v126, v126, v6
  v_max_f32 v125, v125, v5
  v_max_f32 v127, v127, v7
  v_cvt_pk_bf16_f32 v164, v108, v109
  v_cvt_pk_bf16_f32 v165, v110, v111
  v_cvt_pk_bf16_f32 v166, v112, v113
  v_cvt_pk_bf16_f32 v167, v114, v115
  v_cvt_pk_bf16_f32 v168, v116, v117
  v_cvt_pk_bf16_f32 v169, v118, v119
  v_cvt_pk_bf16_f32 v170, v120, v121
  v_cvt_pk_bf16_f32 v171, v122, v123
  v_cvt_pk_bf16_f32 v172, v124, v125
  v_cvt_pk_bf16_f32 v173, v126, v127
  v_mov_b32 v174, 0
  v_mov_b32 v175, 0
  v_mov_b32 v176, 0
  v_mov_b32 v177, 0
  v_mov_b32 v178, 0
  v_mov_b32 v179, 0
  v_mov_b32 v180, 0
  v_mov_b32 v181, 0
  v_mov_b32 v182, 0
  v_mov_b32 v183, 0
  v_mov_b32 v184, 0
  v_mov_b32 v185, 0
  v_mov_b32 v186, 0
  v_mov_b32 v187, 0
  v_mov_b32 v188, 0
  v_mov_b32 v189, 0
  v_mov_b32 v190, 0
  v_mov_b32 v191, 0
  v_mov_b32 v192, 0
  v_mov_b32 v193, 0
  v_mov_b32 v194, 0
  v_mov_b32 v195, 0
  v_mov_b32 v196, 0
  v_mov_b32 v197, 0
  v_mov_b32 v198, 0
  v_mov_b32 v199, 0
  v_mov_b32 v200, 0
  v_mov_b32 v201, 0
  v_mov_b32 v202, 0
  v_mov_b32 v203, 0
  v_mov_b32 v204, 0
  v_mov_b32 v205, 0
  v_mov_b32 v206, 0
  v_mov_b32 v207, 0
  v_mov_b32 v208, 0
  v_mov_b32 v209, 0
  v_mov_b32 v210, 0
  v_mov_b32 v211, 0
  v_mov_b32 v212, 0
  v_mov_b32 v213, 0
  v_mov_b32 v214, 0
  v_mov_b32 v215, 0
  v_mov_b32 v216, 0
  v_mov_b32 v217, 0
  v_mov_b32 v218, 0
  v_mov_b32 v219, 0
  v_mov_b32 v220, 0
  v_mov_b32 v221, 0
  v_mov_b32 v222, 0
  v_mov_b32 v223, 0
  v_mov_b32 v224, 0
  v_mov_b32 v225, 0
  v_mov_b32 v226, 0
  v_mov_b32 v227, 0
  v_mov_b32 v228, 0
  v_mov_b32 v229, 0
  v_mov_b32 v230, 0
  v_mov_b32 v231, 0
  v_mov_b32 v232, 0
  v_mov_b32 v233, 0
  v_mov_b32 v234, 0
  v_mov_b32 v235, 0
  v_mov_b32 v236, 0
  v_mov_b32 v237, 0
  v_mov_b32 v238, 0
  v_mov_b32 v239, 0
  v_mov_b32 v240, 0
  v_mov_b32 v241, 0
  v_mov_b32 v242, 0
  v_mov_b32 v243, 0
  v_mov_b32 v244, 0
  v_mov_b32 v245, 0
  v_mov_b32 v246, 0
  v_mov_b32 v247, 0
  s_add_u32 s75, s4, 20480
  s_add_u32 s76, s4, 40960
  s_add_u32 s77, s4, 61440
  s_add_u32 s78, s5, 40960
  s_mov_b32 s72, 0x10000
  s_mov_b64 s[0:1], -1
L_pl_kv:
  s_mov_b64 exec, s[0:1]
  buffer_load_dword v15, v43, s[40:43], 0 offen sc1
  s_mov_b64 exec, -1
  s_waitcnt vmcnt(0)
  v_cmp_eq_u32 vcc, 0, v15
  s_cbranch_vccz L_pd_kv
  s_mov_b64 s[0:1], vcc
  s_sub_u32 s72, s72, 1
  s_cmp_lg_u32 s72, 0
  s_cbranch_scc1 L_pl_kv
L_pd_kv:
  buffer_load_dwordx4 v[96:99], v34, s[40:43], 0 offen sc1
  buffer_load_dwordx4 v[100:103], v35, s[40:43], 0 offen sc1
  buffer_load_dwordx4 v[104:107], v36, s[40:43], 0 offen sc1
  buffer_load_dwordx4 v[108:111], v37, s[40:43], 0 offen sc1
  s_waitcnt vmcnt(3)
  v_cvt_pk_bf16_f32 v96, v96, v97
  v_cvt_pk_bf16_f32 v97, v98, v99
  ds_write_b64 v38, v[96:97]
  s_waitcnt vmcnt(2)
  v_cvt_pk_bf16_f32 v100, v100, v101
  v_cvt_pk_bf16_f32 v101, v102, v103
  ds_write_b64 v39, v[100:101]
  s_waitcnt vmcnt(1)
  v_cvt_pk_bf16_f32 v104, v104, v105
  v_cvt_pk_bf16_f32 v105, v106, v107
  ds_write_b64 v40, v[104:105]
  s_waitcnt vmcnt(0)
  v_cvt_pk_bf16_f32 v108, v108, v109
  v_cvt_pk_bf16_f32 v109, v110, v111
  ds_write_b64 v41, v[108:109]
  s_waitcnt lgkmcnt(0)
  s_mov_b64 exec, 1
  ds_add_u32 v44, v45 offset:4
  s_mov_b64 exec, -1
  s_mov_b32 s72, 0x100000
L_aw12:
  ds_read_b32 v4, v44 offset:4
  s_sub_u32 s72, s72, 1
  s_cbranch_scc1 L_ax12
  s_waitcnt lgkmcnt(0)
  v_cmp_gt_u32 vcc, 4, v4
  s_cbranch_vccnz L_aw12
L_ax12:
  s_mov_b32 exec_lo, 0x00f0000f
  s_mov_b32 exec_hi, 0xf0000f00
  ds_read_b128 v[176:179], v42 offset:960
  ds_read_b128 v[180:183], v42 offset:976
  ds_read_b128 v[184:187], v42 offset:992
  ds_read_b128 v[188:191], v42 offset:0
  ds_read_b128 v[192:195], v42 offset:16
  ds_read_b128 v[196:199], v42 offset:32
  ds_read_b128 v[200:203], v42 offset:192
  ds_read_b128 v[204:207], v42 offset:208
  ds_read_b128 v[208:211], v42 offset:224
  ds_read_b128 v[212:215], v42 offset:384
  ds_read_b128 v[216:219], v42 offset:400
  ds_read_b128 v[220:223], v42 offset:416
  ds_read_b128 v[224:227], v42 offset:576
  ds_read_b128 v[228:231], v42 offset:592
  ds_read_b128 v[232:235], v42 offset:608
  ds_read_b128 v[236:239], v42 offset:768
  ds_read_b128 v[240:243], v42 offset:784
  ds_read_b128 v[244:247], v42 offset:800
  s_mov_b64 exec, -1
  s_waitcnt lgkmcnt(15)
  v_mfma_f32_16x16x32_bf16 v[48:51], v[176:179], v[128:131], 0
  v_mfma_f32_16x16x32_bf16 v[52:55], v[176:179], v[140:143], 0
  v_mfma_f32_16x16x32_bf16 v[56:59], v[176:179], v[152:155], 0
  v_mfma_f32_16x16x32_bf16 v[60:63], v[176:179], v[164:167], 0
  v_mfma_f32_16x16x32_bf16 v[48:51], v[180:183], v[132:135], v[48:51]
  v_mfma_f32_16x16x32_bf16 v[52:55], v[180:183], v[144:147], v[52:55]
  v_mfma_f32_16x16x32_bf16 v[56:59], v[180:183], v[156:159], v[56:59]
  v_mfma_f32_16x16x32_bf16 v[60:63], v[180:183], v[168:171], v[60:63]
  v_mfma_f32_16x16x32_bf16 v[48:51], v[184:187], v[136:139], v[48:51]
  v_mfma_f32_16x16x32_bf16 v[52:55], v[184:187], v[148:151], v[52:55]
  v_mfma_f32_16x16x32_bf16 v[56:59], v[184:187], v[160:163], v[56:59]
  v_mfma_f32_16x16x32_bf16 v[60:63], v[184:187], v[172:175], v[60:63]
  s_waitcnt lgkmcnt(12)
  v_mfma_f32_16x16x32_bf16 v[80:83], v[188:191], v[128:131], 0
  v_mfma_f32_16x16x32_bf16 v[84:87], v[188:191], v[140:143], 0
  v_mfma_f32_16x16x32_bf16 v[88:91], v[188:191], v[152:155], 0
  v_mfma_f32_16x16x32_bf16 v[92:95], v[188:191], v[164:167], 0
  v_add_f32 v48, s82, v48
  v_mfma_f32_16x16x32_bf16 v[80:83], v[192:195], v[132:135], v[80:83]
  v_add_f32 v52, s82, v52
  v_mfma_f32_16x16x32_bf16 v[84:87], v[192:195], v[144:147], v[84:87]
  v_add_f32 v56, s82, v56
  v_mfma_f32_16x16x32_bf16 v[88:91], v[192:195], v[156:159], v[88:91]
  v_add_f32 v60, s82, v60
  v_mfma_f32_16x16x32_bf16 v[92:95], v[192:195], v[168:171], v[92:95]
  v_rcp_f32 v48, v48
  v_mfma_f32_16x16x32_bf16 v[80:83], v[196:199], v[136:139], v[80:83]
  v_rcp_f32 v52, v52
  v_mfma_f32_16x16x32_bf16 v[84:87], v[196:199], v[148:151], v[84:87]
  v_rcp_f32 v56, v56
  v_mfma_f32_16x16x32_bf16 v[88:91], v[196:199], v[160:163], v[88:91]
  v_rcp_f32 v60, v60
  v_mfma_f32_16x16x32_bf16 v[92:95], v[196:199], v[172:175], v[92:95]
  s_waitcnt lgkmcnt(9)
  v_mfma_f32_16x16x32_bf16 v[64:67], v[200:203], v[128:131], 0
  v_mfma_f32_16x16x32_bf16 v[68:71], v[200:203], v[140:143], 0
  v_mfma_f32_16x16x32_bf16 v[72:75], v[200:203], v[152:155], 0
  v_mfma_f32_16x16x32_bf16 v[76:79], v[200:203], v[164:167], 0
  v_mul_f32 v80, v80, v48
  v_mul_f32 v81, v81, v48
  v_mul_f32 v82, v82, v48
  v_mfma_f32_16x16x32_bf16 v[64:67], v[204:207], v[132:135], v[64:67]
  v_mul_f32 v83, v83, v48
  v_cvt_pk_bf16_f32 v96, v80, v81
  v_cvt_pk_bf16_f32 v97, v82, v83
  v_mfma_f32_16x16x32_bf16 v[68:71], v[204:207], v[144:147], v[68:71]
  v_mul_f32 v84, v84, v52
  v_mul_f32 v85, v85, v52
  v_mfma_f32_16x16x32_bf16 v[72:75], v[204:207], v[156:159], v[72:75]
  v_mul_f32 v86, v86, v52
  v_mul_f32 v87, v87, v52
  v_cvt_pk_bf16_f32 v104, v84, v85
  v_mfma_f32_16x16x32_bf16 v[76:79], v[204:207], v[168:171], v[76:79]
  v_cvt_pk_bf16_f32 v105, v86, v87
  v_mul_f32 v88, v88, v56
  v_mul_f32 v89, v89, v56
  v_mfma_f32_16x16x32_bf16 v[64:67], v[208:211], v[136:139], v[64:67]
  v_mul_f32 v90, v90, v56
  v_mul_f32 v91, v91, v56
  v_mfma_f32_16x16x32_bf16 v[68:71], v[208:211], v[148:151], v[68:71]
  v_cvt_pk_bf16_f32 v112, v88, v89
  v_cvt_pk_bf16_f32 v113, v90, v91
  v_mul_f32 v92, v92, v60
  v_mfma_f32_16x16x32_bf16 v[72:75], v[208:211], v[160:163], v[72:75]
  v_mul_f32 v93, v93, v60
  v_mul_f32 v94, v94, v60
  v_mul_f32 v95, v95, v60
  v_mfma_f32_16x16x32_bf16 v[76:79], v[208:211], v[172:175], v[76:79]
  v_cvt_pk_bf16_f32 v120, v92, v93
  v_cvt_pk_bf16_f32 v121, v94, v95
  s_waitcnt lgkmcnt(6)
  v_mfma_f32_16x16x32_bf16 v[80:83], v[212:215], v[128:131], 0
  v_mfma_f32_16x16x32_bf16 v[84:87], v[212:215], v[140:143], 0
  v_mfma_f32_16x16x32_bf16 v[88:91], v[212:215], v[152:155], 0
  v_mfma_f32_16x16x32_bf16 v[92:95], v[212:215], v[164:167], 0
  v_mul_f32 v64, v64, v48
  v_mul_f32 v65, v65, v48
  v_mul_f32 v66, v66, v48
  v_mul_f32 v67, v67, v48
  v_mfma_f32_16x16x32_bf16 v[80:83], v[216:219], v[132:135], v[80:83]
  v_cvt_pk_bf16_f32 v98, v64, v65
  v_cvt_pk_bf16_f32 v99, v66, v67
  buffer_store_dwordx4 v[96:99], v16, s[40:43], s4 offen offset:0 sc1
  v_mfma_f32_16x16x32_bf16 v[84:87], v[216:219], v[144:147], v[84:87]
  v_mul_f32 v68, v68, v52
  v_mul_f32 v69, v69, v52
  v_mul_f32 v70, v70, v52
  v_mfma_f32_16x16x32_bf16 v[88:91], v[216:219], v[156:159], v[88:91]
  v_mul_f32 v71, v71, v52
  v_cvt_pk_bf16_f32 v106, v68, v69
  v_cvt_pk_bf16_f32 v107, v70, v71
  v_mfma_f32_16x16x32_bf16 v[92:95], v[216:219], v[168:171], v[92:95]
  buffer_store_dwordx4 v[104:107], v16, s[40:43], s75 offen offset:0 sc1
  v_mul_f32 v72, v72, v56
  v_mul_f32 v73, v73, v56
  v_mfma_f32_16x16x32_bf16 v[80:83], v[220:223], v[136:139], v[80:83]
  v_mul_f32 v74, v74, v56
  v_mul_f32 v75, v75, v56
  v_cvt_pk_bf16_f32 v114, v72, v73
  v_mfma_f32_16x16x32_bf16 v[84:87], v[220:223], v[148:151], v[84:87]
  v_cvt_pk_bf16_f32 v115, v74, v75
  buffer_store_dwordx4 v[112:115], v16, s[40:43], s76 offen offset:0 sc1
  v_mul_f32 v76, v76, v60
  v_mfma_f32_16x16x32_bf16 v[88:91], v[220:223], v[160:163], v[88:91]
  v_mul_f32 v77, v77, v60
  v_mul_f32 v78, v78, v60
  v_mul_f32 v79, v79, v60
  v_mfma_f32_16x16x32_bf16 v[92:95], v[220:223], v[172:175], v[92:95]
  v_cvt_pk_bf16_f32 v122, v76, v77
  v_cvt_pk_bf16_f32 v123, v78, v79
  buffer_store_dwordx4 v[120:123], v16, s[40:43], s77 offen offset:0 sc1
  s_waitcnt lgkmcnt(3)
  v_mfma_f32_16x16x32_bf16 v[64:67], v[224:227], v[128:131], 0
  v_mfma_f32_16x16x32_bf16 v[68:71], v[224:227], v[140:143], 0
  v_mfma_f32_16x16x32_bf16 v[72:75], v[224:227], v[152:155], 0
  v_mfma_f32_16x16x32_bf16 v[76:79], v[224:227], v[164:167], 0
  v_mul_f32 v80, v80, v48
  v_mul_f32 v81, v81, v48
  v_mul_f32 v82, v82, v48
  v_mfma_f32_16x16x32_bf16 v[64:67], v[228:231], v[132:135], v[64:67]
  v_mul_f32 v83, v83, v48
  v_cvt_pk_bf16_f32 v100, v80, v81
  v_cvt_pk_bf16_f32 v101, v82, v83
  v_mfma_f32_16x16x32_bf16 v[68:71], v[228:231], v[144:147], v[68:71]
  v_mul_f32 v84, v84, v52
  v_mul_f32 v85, v85, v52
  v_mfma_f32_16x16x32_bf16 v[72:75], v[228:231], v[156:159], v[72:75]
  v_mul_f32 v86, v86, v52
  v_mul_f32 v87, v87, v52
  v_cvt_pk_bf16_f32 v108, v84, v85
  v_mfma_f32_16x16x32_bf16 v[76:79], v[228:231], v[168:171], v[76:79]
  v_cvt_pk_bf16_f32 v109, v86, v87
  v_mul_f32 v88, v88, v56
  v_mul_f32 v89, v89, v56
  v_mfma_f32_16x16x32_bf16 v[64:67], v[232:235], v[136:139], v[64:67]
  v_mul_f32 v90, v90, v56
  v_mul_f32 v91, v91, v56
  v_mfma_f32_16x16x32_bf16 v[68:71], v[232:235], v[148:151], v[68:71]
  v_cvt_pk_bf16_f32 v116, v88, v89
  v_cvt_pk_bf16_f32 v117, v90, v91
  v_mul_f32 v92, v92, v60
  v_mfma_f32_16x16x32_bf16 v[72:75], v[232:235], v[160:163], v[72:75]
  v_mul_f32 v93, v93, v60
  v_mul_f32 v94, v94, v60
  v_mul_f32 v95, v95, v60
  v_mfma_f32_16x16x32_bf16 v[76:79], v[232:235], v[172:175], v[76:79]
  v_cvt_pk_bf16_f32 v124, v92, v93
  v_cvt_pk_bf16_f32 v125, v94, v95
  s_waitcnt lgkmcnt(0)
  v_mfma_f32_16x16x32_bf16 v[80:83], v[236:239], v[128:131], 0
  v_mfma_f32_16x16x32_bf16 v[84:87], v[236:239], v[140:143], 0
  v_mfma_f32_16x16x32_bf16 v[88:91], v[236:239], v[152:155], 0
  v_mfma_f32_16x16x32_bf16 v[92:95], v[236:239], v[164:167], 0
  v_mul_f32 v64, v64, v48
  v_mul_f32 v65, v65, v48
  v_mul_f32 v66, v66, v48
  v_mul_f32 v67, v67, v48
  v_mfma_f32_16x16x32_bf16 v[80:83], v[240:243], v[132:135], v[80:83]
  v_cvt_pk_bf16_f32 v102, v64, v65
  v_cvt_pk_bf16_f32 v103, v66, v67
  buffer_store_dwordx4 v[100:103], v16, s[40:43], s4 offen offset:1024 sc1
  v_mfma_f32_16x16x32_bf16 v[84:87], v[240:243], v[144:147], v[84:87]
  v_mul_f32 v68, v68, v52
  v_mul_f32 v69, v69, v52
  v_mul_f32 v70, v70, v52
  v_mfma_f32_16x16x32_bf16 v[88:91], v[240:243], v[156:159], v[88:91]
  v_mul_f32 v71, v71, v52
  v_cvt_pk_bf16_f32 v110, v68, v69
  v_cvt_pk_bf16_f32 v111, v70, v71
  v_mfma_f32_16x16x32_bf16 v[92:95], v[240:243], v[168:171], v[92:95]
  buffer_store_dwordx4 v[108:111], v16, s[40:43], s75 offen offset:1024 sc1
  v_mul_f32 v72, v72, v56
  v_mul_f32 v73, v73, v56
  v_mfma_f32_16x16x32_bf16 v[80:83], v[244:247], v[136:139], v[80:83]
  v_mul_f32 v74, v74, v56
  v_mul_f32 v75, v75, v56
  v_cvt_pk_bf16_f32 v118, v72, v73
  v_mfma_f32_16x16x32_bf16 v[84:87], v[244:247], v[148:151], v[84:87]
  v_cvt_pk_bf16_f32 v119, v74, v75
  buffer_store_dwordx4 v[116:119], v16, s[40:43], s76 offen offset:1024 sc1
  v_mul_f32 v76, v76, v60
  v_mfma_f32_16x16x32_bf16 v[88:91], v[244:247], v[160:163], v[88:91]
  v_mul_f32 v77, v77, v60
  v_mul_f32 v78, v78, v60
  v_mul_f32 v79, v79, v60
  v_mfma_f32_16x16x32_bf16 v[92:95], v[244:247], v[172:175], v[92:95]
  v_cvt_pk_bf16_f32 v126, v76, v77
  v_cvt_pk_bf16_f32 v127, v78, v79
  buffer_store_dwordx4 v[124:127], v16, s[40:43], s77 offen offset:1024 sc1
  s_waitcnt lgkmcnt(0)
  s_mov_b64 exec, 1
  ds_add_u32 v44, v45 offset:20
  s_mov_b64 exec, -1
  v_mul_f32 v80, v80, v48
  v_mul_f32 v81, v81, v48
  v_mul_f32 v82, v82, v48
  v_mul_f32 v83, v83, v48
  v_cvt_pk_bf16_f32 v248, v80, v81
  v_cvt_pk_bf16_f32 v249, v82, v83
  v_mul_f32 v84, v84, v52
  v_mul_f32 v85, v85, v52
  v_mul_f32 v86, v86, v52
  v_mul_f32 v87, v87, v52
  v_cvt_pk_bf16_f32 v250, v84, v85
  v_cvt_pk_bf16_f32 v251, v86, v87
  v_mul_f32 v88, v88, v56
  v_mul_f32 v89, v89, v56
  v_mul_f32 v90, v90, v56
  v_mul_f32 v91, v91, v56
  v_cvt_pk_bf16_f32 v252, v88, v89
  v_cvt_pk_bf16_f32 v253, v90, v91
  v_mul_f32 v92, v92, v60
  v_mul_f32 v93, v93, v60
  v_mul_f32 v94, v94, v60
  v_mul_f32 v95, v95, v60
  v_cvt_pk_bf16_f32 v254, v92, v93
  v_cvt_pk_bf16_f32 v255, v94, v95
  v_permlane16_swap_b32 v248, v250
  v_permlane16_swap_b32 v249, v251
  buffer_store_dwordx4 v[248:251], v32, s[40:43], s5 offen sc1
  v_permlane16_swap_b32 v252, v254
  v_permlane16_swap_b32 v253, v255
  buffer_store_dwordx4 v[252:255], v32, s[40:43], s78 offen sc1
  s_setprio 0
  s_branch L_P3
L_HQ:
  s_mov_b32 s52, s90
  s_mov_b32 s53, s91
  s_mov_b32 s54, 819200
  s_mov_b32 s55, 0x20000
  s_waitcnt lgkmcnt(0)
  buffer_store_dwordx4 v[8:11], v16, s[40:43], s12 offen sc1
  s_cmp_lg_u32 s61, 0
  s_cbranch_scc1 L_q_nz
  buffer_store_dwordx4 v[8:11], v16, s[40:43], s4 offen sc1
  buffer_store_dword v8, off, s[40:43], s13 sc1
L_q_nz:
  s_lshl_b32 s2, s66, 7
  s_add_u32 m0, s3, 36864
  s_mul_i32 s67, s68, s66
  buffer_load_dwordx4 v17, s[84:87], s2 offen lds
  buffer_load_dwordx4 v18, s[84:87], s2 offen offset:1024 lds
  buffer_load_dwordx4 v19, s[84:87], s2 offen offset:2048 lds
  buffer_load_dwordx4 v20, s[84:87], s2 offen offset:3072 lds
  s_add_u32 m0, s69, 36864
  s_nop 0
  buffer_load_dwordx4 v21, s[36:39], s67 offen lds
  buffer_load_dwordx4 v22, s[36:39], s67 offen offset:1024 lds
  buffer_load_dwordx4 v23, s[36:39], s67 offen offset:2048 lds
  buffer_load_dwordx4 v24, s[36:39], s67 offen offset:3072 lds
  s_add_u32 m0, s69, 40960
  s_add_u32 s66, s66, 1
  buffer_load_dwordx4 v25, s[36:39], s67 offen lds
  s_cmp_eq_u32 s66, 10
  s_cselect_b32 s66, 0, s66
  s_waitcnt vmcnt(9) lgkmcnt(0)
  s_barrier
  s_lshl_b32 s2, s66, 7
  s_add_u32 m0, s3, 73728
  s_mul_i32 s67, s68, s66
  buffer_load_dwordx4 v17, s[84:87], s2 offen lds
  buffer_load_dwordx4 v18, s[84:87], s2 offen offset:1024 lds
  buffer_load_dwordx4 v19, s[84:87], s2 offen offset:2048 lds
  buffer_load_dwordx4 v20, s[84:87], s2 offen offset:3072 lds
  s_add_u32 m0, s69, 73728
  s_nop 0
  buffer_load_dwordx4 v21, s[36:39], s67 offen lds
  buffer_load_dwordx4 v22, s[36:39], s67 offen offset:1024 lds
  buffer_load_dwordx4 v23, s[36:39], s67 offen offset:2048 lds
  buffer_load_dwordx4 v24, s[36:39], s67 offen offset:3072 lds
  s_add_u32 m0, s69, 77824
  s_add_u32 s66, s66, 1
  buffer_load_dwordx4 v25, s[36:39], s67 offen lds
  s_cmp_eq_u32 s66, 10
  s_cselect_b32 s66, 0, s66
  s_waitcnt vmcnt(9)
  s_barrier
  s_lshl_b32 s2, s66, 7
  s_add_u32 m0, s3, 110592
  s_mul_i32 s67, s68, s66
  buffer_load_dwordx4 v17, s[84:87], s2 offen lds
  buffer_load_dwordx4 v18, s[84:87], s2 offen offset:1024 lds
  buffer_load_dwordx4 v19, s[84:87], s2 offen offset:2048 lds
  buffer_load_dwordx4 v20, s[84:87], s2 offen offset:3072 lds
  s_add_u32 m0, s69, 110592
  s_nop 0
  buffer_load_dwordx4 v21, s[36:39], s67 offen lds
  buffer_load_dwordx4 v22, s[36:39], s67 offen offset:1024 lds
  buffer_load_dwordx4 v23, s[36:39], s67 offen offset:2048 lds
  buffer_load_dwordx4 v24, s[36:39], s67 offen offset:3072 lds
  s_add_u32 m0, s69, 114688
  s_add_u32 s66, s66, 1
  buffer_load_dwordx4 v25, s[36:39], s67 offen lds
  s_cmp_eq_u32 s66, 10
  s_cselect_b32 s66, 0, s66
  s_cmp_lg_u32 s61, 0
  s_cbranch_scc1 L_q_nc
  s_mov_b64 exec, 1
  buffer_atomic_add v45, off, s[56:59], 0 sc1
  s_mov_b64 exec, -1
L_q_nc:
  v_add_u32 v46, s34, v46
  v_cvt_f32_i32 v46, v46
  v_add_u32 v31, s28, v31
  s_lshl_b32 s75, s61, 8
  v_add_u32 v5, s75, v1
  v_min_u32 v5, 799, v5
  v_mul_u32_u24 v4, 6554, v5
  v_lshrrev_b32 v4, 16, v4
  v_mul_u32_u24 v8, 10, v4
  v_sub_u32 v8, v5, v8
  v_mul_u32_u24 v4, 1280, v4
  v_lshl_add_u32 v48, v8, 4, v4
  s_add_u32 s75, s75, 64
  v_add_u32 v5, s75, v1
  v_min_u32 v5, 799, v5
  v_mul_u32_u24 v4, 6554, v5
  v_lshrrev_b32 v4, 16, v4
  v_mul_u32_u24 v8, 10, v4
  v_sub_u32 v8, v5, v8
  v_mul_u32_u24 v4, 1280, v4
  v_lshl_add_u32 v49, v8, 4, v4
  s_add_u32 s75, s75, 64
  v_add_u32 v5, s75, v1
  v_min_u32 v5, 799, v5
  v_mul_u32_u24 v4, 6554, v5
  v_lshrrev_b32 v4, 16, v4
  v_mul_u32_u24 v8, 10, v4
  v_sub_u32 v8, v5, v8
  v_mul_u32_u24 v4, 1280, v4
  v_lshl_add_u32 v50, v8, 4, v4
  s_add_u32 s75, s75, 64
  v_add_u32 v5, s75, v1
  v_min_u32 v5, 799, v5
  v_mul_u32_u24 v4, 6554, v5
  v_lshrrev_b32 v4, 16, v4
  v_mul_u32_u24 v8, 10, v4
  v_sub_u32 v8, v5, v8
  v_mul_u32_u24 v4, 1280, v4
  v_lshl_add_u32 v51, v8, 4, v4
  s_add_u32 s75, s75, 64
  v_bfe_u32 v5, v1, 2, 2
  v_and_b32 v6, 3, v1
  v_mul_u32_u24 v5, 160, v5
  v_mul_u32_u24 v6, 40, v6
  v_add_u32 v5, v5, v6
  v_mov_b32 v7, 0x7ffffff0
  v_cmp_gt_u32 vcc, 2, v2
  s_cmp_ge_u32 s61, 2
  s_cselect_b32 s75, 1, 3
  s_cselect_b32 s76, 40, 20
  s_cselect_b32 s77, 20, 4
  s_cselect_b64 vcc, vcc, -1
  v_cndmask_b32 v54, v7, v16, vcc
  v_and_b32 v6, s75, v2
  v_mul_u32_u24 v6, s76, v6
  s_min_u32 s75, s61, 2
  s_lshl_b32 s75, s75, 3
  v_add_u32 v6, s75, v6
  v_mul_u32_u24 v6, 160, v6
  v_add_u32 v5, v5, v6
  v_add_u32 v52, 147456, v5
  s_mul_i32 s77, s77, 160
  v_add_u32 v53, s77, v52
  s_waitcnt vmcnt(9)
  s_barrier
  s_lshl_b32 s2, s66, 7
  s_add_u32 m0, s3, 0
  s_mul_i32 s67, s68, s66
  buffer_load_dwordx4 v17, s[84:87], s2 offen lds
  buffer_load_dwordx4 v18, s[84:87], s2 offen offset:1024 lds
  buffer_load_dwordx4 v19, s[84:87], s2 offen offset:2048 lds
  buffer_load_dwordx4 v20, s[84:87], s2 offen offset:3072 lds
  s_add_u32 m0, s69, 0
  s_nop 0
  buffer_load_dwordx4 v21, s[36:39], s67 offen lds
  buffer_load_dwordx4 v22, s[36:39], s67 offen offset:1024 lds
  buffer_load_dwordx4 v23, s[36:39], s67 offen offset:2048 lds
  buffer_load_dwordx4 v24, s[36:39], s67 offen offset:3072 lds
  s_add_u32 m0, s69, 4096
  s_add_u32 s66, s66, 1
  buffer_load_dwordx4 v25, s[36:39], s67 offen lds
  s_cmp_eq_u32 s66, 10
  s_cselect_b32 s66, 0, s66
  s_mov_b32 s50, 1314816
  s_mov_b32 s51, 0x20000
  v_mul_u32_u24 v4, 43, v1
  v_lshrrev_b32 v4, 8, v4
  v_mul_u32_u24 v5, 6, v4
  v_sub_u32 v5, v1, v5
  s_lshl_b32 s75, s65, 1
  v_bfe_u32 v6, v4, 1, 1
  v_add_u32 v6, s75, v6
  v_sub_u32 v7, 0, v6
  v_cmp_eq_u32 vcc, 0, v6
  s_nop 1
  v_cndmask_b32 v7, v7, 16, vcc
  v_and_b32 v8, 1, v4
  v_cmp_eq_u32 vcc, 1, v8
  s_nop 1
  v_cndmask_b32 v6, v6, v7, vcc
  v_lshrrev_b32 v4, 2, v4
  v_lshl_add_u32 v6, v4, 5, v6
  s_and_b32 s75, s64, 28
  s_add_u32 s75, s75, s61
  s_lshl_b32 s75, s75, 6
  v_add_u32 v6, s75, v6
  v_and_b32 v6, 0x7ff, v6
  v_mul_u32_u24 v6, 642, v6
  v_lshl_add_u32 v6, v5, 7, v6
  s_mov_b32 exec_hi, 0xffff
  buffer_load_ushort v101, v6, s[48:51], 0 offen
  s_mov_b32 s48, s100
  s_mov_b32 s49, s101
  s_nop 0
  buffer_load_ushort v102, v6, s[48:51], 0 offen
  s_mov_b64 exec, -1
L_q_t:
  s_lshl_b32 m0, s61, 12
  s_add_u32 m0, m0, 147456
  s_nop 0
  buffer_load_dwordx4 v48, s[52:55], s14 offen lds
  s_cmp_eq_u32 s61, 3
  s_cbranch_scc1 L_q_w3
  s_lshl_b32 m0, s61, 12
  s_add_u32 m0, m0, 148480
  s_nop 0
  buffer_load_dwordx4 v49, s[52:55], s14 offen lds
  s_lshl_b32 m0, s61, 12
  s_add_u32 m0, m0, 149504
  s_nop 0
  buffer_load_dwordx4 v50, s[52:55], s14 offen lds
  s_lshl_b32 m0, s61, 12
  s_add_u32 m0, m0, 150528
  s_nop 0
  buffer_load_dwordx4 v51, s[52:55], s14 offen lds
L_q_w3:
  s_waitcnt vmcnt(9)
  s_barrier
  s_lshl_b32 s2, s66, 7
  s_add_u32 m0, s3, 36864
  s_mul_i32 s67, s68, s66
  buffer_load_dwordx4 v17, s[84:87], s2 offen lds
  buffer_load_dwordx4 v18, s[84:87], s2 offen offset:1024 lds
  buffer_load_dwordx4 v19, s[84:87], s2 offen offset:2048 lds
  buffer_load_dwordx4 v20, s[84:87], s2 offen offset:3072 lds
  s_add_u32 m0, s69, 36864
  s_nop 0
  buffer_load_dwordx4 v21, s[36:39], s67 offen lds
  buffer_load_dwordx4 v22, s[36:39], s67 offen offset:1024 lds
  buffer_load_dwordx4 v23, s[36:39], s67 offen offset:2048 lds
  buffer_load_dwordx4 v24, s[36:39], s67 offen offset:3072 lds
  s_add_u32 m0, s69, 40960
  s_add_u32 s66, s66, 1
  buffer_load_dwordx4 v25, s[36:39], s67 offen lds
  s_cmp_eq_u32 s66, 10
  s_cselect_b32 s66, 0, s66
  s_waitcnt vmcnt(9)
  s_barrier
  s_lshl_b32 s2, s66, 7
  s_add_u32 m0, s3, 73728
  s_mul_i32 s67, s68, s66
  buffer_load_dwordx4 v17, s[84:87], s2 offen lds
  buffer_load_dwordx4 v18, s[84:87], s2 offen offset:1024 lds
  buffer_load_dwordx4 v19, s[84:87], s2 offen offset:2048 lds
  buffer_load_dwordx4 v20, s[84:87], s2 offen offset:3072 lds
  s_add_u32 m0, s69, 73728
  s_nop 0
  buffer_load_dwordx4 v21, s[36:39], s67 offen lds
  buffer_load_dwordx4 v22, s[36:39], s67 offen offset:1024 lds
  buffer_load_dwordx4 v23, s[36:39], s67 offen offset:2048 lds
  buffer_load_dwordx4 v24, s[36:39], s67 offen offset:3072 lds
  s_add_u32 m0, s69, 77824
  s_add_u32 s66, s66, 1
  buffer_load_dwordx4 v25, s[36:39], s67 offen lds
  s_cmp_eq_u32 s66, 10
  s_cselect_b32 s66, 0, s66
  s_cmp_eq_u32 s61, 3
  s_cbranch_scc1 L_q_nwo
  ds_read_b64_tr_b16 v[64:65], v52 offset:0
  ds_read_b64_tr_b16 v[66:67], v53 offset:0
  ds_read_b64_tr_b16 v[68:69], v52 offset:8
  ds_read_b64_tr_b16 v[70:71], v53 offset:8
  ds_read_b64_tr_b16 v[72:73], v52 offset:16
  ds_read_b64_tr_b16 v[74:75], v53 offset:16
  ds_read_b64_tr_b16 v[76:77], v52 offset:24
  ds_read_b64_tr_b16 v[78:79], v53 offset:24
  ds_read_b64_tr_b16 v[80:81], v52 offset:32
  ds_read_b64_tr_b16 v[82:83], v53 offset:32
  s_add_u32 s74, s15, 4096
  s_waitcnt lgkmcnt(8)
  buffer_store_dwordx4 v[64:67], v54, s[40:43], s15 offen offset:0 sc1
  s_waitcnt lgkmcnt(6)
  buffer_store_dwordx4 v[68:71], v54, s[40:43], s15 offen offset:1024 sc1
  s_waitcnt lgkmcnt(4)
  buffer_store_dwordx4 v[72:75], v54, s[40:43], s15 offen offset:2048 sc1
  s_waitcnt lgkmcnt(2)
  buffer_store_dwordx4 v[76:79], v54, s[40:43], s15 offen offset:3072 sc1
  s_waitcnt lgkmcnt(0)
  buffer_store_dwordx4 v[80:83], v54, s[40:43], s74 offen offset:0 sc1
L_q_nwo:
  s_waitcnt vmcnt(9)
  s_barrier
  s_lshl_b32 s74, s61, 10
  s_lshl_b32 s2, s66, 7
  s_add_u32 m0, s3, 110592
  s_mul_i32 s67, s68, s66
  buffer_load_dwordx4 v17, s[84:87], s2 offen lds
  s_add_u32 s74, s74, 147456
  buffer_load_dwordx4 v18, s[84:87], s2 offen offset:1024 lds
  v_add_u32 v4, s74, v16
  buffer_load_dwordx4 v19, s[84:87], s2 offen offset:2048 lds
  v_mov_b32 v8, 0
  buffer_load_dwordx4 v20, s[84:87], s2 offen offset:3072 lds
  v_mov_b32 v9, 0
  s_add_u32 m0, s69, 110592
  s_nop 0
  buffer_load_dwordx4 v21, s[36:39], s67 offen lds
  v_mov_b32 v10, 0
  v_mov_b32 v11, 0
  buffer_load_dwordx4 v22, s[36:39], s67 offen offset:1024 lds
  ds_write_b128 v4, v[8:11]
  buffer_load_dwordx4 v23, s[36:39], s67 offen offset:2048 lds
  ds_write_b128 v4, v[8:11] offset:4096
  buffer_load_dwordx4 v24, s[36:39], s67 offen offset:3072 lds
  ds_write_b128 v4, v[8:11] offset:8192
  s_add_u32 m0, s69, 114688
  s_add_u32 s66, s66, 1
  buffer_load_dwordx4 v25, s[36:39], s67 offen lds
  s_cmp_eq_u32 s66, 10
  s_cselect_b32 s66, 0, s66
  s_waitcnt lgkmcnt(0)
  s_waitcnt vmcnt(9)
  s_barrier
  s_lshl_b32 s2, s66, 7
  s_add_u32 m0, s3, 0
  s_mul_i32 s67, s68, s66
  buffer_load_dwordx4 v17, s[84:87], s2 offen lds
  buffer_load_dwordx4 v18, s[84:87], s2 offen offset:1024 lds
  buffer_load_dwordx4 v19, s[84:87], s2 offen offset:2048 lds
  buffer_load_dwordx4 v20, s[84:87], s2 offen offset:3072 lds
  s_add_u32 m0, s69, 0
  s_nop 0
  buffer_load_dwordx4 v21, s[36:39], s67 offen lds
  buffer_load_dwordx4 v22, s[36:39], s67 offen offset:1024 lds
  buffer_load_dwordx4 v23, s[36:39], s67 offen offset:2048 lds
  buffer_load_dwordx4 v24, s[36:39], s67 offen offset:3072 lds
  s_add_u32 m0, s69, 4096
  s_add_u32 s66, s66, 1
  buffer_load_dwordx4 v25, s[36:39], s67 offen lds
  s_cmp_eq_u32 s66, 10
  s_cselect_b32 s66, 0, s66
  s_cmp_lg_u32 s61, 0
  s_cbranch_scc1 L_q_npf
  v_mov_b32 v4, 1
  s_mov_b64 exec, 1
  buffer_store_dword v4, off, s[40:43], s13 sc1
  s_mov_b64 exec, -1
L_q_npf:
  s_waitcnt vmcnt(9)
  s_barrier
  s_lshl_b32 s2, s66, 7
  s_add_u32 m0, s3, 36864
  s_mul_i32 s67, s68, s66
  buffer_load_dwordx4 v17, s[84:87], s2 offen lds
  buffer_load_dwordx4 v18, s[84:87], s2 offen offset:1024 lds
  buffer_load_dwordx4 v19, s[84:87], s2 offen offset:2048 lds
  buffer_load_dwordx4 v20, s[84:87], s2 offen offset:3072 lds
  s_add_u32 m0, s69, 36864
  s_nop 0
  buffer_load_dwordx4 v21, s[36:39], s67 offen lds
  buffer_load_dwordx4 v22, s[36:39], s67 offen offset:1024 lds
  buffer_load_dwordx4 v23, s[36:39], s67 offen offset:2048 lds
  buffer_load_dwordx4 v24, s[36:39], s67 offen offset:3072 lds
  s_add_u32 m0, s69, 40960
  s_add_u32 s66, s66, 1
  buffer_load_dwordx4 v25, s[36:39], s67 offen lds
  s_cmp_eq_u32 s66, 10
  s_cselect_b32 s66, 0, s66
  buffer_load_dword v15, off, s[56:59], 0 sc1
  s_waitcnt vmcnt(10)
  s_barrier
  s_waitcnt vmcnt(0)
  v_cmp_gt_u32 vcc, 64, v15
  s_cbranch_vccz L_icd_hq
  s_mov_b32 s72, 0x10000
L_ic_hq:
  buffer_load_dword v15, off, s[56:59], 0 sc1
  s_waitcnt vmcnt(0)
  v_cmp_gt_u32 vcc, 64, v15
  s_cbranch_vccz L_icd_hq
  s_sub_u32 s72, s72, 1
  s_cmp_lg_u32 s72, 0
  s_cbranch_scc1 L_ic_hq
L_icd_hq:
  s_barrier
  s_mov_b32 s72, 0x10000
  s_mov_b64 s[0:1], -1
L_pl_pq:
  s_mov_b64 exec, s[0:1]
  buffer_load_dword v15, v31, s[40:43], 0 offen sc1
  s_mov_b64 exec, -1
  s_waitcnt vmcnt(0)
  v_cmp_eq_u32 vcc, 0, v15
  s_cbranch_vccz L_pd_pq
  s_mov_b64 s[0:1], vcc
  s_sub_u32 s72, s72, 1
  s_cmp_lg_u32 s72, 0
  s_cbranch_scc1 L_pl_pq
L_pd_pq:
  s_add_u32 s79, s33, 0
  s_add_u32 s78, s33, 4096
  buffer_load_dwordx4 v[156:159], v16, s[40:43], s79 offen offset:0 sc1
  buffer_load_dwordx4 v[160:163], v16, s[40:43], s79 offen offset:1024 sc1
  buffer_load_dwordx4 v[164:167], v16, s[40:43], s79 offen offset:2048 sc1
  buffer_load_dwordx4 v[168:171], v16, s[40:43], s79 offen offset:3072 sc1
  buffer_load_dwordx4 v[172:175], v16, s[40:43], s78 offen offset:0 sc1
  s_add_u32 s79, s33, 5120
  s_add_u32 s78, s33, 9216
  buffer_load_dwordx4 v[176:179], v16, s[40:43], s79 offen offset:0 sc1
  buffer_load_dwordx4 v[180:183], v16, s[40:43], s79 offen offset:1024 sc1
  buffer_load_dwordx4 v[184:187], v16, s[40:43], s79 offen offset:2048 sc1
  buffer_load_dwordx4 v[188:191], v16, s[40:43], s79 offen offset:3072 sc1
  buffer_load_dwordx4 v[192:195], v16, s[40:43], s78 offen offset:0 sc1
  s_add_u32 s79, s33, 10240
  s_add_u32 s78, s33, 14336
  buffer_load_dwordx4 v[196:199], v16, s[40:43], s79 offen offset:0 sc1
  buffer_load_dwordx4 v[200:203], v16, s[40:43], s79 offen offset:1024 sc1
  buffer_load_dwordx4 v[204:207], v16, s[40:43], s79 offen offset:2048 sc1
  buffer_load_dwordx4 v[208:211], v16, s[40:43], s79 offen offset:3072 sc1
  buffer_load_dwordx4 v[212:215], v16, s[40:43], s78 offen offset:0 sc1
  s_add_u32 s79, s33, 15360
  s_add_u32 s78, s33, 19456
  buffer_load_dwordx4 v[216:219], v16, s[40:43], s79 offen offset:0 sc1
  buffer_load_dwordx4 v[220:223], v16, s[40:43], s79 offen offset:1024 sc1
  buffer_load_dwordx4 v[224:227], v16, s[40:43], s79 offen offset:2048 sc1
  buffer_load_dwordx4 v[228:231], v16, s[40:43], s79 offen offset:3072 sc1
  buffer_load_dwordx4 v[232:235], v16, s[40:43], s78 offen offset:0 sc1
  s_add_u32 s79, s33, 20480
  s_add_u32 s78, s33, 24576
  buffer_load_dwordx4 v[236:239], v16, s[40:43], s79 offen offset:0 sc1
  buffer_load_dwordx4 v[240:243], v16, s[40:43], s79 offen offset:1024 sc1
  buffer_load_dwordx4 v[244:247], v16, s[40:43], s79 offen offset:2048 sc1
  buffer_load_dwordx4 v[248:251], v16, s[40:43], s79 offen offset:3072 sc1
  buffer_load_dwordx4 v[252:255], v16, s[40:43], s78 offen offset:0 sc1
  s_mov_b32 s72, 0x100000
L_aw13:
  s_sleep 2
  ds_read_b32 v4, v44 offset:0
  s_sub_u32 s72, s72, 1
  s_cbranch_scc1 L_ax13
  s_waitcnt lgkmcnt(0)
  v_cmp_gt_u32 vcc, 4, v4
  s_cbranch_vccnz L_aw13
L_ax13:
  s_cmp_ge_u32 s71, 5
  s_cbranch_scc1 L_ifd14
L_if14:
  v_mul_f32 v6, 0x3acccccd, v46
  v_add_f32 v46, 4.0, v46
  v_cmp_eq_f32 vcc, 0, v47
  v_mov_b32 v4, 0x3f00
  v_mul_f32 v7, v6, v47
  s_lshl_b32 s74, s71, 2
  s_lshr_b32 s74, 0x43021, s74
  s_and_b32 s74, s74, 15
  s_lshl_b32 s74, s74, 2
  s_add_u32 s74, s74, s61
  s_mul_i32 s74, s74, 5120
  v_add_u32 v5, s74, v16
  s_add_u32 s71, s71, 1
  v_mul_f32 v12, 0x41800000, v6
  v_cos_f32 v8, v12
  v_sin_f32 v9, v12
  v_fmamk_f32 v12, v6, 0x0, v7
  v_cos_f32 v18, v12
  v_sin_f32 v19, v12
  v_fmamk_f32 v13, v6, 0x3f800000, v7
  v_cos_f32 v20, v13
  v_sin_f32 v21, v13
  v_fmamk_f32 v12, v6, 0x40000000, v7
  v_cos_f32 v22, v12
  v_sin_f32 v23, v12
  v_fmamk_f32 v13, v6, 0x40400000, v7
  v_cos_f32 v24, v13
  v_sin_f32 v25, v13
  v_cvt_pk_bf16_f32 v26, v18, v19
  v_cvt_pk_bf16_f32 v27, v20, v21
  v_cvt_pk_bf16_f32 v28, v22, v23
  v_cvt_pk_bf16_f32 v29, v24, v25
  v_cndmask_b32 v26, v26, v4, vcc
  ds_write_b128 v5, v[26:29] offset:0
  v_pk_mul_f32 v[10:11], v[18:19], v[8:9] op_sel:[0,0] op_sel_hi:[1,0]
  v_pk_mul_f32 v[12:13], v[20:21], v[8:9] op_sel:[0,0] op_sel_hi:[1,0]
  v_pk_fma_f32 v[18:19], v[18:19], v[8:9], v[10:11] op_sel:[1,1,0] op_sel_hi:[0,1,1] neg_lo:[0,1,0]
  v_pk_fma_f32 v[20:21], v[20:21], v[8:9], v[12:13] op_sel:[1,1,0] op_sel_hi:[0,1,1] neg_lo:[0,1,0]
  v_pk_mul_f32 v[10:11], v[22:23], v[8:9] op_sel:[0,0] op_sel_hi:[1,0]
  v_pk_mul_f32 v[12:13], v[24:25], v[8:9] op_sel:[0,0] op_sel_hi:[1,0]
  v_pk_fma_f32 v[22:23], v[22:23], v[8:9], v[10:11] op_sel:[1,1,0] op_sel_hi:[0,1,1] neg_lo:[0,1,0]
  v_pk_fma_f32 v[24:25], v[24:25], v[8:9], v[12:13] op_sel:[1,1,0] op_sel_hi:[0,1,1] neg_lo:[0,1,0]
  v_cvt_pk_bf16_f32 v26, v18, v19
  v_cvt_pk_bf16_f32 v27, v20, v21
  v_cvt_pk_bf16_f32 v28, v22, v23
  v_cvt_pk_bf16_f32 v29, v24, v25
  ds_write_b128 v5, v[26:29] offset:1024
  v_pk_mul_f32 v[10:11], v[18:19], v[8:9] op_sel:[0,0] op_sel_hi:[1,0]
  v_pk_mul_f32 v[12:13], v[20:21], v[8:9] op_sel:[0,0] op_sel_hi:[1,0]
  v_pk_fma_f32 v[18:19], v[18:19], v[8:9], v[10:11] op_sel:[1,1,0] op_sel_hi:[0,1,1] neg_lo:[0,1,0]
  v_pk_fma_f32 v[20:21], v[20:21], v[8:9], v[12:13] op_sel:[1,1,0] op_sel_hi:[0,1,1] neg_lo:[0,1,0]
  v_pk_mul_f32 v[10:11], v[22:23], v[8:9] op_sel:[0,0] op_sel_hi:[1,0]
  v_pk_mul_f32 v[12:13], v[24:25], v[8:9] op_sel:[0,0] op_sel_hi:[1,0]
  v_pk_fma_f32 v[22:23], v[22:23], v[8:9], v[10:11] op_sel:[1,1,0] op_sel_hi:[0,1,1] neg_lo:[0,1,0]
  v_pk_fma_f32 v[24:25], v[24:25], v[8:9], v[12:13] op_sel:[1,1,0] op_sel_hi:[0,1,1] neg_lo:[0,1,0]
  v_cvt_pk_bf16_f32 v26, v18, v19
  v_cvt_pk_bf16_f32 v27, v20, v21
  v_cvt_pk_bf16_f32 v28, v22, v23
  v_cvt_pk_bf16_f32 v29, v24, v25
  ds_write_b128 v5, v[26:29] offset:2048
  v_pk_mul_f32 v[10:11], v[18:19], v[8:9] op_sel:[0,0] op_sel_hi:[1,0]
  v_pk_mul_f32 v[12:13], v[20:21], v[8:9] op_sel:[0,0] op_sel_hi:[1,0]
  v_pk_fma_f32 v[18:19], v[18:19], v[8:9], v[10:11] op_sel:[1,1,0] op_sel_hi:[0,1,1] neg_lo:[0,1,0]
  v_pk_fma_f32 v[20:21], v[20:21], v[8:9], v[12:13] op_sel:[1,1,0] op_sel_hi:[0,1,1] neg_lo:[0,1,0]
  v_pk_mul_f32 v[10:11], v[22:23], v[8:9] op_sel:[0,0] op_sel_hi:[1,0]
  v_pk_mul_f32 v[12:13], v[24:25], v[8:9] op_sel:[0,0] op_sel_hi:[1,0]
  v_pk_fma_f32 v[22:23], v[22:23], v[8:9], v[10:11] op_sel:[1,1,0] op_sel_hi:[0,1,1] neg_lo:[0,1,0]
  v_pk_fma_f32 v[24:25], v[24:25], v[8:9], v[12:13] op_sel:[1,1,0] op_sel_hi:[0,1,1] neg_lo:[0,1,0]
  v_cvt_pk_bf16_f32 v26, v18, v19
  v_cvt_pk_bf16_f32 v27, v20, v21
  v_cvt_pk_bf16_f32 v28, v22, v23
  v_cvt_pk_bf16_f32 v29, v24, v25
  ds_write_b128 v5, v[26:29] offset:3072
  v_pk_mul_f32 v[10:11], v[18:19], v[8:9] op_sel:[0,0] op_sel_hi:[1,0]
  v_pk_mul_f32 v[12:13], v[20:21], v[8:9] op_sel:[0,0] op_sel_hi:[1,0]
  v_pk_fma_f32 v[18:19], v[18:19], v[8:9], v[10:11] op_sel:[1,1,0] op_sel_hi:[0,1,1] neg_lo:[0,1,0]
  v_pk_fma_f32 v[20:21], v[20:21], v[8:9], v[12:13] op_sel:[1,1,0] op_sel_hi:[0,1,1] neg_lo:[0,1,0]
  v_pk_mul_f32 v[10:11], v[22:23], v[8:9] op_sel:[0,0] op_sel_hi:[1,0]
  v_pk_mul_f32 v[12:13], v[24:25], v[8:9] op_sel:[0,0] op_sel_hi:[1,0]
  v_pk_fma_f32 v[22:23], v[22:23], v[8:9], v[10:11] op_sel:[1,1,0] op_sel_hi:[0,1,1] neg_lo:[0,1,0]
  v_pk_fma_f32 v[24:25], v[24:25], v[8:9], v[12:13] op_sel:[1,1,0] op_sel_hi:[0,1,1] neg_lo:[0,1,0]
  v_cvt_pk_bf16_f32 v26, v18, v19
  v_cvt_pk_bf16_f32 v27, v20, v21
  v_cvt_pk_bf16_f32 v28, v22, v23
  v_cvt_pk_bf16_f32 v29, v24, v25
  ds_write_b128 v5, v[26:29] offset:4096
  s_cmp_lt_u32 s71, 5
  s_cbranch_scc1 L_if14
L_ifd14:
  s_waitcnt lgkmcnt(0)
  s_mov_b64 exec, 1
  ds_add_u32 v44, v45 offset:24
  s_mov_b64 exec, -1
  s_mov_b32 s72, 0x100000
L_aw15:
  s_sleep 2
  ds_read_b32 v4, v44 offset:20
  s_sub_u32 s72, s72, 1
  s_cbranch_scc1 L_ax15
  s_waitcnt lgkmcnt(0)
  v_cmp_gt_u32 vcc, 4, v4
  s_cbranch_vccnz L_aw15
L_ax15:
  s_branch L_P3
L_end:
  s_endpgm
.section .rodata,"a"
.p2align 6
.amdhsa_kernel gated_mix__spectral_gfnet__linear_attn_block__prompt_kernel
  .amdhsa_next_free_vgpr 256
  .amdhsa_next_free_sgpr 102
  .amdhsa_accum_offset 256
  .amdhsa_group_segment_fixed_size 0
  .amdhsa_kernarg_size 80
  .amdhsa_user_sgpr_count 2
  .amdhsa_user_sgpr_kernarg_segment_ptr 1
  .amdhsa_system_sgpr_workgroup_id_x 1
.end_amdhsa_kernel
.text
.p2align 8
.type stab,@object
stab:
.long 0,1310720,7872512,8454144,0,0,0,0,0,0,0,0,0,0,0,0,5242880,5263360,5283840,5304320,117760,138240,158720,102400,7880704,0,7872512,0,0,9437184,0,8638464
.long 5120,1315840,7872640,8454272,0,0,0,0,0,0,0,0,1,0,0,0,5268480,5288960,5309440,5248000,133120,153600,112640,117760,7880960,0,7872576,1310720,1024,9462784,0,8638976
.long 10240,1320960,7872768,8454400,0,0,0,0,0,0,0,0,2,0,0,0,5294080,5314560,5253120,5273600,148480,107520,128000,133120,7881216,1024,7872640,1280,1,9488384,0,8639488
.long 15360,1326080,7872896,8454528,0,0,0,0,0,0,0,0,3,0,0,0,5319680,5258240,5278720,5299200,102400,122880,143360,148480,7881472,1024,7872704,1312000,1025,9513984,0,8640000
.long 0,0,0,0,1,0,1,8454144,256,2623488,8552576,73728,0,106496,106496,0,2621440,2631680,2641920,2652160,0,0,0,0,7880704,8552448,7864320,0,0,9437184,0,0
.long 0,0,0,0,1,0,1,8456192,82176,3278848,8574080,79872,0,107520,110592,0,2622464,2632704,2642944,2653184,8,0,0,0,7880960,8563200,7864384,1310720,1024,9462784,0,0
.long 0,0,0,0,1,0,1,8458240,164096,3934208,8595584,86016,0,108544,114688,0,2662400,2672640,2682880,2693120,1024,0,0,0,7881216,8552448,7864448,1280,1,9488384,0,0
.long 0,0,0,0,1,0,1,8460288,246016,4589568,8617088,92160,0,109568,118784,0,2663424,2673664,2683904,2694144,1032,0,0,0,7881472,8563200,7864512,1312000,1025,9513984,0,0
.long 1280,1312000,7872512,8462336,0,0,0,0,0,0,0,0,0,0,0,0,5570560,5591040,5611520,5632000,117760,138240,158720,102400,7880704,0,7873536,10240,8,9437184,0,8642560
.long 6400,1317120,7872640,8462464,0,0,0,0,0,0,0,0,1,0,0,0,5596160,5616640,5637120,5575680,133120,153600,112640,117760,7880960,0,7873600,1320960,1032,9462784,0,8643072
.long 11520,1322240,7872768,8462592,0,0,0,0,0,0,0,0,2,0,0,0,5621760,5642240,5580800,5601280,148480,107520,128000,133120,7881216,1024,7873664,11520,9,9488384,0,8643584
.long 16640,1327360,7872896,8462720,0,0,0,0,0,0,0,0,3,0,0,0,5647360,5585920,5606400,5626880,102400,122880,143360,148480,7881472,1024,7873728,1322240,1033,9513984,0,8644096
.long 0,0,0,0,1,1,1,8454144,327936,2623744,8555264,73728,0,106496,106496,0,2949120,2959360,2969600,2979840,0,0,0,0,7880704,8552448,7865344,10240,8,9437184,0,0
.long 0,0,0,0,1,1,1,8456192,409856,3279104,8576768,79872,0,107520,110592,0,2950144,2960384,2970624,2980864,8,0,0,0,7880960,8563200,7865408,1320960,1032,9462784,0,0
.long 0,0,0,0,1,1,1,8458240,491776,3934464,8598272,86016,0,108544,114688,0,2990080,3000320,3010560,3020800,1024,0,0,0,7881216,8552448,7865472,11520,9,9488384,0,0
.long 0,0,0,0,1,1,1,8460288,573696,4589824,8619776,92160,0,109568,118784,0,2991104,3001344,3011584,3021824,1032,0,0,0,7881472,8563200,7865536,1322240,1033,9513984,0,0
.long 2560,1313280,7872512,8470528,0,0,0,0,0,0,0,0,0,0,0,0,5898240,5918720,5939200,5959680,117760,138240,158720,102400,7880704,0,7874560,20480,16,9437184,0,8646656
.long 7680,1318400,7872640,8470656,0,0,0,0,0,0,0,0,1,0,0,0,5923840,5944320,5964800,5903360,133120,153600,112640,117760,7880960,0,7874624,1331200,1040,9462784,0,8647168
.long 12800,1323520,7872768,8470784,0,0,0,0,0,0,0,0,2,0,0,0,5949440,5969920,5908480,5928960,148480,107520,128000,133120,7881216,1024,7874688,21760,17,9488384,0,8647680
.long 17920,1328640,7872896,8470912,0,0,0,0,0,0,0,0,3,0,0,0,5975040,5913600,5934080,5954560,102400,122880,143360,148480,7881472,1024,7874752,1332480,1041,9513984,0,8648192
.long 0,0,0,0,1,2,1,8454144,655616,2624000,8557952,73728,0,106496,106496,0,3276800,3287040,3297280,3307520,0,0,0,0,7880704,8573952,7866368,20480,16,9437184,0,0
.long 0,0,0,0,1,2,1,8456192,737536,3279360,8579456,79872,0,107520,110592,0,3277824,3288064,3298304,3308544,8,0,0,0,7880960,8584704,7866432,1331200,1040,9462784,0,0
.long 0,0,0,0,1,2,1,8458240,819456,3934720,8600960,86016,0,108544,114688,0,3317760,3328000,3338240,3348480,1024,0,0,0,7881216,8573952,7866496,21760,17,9488384,0,0
.long 0,0,0,0,1,2,1,8460288,901376,4590080,8622464,92160,0,109568,118784,0,3318784,3329024,3339264,3349504,1032,0,0,0,7881472,8584704,7866560,1332480,1041,9513984,0,0
.long 3840,1314560,7872512,8478720,0,0,0,0,0,0,0,0,0,0,0,0,6225920,6246400,6266880,6287360,117760,138240,158720,102400,7880704,0,7875584,30720,24,9437184,0,8650752
.long 8960,1319680,7872640,8478848,0,0,0,0,0,0,0,0,1,0,0,0,6251520,6272000,6292480,6231040,133120,153600,112640,117760,7880960,0,7875648,1341440,1048,9462784,0,8651264
.long 14080,1324800,7872768,8478976,0,0,0,0,0,0,0,0,2,0,0,0,6277120,6297600,6236160,6256640,148480,107520,128000,133120,7881216,1024,7875712,32000,25,9488384,0,8651776
.long 19200,1329920,7872896,8479104,0,0,0,0,0,0,0,0,3,0,0,0,6302720,6241280,6261760,6282240,102400,122880,143360,148480,7881472,1024,7875776,1342720,1049,9513984,0,8652288
.long 0,0,0,0,1,3,1,8454144,983296,2624256,8560640,73728,0,106496,106496,0,3604480,3614720,3624960,3635200,0,0,0,0,7880704,8573952,7867392,30720,24,9437184,0,0
.long 0,0,0,0,1,3,1,8456192,1065216,3279616,8582144,79872,0,107520,110592,0,3605504,3615744,3625984,3636224,8,0,0,0,7880960,8584704,7867456,1341440,1048,9462784,0,0
.long 0,0,0,0,1,3,1,8458240,1147136,3934976,8603648,86016,0,108544,114688,0,3645440,3655680,3665920,3676160,1024,0,0,0,7881216,8573952,7867520,32000,25,9488384,0,0
.long 0,0,0,0,1,3,1,8460288,1229056,4590336,8625152,92160,0,109568,118784,0,3646464,3656704,3666944,3677184,1032,0,0,0,7881472,8584704,7867584,1342720,1049,9513984,0,0
.long 163840,1474560,7876608,8458240,0,0,0,0,0,0,0,0,32,0,0,0,6553600,6574080,6594560,6615040,117760,138240,158720,102400,7880704,0,7876608,40960,32,9437184,0,8654848
.long 168960,1479680,7876736,8458368,0,0,0,0,0,0,0,0,33,0,0,0,6579200,6599680,6620160,6558720,133120,153600,112640,117760,7880960,0,7876672,1351680,1056,9462784,0,8655360
.long 174080,1484800,7876864,8458496,0,0,0,0,0,0,0,0,34,0,0,0,6604800,6625280,6563840,6584320,148480,107520,128000,133120,7881216,1024,7876736,42240,33,9488384,0,8655872
.long 179200,1489920,7876992,8458624,0,0,0,0,0,0,0,0,35,0,0,0,6630400,6568960,6589440,6609920,102400,122880,143360,148480,7881472,1024,7876800,1352960,1057,9513984,0,8656384
.long 0,0,0,0,1,4,1,8454144,1310976,2624512,8563328,73728,0,106496,106496,0,3932160,3942400,3952640,3962880,0,0,0,0,7880704,8595456,7868416,40960,32,9437184,0,0
.long 0,0,0,0,1,4,1,8456192,1392896,3279872,8584832,79872,0,107520,110592,0,3933184,3943424,3953664,3963904,8,0,0,0,7880960,8606208,7868480,1351680,1056,9462784,0,0
.long 0,0,0,0,1,4,1,8458240,1474816,3935232,8606336,86016,0,108544,114688,0,3973120,3983360,3993600,4003840,1024,0,0,0,7881216,8595456,7868544,42240,33,9488384,0,0
.long 0,0,0,0,1,4,1,8460288,1556736,4590592,8627840,92160,0,109568,118784,0,3974144,3984384,3994624,4004864,1032,0,0,0,7881472,8606208,7868608,1352960,1057,9513984,0,0
.long 165120,1475840,7876608,8466432,0,0,0,0,0,0,0,0,32,0,0,0,6881280,6901760,6922240,6942720,117760,138240,158720,102400,7880704,0,7877632,51200,40,9437184,0,8658944
.long 170240,1480960,7876736,8466560,0,0,0,0,0,0,0,0,33,0,0,0,6906880,6927360,6947840,6886400,133120,153600,112640,117760,7880960,0,7877696,1361920,1064,9462784,0,8659456
.long 175360,1486080,7876864,8466688,0,0,0,0,0,0,0,0,34,0,0,0,6932480,6952960,6891520,6912000,148480,107520,128000,133120,7881216,1024,7877760,52480,41,9488384,0,8659968
.long 180480,1491200,7876992,8466816,0,0,0,0,0,0,0,0,35,0,0,0,6958080,6896640,6917120,6937600,102400,122880,143360,148480,7881472,1024,7877824,1363200,1065,9513984,0,8660480
.long 0,0,0,0,1,5,1,8454144,1638656,2624768,8566016,73728,0,106496,106496,0,4259840,4270080,4280320,4290560,0,0,0,0,7880704,8595456,7869440,51200,40,9437184,0,0
.long 0,0,0,0,1,5,1,8456192,1720576,3280128,8587520,79872,0,107520,110592,0,4260864,4271104,4281344,4291584,8,0,0,0,7880960,8606208,7869504,1361920,1064,9462784,0,0
.long 0,0,0,0,1,5,1,8458240,1802496,3935488,8609024,86016,0,108544,114688,0,4300800,4311040,4321280,4331520,1024,0,0,0,7881216,8595456,7869568,52480,41,9488384,0,0
.long 0,0,0,0,1,5,1,8460288,1884416,4590848,8630528,92160,0,109568,118784,0,4301824,4312064,4322304,4332544,1032,0,0,0,7881472,8606208,7869632,1363200,1065,9513984,0,0
.long 166400,1477120,7876608,8474624,0,0,0,0,0,0,0,0,32,0,0,0,7208960,7229440,7249920,7270400,117760,138240,158720,102400,7880704,0,7878656,61440,48,9437184,0,8663040
.long 171520,1482240,7876736,8474752,0,0,0,0,0,0,0,0,33,0,0,0,7234560,7255040,7275520,7214080,133120,153600,112640,117760,7880960,0,7878720,1372160,1072,9462784,0,8663552
.long 176640,1487360,7876864,8474880,0,0,0,0,0,0,0,0,34,0,0,0,7260160,7280640,7219200,7239680,148480,107520,128000,133120,7881216,1024,7878784,62720,49,9488384,0,8664064
.long 181760,1492480,7876992,8475008,0,0,0,0,0,0,0,0,35,0,0,0,7285760,7224320,7244800,7265280,102400,122880,143360,148480,7881472,1024,7878848,1373440,1073,9513984,0,8664576
.long 0,0,0,0,1,6,1,8454144,1966336,2625024,8568704,73728,0,106496,106496,0,4587520,4597760,4608000,4618240,0,0,0,0,7880704,8616960,7870464,61440,48,9437184,0,0
.long 0,0,0,0,1,6,1,8456192,2048256,3280384,8590208,79872,0,107520,110592,0,4588544,4598784,4609024,4619264,8,0,0,0,7880960,8627712,7870528,1372160,1072,9462784,0,0
.long 0,0,0,0,1,6,1,8458240,2130176,3935744,8611712,86016,0,108544,114688,0,4628480,4638720,4648960,4659200,1024,0,0,0,7881216,8616960,7870592,62720,49,9488384,0,0
.long 0,0,0,0,1,6,1,8460288,2212096,4591104,8633216,92160,0,109568,118784,0,4629504,4639744,4649984,4660224,1032,0,0,0,7881472,8627712,7870656,1373440,1073,9513984,0,0
.long 167680,1478400,7876608,8482816,0,0,0,0,0,0,0,0,32,0,0,0,7536640,7557120,7577600,7598080,117760,138240,158720,102400,7880704,0,7879680,71680,56,9437184,0,8667136
.long 172800,1483520,7876736,8482944,0,0,0,0,0,0,0,0,33,0,0,0,7562240,7582720,7603200,7541760,133120,153600,112640,117760,7880960,0,7879744,1382400,1080,9462784,0,8667648
.long 177920,1488640,7876864,8483072,0,0,0,0,0,0,0,0,34,0,0,0,7587840,7608320,7546880,7567360,148480,107520,128000,133120,7881216,1024,7879808,72960,57,9488384,0,8668160
.long 183040,1493760,7876992,8483200,0,0,0,0,0,0,0,0,35,0,0,0,7613440,7552000,7572480,7592960,102400,122880,143360,148480,7881472,1024,7879872,1383680,1081,9513984,0,8668672
.long 0,0,0,0,1,7,1,8454144,2294016,2625280,8571392,73728,0,106496,106496,0,4915200,4925440,4935680,4945920,0,0,0,0,7880704,8616960,7871488,71680,56,9437184,0,0
.long 0,0,0,0,1,7,1,8456192,2375936,3280640,8592896,79872,0,107520,110592,0,4916224,4926464,4936704,4946944,8,0,0,0,7880960,8627712,7871552,1382400,1080,9462784,0,0
.long 0,0,0,0,1,7,1,8458240,2457856,3936000,8614400,86016,0,108544,114688,0,4956160,4966400,4976640,4986880,1024,0,0,0,7881216,8616960,7871616,72960,57,9488384,0,0
.long 0,0,0,0,1,7,1,8460288,2539776,4591360,8635904,92160,0,109568,118784,0,4957184,4967424,4977664,4987904,1032,0,0,0,7881472,8627712,7871680,1383680,1081,9513984,0,0
.long 5242880,5244928,8388608,8638464,0,0,0,8486912,0,0,0,0,147456,147456,0,1,2632704,2642944,2653184,2622464,5128,0,0,0,7881728,8563200,7864384,1310880,1024,9539584,80,0
.long 5245952,5245440,8392064,8638592,0,0,0,8491008,0,0,0,0,149760,152064,0,1,2672640,2682880,2693120,2662400,6144,0,0,0,7881984,8552448,7864448,1440,1,9565184,80,0
.long 5324800,5326848,8395520,8638720,0,0,0,8495104,0,0,0,0,152064,147456,0,1,2673664,2683904,2694144,2663424,6152,0,0,0,7882240,8563200,7864512,1312160,1025,9590784,80,0
.long 5327872,5327360,8398976,8638848,0,0,0,8499200,0,0,0,0,154368,152064,0,1,2631680,2641920,2652160,2621440,5120,0,0,0,7882496,8552448,7864320,160,0,9616384,80,0
.long 8392704,0,0,0,0,0,0,0,8388608,7880704,0,9437184,0,0,0,1,5263360,5283840,5304320,5242880,133120,153600,112640,117760,7881728,5120,7872576,1310880,1024,9539584,80,8638464
.long 8392704,0,0,0,0,0,0,0,8389632,7880704,0,9442304,0,0,0,1,5288960,5309440,5248000,5268480,148480,107520,128000,133120,7881984,6144,7872640,1440,1,9565184,80,8638976
.long 8392704,0,0,0,0,0,0,0,8390656,7880704,0,9447424,0,0,0,1,5314560,5253120,5273600,5294080,102400,122880,143360,148480,7882240,6144,7872704,1312160,1025,9590784,80,8639488
.long 8392704,0,0,0,0,0,0,0,8391680,7880704,0,9447424,0,0,0,1,5258240,5278720,5299200,5319680,117760,138240,158720,102400,7882496,5120,7872512,160,0,9616384,80,8640000
.long 5248000,5250048,8402432,8638976,0,0,0,8503296,0,0,0,0,147456,147456,0,1,2960384,2970624,2980864,2950144,5128,0,0,0,7881728,8563200,7865408,1321120,1032,9539584,80,0
.long 5251072,5250560,8405888,8639104,0,0,0,8507392,0,0,0,0,149760,152064,0,1,3000320,3010560,3020800,2990080,6144,0,0,0,7881984,8552448,7865472,11680,9,9565184,80,0
.long 5329920,5331968,8409344,8639232,0,0,0,8511488,0,0,0,0,152064,147456,0,1,3001344,3011584,3021824,2991104,6152,0,0,0,7882240,8563200,7865536,1322400,1033,9590784,80,0
.long 5332992,5332480,8412800,8639360,0,0,0,8515584,0,0,0,0,154368,152064,0,1,2959360,2969600,2979840,2949120,5120,0,0,0,7882496,8552448,7865344,10400,8,9616384,80,0
.long 8397824,0,0,0,0,0,0,0,8393728,7880832,102400,9452544,0,0,0,1,5591040,5611520,5632000,5570560,133120,153600,112640,117760,7881728,5120,7873600,1321120,1032,9539584,80,8642560
.long 8397824,0,0,0,0,0,0,0,8394752,7880832,102400,9457664,0,0,0,1,5616640,5637120,5575680,5596160,148480,107520,128000,133120,7881984,6144,7873664,11680,9,9565184,80,8643072
.long 8397824,0,0,0,0,0,0,0,8395776,7880832,102400,9447936,0,0,0,1,5642240,5580800,5601280,5621760,102400,122880,143360,148480,7882240,6144,7873728,1322400,1033,9590784,80,8643584
.long 8397824,0,0,0,0,0,0,0,8396800,7880832,102400,9447936,0,0,0,1,5585920,5606400,5626880,5647360,117760,138240,158720,102400,7882496,5120,7873536,10400,8,9616384,80,8644096
.long 5253120,5255168,8416256,8639488,0,0,0,8519680,0,0,0,0,147456,147456,0,1,3288064,3298304,3308544,3277824,5128,0,0,0,7881728,8584704,7866432,1331360,1040,9539584,80,0
.long 5256192,5255680,8419712,8639616,0,0,0,8523776,0,0,0,0,149760,152064,0,1,3328000,3338240,3348480,3317760,6144,0,0,0,7881984,8573952,7866496,21920,17,9565184,80,0
.long 5335040,5337088,8423168,8639744,0,0,0,8527872,0,0,0,0,152064,147456,0,1,3329024,3339264,3349504,3318784,6152,0,0,0,7882240,8584704,7866560,1332640,1041,9590784,80,0
.long 5338112,5337600,8426624,8639872,0,0,0,8531968,0,0,0,0,154368,152064,0,1,3287040,3297280,3307520,3276800,5120,0,0,0,7882496,8573952,7866368,20640,16,9616384,80,0
.long 8402944,0,0,0,0,0,0,0,8398848,7880960,204800,9462784,0,0,0,1,5918720,5939200,5959680,5898240,133120,153600,112640,117760,7881728,5120,7874624,1331360,1040,9539584,80,8646656
.long 8402944,0,0,0,0,0,0,0,8399872,7880960,204800,9467904,0,0,0,1,5944320,5964800,5903360,5923840,148480,107520,128000,133120,7881984,6144,7874688,21920,17,9565184,80,8647168
.long 8402944,0,0,0,0,0,0,0,8400896,7880960,204800,9473024,0,0,0,1,5969920,5908480,5928960,5949440,102400,122880,143360,148480,7882240,6144,7874752,1332640,1041,9590784,80,8647680
.long 8402944,0,0,0,0,0,0,0,8401920,7880960,204800,9473024,0,0,0,1,5913600,5934080,5954560,5975040,117760,138240,158720,102400,7882496,5120,7874560,20640,16,9616384,80,8648192
.long 5258240,5260288,8430080,8640000,0,0,0,8536064,0,0,0,0,147456,147456,0,1,3615744,3625984,3636224,3605504,5128,0,0,0,7881728,8584704,7867456,1341600,1048,9539584,80,0
.long 5261312,5260800,8433536,8640128,0,0,0,8540160,0,0,0,0,149760,152064,0,1,3655680,3665920,3676160,3645440,6144,0,0,0,7881984,8573952,7867520,32160,25,9565184,80,0
.long 5340160,5342208,8436992,8640256,0,0,0,8544256,0,0,0,0,152064,147456,0,1,3656704,3666944,3677184,3646464,6152,0,0,0,7882240,8584704,7867584,1342880,1049,9590784,80,0
.long 5343232,5342720,8440448,8640384,0,0,0,8548352,0,0,0,0,154368,152064,0,1,3614720,3624960,3635200,3604480,5120,0,0,0,7882496,8573952,7867392,30880,24,9616384,80,0
.long 8408064,0,0,0,0,0,0,0,8403968,7881088,307200,9478144,0,0,0,1,6246400,6266880,6287360,6225920,133120,153600,112640,117760,7881728,5120,7875648,1341600,1048,9539584,80,8650752
.long 8408064,0,0,0,0,0,0,0,8404992,7881088,307200,9483264,0,0,0,1,6272000,6292480,6231040,6251520,148480,107520,128000,133120,7881984,6144,7875712,32160,25,9565184,80,8651264
.long 8408064,0,0,0,0,0,0,0,8406016,7881088,307200,9473536,0,0,0,1,6297600,6236160,6256640,6277120,102400,122880,143360,148480,7882240,6144,7875776,1342880,1049,9590784,80,8651776
.long 8408064,0,0,0,0,0,0,0,8407040,7881088,307200,9473536,0,0,0,1,6241280,6261760,6282240,6302720,117760,138240,158720,102400,7882496,5120,7875584,30880,24,9616384,80,8652288
.long 6553600,6555648,8388608,8654848,0,0,0,8486912,0,0,0,0,147456,147456,0,1,3943424,3953664,3963904,3933184,5128,0,0,0,7881728,8606208,7868480,1351840,1056,9539584,80,0
.long 6556672,6556160,8392064,8654976,0,0,0,8491008,0,0,0,0,149760,152064,0,1,3983360,3993600,4003840,3973120,6144,0,0,0,7881984,8595456,7868544,42400,33,9565184,80,0
.long 6635520,6637568,8395520,8655104,0,0,0,8495104,0,0,0,0,152064,147456,0,1,3984384,3994624,4004864,3974144,6152,0,0,0,7882240,8606208,7868608,1353120,1057,9590784,80,0
.long 6638592,6638080,8398976,8655232,0,0,0,8499200,0,0,0,0,154368,152064,0,1,3942400,3952640,3962880,3932160,5120,0,0,0,7882496,8595456,7868416,41120,32,9616384,80,0
.long 8556544,0,0,0,0,0,0,0,8552448,7884800,640,9846784,0,0,0,1,6574080,6594560,6615040,6553600,133120,153600,112640,117760,7881728,5120,7876672,1351840,1056,9539584,80,8654848
.long 8556544,0,0,0,0,0,0,0,8553472,7884800,640,9851904,0,0,0,1,6599680,6620160,6558720,6579200,148480,107520,128000,133120,7881984,6144,7876736,42400,33,9565184,80,8655360
.long 8556544,0,0,0,0,0,0,0,8554496,7884800,640,9857024,0,0,0,1,6625280,6563840,6584320,6604800,102400,122880,143360,148480,7882240,6144,7876800,1353120,1057,9590784,80,8655872
.long 8556544,0,0,0,0,0,0,0,8555520,7884800,640,9857024,0,0,0,1,6568960,6589440,6609920,6630400,117760,138240,158720,102400,7882496,5120,7876608,41120,32,9616384,80,8656384
.long 6558720,6560768,8402432,8655360,0,0,0,8503296,0,0,0,0,147456,147456,0,1,4271104,4281344,4291584,4260864,5128,0,0,0,7881728,8606208,7869504,1362080,1064,9539584,80,0
.long 6561792,6561280,8405888,8655488,0,0,0,8507392,0,0,0,0,149760,152064,0,1,4311040,4321280,4331520,4300800,6144,0,0,0,7881984,8595456,7869568,52640,41,9565184,80,0
.long 6640640,6642688,8409344,8655616,0,0,0,8511488,0,0,0,0,152064,147456,0,1,4312064,4322304,4332544,4301824,6152,0,0,0,7882240,8606208,7869632,1363360,1065,9590784,80,0
.long 6643712,6643200,8412800,8655744,0,0,0,8515584,0,0,0,0,154368,152064,0,1,4270080,4280320,4290560,4259840,5120,0,0,0,7882496,8595456,7869440,51360,40,9616384,80,0
.long 8561664,0,0,0,0,0,0,0,8557568,7884928,103040,9862144,0,0,0,1,6901760,6922240,6942720,6881280,133120,153600,112640,117760,7881728,5120,7877696,1362080,1064,9539584,80,8658944
.long 8561664,0,0,0,0,0,0,0,8558592,7884928,103040,9867264,0,0,0,1,6927360,6947840,6886400,6906880,148480,107520,128000,133120,7881984,6144,7877760,52640,41,9565184,80,8659456
.long 8561664,0,0,0,0,0,0,0,8559616,7884928,103040,9857536,0,0,0,1,6952960,6891520,6912000,6932480,102400,122880,143360,148480,7882240,6144,7877824,1363360,1065,9590784,80,8659968
.long 8561664,0,0,0,0,0,0,0,8560640,7884928,103040,9857536,0,0,0,1,6896640,6917120,6937600,6958080,117760,138240,158720,102400,7882496,5120,7877632,51360,40,9616384,80,8660480
.long 6563840,6565888,8416256,8655872,0,0,0,8519680,0,0,0,0,147456,147456,0,1,4598784,4609024,4619264,4588544,5128,0,0,0,7881728,8627712,7870528,1372320,1072,9539584,80,0
.long 6566912,6566400,8419712,8656000,0,0,0,8523776,0,0,0,0,149760,152064,0,1,4638720,4648960,4659200,4628480,6144,0,0,0,7881984,8616960,7870592,62880,49,9565184,80,0
.long 6645760,6647808,8423168,8656128,0,0,0,8527872,0,0,0,0,152064,147456,0,1,4639744,4649984,4660224,4629504,6152,0,0,0,7882240,8627712,7870656,1373600,1073,9590784,80,0
.long 6648832,6648320,8426624,8656256,0,0,0,8531968,0,0,0,0,154368,152064,0,1,4597760,4608000,4618240,4587520,5120,0,0,0,7882496,8616960,7870464,61600,48,9616384,80,0
.long 8566784,0,0,0,0,0,0,0,8562688,7885056,205440,9872384,0,0,0,1,7229440,7249920,7270400,7208960,133120,153600,112640,117760,7881728,5120,7878720,1372320,1072,9539584,80,8663040
.long 8566784,0,0,0,0,0,0,0,8563712,7885056,205440,9877504,0,0,0,1,7255040,7275520,7214080,7234560,148480,107520,128000,133120,7881984,6144,7878784,62880,49,9565184,80,8663552
.long 8566784,0,0,0,0,0,0,0,8564736,7885056,205440,9882624,0,0,0,1,7280640,7219200,7239680,7260160,102400,122880,143360,148480,7882240,6144,7878848,1373600,1073,9590784,80,8664064
.long 8566784,0,0,0,0,0,0,0,8565760,7885056,205440,9882624,0,0,0,1,7224320,7244800,7265280,7285760,117760,138240,158720,102400,7882496,5120,7878656,61600,48,9616384,80,8664576
.long 6568960,6571008,8430080,8656384,0,0,0,8536064,0,0,0,0,147456,147456,0,1,4926464,4936704,4946944,4916224,5128,0,0,0,7881728,8627712,7871552,1382560,1080,9539584,80,0
.long 6572032,6571520,8433536,8656512,0,0,0,8540160,0,0,0,0,149760,152064,0,1,4966400,4976640,4986880,4956160,6144,0,0,0,7881984,8616960,7871616,73120,57,9565184,80,0
.long 6650880,6652928,8436992,8656640,0,0,0,8544256,0,0,0,0,152064,147456,0,1,4967424,4977664,4987904,4957184,6152,0,0,0,7882240,8627712,7871680,1383840,1081,9590784,80,0
.long 6653952,6653440,8440448,8656768,0,0,0,8548352,0,0,0,0,154368,152064,0,1,4925440,4935680,4945920,4915200,5120,0,0,0,7882496,8616960,7871488,71840,56,9616384,80,0
.long 8571904,0,0,0,0,0,0,0,8567808,7885184,307840,9887744,0,0,0,1,7557120,7577600,7598080,7536640,133120,153600,112640,117760,7881728,5120,7879744,1382560,1080,9539584,80,8667136
.long 8571904,0,0,0,0,0,0,0,8568832,7885184,307840,9892864,0,0,0,1,7582720,7603200,7541760,7562240,148480,107520,128000,133120,7881984,6144,7879808,73120,57,9565184,80,8667648
.long 8571904,0,0,0,0,0,0,0,8569856,7885184,307840,9883136,0,0,0,1,7608320,7546880,7567360,7587840,102400,122880,143360,148480,7882240,6144,7879872,1383840,1081,9590784,80,8668160
.long 8571904,0,0,0,0,0,0,0,8570880,7885184,307840,9883136,0,0,0,1,7552000,7572480,7592960,7613440,117760,138240,158720,102400,7882496,5120,7879680,71840,56,9616384,80,8668672
.long 8388608,106496,106496,8486912,0,0,0,0,0,0,0,0,0,0,0,2,5283840,5304320,5242880,5263360,148480,107520,128000,133120,7882752,11264,7872640,1600,1,9641984,160,8638464
.long 8390336,126976,110592,8488960,0,0,0,0,0,0,0,0,0,0,0,2,5309440,5248000,5268480,5288960,102400,122880,143360,148480,7883008,11264,7872704,1312320,1025,9667584,160,8638976
.long 8392064,108544,126976,8491008,0,0,0,0,0,0,0,0,0,0,0,2,5253120,5273600,5294080,5314560,117760,138240,158720,102400,7883264,10240,7872512,320,0,9693184,160,8639488
.long 8393792,129024,131072,8493056,0,0,0,0,0,0,0,0,0,0,0,2,5278720,5299200,5319680,5258240,133120,153600,112640,117760,7883520,10240,7872576,1311040,1024,9718784,160,8640000
.long 0,0,0,0,0,0,0,8454144,0,2621440,8552448,73728,0,106496,106496,2,2682880,2693120,2662400,2672640,11264,0,0,0,7882752,8552448,7864448,1600,1,9641984,160,0
.long 0,0,0,0,0,0,0,8456192,81920,3276800,8573952,79872,0,107520,110592,2,2683904,2694144,2663424,2673664,11272,0,0,0,7883008,8563200,7864512,1312320,1025,9667584,160,0
.long 0,0,0,0,0,0,0,8458240,163840,3932160,8595456,86016,0,108544,114688,2,2641920,2652160,2621440,2631680,10240,0,0,0,7883264,8552448,7864320,320,0,9693184,160,0
.long 0,0,0,0,0,0,0,8460288,245760,4587520,8616960,92160,0,109568,118784,2,2642944,2653184,2622464,2632704,10248,0,0,0,7883520,8563200,7864384,1311040,1024,9718784,160,0
.long 8402432,106496,106496,8503296,0,0,0,0,0,0,0,0,0,0,0,2,5611520,5632000,5570560,5591040,148480,107520,128000,133120,7882752,11264,7873664,11840,9,9641984,160,8642560
.long 8404160,126976,110592,8505344,0,0,0,0,0,0,0,0,0,0,0,2,5637120,5575680,5596160,5616640,102400,122880,143360,148480,7883008,11264,7873728,1322560,1033,9667584,160,8643072
.long 8405888,108544,126976,8507392,0,0,0,0,0,0,0,0,0,0,0,2,5580800,5601280,5621760,5642240,117760,138240,158720,102400,7883264,10240,7873536,10560,8,9693184,160,8643584
.long 8407616,129024,131072,8509440,0,0,0,0,0,0,0,0,0,0,0,2,5606400,5626880,5647360,5585920,133120,153600,112640,117760,7883520,10240,7873600,1321280,1032,9718784,160,8644096
.long 0,0,0,0,0,1,0,8454144,327680,2621696,8555136,73728,0,106496,106496,2,3010560,3020800,2990080,3000320,11264,0,0,0,7882752,8552448,7865472,11840,9,9641984,160,0
.long 0,0,0,0,0,1,0,8456192,409600,3277056,8576640,79872,0,107520,110592,2,3011584,3021824,2991104,3001344,11272,0,0,0,7883008,8563200,7865536,1322560,1033,9667584,160,0
.long 0,0,0,0,0,1,0,8458240,491520,3932416,8598144,86016,0,108544,114688,2,2969600,2979840,2949120,2959360,10240,0,0,0,7883264,8552448,7865344,10560,8,9693184,160,0
.long 0,0,0,0,0,1,0,8460288,573440,4587776,8619648,92160,0,109568,118784,2,2970624,2980864,2950144,2960384,10248,0,0,0,7883520,8563200,7865408,1321280,1032,9718784,160,0
.long 8416256,106496,106496,8519680,0,0,0,0,0,0,0,0,0,0,0,2,5939200,5959680,5898240,5918720,148480,107520,128000,133120,7882752,11264,7874688,22080,17,9641984,160,8646656
.long 8417984,126976,110592,8521728,0,0,0,0,0,0,0,0,0,0,0,2,5964800,5903360,5923840,5944320,102400,122880,143360,148480,7883008,11264,7874752,1332800,1041,9667584,160,8647168
.long 8419712,108544,126976,8523776,0,0,0,0,0,0,0,0,0,0,0,2,5908480,5928960,5949440,5969920,117760,138240,158720,102400,7883264,10240,7874560,20800,16,9693184,160,8647680
.long 8421440,129024,131072,8525824,0,0,0,0,0,0,0,0,0,0,0,2,5934080,5954560,5975040,5913600,133120,153600,112640,117760,7883520,10240,7874624,1331520,1040,9718784,160,8648192
.long 0,0,0,0,0,2,0,8454144,655360,2621952,8557824,73728,0,106496,106496,2,3338240,3348480,3317760,3328000,11264,0,0,0,7882752,8573952,7866496,22080,17,9641984,160,0
.long 0,0,0,0,0,2,0,8456192,737280,3277312,8579328,79872,0,107520,110592,2,3339264,3349504,3318784,3329024,11272,0,0,0,7883008,8584704,7866560,1332800,1041,9667584,160,0
.long 0,0,0,0,0,2,0,8458240,819200,3932672,8600832,86016,0,108544,114688,2,3297280,3307520,3276800,3287040,10240,0,0,0,7883264,8573952,7866368,20800,16,9693184,160,0
.long 0,0,0,0,0,2,0,8460288,901120,4588032,8622336,92160,0,109568,118784,2,3298304,3308544,3277824,3288064,10248,0,0,0,7883520,8584704,7866432,1331520,1040,9718784,160,0
.long 8430080,106496,106496,8536064,0,0,0,0,0,0,0,0,0,0,0,2,6266880,6287360,6225920,6246400,148480,107520,128000,133120,7882752,11264,7875712,32320,25,9641984,160,8650752
.long 8431808,126976,110592,8538112,0,0,0,0,0,0,0,0,0,0,0,2,6292480,6231040,6251520,6272000,102400,122880,143360,148480,7883008,11264,7875776,1343040,1049,9667584,160,8651264
.long 8433536,108544,126976,8540160,0,0,0,0,0,0,0,0,0,0,0,2,6236160,6256640,6277120,6297600,117760,138240,158720,102400,7883264,10240,7875584,31040,24,9693184,160,8651776
.long 8435264,129024,131072,8542208,0,0,0,0,0,0,0,0,0,0,0,2,6261760,6282240,6302720,6241280,133120,153600,112640,117760,7883520,10240,7875648,1341760,1048,9718784,160,8652288
.long 0,0,0,0,0,3,0,8454144,983040,2622208,8560512,73728,0,106496,106496,2,3665920,3676160,3645440,3655680,11264,0,0,0,7882752,8573952,7867520,32320,25,9641984,160,0
.long 0,0,0,0,0,3,0,8456192,1064960,3277568,8582016,79872,0,107520,110592,2,3666944,3677184,3646464,3656704,11272,0,0,0,7883008,8584704,7867584,1343040,1049,9667584,160,0
.long 0,0,0,0,0,3,0,8458240,1146880,3932928,8603520,86016,0,108544,114688,2,3624960,3635200,3604480,3614720,10240,0,0,0,7883264,8573952,7867392,31040,24,9693184,160,0
.long 0,0,0,0,0,3,0,8460288,1228800,4588288,8625024,92160,0,109568,118784,2,3625984,3636224,3605504,3615744,10248,0,0,0,7883520,8584704,7867456,1341760,1048,9718784,160,0
.long 8388608,106496,106496,8487936,0,0,0,0,0,0,0,0,0,0,0,2,6594560,6615040,6553600,6574080,148480,107520,128000,133120,7882752,11264,7876736,42560,33,9641984,160,8654848
.long 8390336,126976,110592,8489984,0,0,0,0,0,0,0,0,0,0,0,2,6620160,6558720,6579200,6599680,102400,122880,143360,148480,7883008,11264,7876800,1353280,1057,9667584,160,8655360
.long 8392064,108544,126976,8492032,0,0,0,0,0,0,0,0,0,0,0,2,6563840,6584320,6604800,6625280,117760,138240,158720,102400,7883264,10240,7876608,41280,32,9693184,160,8655872
.long 8393792,129024,131072,8494080,0,0,0,0,0,0,0,0,0,0,0,2,6589440,6609920,6630400,6568960,133120,153600,112640,117760,7883520,10240,7876672,1352000,1056,9718784,160,8656384
.long 0,0,0,0,0,4,0,8454144,1310720,2622464,8563200,73728,0,106496,106496,2,3993600,4003840,3973120,3983360,11264,0,0,0,7882752,8595456,7868544,42560,33,9641984,160,0
.long 0,0,0,0,0,4,0,8456192,1392640,3277824,8584704,79872,0,107520,110592,2,3994624,4004864,3974144,3984384,11272,0,0,0,7883008,8606208,7868608,1353280,1057,9667584,160,0
.long 0,0,0,0,0,4,0,8458240,1474560,3933184,8606208,86016,0,108544,114688,2,3952640,3962880,3932160,3942400,10240,0,0,0,7883264,8595456,7868416,41280,32,9693184,160,0
.long 0,0,0,0,0,4,0,8460288,1556480,4588544,8627712,92160,0,109568,118784,2,3953664,3963904,3933184,3943424,10248,0,0,0,7883520,8606208,7868480,1352000,1056,9718784,160,0
.long 8402432,106496,106496,8504320,0,0,0,0,0,0,0,0,0,0,0,2,6922240,6942720,6881280,6901760,148480,107520,128000,133120,7882752,11264,7877760,52800,41,9641984,160,8658944
.long 8404160,126976,110592,8506368,0,0,0,0,0,0,0,0,0,0,0,2,6947840,6886400,6906880,6927360,102400,122880,143360,148480,7883008,11264,7877824,1363520,1065,9667584,160,8659456
.long 8405888,108544,126976,8508416,0,0,0,0,0,0,0,0,0,0,0,2,6891520,6912000,6932480,6952960,117760,138240,158720,102400,7883264,10240,7877632,51520,40,9693184,160,8659968
.long 8407616,129024,131072,8510464,0,0,0,0,0,0,0,0,0,0,0,2,6917120,6937600,6958080,6896640,133120,153600,112640,117760,7883520,10240,7877696,1362240,1064,9718784,160,8660480
.long 0,0,0,0,0,5,0,8454144,1638400,2622720,8565888,73728,0,106496,106496,2,4321280,4331520,4300800,4311040,11264,0,0,0,7882752,8595456,7869568,52800,41,9641984,160,0
.long 0,0,0,0,0,5,0,8456192,1720320,3278080,8587392,79872,0,107520,110592,2,4322304,4332544,4301824,4312064,11272,0,0,0,7883008,8606208,7869632,1363520,1065,9667584,160,0
.long 0,0,0,0,0,5,0,8458240,1802240,3933440,8608896,86016,0,108544,114688,2,4280320,4290560,4259840,4270080,10240,0,0,0,7883264,8595456,7869440,51520,40,9693184,160,0
.long 0,0,0,0,0,5,0,8460288,1884160,4588800,8630400,92160,0,109568,118784,2,4281344,4291584,4260864,4271104,10248,0,0,0,7883520,8606208,7869504,1362240,1064,9718784,160,0
.long 8416256,106496,106496,8520704,0,0,0,0,0,0,0,0,0,0,0,2,7249920,7270400,7208960,7229440,148480,107520,128000,133120,7882752,11264,7878784,63040,49,9641984,160,8663040
.long 8417984,126976,110592,8522752,0,0,0,0,0,0,0,0,0,0,0,2,7275520,7214080,7234560,7255040,102400,122880,143360,148480,7883008,11264,7878848,1373760,1073,9667584,160,8663552
.long 8419712,108544,126976,8524800,0,0,0,0,0,0,0,0,0,0,0,2,7219200,7239680,7260160,7280640,117760,138240,158720,102400,7883264,10240,7878656,61760,48,9693184,160,8664064
.long 8421440,129024,131072,8526848,0,0,0,0,0,0,0,0,0,0,0,2,7244800,7265280,7285760,7224320,133120,153600,112640,117760,7883520,10240,7878720,1372480,1072,9718784,160,8664576
.long 0,0,0,0,0,6,0,8454144,1966080,2622976,8568576,73728,0,106496,106496,2,4648960,4659200,4628480,4638720,11264,0,0,0,7882752,8616960,7870592,63040,49,9641984,160,0
.long 0,0,0,0,0,6,0,8456192,2048000,3278336,8590080,79872,0,107520,110592,2,4649984,4660224,4629504,4639744,11272,0,0,0,7883008,8627712,7870656,1373760,1073,9667584,160,0
.long 0,0,0,0,0,6,0,8458240,2129920,3933696,8611584,86016,0,108544,114688,2,4608000,4618240,4587520,4597760,10240,0,0,0,7883264,8616960,7870464,61760,48,9693184,160,0
.long 0,0,0,0,0,6,0,8460288,2211840,4589056,8633088,92160,0,109568,118784,2,4609024,4619264,4588544,4598784,10248,0,0,0,7883520,8627712,7870528,1372480,1072,9718784,160,0
.long 8430080,106496,106496,8537088,0,0,0,0,0,0,0,0,0,0,0,2,7577600,7598080,7536640,7557120,148480,107520,128000,133120,7882752,11264,7879808,73280,57,9641984,160,8667136
.long 8431808,126976,110592,8539136,0,0,0,0,0,0,0,0,0,0,0,2,7603200,7541760,7562240,7582720,102400,122880,143360,148480,7883008,11264,7879872,1384000,1081,9667584,160,8667648
.long 8433536,108544,126976,8541184,0,0,0,0,0,0,0,0,0,0,0,2,7546880,7567360,7587840,7608320,117760,138240,158720,102400,7883264,10240,7879680,72000,56,9693184,160,8668160
.long 8435264,129024,131072,8543232,0,0,0,0,0,0,0,0,0,0,0,2,7572480,7592960,7613440,7552000,133120,153600,112640,117760,7883520,10240,7879744,1382720,1080,9718784,160,8668672
.long 0,0,0,0,0,7,0,8454144,2293760,2623232,8571264,73728,0,106496,106496,2,4976640,4986880,4956160,4966400,11264,0,0,0,7882752,8616960,7871616,73280,57,9641984,160,0
.long 0,0,0,0,0,7,0,8456192,2375680,3278592,8592768,79872,0,107520,110592,2,4977664,4987904,4957184,4967424,11272,0,0,0,7883008,8627712,7871680,1384000,1081,9667584,160,0
.long 0,0,0,0,0,7,0,8458240,2457600,3933952,8614272,86016,0,108544,114688,2,4935680,4945920,4915200,4925440,10240,0,0,0,7883264,8616960,7871488,72000,56,9693184,160,0
.long 0,0,0,0,0,7,0,8460288,2539520,4589312,8635776,92160,0,109568,118784,2,4936704,4946944,4916224,4926464,10248,0,0,0,7883520,8627712,7871552,1382720,1080,9718784,160,0
.long 8395520,106496,106496,8495104,0,0,0,0,0,0,0,0,0,0,0,3,5304320,5242880,5263360,5283840,102400,122880,143360,148480,7883776,16384,7872704,1312480,1025,9744384,240,8638464
.long 8397248,126976,110592,8497152,0,0,0,0,0,0,0,0,0,0,0,3,5248000,5268480,5288960,5309440,117760,138240,158720,102400,7884032,15360,7872512,480,0,9769984,240,8638976
.long 8398976,108544,126976,8499200,0,0,0,0,0,0,0,0,0,0,0,3,5273600,5294080,5314560,5253120,133120,153600,112640,117760,7884288,15360,7872576,1311200,1024,9795584,240,8639488
.long 8400704,129024,131072,8501248,0,0,0,0,0,0,0,0,0,0,0,3,5299200,5319680,5258240,5278720,148480,107520,128000,133120,7884544,16384,7872640,1760,1,9821184,240,8640000
.long 0,0,0,0,2,0,2,8454144,512,2625536,8552704,73728,0,106496,106496,3,2694144,2663424,2673664,2683904,16392,0,0,0,7883776,8563200,7864512,1312480,1025,9744384,240,0
.long 0,0,0,0,2,0,2,8456192,82432,3280896,8574208,79872,0,107520,110592,3,2652160,2621440,2631680,2641920,15360,0,0,0,7884032,8552448,7864320,480,0,9769984,240,0
.long 0,0,0,0,2,0,2,8458240,164352,3936256,8595712,86016,0,108544,114688,3,2653184,2622464,2632704,2642944,15368,0,0,0,7884288,8563200,7864384,1311200,1024,9795584,240,0
.long 0,0,0,0,2,0,2,8460288,246272,4591616,8617216,92160,0,109568,118784,3,2693120,2662400,2672640,2682880,16384,0,0,0,7884544,8552448,7864448,1760,1,9821184,240,0
.long 8409344,106496,106496,8511488,0,0,0,0,0,0,0,0,0,0,0,3,5632000,5570560,5591040,5611520,102400,122880,143360,148480,7883776,16384,7873728,1322720,1033,9744384,240,8642560
.long 8411072,126976,110592,8513536,0,0,0,0,0,0,0,0,0,0,0,3,5575680,5596160,5616640,5637120,117760,138240,158720,102400,7884032,15360,7873536,10720,8,9769984,240,8643072
.long 8412800,108544,126976,8515584,0,0,0,0,0,0,0,0,0,0,0,3,5601280,5621760,5642240,5580800,133120,153600,112640,117760,7884288,15360,7873600,1321440,1032,9795584,240,8643584
.long 8414528,129024,131072,8517632,0,0,0,0,0,0,0,0,0,0,0,3,5626880,5647360,5585920,5606400,148480,107520,128000,133120,7884544,16384,7873664,12000,9,9821184,240,8644096
.long 0,0,0,0,2,1,2,8454144,328192,2625792,8555392,73728,0,106496,106496,3,3021824,2991104,3001344,3011584,16392,0,0,0,7883776,8563200,7865536,1322720,1033,9744384,240,0
.long 0,0,0,0,2,1,2,8456192,410112,3281152,8576896,79872,0,107520,110592,3,2979840,2949120,2959360,2969600,15360,0,0,0,7884032,8552448,7865344,10720,8,9769984,240,0
.long 0,0,0,0,2,1,2,8458240,492032,3936512,8598400,86016,0,108544,114688,3,2980864,2950144,2960384,2970624,15368,0,0,0,7884288,8563200,7865408,1321440,1032,9795584,240,0
.long 0,0,0,0,2,1,2,8460288,573952,4591872,8619904,92160,0,109568,118784,3,3020800,2990080,3000320,3010560,16384,0,0,0,7884544,8552448,7865472,12000,9,9821184,240,0
.long 8423168,106496,106496,8527872,0,0,0,0,0,0,0,0,0,0,0,3,5959680,5898240,5918720,5939200,102400,122880,143360,148480,7883776,16384,7874752,1332960,1041,9744384,240,8646656
.long 8424896,126976,110592,8529920,0,0,0,0,0,0,0,0,0,0,0,3,5903360,5923840,5944320,5964800,117760,138240,158720,102400,7884032,15360,7874560,20960,16,9769984,240,8647168
.long 8426624,108544,126976,8531968,0,0,0,0,0,0,0,0,0,0,0,3,5928960,5949440,5969920,5908480,133120,153600,112640,117760,7884288,15360,7874624,1331680,1040,9795584,240,8647680
.long 8428352,129024,131072,8534016,0,0,0,0,0,0,0,0,0,0,0,3,5954560,5975040,5913600,5934080,148480,107520,128000,133120,7884544,16384,7874688,22240,17,9821184,240,8648192
.long 0,0,0,0,2,2,2,8454144,655872,2626048,8558080,73728,0,106496,106496,3,3349504,3318784,3329024,3339264,16392,0,0,0,7883776,8584704,7866560,1332960,1041,9744384,240,0
.long 0,0,0,0,2,2,2,8456192,737792,3281408,8579584,79872,0,107520,110592,3,3307520,3276800,3287040,3297280,15360,0,0,0,7884032,8573952,7866368,20960,16,9769984,240,0
.long 0,0,0,0,2,2,2,8458240,819712,3936768,8601088,86016,0,108544,114688,3,3308544,3277824,3288064,3298304,15368,0,0,0,7884288,8584704,7866432,1331680,1040,9795584,240,0
.long 0,0,0,0,2,2,2,8460288,901632,4592128,8622592,92160,0,109568,118784,3,3348480,3317760,3328000,3338240,16384,0,0,0,7884544,8573952,7866496,22240,17,9821184,240,0
.long 8436992,106496,106496,8544256,0,0,0,0,0,0,0,0,0,0,0,3,6287360,6225920,6246400,6266880,102400,122880,143360,148480,7883776,16384,7875776,1343200,1049,9744384,240,8650752
.long 8438720,126976,110592,8546304,0,0,0,0,0,0,0,0,0,0,0,3,6231040,6251520,6272000,6292480,117760,138240,158720,102400,7884032,15360,7875584,31200,24,9769984,240,8651264
.long 8440448,108544,126976,8548352,0,0,0,0,0,0,0,0,0,0,0,3,6256640,6277120,6297600,6236160,133120,153600,112640,117760,7884288,15360,7875648,1341920,1048,9795584,240,8651776
.long 8442176,129024,131072,8550400,0,0,0,0,0,0,0,0,0,0,0,3,6282240,6302720,6241280,6261760,148480,107520,128000,133120,7884544,16384,7875712,32480,25,9821184,240,8652288
.long 0,0,0,0,2,3,2,8454144,983552,2626304,8560768,73728,0,106496,106496,3,3677184,3646464,3656704,3666944,16392,0,0,0,7883776,8584704,7867584,1343200,1049,9744384,240,0
.long 0,0,0,0,2,3,2,8456192,1065472,3281664,8582272,79872,0,107520,110592,3,3635200,3604480,3614720,3624960,15360,0,0,0,7884032,8573952,7867392,31200,24,9769984,240,0
.long 0,0,0,0,2,3,2,8458240,1147392,3937024,8603776,86016,0,108544,114688,3,3636224,3605504,3615744,3625984,15368,0,0,0,7884288,8584704,7867456,1341920,1048,9795584,240,0
.long 0,0,0,0,2,3,2,8460288,1229312,4592384,8625280,92160,0,109568,118784,3,3676160,3645440,3655680,3665920,16384,0,0,0,7884544,8573952,7867520,32480,25,9821184,240,0
.long 8395520,106496,106496,8496128,0,0,0,0,0,0,0,0,0,0,0,3,6615040,6553600,6574080,6594560,102400,122880,143360,148480,7883776,16384,7876800,1353440,1057,9744384,240,8654848
.long 8397248,126976,110592,8498176,0,0,0,0,0,0,0,0,0,0,0,3,6558720,6579200,6599680,6620160,117760,138240,158720,102400,7884032,15360,7876608,41440,32,9769984,240,8655360
.long 8398976,108544,126976,8500224,0,0,0,0,0,0,0,0,0,0,0,3,6584320,6604800,6625280,6563840,133120,153600,112640,117760,7884288,15360,7876672,1352160,1056,9795584,240,8655872
.long 8400704,129024,131072,8502272,0,0,0,0,0,0,0,0,0,0,0,3,6609920,6630400,6568960,6589440,148480,107520,128000,133120,7884544,16384,7876736,42720,33,9821184,240,8656384
.long 0,0,0,0,2,4,2,8454144,1311232,2626560,8563456,73728,0,106496,106496,3,4004864,3974144,3984384,3994624,16392,0,0,0,7883776,8606208,7868608,1353440,1057,9744384,240,0
.long 0,0,0,0,2,4,2,8456192,1393152,3281920,8584960,79872,0,107520,110592,3,3962880,3932160,3942400,3952640,15360,0,0,0,7884032,8595456,7868416,41440,32,9769984,240,0
.long 0,0,0,0,2,4,2,8458240,1475072,3937280,8606464,86016,0,108544,114688,3,3963904,3933184,3943424,3953664,15368,0,0,0,7884288,8606208,7868480,1352160,1056,9795584,240,0
.long 0,0,0,0,2,4,2,8460288,1556992,4592640,8627968,92160,0,109568,118784,3,4003840,3973120,3983360,3993600,16384,0,0,0,7884544,8595456,7868544,42720,33,9821184,240,0
.long 8409344,106496,106496,8512512,0,0,0,0,0,0,0,0,0,0,0,3,6942720,6881280,6901760,6922240,102400,122880,143360,148480,7883776,16384,7877824,1363680,1065,9744384,240,8658944
.long 8411072,126976,110592,8514560,0,0,0,0,0,0,0,0,0,0,0,3,6886400,6906880,6927360,6947840,117760,138240,158720,102400,7884032,15360,7877632,51680,40,9769984,240,8659456
.long 8412800,108544,126976,8516608,0,0,0,0,0,0,0,0,0,0,0,3,6912000,6932480,6952960,6891520,133120,153600,112640,117760,7884288,15360,7877696,1362400,1064,9795584,240,8659968
.long 8414528,129024,131072,8518656,0,0,0,0,0,0,0,0,0,0,0,3,6937600,6958080,6896640,6917120,148480,107520,128000,133120,7884544,16384,7877760,52960,41,9821184,240,8660480
.long 0,0,0,0,2,5,2,8454144,1638912,2626816,8566144,73728,0,106496,106496,3,4332544,4301824,4312064,4322304,16392,0,0,0,7883776,8606208,7869632,1363680,1065,9744384,240,0
.long 0,0,0,0,2,5,2,8456192,1720832,3282176,8587648,79872,0,107520,110592,3,4290560,4259840,4270080,4280320,15360,0,0,0,7884032,8595456,7869440,51680,40,9769984,240,0
.long 0,0,0,0,2,5,2,8458240,1802752,3937536,8609152,86016,0,108544,114688,3,4291584,4260864,4271104,4281344,15368,0,0,0,7884288,8606208,7869504,1362400,1064,9795584,240,0
.long 0,0,0,0,2,5,2,8460288,1884672,4592896,8630656,92160,0,109568,118784,3,4331520,4300800,4311040,4321280,16384,0,0,0,7884544,8595456,7869568,52960,41,9821184,240,0
.long 8423168,106496,106496,8528896,0,0,0,0,0,0,0,0,0,0,0,3,7270400,7208960,7229440,7249920,102400,122880,143360,148480,7883776,16384,7878848,1373920,1073,9744384,240,8663040
.long 8424896,126976,110592,8530944,0,0,0,0,0,0,0,0,0,0,0,3,7214080,7234560,7255040,7275520,117760,138240,158720,102400,7884032,15360,7878656,61920,48,9769984,240,8663552
.long 8426624,108544,126976,8532992,0,0,0,0,0,0,0,0,0,0,0,3,7239680,7260160,7280640,7219200,133120,153600,112640,117760,7884288,15360,7878720,1372640,1072,9795584,240,8664064
.long 8428352,129024,131072,8535040,0,0,0,0,0,0,0,0,0,0,0,3,7265280,7285760,7224320,7244800,148480,107520,128000,133120,7884544,16384,7878784,63200,49,9821184,240,8664576
.long 0,0,0,0,2,6,2,8454144,1966592,2627072,8568832,73728,0,106496,106496,3,4660224,4629504,4639744,4649984,16392,0,0,0,7883776,8627712,7870656,1373920,1073,9744384,240,0
.long 0,0,0,0,2,6,2,8456192,2048512,3282432,8590336,79872,0,107520,110592,3,4618240,4587520,4597760,4608000,15360,0,0,0,7884032,8616960,7870464,61920,48,9769984,240,0
.long 0,0,0,0,2,6,2,8458240,2130432,3937792,8611840,86016,0,108544,114688,3,4619264,4588544,4598784,4609024,15368,0,0,0,7884288,8627712,7870528,1372640,1072,9795584,240,0
.long 0,0,0,0,2,6,2,8460288,2212352,4593152,8633344,92160,0,109568,118784,3,4659200,4628480,4638720,4648960,16384,0,0,0,7884544,8616960,7870592,63200,49,9821184,240,0
.long 8436992,106496,106496,8545280,0,0,0,0,0,0,0,0,0,0,0,3,7598080,7536640,7557120,7577600,102400,122880,143360,148480,7883776,16384,7879872,1384160,1081,9744384,240,8667136
.long 8438720,126976,110592,8547328,0,0,0,0,0,0,0,0,0,0,0,3,7541760,7562240,7582720,7603200,117760,138240,158720,102400,7884032,15360,7879680,72160,56,9769984,240,8667648
.long 8440448,108544,126976,8549376,0,0,0,0,0,0,0,0,0,0,0,3,7567360,7587840,7608320,7546880,133120,153600,112640,117760,7884288,15360,7879744,1382880,1080,9795584,240,8668160
.long 8442176,129024,131072,8551424,0,0,0,0,0,0,0,0,0,0,0,3,7592960,7613440,7552000,7572480,148480,107520,128000,133120,7884544,16384,7879808,73440,57,9821184,240,8668672
.long 0,0,0,0,2,7,2,8454144,2294272,2627328,8571520,73728,0,106496,106496,3,4987904,4957184,4967424,4977664,16392,0,0,0,7883776,8627712,7871680,1384160,1081,9744384,240,0
.long 0,0,0,0,2,7,2,8456192,2376192,3282688,8593024,79872,0,107520,110592,3,4945920,4915200,4925440,4935680,15360,0,0,0,7884032,8616960,7871488,72160,56,9769984,240,0
.long 0,0,0,0,2,7,2,8458240,2458112,3938048,8614528,86016,0,108544,114688,3,4946944,4916224,4926464,4936704,15368,0,0,0,7884288,8627712,7871552,1382880,1080,9795584,240,0
.long 0,0,0,0,2,7,2,8460288,2540032,4593408,8636032,92160,0,109568,118784,3,4986880,4956160,4966400,4976640,16384,0,0,0,7884544,8616960,7871616,73440,57,9821184,240,0
.long 20480,1331200,7873024,8454656,0,0,0,0,0,0,0,0,4,0,0,4,5242880,5263360,5283840,5304320,117760,138240,158720,102400,7884800,0,7872512,640,0,9846784,4294966976,8638464
.long 25600,1336320,7873152,8454784,0,0,0,0,0,0,0,0,5,0,0,4,5268480,5288960,5309440,5248000,133120,153600,112640,117760,7885056,0,7872576,1311360,1024,9872384,4294966976,8638976
.long 30720,1341440,7873280,8454912,0,0,0,0,0,0,0,0,6,0,0,4,5294080,5314560,5253120,5273600,148480,107520,128000,133120,7885312,1024,7872640,1920,1,9897984,4294966976,8639488
.long 35840,1346560,7873408,8455040,0,0,0,0,0,0,0,0,7,0,0,4,5319680,5258240,5278720,5299200,102400,122880,143360,148480,7885568,1024,7872704,1312640,1025,9923584,4294966976,8640000
.long 0,0,0,0,4,0,4,8454144,1024,2629632,8552960,73728,0,106496,106496,4,2621440,2631680,2641920,2652160,0,0,0,0,7884800,8552448,7864320,640,0,9846784,4294966976,0
.long 0,0,0,0,4,0,4,8456192,82944,3284992,8574464,79872,0,107520,110592,4,2622464,2632704,2642944,2653184,8,0,0,0,7885056,8563200,7864384,1311360,1024,9872384,4294966976,0
.long 0,0,0,0,4,0,4,8458240,164864,3940352,8595968,86016,0,108544,114688,4,2662400,2672640,2682880,2693120,1024,0,0,0,7885312,8552448,7864448,1920,1,9897984,4294966976,0
.long 0,0,0,0,4,0,4,8460288,246784,4595712,8617472,92160,0,109568,118784,4,2663424,2673664,2683904,2694144,1032,0,0,0,7885568,8563200,7864512,1312640,1025,9923584,4294966976,0
.long 21760,1332480,7873024,8462848,0,0,0,0,0,0,0,0,4,0,0,4,5570560,5591040,5611520,5632000,117760,138240,158720,102400,7884800,0,7873536,10880,8,9846784,4294966976,8642560
.long 26880,1337600,7873152,8462976,0,0,0,0,0,0,0,0,5,0,0,4,5596160,5616640,5637120,5575680,133120,153600,112640,117760,7885056,0,7873600,1321600,1032,9872384,4294966976,8643072
.long 32000,1342720,7873280,8463104,0,0,0,0,0,0,0,0,6,0,0,4,5621760,5642240,5580800,5601280,148480,107520,128000,133120,7885312,1024,7873664,12160,9,9897984,4294966976,8643584
.long 37120,1347840,7873408,8463232,0,0,0,0,0,0,0,0,7,0,0,4,5647360,5585920,5606400,5626880,102400,122880,143360,148480,7885568,1024,7873728,1322880,1033,9923584,4294966976,8644096
.long 0,0,0,0,4,1,4,8454144,328704,2629888,8555648,73728,0,106496,106496,4,2949120,2959360,2969600,2979840,0,0,0,0,7884800,8552448,7865344,10880,8,9846784,4294966976,0
.long 0,0,0,0,4,1,4,8456192,410624,3285248,8577152,79872,0,107520,110592,4,2950144,2960384,2970624,2980864,8,0,0,0,7885056,8563200,7865408,1321600,1032,9872384,4294966976,0
.long 0,0,0,0,4,1,4,8458240,492544,3940608,8598656,86016,0,108544,114688,4,2990080,3000320,3010560,3020800,1024,0,0,0,7885312,8552448,7865472,12160,9,9897984,4294966976,0
.long 0,0,0,0,4,1,4,8460288,574464,4595968,8620160,92160,0,109568,118784,4,2991104,3001344,3011584,3021824,1032,0,0,0,7885568,8563200,7865536,1322880,1033,9923584,4294966976,0
.long 23040,1333760,7873024,8471040,0,0,0,0,0,0,0,0,4,0,0,4,5898240,5918720,5939200,5959680,117760,138240,158720,102400,7884800,0,7874560,21120,16,9846784,4294966976,8646656
.long 28160,1338880,7873152,8471168,0,0,0,0,0,0,0,0,5,0,0,4,5923840,5944320,5964800,5903360,133120,153600,112640,117760,7885056,0,7874624,1331840,1040,9872384,4294966976,8647168
.long 33280,1344000,7873280,8471296,0,0,0,0,0,0,0,0,6,0,0,4,5949440,5969920,5908480,5928960,148480,107520,128000,133120,7885312,1024,7874688,22400,17,9897984,4294966976,8647680
.long 38400,1349120,7873408,8471424,0,0,0,0,0,0,0,0,7,0,0,4,5975040,5913600,5934080,5954560,102400,122880,143360,148480,7885568,1024,7874752,1333120,1041,9923584,4294966976,8648192
.long 0,0,0,0,4,2,4,8454144,656384,2630144,8558336,73728,0,106496,106496,4,3276800,3287040,3297280,3307520,0,0,0,0,7884800,8573952,7866368,21120,16,9846784,4294966976,0
.long 0,0,0,0,4,2,4,8456192,738304,3285504,8579840,79872,0,107520,110592,4,3277824,3288064,3298304,3308544,8,0,0,0,7885056,8584704,7866432,1331840,1040,9872384,4294966976,0
.long 0,0,0,0,4,2,4,8458240,820224,3940864,8601344,86016,0,108544,114688,4,3317760,3328000,3338240,3348480,1024,0,0,0,7885312,8573952,7866496,22400,17,9897984,4294966976,0
.long 0,0,0,0,4,2,4,8460288,902144,4596224,8622848,92160,0,109568,118784,4,3318784,3329024,3339264,3349504,1032,0,0,0,7885568,8584704,7866560,1333120,1041,9923584,4294966976,0
.long 24320,1335040,7873024,8479232,0,0,0,0,0,0,0,0,4,0,0,4,6225920,6246400,6266880,6287360,117760,138240,158720,102400,7884800,0,7875584,31360,24,9846784,4294966976,8650752
.long 29440,1340160,7873152,8479360,0,0,0,0,0,0,0,0,5,0,0,4,6251520,6272000,6292480,6231040,133120,153600,112640,117760,7885056,0,7875648,1342080,1048,9872384,4294966976,8651264
.long 34560,1345280,7873280,8479488,0,0,0,0,0,0,0,0,6,0,0,4,6277120,6297600,6236160,6256640,148480,107520,128000,133120,7885312,1024,7875712,32640,25,9897984,4294966976,8651776
.long 39680,1350400,7873408,8479616,0,0,0,0,0,0,0,0,7,0,0,4,6302720,6241280,6261760,6282240,102400,122880,143360,148480,7885568,1024,7875776,1343360,1049,9923584,4294966976,8652288
.long 0,0,0,0,4,3,4,8454144,984064,2630400,8561024,73728,0,106496,106496,4,3604480,3614720,3624960,3635200,0,0,0,0,7884800,8573952,7867392,31360,24,9846784,4294966976,0
.long 0,0,0,0,4,3,4,8456192,1065984,3285760,8582528,79872,0,107520,110592,4,3605504,3615744,3625984,3636224,8,0,0,0,7885056,8584704,7867456,1342080,1048,9872384,4294966976,0
.long 0,0,0,0,4,3,4,8458240,1147904,3941120,8604032,86016,0,108544,114688,4,3645440,3655680,3665920,3676160,1024,0,0,0,7885312,8573952,7867520,32640,25,9897984,4294966976,0
.long 0,0,0,0,4,3,4,8460288,1229824,4596480,8625536,92160,0,109568,118784,4,3646464,3656704,3666944,3677184,1032,0,0,0,7885568,8584704,7867584,1343360,1049,9923584,4294966976,0
.long 184320,1495040,7877120,8458752,0,0,0,0,0,0,0,0,36,0,0,4,6553600,6574080,6594560,6615040,117760,138240,158720,102400,7884800,0,7876608,41600,32,9846784,4294966976,8654848
.long 189440,1500160,7877248,8458880,0,0,0,0,0,0,0,0,37,0,0,4,6579200,6599680,6620160,6558720,133120,153600,112640,117760,7885056,0,7876672,1352320,1056,9872384,4294966976,8655360
.long 194560,1505280,7877376,8459008,0,0,0,0,0,0,0,0,38,0,0,4,6604800,6625280,6563840,6584320,148480,107520,128000,133120,7885312,1024,7876736,42880,33,9897984,4294966976,8655872
.long 199680,1510400,7877504,8459136,0,0,0,0,0,0,0,0,39,0,0,4,6630400,6568960,6589440,6609920,102400,122880,143360,148480,7885568,1024,7876800,1353600,1057,9923584,4294966976,8656384
.long 0,0,0,0,4,4,4,8454144,1311744,2630656,8563712,73728,0,106496,106496,4,3932160,3942400,3952640,3962880,0,0,0,0,7884800,8595456,7868416,41600,32,9846784,4294966976,0
.long 0,0,0,0,4,4,4,8456192,1393664,3286016,8585216,79872,0,107520,110592,4,3933184,3943424,3953664,3963904,8,0,0,0,7885056,8606208,7868480,1352320,1056,9872384,4294966976,0
.long 0,0,0,0,4,4,4,8458240,1475584,3941376,8606720,86016,0,108544,114688,4,3973120,3983360,3993600,4003840,1024,0,0,0,7885312,8595456,7868544,42880,33,9897984,4294966976,0
.long 0,0,0,0,4,4,4,8460288,1557504,4596736,8628224,92160,0,109568,118784,4,3974144,3984384,3994624,4004864,1032,0,0,0,7885568,8606208,7868608,1353600,1057,9923584,4294966976,0
.long 185600,1496320,7877120,8466944,0,0,0,0,0,0,0,0,36,0,0,4,6881280,6901760,6922240,6942720,117760,138240,158720,102400,7884800,0,7877632,51840,40,9846784,4294966976,8658944
.long 190720,1501440,7877248,8467072,0,0,0,0,0,0,0,0,37,0,0,4,6906880,6927360,6947840,6886400,133120,153600,112640,117760,7885056,0,7877696,1362560,1064,9872384,4294966976,8659456
.long 195840,1506560,7877376,8467200,0,0,0,0,0,0,0,0,38,0,0,4,6932480,6952960,6891520,6912000,148480,107520,128000,133120,7885312,1024,7877760,53120,41,9897984,4294966976,8659968
.long 200960,1511680,7877504,8467328,0,0,0,0,0,0,0,0,39,0,0,4,6958080,6896640,6917120,6937600,102400,122880,143360,148480,7885568,1024,7877824,1363840,1065,9923584,4294966976,8660480
.long 0,0,0,0,4,5,4,8454144,1639424,2630912,8566400,73728,0,106496,106496,4,4259840,4270080,4280320,4290560,0,0,0,0,7884800,8595456,7869440,51840,40,9846784,4294966976,0
.long 0,0,0,0,4,5,4,8456192,1721344,3286272,8587904,79872,0,107520,110592,4,4260864,4271104,4281344,4291584,8,0,0,0,7885056,8606208,7869504,1362560,1064,9872384,4294966976,0
.long 0,0,0,0,4,5,4,8458240,1803264,3941632,8609408,86016,0,108544,114688,4,4300800,4311040,4321280,4331520,1024,0,0,0,7885312,8595456,7869568,53120,41,9897984,4294966976,0
.long 0,0,0,0,4,5,4,8460288,1885184,4596992,8630912,92160,0,109568,118784,4,4301824,4312064,4322304,4332544,1032,0,0,0,7885568,8606208,7869632,1363840,1065,9923584,4294966976,0
.long 186880,1497600,7877120,8475136,0,0,0,0,0,0,0,0,36,0,0,4,7208960,7229440,7249920,7270400,117760,138240,158720,102400,7884800,0,7878656,62080,48,9846784,4294966976,8663040
.long 192000,1502720,7877248,8475264,0,0,0,0,0,0,0,0,37,0,0,4,7234560,7255040,7275520,7214080,133120,153600,112640,117760,7885056,0,7878720,1372800,1072,9872384,4294966976,8663552
.long 197120,1507840,7877376,8475392,0,0,0,0,0,0,0,0,38,0,0,4,7260160,7280640,7219200,7239680,148480,107520,128000,133120,7885312,1024,7878784,63360,49,9897984,4294966976,8664064
.long 202240,1512960,7877504,8475520,0,0,0,0,0,0,0,0,39,0,0,4,7285760,7224320,7244800,7265280,102400,122880,143360,148480,7885568,1024,7878848,1374080,1073,9923584,4294966976,8664576
.long 0,0,0,0,4,6,4,8454144,1967104,2631168,8569088,73728,0,106496,106496,4,4587520,4597760,4608000,4618240,0,0,0,0,7884800,8616960,7870464,62080,48,9846784,4294966976,0
.long 0,0,0,0,4,6,4,8456192,2049024,3286528,8590592,79872,0,107520,110592,4,4588544,4598784,4609024,4619264,8,0,0,0,7885056,8627712,7870528,1372800,1072,9872384,4294966976,0
.long 0,0,0,0,4,6,4,8458240,2130944,3941888,8612096,86016,0,108544,114688,4,4628480,4638720,4648960,4659200,1024,0,0,0,7885312,8616960,7870592,63360,49,9897984,4294966976,0
.long 0,0,0,0,4,6,4,8460288,2212864,4597248,8633600,92160,0,109568,118784,4,4629504,4639744,4649984,4660224,1032,0,0,0,7885568,8627712,7870656,1374080,1073,9923584,4294966976,0
.long 188160,1498880,7877120,8483328,0,0,0,0,0,0,0,0,36,0,0,4,7536640,7557120,7577600,7598080,117760,138240,158720,102400,7884800,0,7879680,72320,56,9846784,4294966976,8667136
.long 193280,1504000,7877248,8483456,0,0,0,0,0,0,0,0,37,0,0,4,7562240,7582720,7603200,7541760,133120,153600,112640,117760,7885056,0,7879744,1383040,1080,9872384,4294966976,8667648
.long 198400,1509120,7877376,8483584,0,0,0,0,0,0,0,0,38,0,0,4,7587840,7608320,7546880,7567360,148480,107520,128000,133120,7885312,1024,7879808,73600,57,9897984,4294966976,8668160
.long 203520,1514240,7877504,8483712,0,0,0,0,0,0,0,0,39,0,0,4,7613440,7552000,7572480,7592960,102400,122880,143360,148480,7885568,1024,7879872,1384320,1081,9923584,4294966976,8668672
.long 0,0,0,0,4,7,4,8454144,2294784,2631424,8571776,73728,0,106496,106496,4,4915200,4925440,4935680,4945920,0,0,0,0,7884800,8616960,7871488,72320,56,9846784,4294966976,0
.long 0,0,0,0,4,7,4,8456192,2376704,3286784,8593280,79872,0,107520,110592,4,4916224,4926464,4936704,4946944,8,0,0,0,7885056,8627712,7871552,1383040,1080,9872384,4294966976,0
.long 0,0,0,0,4,7,4,8458240,2458624,3942144,8614784,86016,0,108544,114688,4,4956160,4966400,4976640,4986880,1024,0,0,0,7885312,8616960,7871616,73600,57,9897984,4294966976,0
.long 0,0,0,0,4,7,4,8460288,2540544,4597504,8636288,92160,0,109568,118784,4,4957184,4967424,4977664,4987904,1032,0,0,0,7885568,8627712,7871680,1384320,1081,9923584,4294966976,0
.long 5406720,5408768,8388608,8640512,0,0,0,8486912,0,0,0,0,147456,147456,0,5,2632704,2642944,2653184,2622464,5128,0,0,0,7885824,8563200,7864384,1311520,1024,9949184,4294967056,0
.long 5409792,5409280,8392064,8640640,0,0,0,8491008,0,0,0,0,149760,152064,0,5,2672640,2682880,2693120,2662400,6144,0,0,0,7886080,8552448,7864448,2080,1,9974784,4294967056,0
.long 5488640,5490688,8395520,8640768,0,0,0,8495104,0,0,0,0,152064,147456,0,5,2673664,2683904,2694144,2663424,6152,0,0,0,7886336,8563200,7864512,1312800,1025,10000384,4294967056,0
.long 5491712,5491200,8398976,8640896,0,0,0,8499200,0,0,0,0,154368,152064,0,5,2631680,2641920,2652160,2621440,5120,0,0,0,7886592,8552448,7864320,800,0,10025984,4294967056,0
.long 8413184,0,0,0,0,0,0,0,8409088,7881216,409600,9488384,0,0,0,5,5263360,5283840,5304320,5242880,133120,153600,112640,117760,7885824,5120,7872576,1311520,1024,9949184,4294967056,8638464
.long 8413184,0,0,0,0,0,0,0,8410112,7881216,409600,9493504,0,0,0,5,5288960,5309440,5248000,5268480,148480,107520,128000,133120,7886080,6144,7872640,2080,1,9974784,4294967056,8638976
.long 8413184,0,0,0,0,0,0,0,8411136,7881216,409600,9498624,0,0,0,5,5314560,5253120,5273600,5294080,102400,122880,143360,148480,7886336,6144,7872704,1312800,1025,10000384,4294967056,8639488
.long 8413184,0,0,0,0,0,0,0,8412160,7881216,409600,9498624,0,0,0,5,5258240,5278720,5299200,5319680,117760,138240,158720,102400,7886592,5120,7872512,800,0,10025984,4294967056,8640000
.long 5411840,5413888,8402432,8641024,0,0,0,8503296,0,0,0,0,147456,147456,0,5,2960384,2970624,2980864,2950144,5128,0,0,0,7885824,8563200,7865408,1321760,1032,9949184,4294967056,0
.long 5414912,5414400,8405888,8641152,0,0,0,8507392,0,0,0,0,149760,152064,0,5,3000320,3010560,3020800,2990080,6144,0,0,0,7886080,8552448,7865472,12320,9,9974784,4294967056,0
.long 5493760,5495808,8409344,8641280,0,0,0,8511488,0,0,0,0,152064,147456,0,5,3001344,3011584,3021824,2991104,6152,0,0,0,7886336,8563200,7865536,1323040,1033,10000384,4294967056,0
.long 5496832,5496320,8412800,8641408,0,0,0,8515584,0,0,0,0,154368,152064,0,5,2959360,2969600,2979840,2949120,5120,0,0,0,7886592,8552448,7865344,11040,8,10025984,4294967056,0
.long 8418304,0,0,0,0,0,0,0,8414208,7881344,512000,9503744,0,0,0,5,5591040,5611520,5632000,5570560,133120,153600,112640,117760,7885824,5120,7873600,1321760,1032,9949184,4294967056,8642560
.long 8418304,0,0,0,0,0,0,0,8415232,7881344,512000,9508864,0,0,0,5,5616640,5637120,5575680,5596160,148480,107520,128000,133120,7886080,6144,7873664,12320,9,9974784,4294967056,8643072
.long 8418304,0,0,0,0,0,0,0,8416256,7881344,512000,9499136,0,0,0,5,5642240,5580800,5601280,5621760,102400,122880,143360,148480,7886336,6144,7873728,1323040,1033,10000384,4294967056,8643584
.long 8418304,0,0,0,0,0,0,0,8417280,7881344,512000,9499136,0,0,0,5,5585920,5606400,5626880,5647360,117760,138240,158720,102400,7886592,5120,7873536,11040,8,10025984,4294967056,8644096
.long 5416960,5419008,8416256,8641536,0,0,0,8519680,0,0,0,0,147456,147456,0,5,3288064,3298304,3308544,3277824,5128,0,0,0,7885824,8584704,7866432,1332000,1040,9949184,4294967056,0
.long 5420032,5419520,8419712,8641664,0,0,0,8523776,0,0,0,0,149760,152064,0,5,3328000,3338240,3348480,3317760,6144,0,0,0,7886080,8573952,7866496,22560,17,9974784,4294967056,0
.long 5498880,5500928,8423168,8641792,0,0,0,8527872,0,0,0,0,152064,147456,0,5,3329024,3339264,3349504,3318784,6152,0,0,0,7886336,8584704,7866560,1333280,1041,10000384,4294967056,0
.long 5501952,5501440,8426624,8641920,0,0,0,8531968,0,0,0,0,154368,152064,0,5,3287040,3297280,3307520,3276800,5120,0,0,0,7886592,8573952,7866368,21280,16,10025984,4294967056,0
.long 8423424,0,0,0,0,0,0,0,8419328,7881472,614400,9513984,0,0,0,5,5918720,5939200,5959680,5898240,133120,153600,112640,117760,7885824,5120,7874624,1332000,1040,9949184,4294967056,8646656
.long 8423424,0,0,0,0,0,0,0,8420352,7881472,614400,9519104,0,0,0,5,5944320,5964800,5903360,5923840,148480,107520,128000,133120,7886080,6144,7874688,22560,17,9974784,4294967056,8647168
.long 8423424,0,0,0,0,0,0,0,8421376,7881472,614400,9524224,0,0,0,5,5969920,5908480,5928960,5949440,102400,122880,143360,148480,7886336,6144,7874752,1333280,1041,10000384,4294967056,8647680
.long 8423424,0,0,0,0,0,0,0,8422400,7881472,614400,9524224,0,0,0,5,5913600,5934080,5954560,5975040,117760,138240,158720,102400,7886592,5120,7874560,21280,16,10025984,4294967056,8648192
.long 5422080,5424128,8430080,8642048,0,0,0,8536064,0,0,0,0,147456,147456,0,5,3615744,3625984,3636224,3605504,5128,0,0,0,7885824,8584704,7867456,1342240,1048,9949184,4294967056,0
.long 5425152,5424640,8433536,8642176,0,0,0,8540160,0,0,0,0,149760,152064,0,5,3655680,3665920,3676160,3645440,6144,0,0,0,7886080,8573952,7867520,32800,25,9974784,4294967056,0
.long 5504000,5506048,8436992,8642304,0,0,0,8544256,0,0,0,0,152064,147456,0,5,3656704,3666944,3677184,3646464,6152,0,0,0,7886336,8584704,7867584,1343520,1049,10000384,4294967056,0
.long 5507072,5506560,8440448,8642432,0,0,0,8548352,0,0,0,0,154368,152064,0,5,3614720,3624960,3635200,3604480,5120,0,0,0,7886592,8573952,7867392,31520,24,10025984,4294967056,0
.long 8428544,0,0,0,0,0,0,0,8424448,7881600,716800,9529344,0,0,0,5,6246400,6266880,6287360,6225920,133120,153600,112640,117760,7885824,5120,7875648,1342240,1048,9949184,4294967056,8650752
.long 8428544,0,0,0,0,0,0,0,8425472,7881600,716800,9534464,0,0,0,5,6272000,6292480,6231040,6251520,148480,107520,128000,133120,7886080,6144,7875712,32800,25,9974784,4294967056,8651264
.long 8428544,0,0,0,0,0,0,0,8426496,7881600,716800,9524736,0,0,0,5,6297600,6236160,6256640,6277120,102400,122880,143360,148480,7886336,6144,7875776,1343520,1049,10000384,4294967056,8651776
.long 8428544,0,0,0,0,0,0,0,8427520,7881600,716800,9524736,0,0,0,5,6241280,6261760,6282240,6302720,117760,138240,158720,102400,7886592,5120,7875584,31520,24,10025984,4294967056,8652288
.long 6717440,6719488,8388608,8656896,0,0,0,8486912,0,0,0,0,147456,147456,0,5,3943424,3953664,3963904,3933184,5128,0,0,0,7885824,8606208,7868480,1352480,1056,9949184,4294967056,0
.long 6720512,6720000,8392064,8657024,0,0,0,8491008,0,0,0,0,149760,152064,0,5,3983360,3993600,4003840,3973120,6144,0,0,0,7886080,8595456,7868544,43040,33,9974784,4294967056,0
.long 6799360,6801408,8395520,8657152,0,0,0,8495104,0,0,0,0,152064,147456,0,5,3984384,3994624,4004864,3974144,6152,0,0,0,7886336,8606208,7868608,1353760,1057,10000384,4294967056,0
.long 6802432,6801920,8398976,8657280,0,0,0,8499200,0,0,0,0,154368,152064,0,5,3942400,3952640,3962880,3932160,5120,0,0,0,7886592,8595456,7868416,41760,32,10025984,4294967056,0
.long 8577024,0,0,0,0,0,0,0,8572928,7885312,410240,9897984,0,0,0,5,6574080,6594560,6615040,6553600,133120,153600,112640,117760,7885824,5120,7876672,1352480,1056,9949184,4294967056,8654848
.long 8577024,0,0,0,0,0,0,0,8573952,7885312,410240,9903104,0,0,0,5,6599680,6620160,6558720,6579200,148480,107520,128000,133120,7886080,6144,7876736,43040,33,9974784,4294967056,8655360
.long 8577024,0,0,0,0,0,0,0,8574976,7885312,410240,9908224,0,0,0,5,6625280,6563840,6584320,6604800,102400,122880,143360,148480,7886336,6144,7876800,1353760,1057,10000384,4294967056,8655872
.long 8577024,0,0,0,0,0,0,0,8576000,7885312,410240,9908224,0,0,0,5,6568960,6589440,6609920,6630400,117760,138240,158720,102400,7886592,5120,7876608,41760,32,10025984,4294967056,8656384
.long 6722560,6724608,8402432,8657408,0,0,0,8503296,0,0,0,0,147456,147456,0,5,4271104,4281344,4291584,4260864,5128,0,0,0,7885824,8606208,7869504,1362720,1064,9949184,4294967056,0
.long 6725632,6725120,8405888,8657536,0,0,0,8507392,0,0,0,0,149760,152064,0,5,4311040,4321280,4331520,4300800,6144,0,0,0,7886080,8595456,7869568,53280,41,9974784,4294967056,0
.long 6804480,6806528,8409344,8657664,0,0,0,8511488,0,0,0,0,152064,147456,0,5,4312064,4322304,4332544,4301824,6152,0,0,0,7886336,8606208,7869632,1364000,1065,10000384,4294967056,0
.long 6807552,6807040,8412800,8657792,0,0,0,8515584,0,0,0,0,154368,152064,0,5,4270080,4280320,4290560,4259840,5120,0,0,0,7886592,8595456,7869440,52000,40,10025984,4294967056,0
.long 8582144,0,0,0,0,0,0,0,8578048,7885440,512640,9913344,0,0,0,5,6901760,6922240,6942720,6881280,133120,153600,112640,117760,7885824,5120,7877696,1362720,1064,9949184,4294967056,8658944
.long 8582144,0,0,0,0,0,0,0,8579072,7885440,512640,9918464,0,0,0,5,6927360,6947840,6886400,6906880,148480,107520,128000,133120,7886080,6144,7877760,53280,41,9974784,4294967056,8659456
.long 8582144,0,0,0,0,0,0,0,8580096,7885440,512640,9908736,0,0,0,5,6952960,6891520,6912000,6932480,102400,122880,143360,148480,7886336,6144,7877824,1364000,1065,10000384,4294967056,8659968
.long 8582144,0,0,0,0,0,0,0,8581120,7885440,512640,9908736,0,0,0,5,6896640,6917120,6937600,6958080,117760,138240,158720,102400,7886592,5120,7877632,52000,40,10025984,4294967056,8660480
.long 6727680,6729728,8416256,8657920,0,0,0,8519680,0,0,0,0,147456,147456,0,5,4598784,4609024,4619264,4588544,5128,0,0,0,7885824,8627712,7870528,1372960,1072,9949184,4294967056,0
.long 6730752,6730240,8419712,8658048,0,0,0,8523776,0,0,0,0,149760,152064,0,5,4638720,4648960,4659200,4628480,6144,0,0,0,7886080,8616960,7870592,63520,49,9974784,4294967056,0
.long 6809600,6811648,8423168,8658176,0,0,0,8527872,0,0,0,0,152064,147456,0,5,4639744,4649984,4660224,4629504,6152,0,0,0,7886336,8627712,7870656,1374240,1073,10000384,4294967056,0
.long 6812672,6812160,8426624,8658304,0,0,0,8531968,0,0,0,0,154368,152064,0,5,4597760,4608000,4618240,4587520,5120,0,0,0,7886592,8616960,7870464,62240,48,10025984,4294967056,0
.long 8587264,0,0,0,0,0,0,0,8583168,7885568,615040,9923584,0,0,0,5,7229440,7249920,7270400,7208960,133120,153600,112640,117760,7885824,5120,7878720,1372960,1072,9949184,4294967056,8663040
.long 8587264,0,0,0,0,0,0,0,8584192,7885568,615040,9928704,0,0,0,5,7255040,7275520,7214080,7234560,148480,107520,128000,133120,7886080,6144,7878784,63520,49,9974784,4294967056,8663552
.long 8587264,0,0,0,0,0,0,0,8585216,7885568,615040,9933824,0,0,0,5,7280640,7219200,7239680,7260160,102400,122880,143360,148480,7886336,6144,7878848,1374240,1073,10000384,4294967056,8664064
.long 8587264,0,0,0,0,0,0,0,8586240,7885568,615040,9933824,0,0,0,5,7224320,7244800,7265280,7285760,117760,138240,158720,102400,7886592,5120,7878656,62240,48,10025984,4294967056,8664576
.long 6732800,6734848,8430080,8658432,0,0,0,8536064,0,0,0,0,147456,147456,0,5,4926464,4936704,4946944,4916224,5128,0,0,0,7885824,8627712,7871552,1383200,1080,9949184,4294967056,0
.long 6735872,6735360,8433536,8658560,0,0,0,8540160,0,0,0,0,149760,152064,0,5,4966400,4976640,4986880,4956160,6144,0,0,0,7886080,8616960,7871616,73760,57,9974784,4294967056,0
.long 6814720,6816768,8436992,8658688,0,0,0,8544256,0,0,0,0,152064,147456,0,5,4967424,4977664,4987904,4957184,6152,0,0,0,7886336,8627712,7871680,1384480,1081,10000384,4294967056,0
.long 6817792,6817280,8440448,8658816,0,0,0,8548352,0,0,0,0,154368,152064,0,5,4925440,4935680,4945920,4915200,5120,0,0,0,7886592,8616960,7871488,72480,56,10025984,4294967056,0
.long 8592384,0,0,0,0,0,0,0,8588288,7885696,717440,9938944,0,0,0,5,7557120,7577600,7598080,7536640,133120,153600,112640,117760,7885824,5120,7879744,1383200,1080,9949184,4294967056,8667136
.long 8592384,0,0,0,0,0,0,0,8589312,7885696,717440,9944064,0,0,0,5,7582720,7603200,7541760,7562240,148480,107520,128000,133120,7886080,6144,7879808,73760,57,9974784,4294967056,8667648
.long 8592384,0,0,0,0,0,0,0,8590336,7885696,717440,9934336,0,0,0,5,7608320,7546880,7567360,7587840,102400,122880,143360,148480,7886336,6144,7879872,1384480,1081,10000384,4294967056,8668160
.long 8592384,0,0,0,0,0,0,0,8591360,7885696,717440,9934336,0,0,0,5,7552000,7572480,7592960,7613440,117760,138240,158720,102400,7886592,5120,7879680,72480,56,10025984,4294967056,8668672
.long 8388608,106496,106496,8487040,0,0,0,0,0,0,0,0,0,0,0,6,5283840,5304320,5242880,5263360,148480,107520,128000,133120,7886848,11264,7872640,2240,1,10051584,4294967136,8638464
.long 8390336,126976,110592,8489088,0,0,0,0,0,0,0,0,0,0,0,6,5309440,5248000,5268480,5288960,102400,122880,143360,148480,7887104,11264,7872704,1312960,1025,10077184,4294967136,8638976
.long 8392064,108544,126976,8491136,0,0,0,0,0,0,0,0,0,0,0,6,5253120,5273600,5294080,5314560,117760,138240,158720,102400,7887360,10240,7872512,960,0,10102784,4294967136,8639488
.long 8393792,129024,131072,8493184,0,0,0,0,0,0,0,0,0,0,0,6,5278720,5299200,5319680,5258240,133120,153600,112640,117760,7887616,10240,7872576,1311680,1024,10128384,4294967136,8640000
.long 0,0,0,0,3,0,3,8454144,768,2627584,8552832,73728,0,106496,106496,6,2682880,2693120,2662400,2672640,11264,0,0,0,7886848,8552448,7864448,2240,1,10051584,4294967136,0
.long 0,0,0,0,3,0,3,8456192,82688,3282944,8574336,79872,0,107520,110592,6,2683904,2694144,2663424,2673664,11272,0,0,0,7887104,8563200,7864512,1312960,1025,10077184,4294967136,0
.long 0,0,0,0,3,0,3,8458240,164608,3938304,8595840,86016,0,108544,114688,6,2641920,2652160,2621440,2631680,10240,0,0,0,7887360,8552448,7864320,960,0,10102784,4294967136,0
.long 0,0,0,0,3,0,3,8460288,246528,4593664,8617344,92160,0,109568,118784,6,2642944,2653184,2622464,2632704,10248,0,0,0,7887616,8563200,7864384,1311680,1024,10128384,4294967136,0
.long 8402432,106496,106496,8503424,0,0,0,0,0,0,0,0,0,0,0,6,5611520,5632000,5570560,5591040,148480,107520,128000,133120,7886848,11264,7873664,12480,9,10051584,4294967136,8642560
.long 8404160,126976,110592,8505472,0,0,0,0,0,0,0,0,0,0,0,6,5637120,5575680,5596160,5616640,102400,122880,143360,148480,7887104,11264,7873728,1323200,1033,10077184,4294967136,8643072
.long 8405888,108544,126976,8507520,0,0,0,0,0,0,0,0,0,0,0,6,5580800,5601280,5621760,5642240,117760,138240,158720,102400,7887360,10240,7873536,11200,8,10102784,4294967136,8643584
.long 8407616,129024,131072,8509568,0,0,0,0,0,0,0,0,0,0,0,6,5606400,5626880,5647360,5585920,133120,153600,112640,117760,7887616,10240,7873600,1321920,1032,10128384,4294967136,8644096
.long 0,0,0,0,3,1,3,8454144,328448,2627840,8555520,73728,0,106496,106496,6,3010560,3020800,2990080,3000320,11264,0,0,0,7886848,8552448,7865472,12480,9,10051584,4294967136,0
.long 0,0,0,0,3,1,3,8456192,410368,3283200,8577024,79872,0,107520,110592,6,3011584,3021824,2991104,3001344,11272,0,0,0,7887104,8563200,7865536,1323200,1033,10077184,4294967136,0
.long 0,0,0,0,3,1,3,8458240,492288,3938560,8598528,86016,0,108544,114688,6,2969600,2979840,2949120,2959360,10240,0,0,0,7887360,8552448,7865344,11200,8,10102784,4294967136,0
.long 0,0,0,0,3,1,3,8460288,574208,4593920,8620032,92160,0,109568,118784,6,2970624,2980864,2950144,2960384,10248,0,0,0,7887616,8563200,7865408,1321920,1032,10128384,4294967136,0
.long 8416256,106496,106496,8519808,0,0,0,0,0,0,0,0,0,0,0,6,5939200,5959680,5898240,5918720,148480,107520,128000,133120,7886848,11264,7874688,22720,17,10051584,4294967136,8646656
.long 8417984,126976,110592,8521856,0,0,0,0,0,0,0,0,0,0,0,6,5964800,5903360,5923840,5944320,102400,122880,143360,148480,7887104,11264,7874752,1333440,1041,10077184,4294967136,8647168
.long 8419712,108544,126976,8523904,0,0,0,0,0,0,0,0,0,0,0,6,5908480,5928960,5949440,5969920,117760,138240,158720,102400,7887360,10240,7874560,21440,16,10102784,4294967136,8647680
.long 8421440,129024,131072,8525952,0,0,0,0,0,0,0,0,0,0,0,6,5934080,5954560,5975040,5913600,133120,153600,112640,117760,7887616,10240,7874624,1332160,1040,10128384,4294967136,8648192
.long 0,0,0,0,3,2,3,8454144,656128,2628096,8558208,73728,0,106496,106496,6,3338240,3348480,3317760,3328000,11264,0,0,0,7886848,8573952,7866496,22720,17,10051584,4294967136,0
.long 0,0,0,0,3,2,3,8456192,738048,3283456,8579712,79872,0,107520,110592,6,3339264,3349504,3318784,3329024,11272,0,0,0,7887104,8584704,7866560,1333440,1041,10077184,4294967136,0
.long 0,0,0,0,3,2,3,8458240,819968,3938816,8601216,86016,0,108544,114688,6,3297280,3307520,3276800,3287040,10240,0,0,0,7887360,8573952,7866368,21440,16,10102784,4294967136,0
.long 0,0,0,0,3,2,3,8460288,901888,4594176,8622720,92160,0,109568,118784,6,3298304,3308544,3277824,3288064,10248,0,0,0,7887616,8584704,7866432,1332160,1040,10128384,4294967136,0
.long 8430080,106496,106496,8536192,0,0,0,0,0,0,0,0,0,0,0,6,6266880,6287360,6225920,6246400,148480,107520,128000,133120,7886848,11264,7875712,32960,25,10051584,4294967136,8650752
.long 8431808,126976,110592,8538240,0,0,0,0,0,0,0,0,0,0,0,6,6292480,6231040,6251520,6272000,102400,122880,143360,148480,7887104,11264,7875776,1343680,1049,10077184,4294967136,8651264
.long 8433536,108544,126976,8540288,0,0,0,0,0,0,0,0,0,0,0,6,6236160,6256640,6277120,6297600,117760,138240,158720,102400,7887360,10240,7875584,31680,24,10102784,4294967136,8651776
.long 8435264,129024,131072,8542336,0,0,0,0,0,0,0,0,0,0,0,6,6261760,6282240,6302720,6241280,133120,153600,112640,117760,7887616,10240,7875648,1342400,1048,10128384,4294967136,8652288
.long 0,0,0,0,3,3,3,8454144,983808,2628352,8560896,73728,0,106496,106496,6,3665920,3676160,3645440,3655680,11264,0,0,0,7886848,8573952,7867520,32960,25,10051584,4294967136,0
.long 0,0,0,0,3,3,3,8456192,1065728,3283712,8582400,79872,0,107520,110592,6,3666944,3677184,3646464,3656704,11272,0,0,0,7887104,8584704,7867584,1343680,1049,10077184,4294967136,0
.long 0,0,0,0,3,3,3,8458240,1147648,3939072,8603904,86016,0,108544,114688,6,3624960,3635200,3604480,3614720,10240,0,0,0,7887360,8573952,7867392,31680,24,10102784,4294967136,0
.long 0,0,0,0,3,3,3,8460288,1229568,4594432,8625408,92160,0,109568,118784,6,3625984,3636224,3605504,3615744,10248,0,0,0,7887616,8584704,7867456,1342400,1048,10128384,4294967136,0
.long 8388608,106496,106496,8488064,0,0,0,0,0,0,0,0,0,0,0,6,6594560,6615040,6553600,6574080,148480,107520,128000,133120,7886848,11264,7876736,43200,33,10051584,4294967136,8654848
.long 8390336,126976,110592,8490112,0,0,0,0,0,0,0,0,0,0,0,6,6620160,6558720,6579200,6599680,102400,122880,143360,148480,7887104,11264,7876800,1353920,1057,10077184,4294967136,8655360
.long 8392064,108544,126976,8492160,0,0,0,0,0,0,0,0,0,0,0,6,6563840,6584320,6604800,6625280,117760,138240,158720,102400,7887360,10240,7876608,41920,32,10102784,4294967136,8655872
.long 8393792,129024,131072,8494208,0,0,0,0,0,0,0,0,0,0,0,6,6589440,6609920,6630400,6568960,133120,153600,112640,117760,7887616,10240,7876672,1352640,1056,10128384,4294967136,8656384
.long 0,0,0,0,3,4,3,8454144,1311488,2628608,8563584,73728,0,106496,106496,6,3993600,4003840,3973120,3983360,11264,0,0,0,7886848,8595456,7868544,43200,33,10051584,4294967136,0
.long 0,0,0,0,3,4,3,8456192,1393408,3283968,8585088,79872,0,107520,110592,6,3994624,4004864,3974144,3984384,11272,0,0,0,7887104,8606208,7868608,1353920,1057,10077184,4294967136,0
.long 0,0,0,0,3,4,3,8458240,1475328,3939328,8606592,86016,0,108544,114688,6,3952640,3962880,3932160,3942400,10240,0,0,0,7887360,8595456,7868416,41920,32,10102784,4294967136,0
.long 0,0,0,0,3,4,3,8460288,1557248,4594688,8628096,92160,0,109568,118784,6,3953664,3963904,3933184,3943424,10248,0,0,0,7887616,8606208,7868480,1352640,1056,10128384,4294967136,0
.long 8402432,106496,106496,8504448,0,0,0,0,0,0,0,0,0,0,0,6,6922240,6942720,6881280,6901760,148480,107520,128000,133120,7886848,11264,7877760,53440,41,10051584,4294967136,8658944
.long 8404160,126976,110592,8506496,0,0,0,0,0,0,0,0,0,0,0,6,6947840,6886400,6906880,6927360,102400,122880,143360,148480,7887104,11264,7877824,1364160,1065,10077184,4294967136,8659456
.long 8405888,108544,126976,8508544,0,0,0,0,0,0,0,0,0,0,0,6,6891520,6912000,6932480,6952960,117760,138240,158720,102400,7887360,10240,7877632,52160,40,10102784,4294967136,8659968
.long 8407616,129024,131072,8510592,0,0,0,0,0,0,0,0,0,0,0,6,6917120,6937600,6958080,6896640,133120,153600,112640,117760,7887616,10240,7877696,1362880,1064,10128384,4294967136,8660480
.long 0,0,0,0,3,5,3,8454144,1639168,2628864,8566272,73728,0,106496,106496,6,4321280,4331520,4300800,4311040,11264,0,0,0,7886848,8595456,7869568,53440,41,10051584,4294967136,0
.long 0,0,0,0,3,5,3,8456192,1721088,3284224,8587776,79872,0,107520,110592,6,4322304,4332544,4301824,4312064,11272,0,0,0,7887104,8606208,7869632,1364160,1065,10077184,4294967136,0
.long 0,0,0,0,3,5,3,8458240,1803008,3939584,8609280,86016,0,108544,114688,6,4280320,4290560,4259840,4270080,10240,0,0,0,7887360,8595456,7869440,52160,40,10102784,4294967136,0
.long 0,0,0,0,3,5,3,8460288,1884928,4594944,8630784,92160,0,109568,118784,6,4281344,4291584,4260864,4271104,10248,0,0,0,7887616,8606208,7869504,1362880,1064,10128384,4294967136,0
.long 8416256,106496,106496,8520832,0,0,0,0,0,0,0,0,0,0,0,6,7249920,7270400,7208960,7229440,148480,107520,128000,133120,7886848,11264,7878784,63680,49,10051584,4294967136,8663040
.long 8417984,126976,110592,8522880,0,0,0,0,0,0,0,0,0,0,0,6,7275520,7214080,7234560,7255040,102400,122880,143360,148480,7887104,11264,7878848,1374400,1073,10077184,4294967136,8663552
.long 8419712,108544,126976,8524928,0,0,0,0,0,0,0,0,0,0,0,6,7219200,7239680,7260160,7280640,117760,138240,158720,102400,7887360,10240,7878656,62400,48,10102784,4294967136,8664064
.long 8421440,129024,131072,8526976,0,0,0,0,0,0,0,0,0,0,0,6,7244800,7265280,7285760,7224320,133120,153600,112640,117760,7887616,10240,7878720,1373120,1072,10128384,4294967136,8664576
.long 0,0,0,0,3,6,3,8454144,1966848,2629120,8568960,73728,0,106496,106496,6,4648960,4659200,4628480,4638720,11264,0,0,0,7886848,8616960,7870592,63680,49,10051584,4294967136,0
.long 0,0,0,0,3,6,3,8456192,2048768,3284480,8590464,79872,0,107520,110592,6,4649984,4660224,4629504,4639744,11272,0,0,0,7887104,8627712,7870656,1374400,1073,10077184,4294967136,0
.long 0,0,0,0,3,6,3,8458240,2130688,3939840,8611968,86016,0,108544,114688,6,4608000,4618240,4587520,4597760,10240,0,0,0,7887360,8616960,7870464,62400,48,10102784,4294967136,0
.long 0,0,0,0,3,6,3,8460288,2212608,4595200,8633472,92160,0,109568,118784,6,4609024,4619264,4588544,4598784,10248,0,0,0,7887616,8627712,7870528,1373120,1072,10128384,4294967136,0
.long 8430080,106496,106496,8537216,0,0,0,0,0,0,0,0,0,0,0,6,7577600,7598080,7536640,7557120,148480,107520,128000,133120,7886848,11264,7879808,73920,57,10051584,4294967136,8667136
.long 8431808,126976,110592,8539264,0,0,0,0,0,0,0,0,0,0,0,6,7603200,7541760,7562240,7582720,102400,122880,143360,148480,7887104,11264,7879872,1384640,1081,10077184,4294967136,8667648
.long 8433536,108544,126976,8541312,0,0,0,0,0,0,0,0,0,0,0,6,7546880,7567360,7587840,7608320,117760,138240,158720,102400,7887360,10240,7879680,72640,56,10102784,4294967136,8668160
.long 8435264,129024,131072,8543360,0,0,0,0,0,0,0,0,0,0,0,6,7572480,7592960,7613440,7552000,133120,153600,112640,117760,7887616,10240,7879744,1383360,1080,10128384,4294967136,8668672
.long 0,0,0,0,3,7,3,8454144,2294528,2629376,8571648,73728,0,106496,106496,6,4976640,4986880,4956160,4966400,11264,0,0,0,7886848,8616960,7871616,73920,57,10051584,4294967136,0
.long 0,0,0,0,3,7,3,8456192,2376448,3284736,8593152,79872,0,107520,110592,6,4977664,4987904,4957184,4967424,11272,0,0,0,7887104,8627712,7871680,1384640,1081,10077184,4294967136,0
.long 0,0,0,0,3,7,3,8458240,2458368,3940096,8614656,86016,0,108544,114688,6,4935680,4945920,4915200,4925440,10240,0,0,0,7887360,8616960,7871488,72640,56,10102784,4294967136,0
.long 0,0,0,0,3,7,3,8460288,2540288,4595456,8636160,92160,0,109568,118784,6,4936704,4946944,4916224,4926464,10248,0,0,0,7887616,8627712,7871552,1383360,1080,10128384,4294967136,0
.long 8395520,106496,106496,8495232,0,0,0,0,0,0,0,0,0,0,0,7,5304320,5242880,5263360,5283840,102400,122880,143360,148480,7887872,16384,7872704,1313120,1025,10153984,4294967216,8638464
.long 8397248,126976,110592,8497280,0,0,0,0,0,0,0,0,0,0,0,7,5248000,5268480,5288960,5309440,117760,138240,158720,102400,7888128,15360,7872512,1120,0,10179584,4294967216,8638976
.long 8398976,108544,126976,8499328,0,0,0,0,0,0,0,0,0,0,0,7,5273600,5294080,5314560,5253120,133120,153600,112640,117760,7888384,15360,7872576,1311840,1024,10205184,4294967216,8639488
.long 8400704,129024,131072,8501376,0,0,0,0,0,0,0,0,0,0,0,7,5299200,5319680,5258240,5278720,148480,107520,128000,133120,7888640,16384,7872640,2400,1,10230784,4294967216,8640000
.long 0,0,0,0,5,0,5,8462336,1280,2631680,8553088,73728,0,106496,106496,7,2694144,2663424,2673664,2683904,16392,0,0,0,7887872,8563200,7864512,1313120,1025,10153984,4294967216,0
.long 0,0,0,0,5,0,5,8464384,83200,3287040,8574592,79872,0,107520,110592,7,2652160,2621440,2631680,2641920,15360,0,0,0,7888128,8552448,7864320,1120,0,10179584,4294967216,0
.long 0,0,0,0,5,0,5,8466432,165120,3942400,8596096,86016,0,108544,114688,7,2653184,2622464,2632704,2642944,15368,0,0,0,7888384,8563200,7864384,1311840,1024,10205184,4294967216,0
.long 0,0,0,0,5,0,5,8468480,247040,4597760,8617600,92160,0,109568,118784,7,2693120,2662400,2672640,2682880,16384,0,0,0,7888640,8552448,7864448,2400,1,10230784,4294967216,0
.long 8409344,106496,106496,8511616,0,0,0,0,0,0,0,0,0,0,0,7,5632000,5570560,5591040,5611520,102400,122880,143360,148480,7887872,16384,7873728,1323360,1033,10153984,4294967216,8642560
.long 8411072,126976,110592,8513664,0,0,0,0,0,0,0,0,0,0,0,7,5575680,5596160,5616640,5637120,117760,138240,158720,102400,7888128,15360,7873536,11360,8,10179584,4294967216,8643072
.long 8412800,108544,126976,8515712,0,0,0,0,0,0,0,0,0,0,0,7,5601280,5621760,5642240,5580800,133120,153600,112640,117760,7888384,15360,7873600,1322080,1032,10205184,4294967216,8643584
.long 8414528,129024,131072,8517760,0,0,0,0,0,0,0,0,0,0,0,7,5626880,5647360,5585920,5606400,148480,107520,128000,133120,7888640,16384,7873664,12640,9,10230784,4294967216,8644096
.long 0,0,0,0,5,1,5,8462336,328960,2631936,8555776,73728,0,106496,106496,7,3021824,2991104,3001344,3011584,16392,0,0,0,7887872,8563200,7865536,1323360,1033,10153984,4294967216,0
.long 0,0,0,0,5,1,5,8464384,410880,3287296,8577280,79872,0,107520,110592,7,2979840,2949120,2959360,2969600,15360,0,0,0,7888128,8552448,7865344,11360,8,10179584,4294967216,0
.long 0,0,0,0,5,1,5,8466432,492800,3942656,8598784,86016,0,108544,114688,7,2980864,2950144,2960384,2970624,15368,0,0,0,7888384,8563200,7865408,1322080,1032,10205184,4294967216,0
.long 0,0,0,0,5,1,5,8468480,574720,4598016,8620288,92160,0,109568,118784,7,3020800,2990080,3000320,3010560,16384,0,0,0,7888640,8552448,7865472,12640,9,10230784,4294967216,0
.long 8423168,106496,106496,8528000,0,0,0,0,0,0,0,0,0,0,0,7,5959680,5898240,5918720,5939200,102400,122880,143360,148480,7887872,16384,7874752,1333600,1041,10153984,4294967216,8646656
.long 8424896,126976,110592,8530048,0,0,0,0,0,0,0,0,0,0,0,7,5903360,5923840,5944320,5964800,117760,138240,158720,102400,7888128,15360,7874560,21600,16,10179584,4294967216,8647168
.long 8426624,108544,126976,8532096,0,0,0,0,0,0,0,0,0,0,0,7,5928960,5949440,5969920,5908480,133120,153600,112640,117760,7888384,15360,7874624,1332320,1040,10205184,4294967216,8647680
.long 8428352,129024,131072,8534144,0,0,0,0,0,0,0,0,0,0,0,7,5954560,5975040,5913600,5934080,148480,107520,128000,133120,7888640,16384,7874688,22880,17,10230784,4294967216,8648192
.long 0,0,0,0,5,2,5,8462336,656640,2632192,8558464,73728,0,106496,106496,7,3349504,3318784,3329024,3339264,16392,0,0,0,7887872,8584704,7866560,1333600,1041,10153984,4294967216,0
.long 0,0,0,0,5,2,5,8464384,738560,3287552,8579968,79872,0,107520,110592,7,3307520,3276800,3287040,3297280,15360,0,0,0,7888128,8573952,7866368,21600,16,10179584,4294967216,0
.long 0,0,0,0,5,2,5,8466432,820480,3942912,8601472,86016,0,108544,114688,7,3308544,3277824,3288064,3298304,15368,0,0,0,7888384,8584704,7866432,1332320,1040,10205184,4294967216,0
.long 0,0,0,0,5,2,5,8468480,902400,4598272,8622976,92160,0,109568,118784,7,3348480,3317760,3328000,3338240,16384,0,0,0,7888640,8573952,7866496,22880,17,10230784,4294967216,0
.long 8436992,106496,106496,8544384,0,0,0,0,0,0,0,0,0,0,0,7,6287360,6225920,6246400,6266880,102400,122880,143360,148480,7887872,16384,7875776,1343840,1049,10153984,4294967216,8650752
.long 8438720,126976,110592,8546432,0,0,0,0,0,0,0,0,0,0,0,7,6231040,6251520,6272000,6292480,117760,138240,158720,102400,7888128,15360,7875584,31840,24,10179584,4294967216,8651264
.long 8440448,108544,126976,8548480,0,0,0,0,0,0,0,0,0,0,0,7,6256640,6277120,6297600,6236160,133120,153600,112640,117760,7888384,15360,7875648,1342560,1048,10205184,4294967216,8651776
.long 8442176,129024,131072,8550528,0,0,0,0,0,0,0,0,0,0,0,7,6282240,6302720,6241280,6261760,148480,107520,128000,133120,7888640,16384,7875712,33120,25,10230784,4294967216,8652288
.long 0,0,0,0,5,3,5,8462336,984320,2632448,8561152,73728,0,106496,106496,7,3677184,3646464,3656704,3666944,16392,0,0,0,7887872,8584704,7867584,1343840,1049,10153984,4294967216,0
.long 0,0,0,0,5,3,5,8464384,1066240,3287808,8582656,79872,0,107520,110592,7,3635200,3604480,3614720,3624960,15360,0,0,0,7888128,8573952,7867392,31840,24,10179584,4294967216,0
.long 0,0,0,0,5,3,5,8466432,1148160,3943168,8604160,86016,0,108544,114688,7,3636224,3605504,3615744,3625984,15368,0,0,0,7888384,8584704,7867456,1342560,1048,10205184,4294967216,0
.long 0,0,0,0,5,3,5,8468480,1230080,4598528,8625664,92160,0,109568,118784,7,3676160,3645440,3655680,3665920,16384,0,0,0,7888640,8573952,7867520,33120,25,10230784,4294967216,0
.long 8395520,106496,106496,8496256,0,0,0,0,0,0,0,0,0,0,0,7,6615040,6553600,6574080,6594560,102400,122880,143360,148480,7887872,16384,7876800,1354080,1057,10153984,4294967216,8654848
.long 8397248,126976,110592,8498304,0,0,0,0,0,0,0,0,0,0,0,7,6558720,6579200,6599680,6620160,117760,138240,158720,102400,7888128,15360,7876608,42080,32,10179584,4294967216,8655360
.long 8398976,108544,126976,8500352,0,0,0,0,0,0,0,0,0,0,0,7,6584320,6604800,6625280,6563840,133120,153600,112640,117760,7888384,15360,7876672,1352800,1056,10205184,4294967216,8655872
.long 8400704,129024,131072,8502400,0,0,0,0,0,0,0,0,0,0,0,7,6609920,6630400,6568960,6589440,148480,107520,128000,133120,7888640,16384,7876736,43360,33,10230784,4294967216,8656384
.long 0,0,0,0,5,4,5,8462336,1312000,2632704,8563840,73728,0,106496,106496,7,4004864,3974144,3984384,3994624,16392,0,0,0,7887872,8606208,7868608,1354080,1057,10153984,4294967216,0
.long 0,0,0,0,5,4,5,8464384,1393920,3288064,8585344,79872,0,107520,110592,7,3962880,3932160,3942400,3952640,15360,0,0,0,7888128,8595456,7868416,42080,32,10179584,4294967216,0
.long 0,0,0,0,5,4,5,8466432,1475840,3943424,8606848,86016,0,108544,114688,7,3963904,3933184,3943424,3953664,15368,0,0,0,7888384,8606208,7868480,1352800,1056,10205184,4294967216,0
.long 0,0,0,0,5,4,5,8468480,1557760,4598784,8628352,92160,0,109568,118784,7,4003840,3973120,3983360,3993600,16384,0,0,0,7888640,8595456,7868544,43360,33,10230784,4294967216,0
.long 8409344,106496,106496,8512640,0,0,0,0,0,0,0,0,0,0,0,7,6942720,6881280,6901760,6922240,102400,122880,143360,148480,7887872,16384,7877824,1364320,1065,10153984,4294967216,8658944
.long 8411072,126976,110592,8514688,0,0,0,0,0,0,0,0,0,0,0,7,6886400,6906880,6927360,6947840,117760,138240,158720,102400,7888128,15360,7877632,52320,40,10179584,4294967216,8659456
.long 8412800,108544,126976,8516736,0,0,0,0,0,0,0,0,0,0,0,7,6912000,6932480,6952960,6891520,133120,153600,112640,117760,7888384,15360,7877696,1363040,1064,10205184,4294967216,8659968
.long 8414528,129024,131072,8518784,0,0,0,0,0,0,0,0,0,0,0,7,6937600,6958080,6896640,6917120,148480,107520,128000,133120,7888640,16384,7877760,53600,41,10230784,4294967216,8660480
.long 0,0,0,0,5,5,5,8462336,1639680,2632960,8566528,73728,0,106496,106496,7,4332544,4301824,4312064,4322304,16392,0,0,0,7887872,8606208,7869632,1364320,1065,10153984,4294967216,0
.long 0,0,0,0,5,5,5,8464384,1721600,3288320,8588032,79872,0,107520,110592,7,4290560,4259840,4270080,4280320,15360,0,0,0,7888128,8595456,7869440,52320,40,10179584,4294967216,0
.long 0,0,0,0,5,5,5,8466432,1803520,3943680,8609536,86016,0,108544,114688,7,4291584,4260864,4271104,4281344,15368,0,0,0,7888384,8606208,7869504,1363040,1064,10205184,4294967216,0
.long 0,0,0,0,5,5,5,8468480,1885440,4599040,8631040,92160,0,109568,118784,7,4331520,4300800,4311040,4321280,16384,0,0,0,7888640,8595456,7869568,53600,41,10230784,4294967216,0
.long 8423168,106496,106496,8529024,0,0,0,0,0,0,0,0,0,0,0,7,7270400,7208960,7229440,7249920,102400,122880,143360,148480,7887872,16384,7878848,1374560,1073,10153984,4294967216,8663040
.long 8424896,126976,110592,8531072,0,0,0,0,0,0,0,0,0,0,0,7,7214080,7234560,7255040,7275520,117760,138240,158720,102400,7888128,15360,7878656,62560,48,10179584,4294967216,8663552
.long 8426624,108544,126976,8533120,0,0,0,0,0,0,0,0,0,0,0,7,7239680,7260160,7280640,7219200,133120,153600,112640,117760,7888384,15360,7878720,1373280,1072,10205184,4294967216,8664064
.long 8428352,129024,131072,8535168,0,0,0,0,0,0,0,0,0,0,0,7,7265280,7285760,7224320,7244800,148480,107520,128000,133120,7888640,16384,7878784,63840,49,10230784,4294967216,8664576
.long 0,0,0,0,5,6,5,8462336,1967360,2633216,8569216,73728,0,106496,106496,7,4660224,4629504,4639744,4649984,16392,0,0,0,7887872,8627712,7870656,1374560,1073,10153984,4294967216,0
.long 0,0,0,0,5,6,5,8464384,2049280,3288576,8590720,79872,0,107520,110592,7,4618240,4587520,4597760,4608000,15360,0,0,0,7888128,8616960,7870464,62560,48,10179584,4294967216,0
.long 0,0,0,0,5,6,5,8466432,2131200,3943936,8612224,86016,0,108544,114688,7,4619264,4588544,4598784,4609024,15368,0,0,0,7888384,8627712,7870528,1373280,1072,10205184,4294967216,0
.long 0,0,0,0,5,6,5,8468480,2213120,4599296,8633728,92160,0,109568,118784,7,4659200,4628480,4638720,4648960,16384,0,0,0,7888640,8616960,7870592,63840,49,10230784,4294967216,0
.long 8436992,106496,106496,8545408,0,0,0,0,0,0,0,0,0,0,0,7,7598080,7536640,7557120,7577600,102400,122880,143360,148480,7887872,16384,7879872,1384800,1081,10153984,4294967216,8667136
.long 8438720,126976,110592,8547456,0,0,0,0,0,0,0,0,0,0,0,7,7541760,7562240,7582720,7603200,117760,138240,158720,102400,7888128,15360,7879680,72800,56,10179584,4294967216,8667648
.long 8440448,108544,126976,8549504,0,0,0,0,0,0,0,0,0,0,0,7,7567360,7587840,7608320,7546880,133120,153600,112640,117760,7888384,15360,7879744,1383520,1080,10205184,4294967216,8668160
.long 8442176,129024,131072,8551552,0,0,0,0,0,0,0,0,0,0,0,7,7592960,7613440,7552000,7572480,148480,107520,128000,133120,7888640,16384,7879808,74080,57,10230784,4294967216,8668672
.long 0,0,0,0,5,7,5,8462336,2295040,2633472,8571904,73728,0,106496,106496,7,4987904,4957184,4967424,4977664,16392,0,0,0,7887872,8627712,7871680,1384800,1081,10153984,4294967216,0
.long 0,0,0,0,5,7,5,8464384,2376960,3288832,8593408,79872,0,107520,110592,7,4945920,4915200,4925440,4935680,15360,0,0,0,7888128,8616960,7871488,72800,56,10179584,4294967216,0
.long 0,0,0,0,5,7,5,8466432,2458880,3944192,8614912,86016,0,108544,114688,7,4946944,4916224,4926464,4936704,15368,0,0,0,7888384,8627712,7871552,1383520,1080,10205184,4294967216,0
.long 0,0,0,0,5,7,5,8468480,2540800,4599552,8636416,92160,0,109568,118784,7,4986880,4956160,4966400,4976640,16384,0,0,0,7888640,8616960,7871616,74080,57,10230784,4294967216,0
.long 40960,1351680,7873536,8455168,0,0,0,0,0,0,0,0,8,0,0,0,5324800,5345280,5365760,5386240,117760,138240,158720,102400,7880704,0,7872768,2560,2,9437184,0,8638720
.long 46080,1356800,7873664,8455296,0,0,0,0,0,0,0,0,9,0,0,0,5350400,5370880,5391360,5329920,133120,153600,112640,117760,7880960,0,7872832,1313280,1026,9462784,0,8639232
.long 51200,1361920,7873792,8455424,0,0,0,0,0,0,0,0,10,0,0,0,5376000,5396480,5335040,5355520,148480,107520,128000,133120,7881216,1024,7872896,3840,3,9488384,0,8639744
.long 56320,1367040,7873920,8455552,0,0,0,0,0,0,0,0,11,0,0,0,5401600,5340160,5360640,5381120,102400,122880,143360,148480,7881472,1024,7872960,1314560,1027,9513984,0,8640256
.long 0,0,0,0,7,0,7,8462336,1792,2635776,8553344,73728,0,106496,106496,0,2703360,2713600,2723840,2734080,0,0,0,0,7880704,8552448,7864576,2560,2,9437184,0,0
.long 0,0,0,0,7,0,7,8464384,83712,3291136,8574848,79872,0,107520,110592,0,2704384,2714624,2724864,2735104,8,0,0,0,7880960,8563200,7864640,1313280,1026,9462784,0,0
.long 0,0,0,0,7,0,7,8466432,165632,3946496,8596352,86016,0,108544,114688,0,2744320,2754560,2764800,2775040,1024,0,0,0,7881216,8552448,7864704,3840,3,9488384,0,0
.long 0,0,0,0,7,0,7,8468480,247552,4601856,8617856,92160,0,109568,118784,0,2745344,2755584,2765824,2776064,1032,0,0,0,7881472,8563200,7864768,1314560,1027,9513984,0,0
.long 42240,1352960,7873536,8463360,0,0,0,0,0,0,0,0,8,0,0,0,5652480,5672960,5693440,5713920,117760,138240,158720,102400,7880704,0,7873792,12800,10,9437184,0,8642816
.long 47360,1358080,7873664,8463488,0,0,0,0,0,0,0,0,9,0,0,0,5678080,5698560,5719040,5657600,133120,153600,112640,117760,7880960,0,7873856,1323520,1034,9462784,0,8643328
.long 52480,1363200,7873792,8463616,0,0,0,0,0,0,0,0,10,0,0,0,5703680,5724160,5662720,5683200,148480,107520,128000,133120,7881216,1024,7873920,14080,11,9488384,0,8643840
.long 57600,1368320,7873920,8463744,0,0,0,0,0,0,0,0,11,0,0,0,5729280,5667840,5688320,5708800,102400,122880,143360,148480,7881472,1024,7873984,1324800,1035,9513984,0,8644352
.long 0,0,0,0,7,1,7,8462336,329472,2636032,8556032,73728,0,106496,106496,0,3031040,3041280,3051520,3061760,0,0,0,0,7880704,8552448,7865600,12800,10,9437184,0,0
.long 0,0,0,0,7,1,7,8464384,411392,3291392,8577536,79872,0,107520,110592,0,3032064,3042304,3052544,3062784,8,0,0,0,7880960,8563200,7865664,1323520,1034,9462784,0,0
.long 0,0,0,0,7,1,7,8466432,493312,3946752,8599040,86016,0,108544,114688,0,3072000,3082240,3092480,3102720,1024,0,0,0,7881216,8552448,7865728,14080,11,9488384,0,0
.long 0,0,0,0,7,1,7,8468480,575232,4602112,8620544,92160,0,109568,118784,0,3073024,3083264,3093504,3103744,1032,0,0,0,7881472,8563200,7865792,1324800,1035,9513984,0,0
.long 43520,1354240,7873536,8471552,0,0,0,0,0,0,0,0,8,0,0,0,5980160,6000640,6021120,6041600,117760,138240,158720,102400,7880704,0,7874816,23040,18,9437184,0,8646912
.long 48640,1359360,7873664,8471680,0,0,0,0,0,0,0,0,9,0,0,0,6005760,6026240,6046720,5985280,133120,153600,112640,117760,7880960,0,7874880,1333760,1042,9462784,0,8647424
.long 53760,1364480,7873792,8471808,0,0,0,0,0,0,0,0,10,0,0,0,6031360,6051840,5990400,6010880,148480,107520,128000,133120,7881216,1024,7874944,24320,19,9488384,0,8647936
.long 58880,1369600,7873920,8471936,0,0,0,0,0,0,0,0,11,0,0,0,6056960,5995520,6016000,6036480,102400,122880,143360,148480,7881472,1024,7875008,1335040,1043,9513984,0,8648448
.long 0,0,0,0,7,2,7,8462336,657152,2636288,8558720,73728,0,106496,106496,0,3358720,3368960,3379200,3389440,0,0,0,0,7880704,8573952,7866624,23040,18,9437184,0,0
.long 0,0,0,0,7,2,7,8464384,739072,3291648,8580224,79872,0,107520,110592,0,3359744,3369984,3380224,3390464,8,0,0,0,7880960,8584704,7866688,1333760,1042,9462784,0,0
.long 0,0,0,0,7,2,7,8466432,820992,3947008,8601728,86016,0,108544,114688,0,3399680,3409920,3420160,3430400,1024,0,0,0,7881216,8573952,7866752,24320,19,9488384,0,0
.long 0,0,0,0,7,2,7,8468480,902912,4602368,8623232,92160,0,109568,118784,0,3400704,3410944,3421184,3431424,1032,0,0,0,7881472,8584704,7866816,1335040,1043,9513984,0,0
.long 44800,1355520,7873536,8479744,0,0,0,0,0,0,0,0,8,0,0,0,6307840,6328320,6348800,6369280,117760,138240,158720,102400,7880704,0,7875840,33280,26,9437184,0,8651008
.long 49920,1360640,7873664,8479872,0,0,0,0,0,0,0,0,9,0,0,0,6333440,6353920,6374400,6312960,133120,153600,112640,117760,7880960,0,7875904,1344000,1050,9462784,0,8651520
.long 55040,1365760,7873792,8480000,0,0,0,0,0,0,0,0,10,0,0,0,6359040,6379520,6318080,6338560,148480,107520,128000,133120,7881216,1024,7875968,34560,27,9488384,0,8652032
.long 60160,1370880,7873920,8480128,0,0,0,0,0,0,0,0,11,0,0,0,6384640,6323200,6343680,6364160,102400,122880,143360,148480,7881472,1024,7876032,1345280,1051,9513984,0,8652544
.long 0,0,0,0,7,3,7,8462336,984832,2636544,8561408,73728,0,106496,106496,0,3686400,3696640,3706880,3717120,0,0,0,0,7880704,8573952,7867648,33280,26,9437184,0,0
.long 0,0,0,0,7,3,7,8464384,1066752,3291904,8582912,79872,0,107520,110592,0,3687424,3697664,3707904,3718144,8,0,0,0,7880960,8584704,7867712,1344000,1050,9462784,0,0
.long 0,0,0,0,7,3,7,8466432,1148672,3947264,8604416,86016,0,108544,114688,0,3727360,3737600,3747840,3758080,1024,0,0,0,7881216,8573952,7867776,34560,27,9488384,0,0
.long 0,0,0,0,7,3,7,8468480,1230592,4602624,8625920,92160,0,109568,118784,0,3728384,3738624,3748864,3759104,1032,0,0,0,7881472,8584704,7867840,1345280,1051,9513984,0,0
.long 204800,1515520,7877632,8459264,0,0,0,0,0,0,0,0,40,0,0,0,6635520,6656000,6676480,6696960,117760,138240,158720,102400,7880704,0,7876864,43520,34,9437184,0,8655104
.long 209920,1520640,7877760,8459392,0,0,0,0,0,0,0,0,41,0,0,0,6661120,6681600,6702080,6640640,133120,153600,112640,117760,7880960,0,7876928,1354240,1058,9462784,0,8655616
.long 215040,1525760,7877888,8459520,0,0,0,0,0,0,0,0,42,0,0,0,6686720,6707200,6645760,6666240,148480,107520,128000,133120,7881216,1024,7876992,44800,35,9488384,0,8656128
.long 220160,1530880,7878016,8459648,0,0,0,0,0,0,0,0,43,0,0,0,6712320,6650880,6671360,6691840,102400,122880,143360,148480,7881472,1024,7877056,1355520,1059,9513984,0,8656640
.long 0,0,0,0,7,4,7,8462336,1312512,2636800,8564096,73728,0,106496,106496,0,4014080,4024320,4034560,4044800,0,0,0,0,7880704,8595456,7868672,43520,34,9437184,0,0
.long 0,0,0,0,7,4,7,8464384,1394432,3292160,8585600,79872,0,107520,110592,0,4015104,4025344,4035584,4045824,8,0,0,0,7880960,8606208,7868736,1354240,1058,9462784,0,0
.long 0,0,0,0,7,4,7,8466432,1476352,3947520,8607104,86016,0,108544,114688,0,4055040,4065280,4075520,4085760,1024,0,0,0,7881216,8595456,7868800,44800,35,9488384,0,0
.long 0,0,0,0,7,4,7,8468480,1558272,4602880,8628608,92160,0,109568,118784,0,4056064,4066304,4076544,4086784,1032,0,0,0,7881472,8606208,7868864,1355520,1059,9513984,0,0
.long 206080,1516800,7877632,8467456,0,0,0,0,0,0,0,0,40,0,0,0,6963200,6983680,7004160,7024640,117760,138240,158720,102400,7880704,0,7877888,53760,42,9437184,0,8659200
.long 211200,1521920,7877760,8467584,0,0,0,0,0,0,0,0,41,0,0,0,6988800,7009280,7029760,6968320,133120,153600,112640,117760,7880960,0,7877952,1364480,1066,9462784,0,8659712
.long 216320,1527040,7877888,8467712,0,0,0,0,0,0,0,0,42,0,0,0,7014400,7034880,6973440,6993920,148480,107520,128000,133120,7881216,1024,7878016,55040,43,9488384,0,8660224
.long 221440,1532160,7878016,8467840,0,0,0,0,0,0,0,0,43,0,0,0,7040000,6978560,6999040,7019520,102400,122880,143360,148480,7881472,1024,7878080,1365760,1067,9513984,0,8660736
.long 0,0,0,0,7,5,7,8462336,1640192,2637056,8566784,73728,0,106496,106496,0,4341760,4352000,4362240,4372480,0,0,0,0,7880704,8595456,7869696,53760,42,9437184,0,0
.long 0,0,0,0,7,5,7,8464384,1722112,3292416,8588288,79872,0,107520,110592,0,4342784,4353024,4363264,4373504,8,0,0,0,7880960,8606208,7869760,1364480,1066,9462784,0,0
.long 0,0,0,0,7,5,7,8466432,1804032,3947776,8609792,86016,0,108544,114688,0,4382720,4392960,4403200,4413440,1024,0,0,0,7881216,8595456,7869824,55040,43,9488384,0,0
.long 0,0,0,0,7,5,7,8468480,1885952,4603136,8631296,92160,0,109568,118784,0,4383744,4393984,4404224,4414464,1032,0,0,0,7881472,8606208,7869888,1365760,1067,9513984,0,0
.long 207360,1518080,7877632,8475648,0,0,0,0,0,0,0,0,40,0,0,0,7290880,7311360,7331840,7352320,117760,138240,158720,102400,7880704,0,7878912,64000,50,9437184,0,8663296
.long 212480,1523200,7877760,8475776,0,0,0,0,0,0,0,0,41,0,0,0,7316480,7336960,7357440,7296000,133120,153600,112640,117760,7880960,0,7878976,1374720,1074,9462784,0,8663808
.long 217600,1528320,7877888,8475904,0,0,0,0,0,0,0,0,42,0,0,0,7342080,7362560,7301120,7321600,148480,107520,128000,133120,7881216,1024,7879040,65280,51,9488384,0,8664320
.long 222720,1533440,7878016,8476032,0,0,0,0,0,0,0,0,43,0,0,0,7367680,7306240,7326720,7347200,102400,122880,143360,148480,7881472,1024,7879104,1376000,1075,9513984,0,8664832
.long 0,0,0,0,7,6,7,8462336,1967872,2637312,8569472,73728,0,106496,106496,0,4669440,4679680,4689920,4700160,0,0,0,0,7880704,8616960,7870720,64000,50,9437184,0,0
.long 0,0,0,0,7,6,7,8464384,2049792,3292672,8590976,79872,0,107520,110592,0,4670464,4680704,4690944,4701184,8,0,0,0,7880960,8627712,7870784,1374720,1074,9462784,0,0
.long 0,0,0,0,7,6,7,8466432,2131712,3948032,8612480,86016,0,108544,114688,0,4710400,4720640,4730880,4741120,1024,0,0,0,7881216,8616960,7870848,65280,51,9488384,0,0
.long 0,0,0,0,7,6,7,8468480,2213632,4603392,8633984,92160,0,109568,118784,0,4711424,4721664,4731904,4742144,1032,0,0,0,7881472,8627712,7870912,1376000,1075,9513984,0,0
.long 208640,1519360,7877632,8483840,0,0,0,0,0,0,0,0,40,0,0,0,7618560,7639040,7659520,7680000,117760,138240,158720,102400,7880704,0,7879936,74240,58,9437184,0,8667392
.long 213760,1524480,7877760,8483968,0,0,0,0,0,0,0,0,41,0,0,0,7644160,7664640,7685120,7623680,133120,153600,112640,117760,7880960,0,7880000,1384960,1082,9462784,0,8667904
.long 218880,1529600,7877888,8484096,0,0,0,0,0,0,0,0,42,0,0,0,7669760,7690240,7628800,7649280,148480,107520,128000,133120,7881216,1024,7880064,75520,59,9488384,0,8668416
.long 224000,1534720,7878016,8484224,0,0,0,0,0,0,0,0,43,0,0,0,7695360,7633920,7654400,7674880,102400,122880,143360,148480,7881472,1024,7880128,1386240,1083,9513984,0,8668928
.long 0,0,0,0,7,7,7,8462336,2295552,2637568,8572160,73728,0,106496,106496,0,4997120,5007360,5017600,5027840,0,0,0,0,7880704,8616960,7871744,74240,58,9437184,0,0
.long 0,0,0,0,7,7,7,8464384,2377472,3292928,8593664,79872,0,107520,110592,0,4998144,5008384,5018624,5028864,8,0,0,0,7880960,8627712,7871808,1384960,1082,9462784,0,0
.long 0,0,0,0,7,7,7,8466432,2459392,3948288,8615168,86016,0,108544,114688,0,5038080,5048320,5058560,5068800,1024,0,0,0,7881216,8616960,7871872,75520,59,9488384,0,0
.long 0,0,0,0,7,7,7,8468480,2541312,4603648,8636672,92160,0,109568,118784,0,5039104,5049344,5059584,5069824,1032,0,0,0,7881472,8627712,7871936,1386240,1083,9513984,0,0
.long 5570560,5572608,8388608,8642560,0,0,0,8486912,0,0,0,0,147456,147456,0,1,2714624,2724864,2735104,2704384,5128,0,0,0,7881728,8563200,7864640,1313440,1026,9539584,80,0
.long 5573632,5573120,8392064,8642688,0,0,0,8491008,0,0,0,0,149760,152064,0,1,2754560,2764800,2775040,2744320,6144,0,0,0,7881984,8552448,7864704,4000,3,9565184,80,0
.long 5652480,5654528,8395520,8642816,0,0,0,8495104,0,0,0,0,152064,147456,0,1,2755584,2765824,2776064,2745344,6152,0,0,0,7882240,8563200,7864768,1314720,1027,9590784,80,0
.long 5655552,5655040,8398976,8642944,0,0,0,8499200,0,0,0,0,154368,152064,0,1,2713600,2723840,2734080,2703360,5120,0,0,0,7882496,8552448,7864576,2720,2,9616384,80,0
.long 8433664,0,0,0,0,0,0,0,8429568,7881728,160,9539584,0,0,0,1,5345280,5365760,5386240,5324800,133120,153600,112640,117760,7881728,5120,7872832,1313440,1026,9539584,80,8638720
.long 8433664,0,0,0,0,0,0,0,8430592,7881728,160,9544704,0,0,0,1,5370880,5391360,5329920,5350400,148480,107520,128000,133120,7881984,6144,7872896,4000,3,9565184,80,8639232
.long 8433664,0,0,0,0,0,0,0,8431616,7881728,160,9549824,0,0,0,1,5396480,5335040,5355520,5376000,102400,122880,143360,148480,7882240,6144,7872960,1314720,1027,9590784,80,8639744
.long 8433664,0,0,0,0,0,0,0,8432640,7881728,160,9549824,0,0,0,1,5340160,5360640,5381120,5401600,117760,138240,158720,102400,7882496,5120,7872768,2720,2,9616384,80,8640256
.long 5575680,5577728,8402432,8643072,0,0,0,8503296,0,0,0,0,147456,147456,0,1,3042304,3052544,3062784,3032064,5128,0,0,0,7881728,8563200,7865664,1323680,1034,9539584,80,0
.long 5578752,5578240,8405888,8643200,0,0,0,8507392,0,0,0,0,149760,152064,0,1,3082240,3092480,3102720,3072000,6144,0,0,0,7881984,8552448,7865728,14240,11,9565184,80,0
.long 5657600,5659648,8409344,8643328,0,0,0,8511488,0,0,0,0,152064,147456,0,1,3083264,3093504,3103744,3073024,6152,0,0,0,7882240,8563200,7865792,1324960,1035,9590784,80,0
.long 5660672,5660160,8412800,8643456,0,0,0,8515584,0,0,0,0,154368,152064,0,1,3041280,3051520,3061760,3031040,5120,0,0,0,7882496,8552448,7865600,12960,10,9616384,80,0
.long 8438784,0,0,0,0,0,0,0,8434688,7881856,102560,9554944,0,0,0,1,5672960,5693440,5713920,5652480,133120,153600,112640,117760,7881728,5120,7873856,1323680,1034,9539584,80,8642816
.long 8438784,0,0,0,0,0,0,0,8435712,7881856,102560,9560064,0,0,0,1,5698560,5719040,5657600,5678080,148480,107520,128000,133120,7881984,6144,7873920,14240,11,9565184,80,8643328
.long 8438784,0,0,0,0,0,0,0,8436736,7881856,102560,9550336,0,0,0,1,5724160,5662720,5683200,5703680,102400,122880,143360,148480,7882240,6144,7873984,1324960,1035,9590784,80,8643840
.long 8438784,0,0,0,0,0,0,0,8437760,7881856,102560,9550336,0,0,0,1,5667840,5688320,5708800,5729280,117760,138240,158720,102400,7882496,5120,7873792,12960,10,9616384,80,8644352
.long 5580800,5582848,8416256,8643584,0,0,0,8519680,0,0,0,0,147456,147456,0,1,3369984,3380224,3390464,3359744,5128,0,0,0,7881728,8584704,7866688,1333920,1042,9539584,80,0
.long 5583872,5583360,8419712,8643712,0,0,0,8523776,0,0,0,0,149760,152064,0,1,3409920,3420160,3430400,3399680,6144,0,0,0,7881984,8573952,7866752,24480,19,9565184,80,0
.long 5662720,5664768,8423168,8643840,0,0,0,8527872,0,0,0,0,152064,147456,0,1,3410944,3421184,3431424,3400704,6152,0,0,0,7882240,8584704,7866816,1335200,1043,9590784,80,0
.long 5665792,5665280,8426624,8643968,0,0,0,8531968,0,0,0,0,154368,152064,0,1,3368960,3379200,3389440,3358720,5120,0,0,0,7882496,8573952,7866624,23200,18,9616384,80,0
.long 8443904,0,0,0,0,0,0,0,8439808,7881984,204960,9565184,0,0,0,1,6000640,6021120,6041600,5980160,133120,153600,112640,117760,7881728,5120,7874880,1333920,1042,9539584,80,8646912
.long 8443904,0,0,0,0,0,0,0,8440832,7881984,204960,9570304,0,0,0,1,6026240,6046720,5985280,6005760,148480,107520,128000,133120,7881984,6144,7874944,24480,19,9565184,80,8647424
.long 8443904,0,0,0,0,0,0,0,8441856,7881984,204960,9575424,0,0,0,1,6051840,5990400,6010880,6031360,102400,122880,143360,148480,7882240,6144,7875008,1335200,1043,9590784,80,8647936
.long 8443904,0,0,0,0,0,0,0,8442880,7881984,204960,9575424,0,0,0,1,5995520,6016000,6036480,6056960,117760,138240,158720,102400,7882496,5120,7874816,23200,18,9616384,80,8648448
.long 5585920,5587968,8430080,8644096,0,0,0,8536064,0,0,0,0,147456,147456,0,1,3697664,3707904,3718144,3687424,5128,0,0,0,7881728,8584704,7867712,1344160,1050,9539584,80,0
.long 5588992,5588480,8433536,8644224,0,0,0,8540160,0,0,0,0,149760,152064,0,1,3737600,3747840,3758080,3727360,6144,0,0,0,7881984,8573952,7867776,34720,27,9565184,80,0
.long 5667840,5669888,8436992,8644352,0,0,0,8544256,0,0,0,0,152064,147456,0,1,3738624,3748864,3759104,3728384,6152,0,0,0,7882240,8584704,7867840,1345440,1051,9590784,80,0
.long 5670912,5670400,8440448,8644480,0,0,0,8548352,0,0,0,0,154368,152064,0,1,3696640,3706880,3717120,3686400,5120,0,0,0,7882496,8573952,7867648,33440,26,9616384,80,0
.long 8449024,0,0,0,0,0,0,0,8444928,7882112,307360,9580544,0,0,0,1,6328320,6348800,6369280,6307840,133120,153600,112640,117760,7881728,5120,7875904,1344160,1050,9539584,80,8651008
.long 8449024,0,0,0,0,0,0,0,8445952,7882112,307360,9585664,0,0,0,1,6353920,6374400,6312960,6333440,148480,107520,128000,133120,7881984,6144,7875968,34720,27,9565184,80,8651520
.long 8449024,0,0,0,0,0,0,0,8446976,7882112,307360,9575936,0,0,0,1,6379520,6318080,6338560,6359040,102400,122880,143360,148480,7882240,6144,7876032,1345440,1051,9590784,80,8652032
.long 8449024,0,0,0,0,0,0,0,8448000,7882112,307360,9575936,0,0,0,1,6323200,6343680,6364160,6384640,117760,138240,158720,102400,7882496,5120,7875840,33440,26,9616384,80,8652544
.long 6881280,6883328,8388608,8658944,0,0,0,8486912,0,0,0,0,147456,147456,0,1,4025344,4035584,4045824,4015104,5128,0,0,0,7881728,8606208,7868736,1354400,1058,9539584,80,0
.long 6884352,6883840,8392064,8659072,0,0,0,8491008,0,0,0,0,149760,152064,0,1,4065280,4075520,4085760,4055040,6144,0,0,0,7881984,8595456,7868800,44960,35,9565184,80,0
.long 6963200,6965248,8395520,8659200,0,0,0,8495104,0,0,0,0,152064,147456,0,1,4066304,4076544,4086784,4056064,6152,0,0,0,7882240,8606208,7868864,1355680,1059,9590784,80,0
.long 6966272,6965760,8398976,8659328,0,0,0,8499200,0,0,0,0,154368,152064,0,1,4024320,4034560,4044800,4014080,5120,0,0,0,7882496,8595456,7868672,43680,34,9616384,80,0
.long 8597504,0,0,0,0,0,0,0,8593408,7885824,800,9949184,0,0,0,1,6656000,6676480,6696960,6635520,133120,153600,112640,117760,7881728,5120,7876928,1354400,1058,9539584,80,8655104
.long 8597504,0,0,0,0,0,0,0,8594432,7885824,800,9954304,0,0,0,1,6681600,6702080,6640640,6661120,148480,107520,128000,133120,7881984,6144,7876992,44960,35,9565184,80,8655616
.long 8597504,0,0,0,0,0,0,0,8595456,7885824,800,9959424,0,0,0,1,6707200,6645760,6666240,6686720,102400,122880,143360,148480,7882240,6144,7877056,1355680,1059,9590784,80,8656128
.long 8597504,0,0,0,0,0,0,0,8596480,7885824,800,9959424,0,0,0,1,6650880,6671360,6691840,6712320,117760,138240,158720,102400,7882496,5120,7876864,43680,34,9616384,80,8656640
.long 6886400,6888448,8402432,8659456,0,0,0,8503296,0,0,0,0,147456,147456,0,1,4353024,4363264,4373504,4342784,5128,0,0,0,7881728,8606208,7869760,1364640,1066,9539584,80,0
.long 6889472,6888960,8405888,8659584,0,0,0,8507392,0,0,0,0,149760,152064,0,1,4392960,4403200,4413440,4382720,6144,0,0,0,7881984,8595456,7869824,55200,43,9565184,80,0
.long 6968320,6970368,8409344,8659712,0,0,0,8511488,0,0,0,0,152064,147456,0,1,4393984,4404224,4414464,4383744,6152,0,0,0,7882240,8606208,7869888,1365920,1067,9590784,80,0
.long 6971392,6970880,8412800,8659840,0,0,0,8515584,0,0,0,0,154368,152064,0,1,4352000,4362240,4372480,4341760,5120,0,0,0,7882496,8595456,7869696,53920,42,9616384,80,0
.long 8602624,0,0,0,0,0,0,0,8598528,7885952,103200,9964544,0,0,0,1,6983680,7004160,7024640,6963200,133120,153600,112640,117760,7881728,5120,7877952,1364640,1066,9539584,80,8659200
.long 8602624,0,0,0,0,0,0,0,8599552,7885952,103200,9969664,0,0,0,1,7009280,7029760,6968320,6988800,148480,107520,128000,133120,7881984,6144,7878016,55200,43,9565184,80,8659712
.long 8602624,0,0,0,0,0,0,0,8600576,7885952,103200,9959936,0,0,0,1,7034880,6973440,6993920,7014400,102400,122880,143360,148480,7882240,6144,7878080,1365920,1067,9590784,80,8660224
.long 8602624,0,0,0,0,0,0,0,8601600,7885952,103200,9959936,0,0,0,1,6978560,6999040,7019520,7040000,117760,138240,158720,102400,7882496,5120,7877888,53920,42,9616384,80,8660736
.long 6891520,6893568,8416256,8659968,0,0,0,8519680,0,0,0,0,147456,147456,0,1,4680704,4690944,4701184,4670464,5128,0,0,0,7881728,8627712,7870784,1374880,1074,9539584,80,0
.long 6894592,6894080,8419712,8660096,0,0,0,8523776,0,0,0,0,149760,152064,0,1,4720640,4730880,4741120,4710400,6144,0,0,0,7881984,8616960,7870848,65440,51,9565184,80,0
.long 6973440,6975488,8423168,8660224,0,0,0,8527872,0,0,0,0,152064,147456,0,1,4721664,4731904,4742144,4711424,6152,0,0,0,7882240,8627712,7870912,1376160,1075,9590784,80,0
.long 6976512,6976000,8426624,8660352,0,0,0,8531968,0,0,0,0,154368,152064,0,1,4679680,4689920,4700160,4669440,5120,0,0,0,7882496,8616960,7870720,64160,50,9616384,80,0
.long 8607744,0,0,0,0,0,0,0,8603648,7886080,205600,9974784,0,0,0,1,7311360,7331840,7352320,7290880,133120,153600,112640,117760,7881728,5120,7878976,1374880,1074,9539584,80,8663296
.long 8607744,0,0,0,0,0,0,0,8604672,7886080,205600,9979904,0,0,0,1,7336960,7357440,7296000,7316480,148480,107520,128000,133120,7881984,6144,7879040,65440,51,9565184,80,8663808
.long 8607744,0,0,0,0,0,0,0,8605696,7886080,205600,9985024,0,0,0,1,7362560,7301120,7321600,7342080,102400,122880,143360,148480,7882240,6144,7879104,1376160,1075,9590784,80,8664320
.long 8607744,0,0,0,0,0,0,0,8606720,7886080,205600,9985024,0,0,0,1,7306240,7326720,7347200,7367680,117760,138240,158720,102400,7882496,5120,7878912,64160,50,9616384,80,8664832
.long 6896640,6898688,8430080,8660480,0,0,0,8536064,0,0,0,0,147456,147456,0,1,5008384,5018624,5028864,4998144,5128,0,0,0,7881728,8627712,7871808,1385120,1082,9539584,80,0
.long 6899712,6899200,8433536,8660608,0,0,0,8540160,0,0,0,0,149760,152064,0,1,5048320,5058560,5068800,5038080,6144,0,0,0,7881984,8616960,7871872,75680,59,9565184,80,0
.long 6978560,6980608,8436992,8660736,0,0,0,8544256,0,0,0,0,152064,147456,0,1,5049344,5059584,5069824,5039104,6152,0,0,0,7882240,8627712,7871936,1386400,1083,9590784,80,0
.long 6981632,6981120,8440448,8660864,0,0,0,8548352,0,0,0,0,154368,152064,0,1,5007360,5017600,5027840,4997120,5120,0,0,0,7882496,8616960,7871744,74400,58,9616384,80,0
.long 8612864,0,0,0,0,0,0,0,8608768,7886208,308000,9990144,0,0,0,1,7639040,7659520,7680000,7618560,133120,153600,112640,117760,7881728,5120,7880000,1385120,1082,9539584,80,8667392
.long 8612864,0,0,0,0,0,0,0,8609792,7886208,308000,9995264,0,0,0,1,7664640,7685120,7623680,7644160,148480,107520,128000,133120,7881984,6144,7880064,75680,59,9565184,80,8667904
.long 8612864,0,0,0,0,0,0,0,8610816,7886208,308000,9985536,0,0,0,1,7690240,7628800,7649280,7669760,102400,122880,143360,148480,7882240,6144,7880128,1386400,1083,9590784,80,8668416
.long 8612864,0,0,0,0,0,0,0,8611840,7886208,308000,9985536,0,0,0,1,7633920,7654400,7674880,7695360,117760,138240,158720,102400,7882496,5120,7879936,74400,58,9616384,80,8668928
.long 8388608,106496,106496,8487168,0,0,0,0,0,0,0,0,0,0,0,2,5365760,5386240,5324800,5345280,148480,107520,128000,133120,7882752,11264,7872896,4160,3,9641984,160,8638720
.long 8390336,126976,110592,8489216,0,0,0,0,0,0,0,0,0,0,0,2,5391360,5329920,5350400,5370880,102400,122880,143360,148480,7883008,11264,7872960,1314880,1027,9667584,160,8639232
.long 8392064,108544,126976,8491264,0,0,0,0,0,0,0,0,0,0,0,2,5335040,5355520,5376000,5396480,117760,138240,158720,102400,7883264,10240,7872768,2880,2,9693184,160,8639744
.long 8393792,129024,131072,8493312,0,0,0,0,0,0,0,0,0,0,0,2,5360640,5381120,5401600,5340160,133120,153600,112640,117760,7883520,10240,7872832,1313600,1026,9718784,160,8640256
.long 0,0,0,0,6,0,6,8462336,1536,2633728,8553216,73728,0,106496,106496,2,2764800,2775040,2744320,2754560,11264,0,0,0,7882752,8552448,7864704,4160,3,9641984,160,0
.long 0,0,0,0,6,0,6,8464384,83456,3289088,8574720,79872,0,107520,110592,2,2765824,2776064,2745344,2755584,11272,0,0,0,7883008,8563200,7864768,1314880,1027,9667584,160,0
.long 0,0,0,0,6,0,6,8466432,165376,3944448,8596224,86016,0,108544,114688,2,2723840,2734080,2703360,2713600,10240,0,0,0,7883264,8552448,7864576,2880,2,9693184,160,0
.long 0,0,0,0,6,0,6,8468480,247296,4599808,8617728,92160,0,109568,118784,2,2724864,2735104,2704384,2714624,10248,0,0,0,7883520,8563200,7864640,1313600,1026,9718784,160,0
.long 8402432,106496,106496,8503552,0,0,0,0,0,0,0,0,0,0,0,2,5693440,5713920,5652480,5672960,148480,107520,128000,133120,7882752,11264,7873920,14400,11,9641984,160,8642816
.long 8404160,126976,110592,8505600,0,0,0,0,0,0,0,0,0,0,0,2,5719040,5657600,5678080,5698560,102400,122880,143360,148480,7883008,11264,7873984,1325120,1035,9667584,160,8643328
.long 8405888,108544,126976,8507648,0,0,0,0,0,0,0,0,0,0,0,2,5662720,5683200,5703680,5724160,117760,138240,158720,102400,7883264,10240,7873792,13120,10,9693184,160,8643840
.long 8407616,129024,131072,8509696,0,0,0,0,0,0,0,0,0,0,0,2,5688320,5708800,5729280,5667840,133120,153600,112640,117760,7883520,10240,7873856,1323840,1034,9718784,160,8644352
.long 0,0,0,0,6,1,6,8462336,329216,2633984,8555904,73728,0,106496,106496,2,3092480,3102720,3072000,3082240,11264,0,0,0,7882752,8552448,7865728,14400,11,9641984,160,0
.long 0,0,0,0,6,1,6,8464384,411136,3289344,8577408,79872,0,107520,110592,2,3093504,3103744,3073024,3083264,11272,0,0,0,7883008,8563200,7865792,1325120,1035,9667584,160,0
.long 0,0,0,0,6,1,6,8466432,493056,3944704,8598912,86016,0,108544,114688,2,3051520,3061760,3031040,3041280,10240,0,0,0,7883264,8552448,7865600,13120,10,9693184,160,0
.long 0,0,0,0,6,1,6,8468480,574976,4600064,8620416,92160,0,109568,118784,2,3052544,3062784,3032064,3042304,10248,0,0,0,7883520,8563200,7865664,1323840,1034,9718784,160,0
.long 8416256,106496,106496,8519936,0,0,0,0,0,0,0,0,0,0,0,2,6021120,6041600,5980160,6000640,148480,107520,128000,133120,7882752,11264,7874944,24640,19,9641984,160,8646912
.long 8417984,126976,110592,8521984,0,0,0,0,0,0,0,0,0,0,0,2,6046720,5985280,6005760,6026240,102400,122880,143360,148480,7883008,11264,7875008,1335360,1043,9667584,160,8647424
.long 8419712,108544,126976,8524032,0,0,0,0,0,0,0,0,0,0,0,2,5990400,6010880,6031360,6051840,117760,138240,158720,102400,7883264,10240,7874816,23360,18,9693184,160,8647936
.long 8421440,129024,131072,8526080,0,0,0,0,0,0,0,0,0,0,0,2,6016000,6036480,6056960,5995520,133120,153600,112640,117760,7883520,10240,7874880,1334080,1042,9718784,160,8648448
.long 0,0,0,0,6,2,6,8462336,656896,2634240,8558592,73728,0,106496,106496,2,3420160,3430400,3399680,3409920,11264,0,0,0,7882752,8573952,7866752,24640,19,9641984,160,0
.long 0,0,0,0,6,2,6,8464384,738816,3289600,8580096,79872,0,107520,110592,2,3421184,3431424,3400704,3410944,11272,0,0,0,7883008,8584704,7866816,1335360,1043,9667584,160,0
.long 0,0,0,0,6,2,6,8466432,820736,3944960,8601600,86016,0,108544,114688,2,3379200,3389440,3358720,3368960,10240,0,0,0,7883264,8573952,7866624,23360,18,9693184,160,0
.long 0,0,0,0,6,2,6,8468480,902656,4600320,8623104,92160,0,109568,118784,2,3380224,3390464,3359744,3369984,10248,0,0,0,7883520,8584704,7866688,1334080,1042,9718784,160,0
.long 8430080,106496,106496,8536320,0,0,0,0,0,0,0,0,0,0,0,2,6348800,6369280,6307840,6328320,148480,107520,128000,133120,7882752,11264,7875968,34880,27,9641984,160,8651008
.long 8431808,126976,110592,8538368,0,0,0,0,0,0,0,0,0,0,0,2,6374400,6312960,6333440,6353920,102400,122880,143360,148480,7883008,11264,7876032,1345600,1051,9667584,160,8651520
.long 8433536,108544,126976,8540416,0,0,0,0,0,0,0,0,0,0,0,2,6318080,6338560,6359040,6379520,117760,138240,158720,102400,7883264,10240,7875840,33600,26,9693184,160,8652032
.long 8435264,129024,131072,8542464,0,0,0,0,0,0,0,0,0,0,0,2,6343680,6364160,6384640,6323200,133120,153600,112640,117760,7883520,10240,7875904,1344320,1050,9718784,160,8652544
.long 0,0,0,0,6,3,6,8462336,984576,2634496,8561280,73728,0,106496,106496,2,3747840,3758080,3727360,3737600,11264,0,0,0,7882752,8573952,7867776,34880,27,9641984,160,0
.long 0,0,0,0,6,3,6,8464384,1066496,3289856,8582784,79872,0,107520,110592,2,3748864,3759104,3728384,3738624,11272,0,0,0,7883008,8584704,7867840,1345600,1051,9667584,160,0
.long 0,0,0,0,6,3,6,8466432,1148416,3945216,8604288,86016,0,108544,114688,2,3706880,3717120,3686400,3696640,10240,0,0,0,7883264,8573952,7867648,33600,26,9693184,160,0
.long 0,0,0,0,6,3,6,8468480,1230336,4600576,8625792,92160,0,109568,118784,2,3707904,3718144,3687424,3697664,10248,0,0,0,7883520,8584704,7867712,1344320,1050,9718784,160,0
.long 8388608,106496,106496,8488192,0,0,0,0,0,0,0,0,0,0,0,2,6676480,6696960,6635520,6656000,148480,107520,128000,133120,7882752,11264,7876992,45120,35,9641984,160,8655104
.long 8390336,126976,110592,8490240,0,0,0,0,0,0,0,0,0,0,0,2,6702080,6640640,6661120,6681600,102400,122880,143360,148480,7883008,11264,7877056,1355840,1059,9667584,160,8655616
.long 8392064,108544,126976,8492288,0,0,0,0,0,0,0,0,0,0,0,2,6645760,6666240,6686720,6707200,117760,138240,158720,102400,7883264,10240,7876864,43840,34,9693184,160,8656128
.long 8393792,129024,131072,8494336,0,0,0,0,0,0,0,0,0,0,0,2,6671360,6691840,6712320,6650880,133120,153600,112640,117760,7883520,10240,7876928,1354560,1058,9718784,160,8656640
.long 0,0,0,0,6,4,6,8462336,1312256,2634752,8563968,73728,0,106496,106496,2,4075520,4085760,4055040,4065280,11264,0,0,0,7882752,8595456,7868800,45120,35,9641984,160,0
.long 0,0,0,0,6,4,6,8464384,1394176,3290112,8585472,79872,0,107520,110592,2,4076544,4086784,4056064,4066304,11272,0,0,0,7883008,8606208,7868864,1355840,1059,9667584,160,0
.long 0,0,0,0,6,4,6,8466432,1476096,3945472,8606976,86016,0,108544,114688,2,4034560,4044800,4014080,4024320,10240,0,0,0,7883264,8595456,7868672,43840,34,9693184,160,0
.long 0,0,0,0,6,4,6,8468480,1558016,4600832,8628480,92160,0,109568,118784,2,4035584,4045824,4015104,4025344,10248,0,0,0,7883520,8606208,7868736,1354560,1058,9718784,160,0
.long 8402432,106496,106496,8504576,0,0,0,0,0,0,0,0,0,0,0,2,7004160,7024640,6963200,6983680,148480,107520,128000,133120,7882752,11264,7878016,55360,43,9641984,160,8659200
.long 8404160,126976,110592,8506624,0,0,0,0,0,0,0,0,0,0,0,2,7029760,6968320,6988800,7009280,102400,122880,143360,148480,7883008,11264,7878080,1366080,1067,9667584,160,8659712
.long 8405888,108544,126976,8508672,0,0,0,0,0,0,0,0,0,0,0,2,6973440,6993920,7014400,7034880,117760,138240,158720,102400,7883264,10240,7877888,54080,42,9693184,160,8660224
.long 8407616,129024,131072,8510720,0,0,0,0,0,0,0,0,0,0,0,2,6999040,7019520,7040000,6978560,133120,153600,112640,117760,7883520,10240,7877952,1364800,1066,9718784,160,8660736
.long 0,0,0,0,6,5,6,8462336,1639936,2635008,8566656,73728,0,106496,106496,2,4403200,4413440,4382720,4392960,11264,0,0,0,7882752,8595456,7869824,55360,43,9641984,160,0
.long 0,0,0,0,6,5,6,8464384,1721856,3290368,8588160,79872,0,107520,110592,2,4404224,4414464,4383744,4393984,11272,0,0,0,7883008,8606208,7869888,1366080,1067,9667584,160,0
.long 0,0,0,0,6,5,6,8466432,1803776,3945728,8609664,86016,0,108544,114688,2,4362240,4372480,4341760,4352000,10240,0,0,0,7883264,8595456,7869696,54080,42,9693184,160,0
.long 0,0,0,0,6,5,6,8468480,1885696,4601088,8631168,92160,0,109568,118784,2,4363264,4373504,4342784,4353024,10248,0,0,0,7883520,8606208,7869760,1364800,1066,9718784,160,0
.long 8416256,106496,106496,8520960,0,0,0,0,0,0,0,0,0,0,0,2,7331840,7352320,7290880,7311360,148480,107520,128000,133120,7882752,11264,7879040,65600,51,9641984,160,8663296
.long 8417984,126976,110592,8523008,0,0,0,0,0,0,0,0,0,0,0,2,7357440,7296000,7316480,7336960,102400,122880,143360,148480,7883008,11264,7879104,1376320,1075,9667584,160,8663808
.long 8419712,108544,126976,8525056,0,0,0,0,0,0,0,0,0,0,0,2,7301120,7321600,7342080,7362560,117760,138240,158720,102400,7883264,10240,7878912,64320,50,9693184,160,8664320
.long 8421440,129024,131072,8527104,0,0,0,0,0,0,0,0,0,0,0,2,7326720,7347200,7367680,7306240,133120,153600,112640,117760,7883520,10240,7878976,1375040,1074,9718784,160,8664832
.long 0,0,0,0,6,6,6,8462336,1967616,2635264,8569344,73728,0,106496,106496,2,4730880,4741120,4710400,4720640,11264,0,0,0,7882752,8616960,7870848,65600,51,9641984,160,0
.long 0,0,0,0,6,6,6,8464384,2049536,3290624,8590848,79872,0,107520,110592,2,4731904,4742144,4711424,4721664,11272,0,0,0,7883008,8627712,7870912,1376320,1075,9667584,160,0
.long 0,0,0,0,6,6,6,8466432,2131456,3945984,8612352,86016,0,108544,114688,2,4689920,4700160,4669440,4679680,10240,0,0,0,7883264,8616960,7870720,64320,50,9693184,160,0
.long 0,0,0,0,6,6,6,8468480,2213376,4601344,8633856,92160,0,109568,118784,2,4690944,4701184,4670464,4680704,10248,0,0,0,7883520,8627712,7870784,1375040,1074,9718784,160,0
.long 8430080,106496,106496,8537344,0,0,0,0,0,0,0,0,0,0,0,2,7659520,7680000,7618560,7639040,148480,107520,128000,133120,7882752,11264,7880064,75840,59,9641984,160,8667392
.long 8431808,126976,110592,8539392,0,0,0,0,0,0,0,0,0,0,0,2,7685120,7623680,7644160,7664640,102400,122880,143360,148480,7883008,11264,7880128,1386560,1083,9667584,160,8667904
.long 8433536,108544,126976,8541440,0,0,0,0,0,0,0,0,0,0,0,2,7628800,7649280,7669760,7690240,117760,138240,158720,102400,7883264,10240,7879936,74560,58,9693184,160,8668416
.long 8435264,129024,131072,8543488,0,0,0,0,0,0,0,0,0,0,0,2,7654400,7674880,7695360,7633920,133120,153600,112640,117760,7883520,10240,7880000,1385280,1082,9718784,160,8668928
.long 0,0,0,0,6,7,6,8462336,2295296,2635520,8572032,73728,0,106496,106496,2,5058560,5068800,5038080,5048320,11264,0,0,0,7882752,8616960,7871872,75840,59,9641984,160,0
.long 0,0,0,0,6,7,6,8464384,2377216,3290880,8593536,79872,0,107520,110592,2,5059584,5069824,5039104,5049344,11272,0,0,0,7883008,8627712,7871936,1386560,1083,9667584,160,0
.long 0,0,0,0,6,7,6,8466432,2459136,3946240,8615040,86016,0,108544,114688,2,5017600,5027840,4997120,5007360,10240,0,0,0,7883264,8616960,7871744,74560,58,9693184,160,0
.long 0,0,0,0,6,7,6,8468480,2541056,4601600,8636544,92160,0,109568,118784,2,5018624,5028864,4998144,5008384,10248,0,0,0,7883520,8627712,7871808,1385280,1082,9718784,160,0
.long 8395520,106496,106496,8495360,0,0,0,0,0,0,0,0,0,0,0,3,5386240,5324800,5345280,5365760,102400,122880,143360,148480,7883776,16384,7872960,1315040,1027,9744384,240,8638720
.long 8397248,126976,110592,8497408,0,0,0,0,0,0,0,0,0,0,0,3,5329920,5350400,5370880,5391360,117760,138240,158720,102400,7884032,15360,7872768,3040,2,9769984,240,8639232
.long 8398976,108544,126976,8499456,0,0,0,0,0,0,0,0,0,0,0,3,5355520,5376000,5396480,5335040,133120,153600,112640,117760,7884288,15360,7872832,1313760,1026,9795584,240,8639744
.long 8400704,129024,131072,8501504,0,0,0,0,0,0,0,0,0,0,0,3,5381120,5401600,5340160,5360640,148480,107520,128000,133120,7884544,16384,7872896,4320,3,9821184,240,8640256
.long 0,0,0,0,8,0,8,8462336,2048,2637824,8553472,73728,0,106496,106496,3,2776064,2745344,2755584,2765824,16392,0,0,0,7883776,8563200,7864768,1315040,1027,9744384,240,0
.long 0,0,0,0,8,0,8,8464384,83968,3293184,8574976,79872,0,107520,110592,3,2734080,2703360,2713600,2723840,15360,0,0,0,7884032,8552448,7864576,3040,2,9769984,240,0
.long 0,0,0,0,8,0,8,8466432,165888,3948544,8596480,86016,0,108544,114688,3,2735104,2704384,2714624,2724864,15368,0,0,0,7884288,8563200,7864640,1313760,1026,9795584,240,0
.long 0,0,0,0,8,0,8,8468480,247808,4603904,8617984,92160,0,109568,118784,3,2775040,2744320,2754560,2764800,16384,0,0,0,7884544,8552448,7864704,4320,3,9821184,240,0
.long 8409344,106496,106496,8511744,0,0,0,0,0,0,0,0,0,0,0,3,5713920,5652480,5672960,5693440,102400,122880,143360,148480,7883776,16384,7873984,1325280,1035,9744384,240,8642816
.long 8411072,126976,110592,8513792,0,0,0,0,0,0,0,0,0,0,0,3,5657600,5678080,5698560,5719040,117760,138240,158720,102400,7884032,15360,7873792,13280,10,9769984,240,8643328
.long 8412800,108544,126976,8515840,0,0,0,0,0,0,0,0,0,0,0,3,5683200,5703680,5724160,5662720,133120,153600,112640,117760,7884288,15360,7873856,1324000,1034,9795584,240,8643840
.long 8414528,129024,131072,8517888,0,0,0,0,0,0,0,0,0,0,0,3,5708800,5729280,5667840,5688320,148480,107520,128000,133120,7884544,16384,7873920,14560,11,9821184,240,8644352
.long 0,0,0,0,8,1,8,8462336,329728,2638080,8556160,73728,0,106496,106496,3,3103744,3073024,3083264,3093504,16392,0,0,0,7883776,8563200,7865792,1325280,1035,9744384,240,0
.long 0,0,0,0,8,1,8,8464384,411648,3293440,8577664,79872,0,107520,110592,3,3061760,3031040,3041280,3051520,15360,0,0,0,7884032,8552448,7865600,13280,10,9769984,240,0
.long 0,0,0,0,8,1,8,8466432,493568,3948800,8599168,86016,0,108544,114688,3,3062784,3032064,3042304,3052544,15368,0,0,0,7884288,8563200,7865664,1324000,1034,9795584,240,0
.long 0,0,0,0,8,1,8,8468480,575488,4604160,8620672,92160,0,109568,118784,3,3102720,3072000,3082240,3092480,16384,0,0,0,7884544,8552448,7865728,14560,11,9821184,240,0
.long 8423168,106496,106496,8528128,0,0,0,0,0,0,0,0,0,0,0,3,6041600,5980160,6000640,6021120,102400,122880,143360,148480,7883776,16384,7875008,1335520,1043,9744384,240,8646912
.long 8424896,126976,110592,8530176,0,0,0,0,0,0,0,0,0,0,0,3,5985280,6005760,6026240,6046720,117760,138240,158720,102400,7884032,15360,7874816,23520,18,9769984,240,8647424
.long 8426624,108544,126976,8532224,0,0,0,0,0,0,0,0,0,0,0,3,6010880,6031360,6051840,5990400,133120,153600,112640,117760,7884288,15360,7874880,1334240,1042,9795584,240,8647936
.long 8428352,129024,131072,8534272,0,0,0,0,0,0,0,0,0,0,0,3,6036480,6056960,5995520,6016000,148480,107520,128000,133120,7884544,16384,7874944,24800,19,9821184,240,8648448
.long 0,0,0,0,8,2,8,8462336,657408,2638336,8558848,73728,0,106496,106496,3,3431424,3400704,3410944,3421184,16392,0,0,0,7883776,8584704,7866816,1335520,1043,9744384,240,0
.long 0,0,0,0,8,2,8,8464384,739328,3293696,8580352,79872,0,107520,110592,3,3389440,3358720,3368960,3379200,15360,0,0,0,7884032,8573952,7866624,23520,18,9769984,240,0
.long 0,0,0,0,8,2,8,8466432,821248,3949056,8601856,86016,0,108544,114688,3,3390464,3359744,3369984,3380224,15368,0,0,0,7884288,8584704,7866688,1334240,1042,9795584,240,0
.long 0,0,0,0,8,2,8,8468480,903168,4604416,8623360,92160,0,109568,118784,3,3430400,3399680,3409920,3420160,16384,0,0,0,7884544,8573952,7866752,24800,19,9821184,240,0
.long 8436992,106496,106496,8544512,0,0,0,0,0,0,0,0,0,0,0,3,6369280,6307840,6328320,6348800,102400,122880,143360,148480,7883776,16384,7876032,1345760,1051,9744384,240,8651008
.long 8438720,126976,110592,8546560,0,0,0,0,0,0,0,0,0,0,0,3,6312960,6333440,6353920,6374400,117760,138240,158720,102400,7884032,15360,7875840,33760,26,9769984,240,8651520
.long 8440448,108544,126976,8548608,0,0,0,0,0,0,0,0,0,0,0,3,6338560,6359040,6379520,6318080,133120,153600,112640,117760,7884288,15360,7875904,1344480,1050,9795584,240,8652032
.long 8442176,129024,131072,8550656,0,0,0,0,0,0,0,0,0,0,0,3,6364160,6384640,6323200,6343680,148480,107520,128000,133120,7884544,16384,7875968,35040,27,9821184,240,8652544
.long 0,0,0,0,8,3,8,8462336,985088,2638592,8561536,73728,0,106496,106496,3,3759104,3728384,3738624,3748864,16392,0,0,0,7883776,8584704,7867840,1345760,1051,9744384,240,0
.long 0,0,0,0,8,3,8,8464384,1067008,3293952,8583040,79872,0,107520,110592,3,3717120,3686400,3696640,3706880,15360,0,0,0,7884032,8573952,7867648,33760,26,9769984,240,0
.long 0,0,0,0,8,3,8,8466432,1148928,3949312,8604544,86016,0,108544,114688,3,3718144,3687424,3697664,3707904,15368,0,0,0,7884288,8584704,7867712,1344480,1050,9795584,240,0
.long 0,0,0,0,8,3,8,8468480,1230848,4604672,8626048,92160,0,109568,118784,3,3758080,3727360,3737600,3747840,16384,0,0,0,7884544,8573952,7867776,35040,27,9821184,240,0
.long 8395520,106496,106496,8496384,0,0,0,0,0,0,0,0,0,0,0,3,6696960,6635520,6656000,6676480,102400,122880,143360,148480,7883776,16384,7877056,1356000,1059,9744384,240,8655104
.long 8397248,126976,110592,8498432,0,0,0,0,0,0,0,0,0,0,0,3,6640640,6661120,6681600,6702080,117760,138240,158720,102400,7884032,15360,7876864,44000,34,9769984,240,8655616
.long 8398976,108544,126976,8500480,0,0,0,0,0,0,0,0,0,0,0,3,6666240,6686720,6707200,6645760,133120,153600,112640,117760,7884288,15360,7876928,1354720,1058,9795584,240,8656128
.long 8400704,129024,131072,8502528,0,0,0,0,0,0,0,0,0,0,0,3,6691840,6712320,6650880,6671360,148480,107520,128000,133120,7884544,16384,7876992,45280,35,9821184,240,8656640
.long 0,0,0,0,8,4,8,8462336,1312768,2638848,8564224,73728,0,106496,106496,3,4086784,4056064,4066304,4076544,16392,0,0,0,7883776,8606208,7868864,1356000,1059,9744384,240,0
.long 0,0,0,0,8,4,8,8464384,1394688,3294208,8585728,79872,0,107520,110592,3,4044800,4014080,4024320,4034560,15360,0,0,0,7884032,8595456,7868672,44000,34,9769984,240,0
.long 0,0,0,0,8,4,8,8466432,1476608,3949568,8607232,86016,0,108544,114688,3,4045824,4015104,4025344,4035584,15368,0,0,0,7884288,8606208,7868736,1354720,1058,9795584,240,0
.long 0,0,0,0,8,4,8,8468480,1558528,4604928,8628736,92160,0,109568,118784,3,4085760,4055040,4065280,4075520,16384,0,0,0,7884544,8595456,7868800,45280,35,9821184,240,0
.long 8409344,106496,106496,8512768,0,0,0,0,0,0,0,0,0,0,0,3,7024640,6963200,6983680,7004160,102400,122880,143360,148480,7883776,16384,7878080,1366240,1067,9744384,240,8659200
.long 8411072,126976,110592,8514816,0,0,0,0,0,0,0,0,0,0,0,3,6968320,6988800,7009280,7029760,117760,138240,158720,102400,7884032,15360,7877888,54240,42,9769984,240,8659712
.long 8412800,108544,126976,8516864,0,0,0,0,0,0,0,0,0,0,0,3,6993920,7014400,7034880,6973440,133120,153600,112640,117760,7884288,15360,7877952,1364960,1066,9795584,240,8660224
.long 8414528,129024,131072,8518912,0,0,0,0,0,0,0,0,0,0,0,3,7019520,7040000,6978560,6999040,148480,107520,128000,133120,7884544,16384,7878016,55520,43,9821184,240,8660736
.long 0,0,0,0,8,5,8,8462336,1640448,2639104,8566912,73728,0,106496,106496,3,4414464,4383744,4393984,4404224,16392,0,0,0,7883776,8606208,7869888,1366240,1067,9744384,240,0
.long 0,0,0,0,8,5,8,8464384,1722368,3294464,8588416,79872,0,107520,110592,3,4372480,4341760,4352000,4362240,15360,0,0,0,7884032,8595456,7869696,54240,42,9769984,240,0
.long 0,0,0,0,8,5,8,8466432,1804288,3949824,8609920,86016,0,108544,114688,3,4373504,4342784,4353024,4363264,15368,0,0,0,7884288,8606208,7869760,1364960,1066,9795584,240,0
.long 0,0,0,0,8,5,8,8468480,1886208,4605184,8631424,92160,0,109568,118784,3,4413440,4382720,4392960,4403200,16384,0,0,0,7884544,8595456,7869824,55520,43,9821184,240,0
.long 8423168,106496,106496,8529152,0,0,0,0,0,0,0,0,0,0,0,3,7352320,7290880,7311360,7331840,102400,122880,143360,148480,7883776,16384,7879104,1376480,1075,9744384,240,8663296
.long 8424896,126976,110592,8531200,0,0,0,0,0,0,0,0,0,0,0,3,7296000,7316480,7336960,7357440,117760,138240,158720,102400,7884032,15360,7878912,64480,50,9769984,240,8663808
.long 8426624,108544,126976,8533248,0,0,0,0,0,0,0,0,0,0,0,3,7321600,7342080,7362560,7301120,133120,153600,112640,117760,7884288,15360,7878976,1375200,1074,9795584,240,8664320
.long 8428352,129024,131072,8535296,0,0,0,0,0,0,0,0,0,0,0,3,7347200,7367680,7306240,7326720,148480,107520,128000,133120,7884544,16384,7879040,65760,51,9821184,240,8664832
.long 0,0,0,0,8,6,8,8462336,1968128,2639360,8569600,73728,0,106496,106496,3,4742144,4711424,4721664,4731904,16392,0,0,0,7883776,8627712,7870912,1376480,1075,9744384,240,0
.long 0,0,0,0,8,6,8,8464384,2050048,3294720,8591104,79872,0,107520,110592,3,4700160,4669440,4679680,4689920,15360,0,0,0,7884032,8616960,7870720,64480,50,9769984,240,0
.long 0,0,0,0,8,6,8,8466432,2131968,3950080,8612608,86016,0,108544,114688,3,4701184,4670464,4680704,4690944,15368,0,0,0,7884288,8627712,7870784,1375200,1074,9795584,240,0
.long 0,0,0,0,8,6,8,8468480,2213888,4605440,8634112,92160,0,109568,118784,3,4741120,4710400,4720640,4730880,16384,0,0,0,7884544,8616960,7870848,65760,51,9821184,240,0
.long 8436992,106496,106496,8545536,0,0,0,0,0,0,0,0,0,0,0,3,7680000,7618560,7639040,7659520,102400,122880,143360,148480,7883776,16384,7880128,1386720,1083,9744384,240,8667392
.long 8438720,126976,110592,8547584,0,0,0,0,0,0,0,0,0,0,0,3,7623680,7644160,7664640,7685120,117760,138240,158720,102400,7884032,15360,7879936,74720,58,9769984,240,8667904
.long 8440448,108544,126976,8549632,0,0,0,0,0,0,0,0,0,0,0,3,7649280,7669760,7690240,7628800,133120,153600,112640,117760,7884288,15360,7880000,1385440,1082,9795584,240,8668416
.long 8442176,129024,131072,8551680,0,0,0,0,0,0,0,0,0,0,0,3,7674880,7695360,7633920,7654400,148480,107520,128000,133120,7884544,16384,7880064,76000,59,9821184,240,8668928
.long 0,0,0,0,8,7,8,8462336,2295808,2639616,8572288,73728,0,106496,106496,3,5069824,5039104,5049344,5059584,16392,0,0,0,7883776,8627712,7871936,1386720,1083,9744384,240,0
.long 0,0,0,0,8,7,8,8464384,2377728,3294976,8593792,79872,0,107520,110592,3,5027840,4997120,5007360,5017600,15360,0,0,0,7884032,8616960,7871744,74720,58,9769984,240,0
.long 0,0,0,0,8,7,8,8466432,2459648,3950336,8615296,86016,0,108544,114688,3,5028864,4998144,5008384,5018624,15368,0,0,0,7884288,8627712,7871808,1385440,1082,9795584,240,0
.long 0,0,0,0,8,7,8,8468480,2541568,4605696,8636800,92160,0,109568,118784,3,5068800,5038080,5048320,5058560,16384,0,0,0,7884544,8616960,7871872,76000,59,9821184,240,0
.long 61440,1372160,7874048,8455680,0,0,0,0,0,0,0,0,12,0,0,4,5324800,5345280,5365760,5386240,117760,138240,158720,102400,7884800,0,7872768,3200,2,9846784,4294966976,8638720
.long 66560,1377280,7874176,8455808,0,0,0,0,0,0,0,0,13,0,0,4,5350400,5370880,5391360,5329920,133120,153600,112640,117760,7885056,0,7872832,1313920,1026,9872384,4294966976,8639232
.long 71680,1382400,7874304,8455936,0,0,0,0,0,0,0,0,14,0,0,4,5376000,5396480,5335040,5355520,148480,107520,128000,133120,7885312,1024,7872896,4480,3,9897984,4294966976,8639744
.long 76800,1387520,7874432,8456064,0,0,0,0,0,0,0,0,15,0,0,4,5401600,5340160,5360640,5381120,102400,122880,143360,148480,7885568,1024,7872960,1315200,1027,9923584,4294966976,8640256
.long 0,0,0,0,10,0,10,8470528,2560,2641920,8553728,73728,0,106496,106496,4,2703360,2713600,2723840,2734080,0,0,0,0,7884800,8552448,7864576,3200,2,9846784,4294966976,0
.long 0,0,0,0,10,0,10,8472576,84480,3297280,8575232,79872,0,107520,110592,4,2704384,2714624,2724864,2735104,8,0,0,0,7885056,8563200,7864640,1313920,1026,9872384,4294966976,0
.long 0,0,0,0,10,0,10,8474624,166400,3952640,8596736,86016,0,108544,114688,4,2744320,2754560,2764800,2775040,1024,0,0,0,7885312,8552448,7864704,4480,3,9897984,4294966976,0
.long 0,0,0,0,10,0,10,8476672,248320,4608000,8618240,92160,0,109568,118784,4,2745344,2755584,2765824,2776064,1032,0,0,0,7885568,8563200,7864768,1315200,1027,9923584,4294966976,0
.long 62720,1373440,7874048,8463872,0,0,0,0,0,0,0,0,12,0,0,4,5652480,5672960,5693440,5713920,117760,138240,158720,102400,7884800,0,7873792,13440,10,9846784,4294966976,8642816
.long 67840,1378560,7874176,8464000,0,0,0,0,0,0,0,0,13,0,0,4,5678080,5698560,5719040,5657600,133120,153600,112640,117760,7885056,0,7873856,1324160,1034,9872384,4294966976,8643328
.long 72960,1383680,7874304,8464128,0,0,0,0,0,0,0,0,14,0,0,4,5703680,5724160,5662720,5683200,148480,107520,128000,133120,7885312,1024,7873920,14720,11,9897984,4294966976,8643840
.long 78080,1388800,7874432,8464256,0,0,0,0,0,0,0,0,15,0,0,4,5729280,5667840,5688320,5708800,102400,122880,143360,148480,7885568,1024,7873984,1325440,1035,9923584,4294966976,8644352
.long 0,0,0,0,10,1,10,8470528,330240,2642176,8556416,73728,0,106496,106496,4,3031040,3041280,3051520,3061760,0,0,0,0,7884800,8552448,7865600,13440,10,9846784,4294966976,0
.long 0,0,0,0,10,1,10,8472576,412160,3297536,8577920,79872,0,107520,110592,4,3032064,3042304,3052544,3062784,8,0,0,0,7885056,8563200,7865664,1324160,1034,9872384,4294966976,0
.long 0,0,0,0,10,1,10,8474624,494080,3952896,8599424,86016,0,108544,114688,4,3072000,3082240,3092480,3102720,1024,0,0,0,7885312,8552448,7865728,14720,11,9897984,4294966976,0
.long 0,0,0,0,10,1,10,8476672,576000,4608256,8620928,92160,0,109568,118784,4,3073024,3083264,3093504,3103744,1032,0,0,0,7885568,8563200,7865792,1325440,1035,9923584,4294966976,0
.long 64000,1374720,7874048,8472064,0,0,0,0,0,0,0,0,12,0,0,4,5980160,6000640,6021120,6041600,117760,138240,158720,102400,7884800,0,7874816,23680,18,9846784,4294966976,8646912
.long 69120,1379840,7874176,8472192,0,0,0,0,0,0,0,0,13,0,0,4,6005760,6026240,6046720,5985280,133120,153600,112640,117760,7885056,0,7874880,1334400,1042,9872384,4294966976,8647424
.long 74240,1384960,7874304,8472320,0,0,0,0,0,0,0,0,14,0,0,4,6031360,6051840,5990400,6010880,148480,107520,128000,133120,7885312,1024,7874944,24960,19,9897984,4294966976,8647936
.long 79360,1390080,7874432,8472448,0,0,0,0,0,0,0,0,15,0,0,4,6056960,5995520,6016000,6036480,102400,122880,143360,148480,7885568,1024,7875008,1335680,1043,9923584,4294966976,8648448
.long 0,0,0,0,10,2,10,8470528,657920,2642432,8559104,73728,0,106496,106496,4,3358720,3368960,3379200,3389440,0,0,0,0,7884800,8573952,7866624,23680,18,9846784,4294966976,0
.long 0,0,0,0,10,2,10,8472576,739840,3297792,8580608,79872,0,107520,110592,4,3359744,3369984,3380224,3390464,8,0,0,0,7885056,8584704,7866688,1334400,1042,9872384,4294966976,0
.long 0,0,0,0,10,2,10,8474624,821760,3953152,8602112,86016,0,108544,114688,4,3399680,3409920,3420160,3430400,1024,0,0,0,7885312,8573952,7866752,24960,19,9897984,4294966976,0
.long 0,0,0,0,10,2,10,8476672,903680,4608512,8623616,92160,0,109568,118784,4,3400704,3410944,3421184,3431424,1032,0,0,0,7885568,8584704,7866816,1335680,1043,9923584,4294966976,0
.long 65280,1376000,7874048,8480256,0,0,0,0,0,0,0,0,12,0,0,4,6307840,6328320,6348800,6369280,117760,138240,158720,102400,7884800,0,7875840,33920,26,9846784,4294966976,8651008
.long 70400,1381120,7874176,8480384,0,0,0,0,0,0,0,0,13,0,0,4,6333440,6353920,6374400,6312960,133120,153600,112640,117760,7885056,0,7875904,1344640,1050,9872384,4294966976,8651520
.long 75520,1386240,7874304,8480512,0,0,0,0,0,0,0,0,14,0,0,4,6359040,6379520,6318080,6338560,148480,107520,128000,133120,7885312,1024,7875968,35200,27,9897984,4294966976,8652032
.long 80640,1391360,7874432,8480640,0,0,0,0,0,0,0,0,15,0,0,4,6384640,6323200,6343680,6364160,102400,122880,143360,148480,7885568,1024,7876032,1345920,1051,9923584,4294966976,8652544
.long 0,0,0,0,10,3,10,8470528,985600,2642688,8561792,73728,0,106496,106496,4,3686400,3696640,3706880,3717120,0,0,0,0,7884800,8573952,7867648,33920,26,9846784,4294966976,0
.long 0,0,0,0,10,3,10,8472576,1067520,3298048,8583296,79872,0,107520,110592,4,3687424,3697664,3707904,3718144,8,0,0,0,7885056,8584704,7867712,1344640,1050,9872384,4294966976,0
.long 0,0,0,0,10,3,10,8474624,1149440,3953408,8604800,86016,0,108544,114688,4,3727360,3737600,3747840,3758080,1024,0,0,0,7885312,8573952,7867776,35200,27,9897984,4294966976,0
.long 0,0,0,0,10,3,10,8476672,1231360,4608768,8626304,92160,0,109568,118784,4,3728384,3738624,3748864,3759104,1032,0,0,0,7885568,8584704,7867840,1345920,1051,9923584,4294966976,0
.long 225280,1536000,7878144,8459776,0,0,0,0,0,0,0,0,44,0,0,4,6635520,6656000,6676480,6696960,117760,138240,158720,102400,7884800,0,7876864,44160,34,9846784,4294966976,8655104
.long 230400,1541120,7878272,8459904,0,0,0,0,0,0,0,0,45,0,0,4,6661120,6681600,6702080,6640640,133120,153600,112640,117760,7885056,0,7876928,1354880,1058,9872384,4294966976,8655616
.long 235520,1546240,7878400,8460032,0,0,0,0,0,0,0,0,46,0,0,4,6686720,6707200,6645760,6666240,148480,107520,128000,133120,7885312,1024,7876992,45440,35,9897984,4294966976,8656128
.long 240640,1551360,7878528,8460160,0,0,0,0,0,0,0,0,47,0,0,4,6712320,6650880,6671360,6691840,102400,122880,143360,148480,7885568,1024,7877056,1356160,1059,9923584,4294966976,8656640
.long 0,0,0,0,10,4,10,8470528,1313280,2642944,8564480,73728,0,106496,106496,4,4014080,4024320,4034560,4044800,0,0,0,0,7884800,8595456,7868672,44160,34,9846784,4294966976,0
.long 0,0,0,0,10,4,10,8472576,1395200,3298304,8585984,79872,0,107520,110592,4,4015104,4025344,4035584,4045824,8,0,0,0,7885056,8606208,7868736,1354880,1058,9872384,4294966976,0
.long 0,0,0,0,10,4,10,8474624,1477120,3953664,8607488,86016,0,108544,114688,4,4055040,4065280,4075520,4085760,1024,0,0,0,7885312,8595456,7868800,45440,35,9897984,4294966976,0
.long 0,0,0,0,10,4,10,8476672,1559040,4609024,8628992,92160,0,109568,118784,4,4056064,4066304,4076544,4086784,1032,0,0,0,7885568,8606208,7868864,1356160,1059,9923584,4294966976,0
.long 226560,1537280,7878144,8467968,0,0,0,0,0,0,0,0,44,0,0,4,6963200,6983680,7004160,7024640,117760,138240,158720,102400,7884800,0,7877888,54400,42,9846784,4294966976,8659200
.long 231680,1542400,7878272,8468096,0,0,0,0,0,0,0,0,45,0,0,4,6988800,7009280,7029760,6968320,133120,153600,112640,117760,7885056,0,7877952,1365120,1066,9872384,4294966976,8659712
.long 236800,1547520,7878400,8468224,0,0,0,0,0,0,0,0,46,0,0,4,7014400,7034880,6973440,6993920,148480,107520,128000,133120,7885312,1024,7878016,55680,43,9897984,4294966976,8660224
.long 241920,1552640,7878528,8468352,0,0,0,0,0,0,0,0,47,0,0,4,7040000,6978560,6999040,7019520,102400,122880,143360,148480,7885568,1024,7878080,1366400,1067,9923584,4294966976,8660736
.long 0,0,0,0,10,5,10,8470528,1640960,2643200,8567168,73728,0,106496,106496,4,4341760,4352000,4362240,4372480,0,0,0,0,7884800,8595456,7869696,54400,42,9846784,4294966976,0
.long 0,0,0,0,10,5,10,8472576,1722880,3298560,8588672,79872,0,107520,110592,4,4342784,4353024,4363264,4373504,8,0,0,0,7885056,8606208,7869760,1365120,1066,9872384,4294966976,0
.long 0,0,0,0,10,5,10,8474624,1804800,3953920,8610176,86016,0,108544,114688,4,4382720,4392960,4403200,4413440,1024,0,0,0,7885312,8595456,7869824,55680,43,9897984,4294966976,0
.long 0,0,0,0,10,5,10,8476672,1886720,4609280,8631680,92160,0,109568,118784,4,4383744,4393984,4404224,4414464,1032,0,0,0,7885568,8606208,7869888,1366400,1067,9923584,4294966976,0
.long 227840,1538560,7878144,8476160,0,0,0,0,0,0,0,0,44,0,0,4,7290880,7311360,7331840,7352320,117760,138240,158720,102400,7884800,0,7878912,64640,50,9846784,4294966976,8663296
.long 232960,1543680,7878272,8476288,0,0,0,0,0,0,0,0,45,0,0,4,7316480,7336960,7357440,7296000,133120,153600,112640,117760,7885056,0,7878976,1375360,1074,9872384,4294966976,8663808
.long 238080,1548800,7878400,8476416,0,0,0,0,0,0,0,0,46,0,0,4,7342080,7362560,7301120,7321600,148480,107520,128000,133120,7885312,1024,7879040,65920,51,9897984,4294966976,8664320
.long 243200,1553920,7878528,8476544,0,0,0,0,0,0,0,0,47,0,0,4,7367680,7306240,7326720,7347200,102400,122880,143360,148480,7885568,1024,7879104,1376640,1075,9923584,4294966976,8664832
.long 0,0,0,0,10,6,10,8470528,1968640,2643456,8569856,73728,0,106496,106496,4,4669440,4679680,4689920,4700160,0,0,0,0,7884800,8616960,7870720,64640,50,9846784,4294966976,0
.long 0,0,0,0,10,6,10,8472576,2050560,3298816,8591360,79872,0,107520,110592,4,4670464,4680704,4690944,4701184,8,0,0,0,7885056,8627712,7870784,1375360,1074,9872384,4294966976,0
.long 0,0,0,0,10,6,10,8474624,2132480,3954176,8612864,86016,0,108544,114688,4,4710400,4720640,4730880,4741120,1024,0,0,0,7885312,8616960,7870848,65920,51,9897984,4294966976,0
.long 0,0,0,0,10,6,10,8476672,2214400,4609536,8634368,92160,0,109568,118784,4,4711424,4721664,4731904,4742144,1032,0,0,0,7885568,8627712,7870912,1376640,1075,9923584,4294966976,0
.long 229120,1539840,7878144,8484352,0,0,0,0,0,0,0,0,44,0,0,4,7618560,7639040,7659520,7680000,117760,138240,158720,102400,7884800,0,7879936,74880,58,9846784,4294966976,8667392
.long 234240,1544960,7878272,8484480,0,0,0,0,0,0,0,0,45,0,0,4,7644160,7664640,7685120,7623680,133120,153600,112640,117760,7885056,0,7880000,1385600,1082,9872384,4294966976,8667904
.long 239360,1550080,7878400,8484608,0,0,0,0,0,0,0,0,46,0,0,4,7669760,7690240,7628800,7649280,148480,107520,128000,133120,7885312,1024,7880064,76160,59,9897984,4294966976,8668416
.long 244480,1555200,7878528,8484736,0,0,0,0,0,0,0,0,47,0,0,4,7695360,7633920,7654400,7674880,102400,122880,143360,148480,7885568,1024,7880128,1386880,1083,9923584,4294966976,8668928
.long 0,0,0,0,10,7,10,8470528,2296320,2643712,8572544,73728,0,106496,106496,4,4997120,5007360,5017600,5027840,0,0,0,0,7884800,8616960,7871744,74880,58,9846784,4294966976,0
.long 0,0,0,0,10,7,10,8472576,2378240,3299072,8594048,79872,0,107520,110592,4,4998144,5008384,5018624,5028864,8,0,0,0,7885056,8627712,7871808,1385600,1082,9872384,4294966976,0
.long 0,0,0,0,10,7,10,8474624,2460160,3954432,8615552,86016,0,108544,114688,4,5038080,5048320,5058560,5068800,1024,0,0,0,7885312,8616960,7871872,76160,59,9897984,4294966976,0
.long 0,0,0,0,10,7,10,8476672,2542080,4609792,8637056,92160,0,109568,118784,4,5039104,5049344,5059584,5069824,1032,0,0,0,7885568,8627712,7871936,1386880,1083,9923584,4294966976,0
.long 5734400,5736448,8388608,8644608,0,0,0,8486912,0,0,0,0,147456,147456,0,5,2714624,2724864,2735104,2704384,5128,0,0,0,7885824,8563200,7864640,1314080,1026,9949184,4294967056,0
.long 5737472,5736960,8392064,8644736,0,0,0,8491008,0,0,0,0,149760,152064,0,5,2754560,2764800,2775040,2744320,6144,0,0,0,7886080,8552448,7864704,4640,3,9974784,4294967056,0
.long 5816320,5818368,8395520,8644864,0,0,0,8495104,0,0,0,0,152064,147456,0,5,2755584,2765824,2776064,2745344,6152,0,0,0,7886336,8563200,7864768,1315360,1027,10000384,4294967056,0
.long 5819392,5818880,8398976,8644992,0,0,0,8499200,0,0,0,0,154368,152064,0,5,2713600,2723840,2734080,2703360,5120,0,0,0,7886592,8552448,7864576,3360,2,10025984,4294967056,0
.long 8454144,0,0,0,0,0,0,0,8450048,7882240,409760,9590784,0,0,0,5,5345280,5365760,5386240,5324800,133120,153600,112640,117760,7885824,5120,7872832,1314080,1026,9949184,4294967056,8638720
.long 8454144,0,0,0,0,0,0,0,8451072,7882240,409760,9595904,0,0,0,5,5370880,5391360,5329920,5350400,148480,107520,128000,133120,7886080,6144,7872896,4640,3,9974784,4294967056,8639232
.long 8454144,0,0,0,0,0,0,0,8452096,7882240,409760,9601024,0,0,0,5,5396480,5335040,5355520,5376000,102400,122880,143360,148480,7886336,6144,7872960,1315360,1027,10000384,4294967056,8639744
.long 8454144,0,0,0,0,0,0,0,8453120,7882240,409760,9601024,0,0,0,5,5340160,5360640,5381120,5401600,117760,138240,158720,102400,7886592,5120,7872768,3360,2,10025984,4294967056,8640256
.long 5739520,5741568,8402432,8645120,0,0,0,8503296,0,0,0,0,147456,147456,0,5,3042304,3052544,3062784,3032064,5128,0,0,0,7885824,8563200,7865664,1324320,1034,9949184,4294967056,0
.long 5742592,5742080,8405888,8645248,0,0,0,8507392,0,0,0,0,149760,152064,0,5,3082240,3092480,3102720,3072000,6144,0,0,0,7886080,8552448,7865728,14880,11,9974784,4294967056,0
.long 5821440,5823488,8409344,8645376,0,0,0,8511488,0,0,0,0,152064,147456,0,5,3083264,3093504,3103744,3073024,6152,0,0,0,7886336,8563200,7865792,1325600,1035,10000384,4294967056,0
.long 5824512,5824000,8412800,8645504,0,0,0,8515584,0,0,0,0,154368,152064,0,5,3041280,3051520,3061760,3031040,5120,0,0,0,7886592,8552448,7865600,13600,10,10025984,4294967056,0
.long 8459264,0,0,0,0,0,0,0,8455168,7882368,512160,9606144,0,0,0,5,5672960,5693440,5713920,5652480,133120,153600,112640,117760,7885824,5120,7873856,1324320,1034,9949184,4294967056,8642816
.long 8459264,0,0,0,0,0,0,0,8456192,7882368,512160,9611264,0,0,0,5,5698560,5719040,5657600,5678080,148480,107520,128000,133120,7886080,6144,7873920,14880,11,9974784,4294967056,8643328
.long 8459264,0,0,0,0,0,0,0,8457216,7882368,512160,9601536,0,0,0,5,5724160,5662720,5683200,5703680,102400,122880,143360,148480,7886336,6144,7873984,1325600,1035,10000384,4294967056,8643840
.long 8459264,0,0,0,0,0,0,0,8458240,7882368,512160,9601536,0,0,0,5,5667840,5688320,5708800,5729280,117760,138240,158720,102400,7886592,5120,7873792,13600,10,10025984,4294967056,8644352
.long 5744640,5746688,8416256,8645632,0,0,0,8519680,0,0,0,0,147456,147456,0,5,3369984,3380224,3390464,3359744,5128,0,0,0,7885824,8584704,7866688,1334560,1042,9949184,4294967056,0
.long 5747712,5747200,8419712,8645760,0,0,0,8523776,0,0,0,0,149760,152064,0,5,3409920,3420160,3430400,3399680,6144,0,0,0,7886080,8573952,7866752,25120,19,9974784,4294967056,0
.long 5826560,5828608,8423168,8645888,0,0,0,8527872,0,0,0,0,152064,147456,0,5,3410944,3421184,3431424,3400704,6152,0,0,0,7886336,8584704,7866816,1335840,1043,10000384,4294967056,0
.long 5829632,5829120,8426624,8646016,0,0,0,8531968,0,0,0,0,154368,152064,0,5,3368960,3379200,3389440,3358720,5120,0,0,0,7886592,8573952,7866624,23840,18,10025984,4294967056,0
.long 8464384,0,0,0,0,0,0,0,8460288,7882496,614560,9616384,0,0,0,5,6000640,6021120,6041600,5980160,133120,153600,112640,117760,7885824,5120,7874880,1334560,1042,9949184,4294967056,8646912
.long 8464384,0,0,0,0,0,0,0,8461312,7882496,614560,9621504,0,0,0,5,6026240,6046720,5985280,6005760,148480,107520,128000,133120,7886080,6144,7874944,25120,19,9974784,4294967056,8647424
.long 8464384,0,0,0,0,0,0,0,8462336,7882496,614560,9626624,0,0,0,5,6051840,5990400,6010880,6031360,102400,122880,143360,148480,7886336,6144,7875008,1335840,1043,10000384,4294967056,8647936
.long 8464384,0,0,0,0,0,0,0,8463360,7882496,614560,9626624,0,0,0,5,5995520,6016000,6036480,6056960,117760,138240,158720,102400,7886592,5120,7874816,23840,18,10025984,4294967056,8648448
.long 5749760,5751808,8430080,8646144,0,0,0,8536064,0,0,0,0,147456,147456,0,5,3697664,3707904,3718144,3687424,5128,0,0,0,7885824,8584704,7867712,1344800,1050,9949184,4294967056,0
.long 5752832,5752320,8433536,8646272,0,0,0,8540160,0,0,0,0,149760,152064,0,5,3737600,3747840,3758080,3727360,6144,0,0,0,7886080,8573952,7867776,35360,27,9974784,4294967056,0
.long 5831680,5833728,8436992,8646400,0,0,0,8544256,0,0,0,0,152064,147456,0,5,3738624,3748864,3759104,3728384,6152,0,0,0,7886336,8584704,7867840,1346080,1051,10000384,4294967056,0
.long 5834752,5834240,8440448,8646528,0,0,0,8548352,0,0,0,0,154368,152064,0,5,3696640,3706880,3717120,3686400,5120,0,0,0,7886592,8573952,7867648,34080,26,10025984,4294967056,0
.long 8469504,0,0,0,0,0,0,0,8465408,7882624,716960,9631744,0,0,0,5,6328320,6348800,6369280,6307840,133120,153600,112640,117760,7885824,5120,7875904,1344800,1050,9949184,4294967056,8651008
.long 8469504,0,0,0,0,0,0,0,8466432,7882624,716960,9636864,0,0,0,5,6353920,6374400,6312960,6333440,148480,107520,128000,133120,7886080,6144,7875968,35360,27,9974784,4294967056,8651520
.long 8469504,0,0,0,0,0,0,0,8467456,7882624,716960,9627136,0,0,0,5,6379520,6318080,6338560,6359040,102400,122880,143360,148480,7886336,6144,7876032,1346080,1051,10000384,4294967056,8652032
.long 8469504,0,0,0,0,0,0,0,8468480,7882624,716960,9627136,0,0,0,5,6323200,6343680,6364160,6384640,117760,138240,158720,102400,7886592,5120,7875840,34080,26,10025984,4294967056,8652544
.long 7045120,7047168,8388608,8660992,0,0,0,8486912,0,0,0,0,147456,147456,0,5,4025344,4035584,4045824,4015104,5128,0,0,0,7885824,8606208,7868736,1355040,1058,9949184,4294967056,0
.long 7048192,7047680,8392064,8661120,0,0,0,8491008,0,0,0,0,149760,152064,0,5,4065280,4075520,4085760,4055040,6144,0,0,0,7886080,8595456,7868800,45600,35,9974784,4294967056,0
.long 7127040,7129088,8395520,8661248,0,0,0,8495104,0,0,0,0,152064,147456,0,5,4066304,4076544,4086784,4056064,6152,0,0,0,7886336,8606208,7868864,1356320,1059,10000384,4294967056,0
.long 7130112,7129600,8398976,8661376,0,0,0,8499200,0,0,0,0,154368,152064,0,5,4024320,4034560,4044800,4014080,5120,0,0,0,7886592,8595456,7868672,44320,34,10025984,4294967056,0
.long 8617984,0,0,0,0,0,0,0,8613888,7886336,410400,10000384,0,0,0,5,6656000,6676480,6696960,6635520,133120,153600,112640,117760,7885824,5120,7876928,1355040,1058,9949184,4294967056,8655104
.long 8617984,0,0,0,0,0,0,0,8614912,7886336,410400,10005504,0,0,0,5,6681600,6702080,6640640,6661120,148480,107520,128000,133120,7886080,6144,7876992,45600,35,9974784,4294967056,8655616
.long 8617984,0,0,0,0,0,0,0,8615936,7886336,410400,10010624,0,0,0,5,6707200,6645760,6666240,6686720,102400,122880,143360,148480,7886336,6144,7877056,1356320,1059,10000384,4294967056,8656128
.long 8617984,0,0,0,0,0,0,0,8616960,7886336,410400,10010624,0,0,0,5,6650880,6671360,6691840,6712320,117760,138240,158720,102400,7886592,5120,7876864,44320,34,10025984,4294967056,8656640
.long 7050240,7052288,8402432,8661504,0,0,0,8503296,0,0,0,0,147456,147456,0,5,4353024,4363264,4373504,4342784,5128,0,0,0,7885824,8606208,7869760,1365280,1066,9949184,4294967056,0
.long 7053312,7052800,8405888,8661632,0,0,0,8507392,0,0,0,0,149760,152064,0,5,4392960,4403200,4413440,4382720,6144,0,0,0,7886080,8595456,7869824,55840,43,9974784,4294967056,0
.long 7132160,7134208,8409344,8661760,0,0,0,8511488,0,0,0,0,152064,147456,0,5,4393984,4404224,4414464,4383744,6152,0,0,0,7886336,8606208,7869888,1366560,1067,10000384,4294967056,0
.long 7135232,7134720,8412800,8661888,0,0,0,8515584,0,0,0,0,154368,152064,0,5,4352000,4362240,4372480,4341760,5120,0,0,0,7886592,8595456,7869696,54560,42,10025984,4294967056,0
.long 8623104,0,0,0,0,0,0,0,8619008,7886464,512800,10015744,0,0,0,5,6983680,7004160,7024640,6963200,133120,153600,112640,117760,7885824,5120,7877952,1365280,1066,9949184,4294967056,8659200
.long 8623104,0,0,0,0,0,0,0,8620032,7886464,512800,10020864,0,0,0,5,7009280,7029760,6968320,6988800,148480,107520,128000,133120,7886080,6144,7878016,55840,43,9974784,4294967056,8659712
.long 8623104,0,0,0,0,0,0,0,8621056,7886464,512800,10011136,0,0,0,5,7034880,6973440,6993920,7014400,102400,122880,143360,148480,7886336,6144,7878080,1366560,1067,10000384,4294967056,8660224
.long 8623104,0,0,0,0,0,0,0,8622080,7886464,512800,10011136,0,0,0,5,6978560,6999040,7019520,7040000,117760,138240,158720,102400,7886592,5120,7877888,54560,42,10025984,4294967056,8660736
.long 7055360,7057408,8416256,8662016,0,0,0,8519680,0,0,0,0,147456,147456,0,5,4680704,4690944,4701184,4670464,5128,0,0,0,7885824,8627712,7870784,1375520,1074,9949184,4294967056,0
.long 7058432,7057920,8419712,8662144,0,0,0,8523776,0,0,0,0,149760,152064,0,5,4720640,4730880,4741120,4710400,6144,0,0,0,7886080,8616960,7870848,66080,51,9974784,4294967056,0
.long 7137280,7139328,8423168,8662272,0,0,0,8527872,0,0,0,0,152064,147456,0,5,4721664,4731904,4742144,4711424,6152,0,0,0,7886336,8627712,7870912,1376800,1075,10000384,4294967056,0
.long 7140352,7139840,8426624,8662400,0,0,0,8531968,0,0,0,0,154368,152064,0,5,4679680,4689920,4700160,4669440,5120,0,0,0,7886592,8616960,7870720,64800,50,10025984,4294967056,0
.long 8628224,0,0,0,0,0,0,0,8624128,7886592,615200,10025984,0,0,0,5,7311360,7331840,7352320,7290880,133120,153600,112640,117760,7885824,5120,7878976,1375520,1074,9949184,4294967056,8663296
.long 8628224,0,0,0,0,0,0,0,8625152,7886592,615200,10031104,0,0,0,5,7336960,7357440,7296000,7316480,148480,107520,128000,133120,7886080,6144,7879040,66080,51,9974784,4294967056,8663808
.long 8628224,0,0,0,0,0,0,0,8626176,7886592,615200,10036224,0,0,0,5,7362560,7301120,7321600,7342080,102400,122880,143360,148480,7886336,6144,7879104,1376800,1075,10000384,4294967056,8664320
.long 8628224,0,0,0,0,0,0,0,8627200,7886592,615200,10036224,0,0,0,5,7306240,7326720,7347200,7367680,117760,138240,158720,102400,7886592,5120,7878912,64800,50,10025984,4294967056,8664832
.long 7060480,7062528,8430080,8662528,0,0,0,8536064,0,0,0,0,147456,147456,0,5,5008384,5018624,5028864,4998144,5128,0,0,0,7885824,8627712,7871808,1385760,1082,9949184,4294967056,0
.long 7063552,7063040,8433536,8662656,0,0,0,8540160,0,0,0,0,149760,152064,0,5,5048320,5058560,5068800,5038080,6144,0,0,0,7886080,8616960,7871872,76320,59,9974784,4294967056,0
.long 7142400,7144448,8436992,8662784,0,0,0,8544256,0,0,0,0,152064,147456,0,5,5049344,5059584,5069824,5039104,6152,0,0,0,7886336,8627712,7871936,1387040,1083,10000384,4294967056,0
.long 7145472,7144960,8440448,8662912,0,0,0,8548352,0,0,0,0,154368,152064,0,5,5007360,5017600,5027840,4997120,5120,0,0,0,7886592,8616960,7871744,75040,58,10025984,4294967056,0
.long 8633344,0,0,0,0,0,0,0,8629248,7886720,717600,10041344,0,0,0,5,7639040,7659520,7680000,7618560,133120,153600,112640,117760,7885824,5120,7880000,1385760,1082,9949184,4294967056,8667392
.long 8633344,0,0,0,0,0,0,0,8630272,7886720,717600,10046464,0,0,0,5,7664640,7685120,7623680,7644160,148480,107520,128000,133120,7886080,6144,7880064,76320,59,9974784,4294967056,8667904
.long 8633344,0,0,0,0,0,0,0,8631296,7886720,717600,10036736,0,0,0,5,7690240,7628800,7649280,7669760,102400,122880,143360,148480,7886336,6144,7880128,1387040,1083,10000384,4294967056,8668416
.long 8633344,0,0,0,0,0,0,0,8632320,7886720,717600,10036736,0,0,0,5,7633920,7654400,7674880,7695360,117760,138240,158720,102400,7886592,5120,7879936,75040,58,10025984,4294967056,8668928
.long 8388608,106496,106496,8487296,0,0,0,0,0,0,0,0,0,0,0,6,5365760,5386240,5324800,5345280,148480,107520,128000,133120,7886848,11264,7872896,4800,3,10051584,4294967136,8638720
.long 8390336,126976,110592,8489344,0,0,0,0,0,0,0,0,0,0,0,6,5391360,5329920,5350400,5370880,102400,122880,143360,148480,7887104,11264,7872960,1315520,1027,10077184,4294967136,8639232
.long 8392064,108544,126976,8491392,0,0,0,0,0,0,0,0,0,0,0,6,5335040,5355520,5376000,5396480,117760,138240,158720,102400,7887360,10240,7872768,3520,2,10102784,4294967136,8639744
.long 8393792,129024,131072,8493440,0,0,0,0,0,0,0,0,0,0,0,6,5360640,5381120,5401600,5340160,133120,153600,112640,117760,7887616,10240,7872832,1314240,1026,10128384,4294967136,8640256
.long 0,0,0,0,9,0,9,8462336,2304,2639872,8553600,73728,0,106496,106496,6,2764800,2775040,2744320,2754560,11264,0,0,0,7886848,8552448,7864704,4800,3,10051584,4294967136,0
.long 0,0,0,0,9,0,9,8464384,84224,3295232,8575104,79872,0,107520,110592,6,2765824,2776064,2745344,2755584,11272,0,0,0,7887104,8563200,7864768,1315520,1027,10077184,4294967136,0
.long 0,0,0,0,9,0,9,8466432,166144,3950592,8596608,86016,0,108544,114688,6,2723840,2734080,2703360,2713600,10240,0,0,0,7887360,8552448,7864576,3520,2,10102784,4294967136,0
.long 0,0,0,0,9,0,9,8468480,248064,4605952,8618112,92160,0,109568,118784,6,2724864,2735104,2704384,2714624,10248,0,0,0,7887616,8563200,7864640,1314240,1026,10128384,4294967136,0
.long 8402432,106496,106496,8503680,0,0,0,0,0,0,0,0,0,0,0,6,5693440,5713920,5652480,5672960,148480,107520,128000,133120,7886848,11264,7873920,15040,11,10051584,4294967136,8642816
.long 8404160,126976,110592,8505728,0,0,0,0,0,0,0,0,0,0,0,6,5719040,5657600,5678080,5698560,102400,122880,143360,148480,7887104,11264,7873984,1325760,1035,10077184,4294967136,8643328
.long 8405888,108544,126976,8507776,0,0,0,0,0,0,0,0,0,0,0,6,5662720,5683200,5703680,5724160,117760,138240,158720,102400,7887360,10240,7873792,13760,10,10102784,4294967136,8643840
.long 8407616,129024,131072,8509824,0,0,0,0,0,0,0,0,0,0,0,6,5688320,5708800,5729280,5667840,133120,153600,112640,117760,7887616,10240,7873856,1324480,1034,10128384,4294967136,8644352
.long 0,0,0,0,9,1,9,8462336,329984,2640128,8556288,73728,0,106496,106496,6,3092480,3102720,3072000,3082240,11264,0,0,0,7886848,8552448,7865728,15040,11,10051584,4294967136,0
.long 0,0,0,0,9,1,9,8464384,411904,3295488,8577792,79872,0,107520,110592,6,3093504,3103744,3073024,3083264,11272,0,0,0,7887104,8563200,7865792,1325760,1035,10077184,4294967136,0
.long 0,0,0,0,9,1,9,8466432,493824,3950848,8599296,86016,0,108544,114688,6,3051520,3061760,3031040,3041280,10240,0,0,0,7887360,8552448,7865600,13760,10,10102784,4294967136,0
.long 0,0,0,0,9,1,9,8468480,575744,4606208,8620800,92160,0,109568,118784,6,3052544,3062784,3032064,3042304,10248,0,0,0,7887616,8563200,7865664,1324480,1034,10128384,4294967136,0
.long 8416256,106496,106496,8520064,0,0,0,0,0,0,0,0,0,0,0,6,6021120,6041600,5980160,6000640,148480,107520,128000,133120,7886848,11264,7874944,25280,19,10051584,4294967136,8646912
.long 8417984,126976,110592,8522112,0,0,0,0,0,0,0,0,0,0,0,6,6046720,5985280,6005760,6026240,102400,122880,143360,148480,7887104,11264,7875008,1336000,1043,10077184,4294967136,8647424
.long 8419712,108544,126976,8524160,0,0,0,0,0,0,0,0,0,0,0,6,5990400,6010880,6031360,6051840,117760,138240,158720,102400,7887360,10240,7874816,24000,18,10102784,4294967136,8647936
.long 8421440,129024,131072,8526208,0,0,0,0,0,0,0,0,0,0,0,6,6016000,6036480,6056960,5995520,133120,153600,112640,117760,7887616,10240,7874880,1334720,1042,10128384,4294967136,8648448
.long 0,0,0,0,9,2,9,8462336,657664,2640384,8558976,73728,0,106496,106496,6,3420160,3430400,3399680,3409920,11264,0,0,0,7886848,8573952,7866752,25280,19,10051584,4294967136,0
.long 0,0,0,0,9,2,9,8464384,739584,3295744,8580480,79872,0,107520,110592,6,3421184,3431424,3400704,3410944,11272,0,0,0,7887104,8584704,7866816,1336000,1043,10077184,4294967136,0
.long 0,0,0,0,9,2,9,8466432,821504,3951104,8601984,86016,0,108544,114688,6,3379200,3389440,3358720,3368960,10240,0,0,0,7887360,8573952,7866624,24000,18,10102784,4294967136,0
.long 0,0,0,0,9,2,9,8468480,903424,4606464,8623488,92160,0,109568,118784,6,3380224,3390464,3359744,3369984,10248,0,0,0,7887616,8584704,7866688,1334720,1042,10128384,4294967136,0
.long 8430080,106496,106496,8536448,0,0,0,0,0,0,0,0,0,0,0,6,6348800,6369280,6307840,6328320,148480,107520,128000,133120,7886848,11264,7875968,35520,27,10051584,4294967136,8651008
.long 8431808,126976,110592,8538496,0,0,0,0,0,0,0,0,0,0,0,6,6374400,6312960,6333440,6353920,102400,122880,143360,148480,7887104,11264,7876032,1346240,1051,10077184,4294967136,8651520
.long 8433536,108544,126976,8540544,0,0,0,0,0,0,0,0,0,0,0,6,6318080,6338560,6359040,6379520,117760,138240,158720,102400,7887360,10240,7875840,34240,26,10102784,4294967136,8652032
.long 8435264,129024,131072,8542592,0,0,0,0,0,0,0,0,0,0,0,6,6343680,6364160,6384640,6323200,133120,153600,112640,117760,7887616,10240,7875904,1344960,1050,10128384,4294967136,8652544
.long 0,0,0,0,9,3,9,8462336,985344,2640640,8561664,73728,0,106496,106496,6,3747840,3758080,3727360,3737600,11264,0,0,0,7886848,8573952,7867776,35520,27,10051584,4294967136,0
.long 0,0,0,0,9,3,9,8464384,1067264,3296000,8583168,79872,0,107520,110592,6,3748864,3759104,3728384,3738624,11272,0,0,0,7887104,8584704,7867840,1346240,1051,10077184,4294967136,0
.long 0,0,0,0,9,3,9,8466432,1149184,3951360,8604672,86016,0,108544,114688,6,3706880,3717120,3686400,3696640,10240,0,0,0,7887360,8573952,7867648,34240,26,10102784,4294967136,0
.long 0,0,0,0,9,3,9,8468480,1231104,4606720,8626176,92160,0,109568,118784,6,3707904,3718144,3687424,3697664,10248,0,0,0,7887616,8584704,7867712,1344960,1050,10128384,4294967136,0
.long 8388608,106496,106496,8488320,0,0,0,0,0,0,0,0,0,0,0,6,6676480,6696960,6635520,6656000,148480,107520,128000,133120,7886848,11264,7876992,45760,35,10051584,4294967136,8655104
.long 8390336,126976,110592,8490368,0,0,0,0,0,0,0,0,0,0,0,6,6702080,6640640,6661120,6681600,102400,122880,143360,148480,7887104,11264,7877056,1356480,1059,10077184,4294967136,8655616
.long 8392064,108544,126976,8492416,0,0,0,0,0,0,0,0,0,0,0,6,6645760,6666240,6686720,6707200,117760,138240,158720,102400,7887360,10240,7876864,44480,34,10102784,4294967136,8656128
.long 8393792,129024,131072,8494464,0,0,0,0,0,0,0,0,0,0,0,6,6671360,6691840,6712320,6650880,133120,153600,112640,117760,7887616,10240,7876928,1355200,1058,10128384,4294967136,8656640
.long 0,0,0,0,9,4,9,8462336,1313024,2640896,8564352,73728,0,106496,106496,6,4075520,4085760,4055040,4065280,11264,0,0,0,7886848,8595456,7868800,45760,35,10051584,4294967136,0
.long 0,0,0,0,9,4,9,8464384,1394944,3296256,8585856,79872,0,107520,110592,6,4076544,4086784,4056064,4066304,11272,0,0,0,7887104,8606208,7868864,1356480,1059,10077184,4294967136,0
.long 0,0,0,0,9,4,9,8466432,1476864,3951616,8607360,86016,0,108544,114688,6,4034560,4044800,4014080,4024320,10240,0,0,0,7887360,8595456,7868672,44480,34,10102784,4294967136,0
.long 0,0,0,0,9,4,9,8468480,1558784,4606976,8628864,92160,0,109568,118784,6,4035584,4045824,4015104,4025344,10248,0,0,0,7887616,8606208,7868736,1355200,1058,10128384,4294967136,0
.long 8402432,106496,106496,8504704,0,0,0,0,0,0,0,0,0,0,0,6,7004160,7024640,6963200,6983680,148480,107520,128000,133120,7886848,11264,7878016,56000,43,10051584,4294967136,8659200
.long 8404160,126976,110592,8506752,0,0,0,0,0,0,0,0,0,0,0,6,7029760,6968320,6988800,7009280,102400,122880,143360,148480,7887104,11264,7878080,1366720,1067,10077184,4294967136,8659712
.long 8405888,108544,126976,8508800,0,0,0,0,0,0,0,0,0,0,0,6,6973440,6993920,7014400,7034880,117760,138240,158720,102400,7887360,10240,7877888,54720,42,10102784,4294967136,8660224
.long 8407616,129024,131072,8510848,0,0,0,0,0,0,0,0,0,0,0,6,6999040,7019520,7040000,6978560,133120,153600,112640,117760,7887616,10240,7877952,1365440,1066,10128384,4294967136,8660736
.long 0,0,0,0,9,5,9,8462336,1640704,2641152,8567040,73728,0,106496,106496,6,4403200,4413440,4382720,4392960,11264,0,0,0,7886848,8595456,7869824,56000,43,10051584,4294967136,0
.long 0,0,0,0,9,5,9,8464384,1722624,3296512,8588544,79872,0,107520,110592,6,4404224,4414464,4383744,4393984,11272,0,0,0,7887104,8606208,7869888,1366720,1067,10077184,4294967136,0
.long 0,0,0,0,9,5,9,8466432,1804544,3951872,8610048,86016,0,108544,114688,6,4362240,4372480,4341760,4352000,10240,0,0,0,7887360,8595456,7869696,54720,42,10102784,4294967136,0
.long 0,0,0,0,9,5,9,8468480,1886464,4607232,8631552,92160,0,109568,118784,6,4363264,4373504,4342784,4353024,10248,0,0,0,7887616,8606208,7869760,1365440,1066,10128384,4294967136,0
.long 8416256,106496,106496,8521088,0,0,0,0,0,0,0,0,0,0,0,6,7331840,7352320,7290880,7311360,148480,107520,128000,133120,7886848,11264,7879040,66240,51,10051584,4294967136,8663296
.long 8417984,126976,110592,8523136,0,0,0,0,0,0,0,0,0,0,0,6,7357440,7296000,7316480,7336960,102400,122880,143360,148480,7887104,11264,7879104,1376960,1075,10077184,4294967136,8663808
.long 8419712,108544,126976,8525184,0,0,0,0,0,0,0,0,0,0,0,6,7301120,7321600,7342080,7362560,117760,138240,158720,102400,7887360,10240,7878912,64960,50,10102784,4294967136,8664320
.long 8421440,129024,131072,8527232,0,0,0,0,0,0,0,0,0,0,0,6,7326720,7347200,7367680,7306240,133120,153600,112640,117760,7887616,10240,7878976,1375680,1074,10128384,4294967136,8664832
.long 0,0,0,0,9,6,9,8462336,1968384,2641408,8569728,73728,0,106496,106496,6,4730880,4741120,4710400,4720640,11264,0,0,0,7886848,8616960,7870848,66240,51,10051584,4294967136,0
.long 0,0,0,0,9,6,9,8464384,2050304,3296768,8591232,79872,0,107520,110592,6,4731904,4742144,4711424,4721664,11272,0,0,0,7887104,8627712,7870912,1376960,1075,10077184,4294967136,0
.long 0,0,0,0,9,6,9,8466432,2132224,3952128,8612736,86016,0,108544,114688,6,4689920,4700160,4669440,4679680,10240,0,0,0,7887360,8616960,7870720,64960,50,10102784,4294967136,0
.long 0,0,0,0,9,6,9,8468480,2214144,4607488,8634240,92160,0,109568,118784,6,4690944,4701184,4670464,4680704,10248,0,0,0,7887616,8627712,7870784,1375680,1074,10128384,4294967136,0
.long 8430080,106496,106496,8537472,0,0,0,0,0,0,0,0,0,0,0,6,7659520,7680000,7618560,7639040,148480,107520,128000,133120,7886848,11264,7880064,76480,59,10051584,4294967136,8667392
.long 8431808,126976,110592,8539520,0,0,0,0,0,0,0,0,0,0,0,6,7685120,7623680,7644160,7664640,102400,122880,143360,148480,7887104,11264,7880128,1387200,1083,10077184,4294967136,8667904
.long 8433536,108544,126976,8541568,0,0,0,0,0,0,0,0,0,0,0,6,7628800,7649280,7669760,7690240,117760,138240,158720,102400,7887360,10240,7879936,75200,58,10102784,4294967136,8668416
.long 8435264,129024,131072,8543616,0,0,0,0,0,0,0,0,0,0,0,6,7654400,7674880,7695360,7633920,133120,153600,112640,117760,7887616,10240,7880000,1385920,1082,10128384,4294967136,8668928
.long 0,0,0,0,9,7,9,8462336,2296064,2641664,8572416,73728,0,106496,106496,6,5058560,5068800,5038080,5048320,11264,0,0,0,7886848,8616960,7871872,76480,59,10051584,4294967136,0
.long 0,0,0,0,9,7,9,8464384,2377984,3297024,8593920,79872,0,107520,110592,6,5059584,5069824,5039104,5049344,11272,0,0,0,7887104,8627712,7871936,1387200,1083,10077184,4294967136,0
.long 0,0,0,0,9,7,9,8466432,2459904,3952384,8615424,86016,0,108544,114688,6,5017600,5027840,4997120,5007360,10240,0,0,0,7887360,8616960,7871744,75200,58,10102784,4294967136,0
.long 0,0,0,0,9,7,9,8468480,2541824,4607744,8636928,92160,0,109568,118784,6,5018624,5028864,4998144,5008384,10248,0,0,0,7887616,8627712,7871808,1385920,1082,10128384,4294967136,0
.long 8395520,106496,106496,8495488,0,0,0,0,0,0,0,0,0,0,0,7,5386240,5324800,5345280,5365760,102400,122880,143360,148480,7887872,16384,7872960,1315680,1027,10153984,4294967216,8638720
.long 8397248,126976,110592,8497536,0,0,0,0,0,0,0,0,0,0,0,7,5329920,5350400,5370880,5391360,117760,138240,158720,102400,7888128,15360,7872768,3680,2,10179584,4294967216,8639232
.long 8398976,108544,126976,8499584,0,0,0,0,0,0,0,0,0,0,0,7,5355520,5376000,5396480,5335040,133120,153600,112640,117760,7888384,15360,7872832,1314400,1026,10205184,4294967216,8639744
.long 8400704,129024,131072,8501632,0,0,0,0,0,0,0,0,0,0,0,7,5381120,5401600,5340160,5360640,148480,107520,128000,133120,7888640,16384,7872896,4960,3,10230784,4294967216,8640256
.long 0,0,0,0,11,0,11,8470528,2816,2643968,8553856,73728,0,106496,106496,7,2776064,2745344,2755584,2765824,16392,0,0,0,7887872,8563200,7864768,1315680,1027,10153984,4294967216,0
.long 0,0,0,0,11,0,11,8472576,84736,3299328,8575360,79872,0,107520,110592,7,2734080,2703360,2713600,2723840,15360,0,0,0,7888128,8552448,7864576,3680,2,10179584,4294967216,0
.long 0,0,0,0,11,0,11,8474624,166656,3954688,8596864,86016,0,108544,114688,7,2735104,2704384,2714624,2724864,15368,0,0,0,7888384,8563200,7864640,1314400,1026,10205184,4294967216,0
.long 0,0,0,0,11,0,11,8476672,248576,4610048,8618368,92160,0,109568,118784,7,2775040,2744320,2754560,2764800,16384,0,0,0,7888640,8552448,7864704,4960,3,10230784,4294967216,0
.long 8409344,106496,106496,8511872,0,0,0,0,0,0,0,0,0,0,0,7,5713920,5652480,5672960,5693440,102400,122880,143360,148480,7887872,16384,7873984,1325920,1035,10153984,4294967216,8642816
.long 8411072,126976,110592,8513920,0,0,0,0,0,0,0,0,0,0,0,7,5657600,5678080,5698560,5719040,117760,138240,158720,102400,7888128,15360,7873792,13920,10,10179584,4294967216,8643328
.long 8412800,108544,126976,8515968,0,0,0,0,0,0,0,0,0,0,0,7,5683200,5703680,5724160,5662720,133120,153600,112640,117760,7888384,15360,7873856,1324640,1034,10205184,4294967216,8643840
.long 8414528,129024,131072,8518016,0,0,0,0,0,0,0,0,0,0,0,7,5708800,5729280,5667840,5688320,148480,107520,128000,133120,7888640,16384,7873920,15200,11,10230784,4294967216,8644352
.long 0,0,0,0,11,1,11,8470528,330496,2644224,8556544,73728,0,106496,106496,7,3103744,3073024,3083264,3093504,16392,0,0,0,7887872,8563200,7865792,1325920,1035,10153984,4294967216,0
.long 0,0,0,0,11,1,11,8472576,412416,3299584,8578048,79872,0,107520,110592,7,3061760,3031040,3041280,3051520,15360,0,0,0,7888128,8552448,7865600,13920,10,10179584,4294967216,0
.long 0,0,0,0,11,1,11,8474624,494336,3954944,8599552,86016,0,108544,114688,7,3062784,3032064,3042304,3052544,15368,0,0,0,7888384,8563200,7865664,1324640,1034,10205184,4294967216,0
.long 0,0,0,0,11,1,11,8476672,576256,4610304,8621056,92160,0,109568,118784,7,3102720,3072000,3082240,3092480,16384,0,0,0,7888640,8552448,7865728,15200,11,10230784,4294967216,0
.long 8423168,106496,106496,8528256,0,0,0,0,0,0,0,0,0,0,0,7,6041600,5980160,6000640,6021120,102400,122880,143360,148480,7887872,16384,7875008,1336160,1043,10153984,4294967216,8646912
.long 8424896,126976,110592,8530304,0,0,0,0,0,0,0,0,0,0,0,7,5985280,6005760,6026240,6046720,117760,138240,158720,102400,7888128,15360,7874816,24160,18,10179584,4294967216,8647424
.long 8426624,108544,126976,8532352,0,0,0,0,0,0,0,0,0,0,0,7,6010880,6031360,6051840,5990400,133120,153600,112640,117760,7888384,15360,7874880,1334880,1042,10205184,4294967216,8647936
.long 8428352,129024,131072,8534400,0,0,0,0,0,0,0,0,0,0,0,7,6036480,6056960,5995520,6016000,148480,107520,128000,133120,7888640,16384,7874944,25440,19,10230784,4294967216,8648448
.long 0,0,0,0,11,2,11,8470528,658176,2644480,8559232,73728,0,106496,106496,7,3431424,3400704,3410944,3421184,16392,0,0,0,7887872,8584704,7866816,1336160,1043,10153984,4294967216,0
.long 0,0,0,0,11,2,11,8472576,740096,3299840,8580736,79872,0,107520,110592,7,3389440,3358720,3368960,3379200,15360,0,0,0,7888128,8573952,7866624,24160,18,10179584,4294967216,0
.long 0,0,0,0,11,2,11,8474624,822016,3955200,8602240,86016,0,108544,114688,7,3390464,3359744,3369984,3380224,15368,0,0,0,7888384,8584704,7866688,1334880,1042,10205184,4294967216,0
.long 0,0,0,0,11,2,11,8476672,903936,4610560,8623744,92160,0,109568,118784,7,3430400,3399680,3409920,3420160,16384,0,0,0,7888640,8573952,7866752,25440,19,10230784,4294967216,0
.long 8436992,106496,106496,8544640,0,0,0,0,0,0,0,0,0,0,0,7,6369280,6307840,6328320,6348800,102400,122880,143360,148480,7887872,16384,7876032,1346400,1051,10153984,4294967216,8651008
.long 8438720,126976,110592,8546688,0,0,0,0,0,0,0,0,0,0,0,7,6312960,6333440,6353920,6374400,117760,138240,158720,102400,7888128,15360,7875840,34400,26,10179584,4294967216,8651520
.long 8440448,108544,126976,8548736,0,0,0,0,0,0,0,0,0,0,0,7,6338560,6359040,6379520,6318080,133120,153600,112640,117760,7888384,15360,7875904,1345120,1050,10205184,4294967216,8652032
.long 8442176,129024,131072,8550784,0,0,0,0,0,0,0,0,0,0,0,7,6364160,6384640,6323200,6343680,148480,107520,128000,133120,7888640,16384,7875968,35680,27,10230784,4294967216,8652544
.long 0,0,0,0,11,3,11,8470528,985856,2644736,8561920,73728,0,106496,106496,7,3759104,3728384,3738624,3748864,16392,0,0,0,7887872,8584704,7867840,1346400,1051,10153984,4294967216,0
.long 0,0,0,0,11,3,11,8472576,1067776,3300096,8583424,79872,0,107520,110592,7,3717120,3686400,3696640,3706880,15360,0,0,0,7888128,8573952,7867648,34400,26,10179584,4294967216,0
.long 0,0,0,0,11,3,11,8474624,1149696,3955456,8604928,86016,0,108544,114688,7,3718144,3687424,3697664,3707904,15368,0,0,0,7888384,8584704,7867712,1345120,1050,10205184,4294967216,0
.long 0,0,0,0,11,3,11,8476672,1231616,4610816,8626432,92160,0,109568,118784,7,3758080,3727360,3737600,3747840,16384,0,0,0,7888640,8573952,7867776,35680,27,10230784,4294967216,0
.long 8395520,106496,106496,8496512,0,0,0,0,0,0,0,0,0,0,0,7,6696960,6635520,6656000,6676480,102400,122880,143360,148480,7887872,16384,7877056,1356640,1059,10153984,4294967216,8655104
.long 8397248,126976,110592,8498560,0,0,0,0,0,0,0,0,0,0,0,7,6640640,6661120,6681600,6702080,117760,138240,158720,102400,7888128,15360,7876864,44640,34,10179584,4294967216,8655616
.long 8398976,108544,126976,8500608,0,0,0,0,0,0,0,0,0,0,0,7,6666240,6686720,6707200,6645760,133120,153600,112640,117760,7888384,15360,7876928,1355360,1058,10205184,4294967216,8656128
.long 8400704,129024,131072,8502656,0,0,0,0,0,0,0,0,0,0,0,7,6691840,6712320,6650880,6671360,148480,107520,128000,133120,7888640,16384,7876992,45920,35,10230784,4294967216,8656640
.long 0,0,0,0,11,4,11,8470528,1313536,2644992,8564608,73728,0,106496,106496,7,4086784,4056064,4066304,4076544,16392,0,0,0,7887872,8606208,7868864,1356640,1059,10153984,4294967216,0
.long 0,0,0,0,11,4,11,8472576,1395456,3300352,8586112,79872,0,107520,110592,7,4044800,4014080,4024320,4034560,15360,0,0,0,7888128,8595456,7868672,44640,34,10179584,4294967216,0
.long 0,0,0,0,11,4,11,8474624,1477376,3955712,8607616,86016,0,108544,114688,7,4045824,4015104,4025344,4035584,15368,0,0,0,7888384,8606208,7868736,1355360,1058,10205184,4294967216,0
.long 0,0,0,0,11,4,11,8476672,1559296,4611072,8629120,92160,0,109568,118784,7,4085760,4055040,4065280,4075520,16384,0,0,0,7888640,8595456,7868800,45920,35,10230784,4294967216,0
.long 8409344,106496,106496,8512896,0,0,0,0,0,0,0,0,0,0,0,7,7024640,6963200,6983680,7004160,102400,122880,143360,148480,7887872,16384,7878080,1366880,1067,10153984,4294967216,8659200
.long 8411072,126976,110592,8514944,0,0,0,0,0,0,0,0,0,0,0,7,6968320,6988800,7009280,7029760,117760,138240,158720,102400,7888128,15360,7877888,54880,42,10179584,4294967216,8659712
.long 8412800,108544,126976,8516992,0,0,0,0,0,0,0,0,0,0,0,7,6993920,7014400,7034880,6973440,133120,153600,112640,117760,7888384,15360,7877952,1365600,1066,10205184,4294967216,8660224
.long 8414528,129024,131072,8519040,0,0,0,0,0,0,0,0,0,0,0,7,7019520,7040000,6978560,6999040,148480,107520,128000,133120,7888640,16384,7878016,56160,43,10230784,4294967216,8660736
.long 0,0,0,0,11,5,11,8470528,1641216,2645248,8567296,73728,0,106496,106496,7,4414464,4383744,4393984,4404224,16392,0,0,0,7887872,8606208,7869888,1366880,1067,10153984,4294967216,0
.long 0,0,0,0,11,5,11,8472576,1723136,3300608,8588800,79872,0,107520,110592,7,4372480,4341760,4352000,4362240,15360,0,0,0,7888128,8595456,7869696,54880,42,10179584,4294967216,0
.long 0,0,0,0,11,5,11,8474624,1805056,3955968,8610304,86016,0,108544,114688,7,4373504,4342784,4353024,4363264,15368,0,0,0,7888384,8606208,7869760,1365600,1066,10205184,4294967216,0
.long 0,0,0,0,11,5,11,8476672,1886976,4611328,8631808,92160,0,109568,118784,7,4413440,4382720,4392960,4403200,16384,0,0,0,7888640,8595456,7869824,56160,43,10230784,4294967216,0
.long 8423168,106496,106496,8529280,0,0,0,0,0,0,0,0,0,0,0,7,7352320,7290880,7311360,7331840,102400,122880,143360,148480,7887872,16384,7879104,1377120,1075,10153984,4294967216,8663296
.long 8424896,126976,110592,8531328,0,0,0,0,0,0,0,0,0,0,0,7,7296000,7316480,7336960,7357440,117760,138240,158720,102400,7888128,15360,7878912,65120,50,10179584,4294967216,8663808
.long 8426624,108544,126976,8533376,0,0,0,0,0,0,0,0,0,0,0,7,7321600,7342080,7362560,7301120,133120,153600,112640,117760,7888384,15360,7878976,1375840,1074,10205184,4294967216,8664320
.long 8428352,129024,131072,8535424,0,0,0,0,0,0,0,0,0,0,0,7,7347200,7367680,7306240,7326720,148480,107520,128000,133120,7888640,16384,7879040,66400,51,10230784,4294967216,8664832
.long 0,0,0,0,11,6,11,8470528,1968896,2645504,8569984,73728,0,106496,106496,7,4742144,4711424,4721664,4731904,16392,0,0,0,7887872,8627712,7870912,1377120,1075,10153984,4294967216,0
.long 0,0,0,0,11,6,11,8472576,2050816,3300864,8591488,79872,0,107520,110592,7,4700160,4669440,4679680,4689920,15360,0,0,0,7888128,8616960,7870720,65120,50,10179584,4294967216,0
.long 0,0,0,0,11,6,11,8474624,2132736,3956224,8612992,86016,0,108544,114688,7,4701184,4670464,4680704,4690944,15368,0,0,0,7888384,8627712,7870784,1375840,1074,10205184,4294967216,0
.long 0,0,0,0,11,6,11,8476672,2214656,4611584,8634496,92160,0,109568,118784,7,4741120,4710400,4720640,4730880,16384,0,0,0,7888640,8616960,7870848,66400,51,10230784,4294967216,0
.long 8436992,106496,106496,8545664,0,0,0,0,0,0,0,0,0,0,0,7,7680000,7618560,7639040,7659520,102400,122880,143360,148480,7887872,16384,7880128,1387360,1083,10153984,4294967216,8667392
.long 8438720,126976,110592,8547712,0,0,0,0,0,0,0,0,0,0,0,7,7623680,7644160,7664640,7685120,117760,138240,158720,102400,7888128,15360,7879936,75360,58,10179584,4294967216,8667904
.long 8440448,108544,126976,8549760,0,0,0,0,0,0,0,0,0,0,0,7,7649280,7669760,7690240,7628800,133120,153600,112640,117760,7888384,15360,7880000,1386080,1082,10205184,4294967216,8668416
.long 8442176,129024,131072,8551808,0,0,0,0,0,0,0,0,0,0,0,7,7674880,7695360,7633920,7654400,148480,107520,128000,133120,7888640,16384,7880064,76640,59,10230784,4294967216,8668928
.long 0,0,0,0,11,7,11,8470528,2296576,2645760,8572672,73728,0,106496,106496,7,5069824,5039104,5049344,5059584,16392,0,0,0,7887872,8627712,7871936,1387360,1083,10153984,4294967216,0
.long 0,0,0,0,11,7,11,8472576,2378496,3301120,8594176,79872,0,107520,110592,7,5027840,4997120,5007360,5017600,15360,0,0,0,7888128,8616960,7871744,75360,58,10179584,4294967216,0
.long 0,0,0,0,11,7,11,8474624,2460416,3956480,8615680,86016,0,108544,114688,7,5028864,4998144,5008384,5018624,15368,0,0,0,7888384,8627712,7871808,1386080,1082,10205184,4294967216,0
.long 0,0,0,0,11,7,11,8476672,2542336,4611840,8637184,92160,0,109568,118784,7,5068800,5038080,5048320,5058560,16384,0,0,0,7888640,8616960,7871872,76640,59,10230784,4294967216,0
.long 81920,1392640,7874560,8456192,0,0,0,0,0,0,0,0,16,0,0,0,5406720,5427200,5447680,5468160,117760,138240,158720,102400,7880704,0,7873024,5120,4,9437184,0,8640512
.long 87040,1397760,7874688,8456320,0,0,0,0,0,0,0,0,17,0,0,0,5432320,5452800,5473280,5411840,133120,153600,112640,117760,7880960,0,7873088,1315840,1028,9462784,0,8641024
.long 92160,1402880,7874816,8456448,0,0,0,0,0,0,0,0,18,0,0,0,5457920,5478400,5416960,5437440,148480,107520,128000,133120,7881216,1024,7873152,6400,5,9488384,0,8641536
.long 97280,1408000,7874944,8456576,0,0,0,0,0,0,0,0,19,0,0,0,5483520,5422080,5442560,5463040,102400,122880,143360,148480,7881472,1024,7873216,1317120,1029,9513984,0,8642048
.long 0,0,0,0,13,0,13,8470528,3328,2648064,8554112,73728,0,106496,106496,0,2785280,2795520,2805760,2816000,0,0,0,0,7880704,8552448,7864832,5120,4,9437184,0,0
.long 0,0,0,0,13,0,13,8472576,85248,3303424,8575616,79872,0,107520,110592,0,2786304,2796544,2806784,2817024,8,0,0,0,7880960,8563200,7864896,1315840,1028,9462784,0,0
.long 0,0,0,0,13,0,13,8474624,167168,3958784,8597120,86016,0,108544,114688,0,2826240,2836480,2846720,2856960,1024,0,0,0,7881216,8552448,7864960,6400,5,9488384,0,0
.long 0,0,0,0,13,0,13,8476672,249088,4614144,8618624,92160,0,109568,118784,0,2827264,2837504,2847744,2857984,1032,0,0,0,7881472,8563200,7865024,1317120,1029,9513984,0,0
.long 83200,1393920,7874560,8464384,0,0,0,0,0,0,0,0,16,0,0,0,5734400,5754880,5775360,5795840,117760,138240,158720,102400,7880704,0,7874048,15360,12,9437184,0,8644608
.long 88320,1399040,7874688,8464512,0,0,0,0,0,0,0,0,17,0,0,0,5760000,5780480,5800960,5739520,133120,153600,112640,117760,7880960,0,7874112,1326080,1036,9462784,0,8645120
.long 93440,1404160,7874816,8464640,0,0,0,0,0,0,0,0,18,0,0,0,5785600,5806080,5744640,5765120,148480,107520,128000,133120,7881216,1024,7874176,16640,13,9488384,0,8645632
.long 98560,1409280,7874944,8464768,0,0,0,0,0,0,0,0,19,0,0,0,5811200,5749760,5770240,5790720,102400,122880,143360,148480,7881472,1024,7874240,1327360,1037,9513984,0,8646144
.long 0,0,0,0,13,1,13,8470528,331008,2648320,8556800,73728,0,106496,106496,0,3112960,3123200,3133440,3143680,0,0,0,0,7880704,8552448,7865856,15360,12,9437184,0,0
.long 0,0,0,0,13,1,13,8472576,412928,3303680,8578304,79872,0,107520,110592,0,3113984,3124224,3134464,3144704,8,0,0,0,7880960,8563200,7865920,1326080,1036,9462784,0,0
.long 0,0,0,0,13,1,13,8474624,494848,3959040,8599808,86016,0,108544,114688,0,3153920,3164160,3174400,3184640,1024,0,0,0,7881216,8552448,7865984,16640,13,9488384,0,0
.long 0,0,0,0,13,1,13,8476672,576768,4614400,8621312,92160,0,109568,118784,0,3154944,3165184,3175424,3185664,1032,0,0,0,7881472,8563200,7866048,1327360,1037,9513984,0,0
.long 84480,1395200,7874560,8472576,0,0,0,0,0,0,0,0,16,0,0,0,6062080,6082560,6103040,6123520,117760,138240,158720,102400,7880704,0,7875072,25600,20,9437184,0,8648704
.long 89600,1400320,7874688,8472704,0,0,0,0,0,0,0,0,17,0,0,0,6087680,6108160,6128640,6067200,133120,153600,112640,117760,7880960,0,7875136,1336320,1044,9462784,0,8649216
.long 94720,1405440,7874816,8472832,0,0,0,0,0,0,0,0,18,0,0,0,6113280,6133760,6072320,6092800,148480,107520,128000,133120,7881216,1024,7875200,26880,21,9488384,0,8649728
.long 99840,1410560,7874944,8472960,0,0,0,0,0,0,0,0,19,0,0,0,6138880,6077440,6097920,6118400,102400,122880,143360,148480,7881472,1024,7875264,1337600,1045,9513984,0,8650240
.long 0,0,0,0,13,2,13,8470528,658688,2648576,8559488,73728,0,106496,106496,0,3440640,3450880,3461120,3471360,0,0,0,0,7880704,8573952,7866880,25600,20,9437184,0,0
.long 0,0,0,0,13,2,13,8472576,740608,3303936,8580992,79872,0,107520,110592,0,3441664,3451904,3462144,3472384,8,0,0,0,7880960,8584704,7866944,1336320,1044,9462784,0,0
.long 0,0,0,0,13,2,13,8474624,822528,3959296,8602496,86016,0,108544,114688,0,3481600,3491840,3502080,3512320,1024,0,0,0,7881216,8573952,7867008,26880,21,9488384,0,0
.long 0,0,0,0,13,2,13,8476672,904448,4614656,8624000,92160,0,109568,118784,0,3482624,3492864,3503104,3513344,1032,0,0,0,7881472,8584704,7867072,1337600,1045,9513984,0,0
.long 85760,1396480,7874560,8480768,0,0,0,0,0,0,0,0,16,0,0,0,6389760,6410240,6430720,6451200,117760,138240,158720,102400,7880704,0,7876096,35840,28,9437184,0,8652800
.long 90880,1401600,7874688,8480896,0,0,0,0,0,0,0,0,17,0,0,0,6415360,6435840,6456320,6394880,133120,153600,112640,117760,7880960,0,7876160,1346560,1052,9462784,0,8653312
.long 96000,1406720,7874816,8481024,0,0,0,0,0,0,0,0,18,0,0,0,6440960,6461440,6400000,6420480,148480,107520,128000,133120,7881216,1024,7876224,37120,29,9488384,0,8653824
.long 101120,1411840,7874944,8481152,0,0,0,0,0,0,0,0,19,0,0,0,6466560,6405120,6425600,6446080,102400,122880,143360,148480,7881472,1024,7876288,1347840,1053,9513984,0,8654336
.long 0,0,0,0,13,3,13,8470528,986368,2648832,8562176,73728,0,106496,106496,0,3768320,3778560,3788800,3799040,0,0,0,0,7880704,8573952,7867904,35840,28,9437184,0,0
.long 0,0,0,0,13,3,13,8472576,1068288,3304192,8583680,79872,0,107520,110592,0,3769344,3779584,3789824,3800064,8,0,0,0,7880960,8584704,7867968,1346560,1052,9462784,0,0
.long 0,0,0,0,13,3,13,8474624,1150208,3959552,8605184,86016,0,108544,114688,0,3809280,3819520,3829760,3840000,1024,0,0,0,7881216,8573952,7868032,37120,29,9488384,0,0
.long 0,0,0,0,13,3,13,8476672,1232128,4614912,8626688,92160,0,109568,118784,0,3810304,3820544,3830784,3841024,1032,0,0,0,7881472,8584704,7868096,1347840,1053,9513984,0,0
.long 245760,1556480,7878656,8460288,0,0,0,0,0,0,0,0,48,0,0,0,6717440,6737920,6758400,6778880,117760,138240,158720,102400,7880704,0,7877120,46080,36,9437184,0,8656896
.long 250880,1561600,7878784,8460416,0,0,0,0,0,0,0,0,49,0,0,0,6743040,6763520,6784000,6722560,133120,153600,112640,117760,7880960,0,7877184,1356800,1060,9462784,0,8657408
.long 256000,1566720,7878912,8460544,0,0,0,0,0,0,0,0,50,0,0,0,6768640,6789120,6727680,6748160,148480,107520,128000,133120,7881216,1024,7877248,47360,37,9488384,0,8657920
.long 261120,1571840,7879040,8460672,0,0,0,0,0,0,0,0,51,0,0,0,6794240,6732800,6753280,6773760,102400,122880,143360,148480,7881472,1024,7877312,1358080,1061,9513984,0,8658432
.long 0,0,0,0,13,4,13,8470528,1314048,2649088,8564864,73728,0,106496,106496,0,4096000,4106240,4116480,4126720,0,0,0,0,7880704,8595456,7868928,46080,36,9437184,0,0
.long 0,0,0,0,13,4,13,8472576,1395968,3304448,8586368,79872,0,107520,110592,0,4097024,4107264,4117504,4127744,8,0,0,0,7880960,8606208,7868992,1356800,1060,9462784,0,0
.long 0,0,0,0,13,4,13,8474624,1477888,3959808,8607872,86016,0,108544,114688,0,4136960,4147200,4157440,4167680,1024,0,0,0,7881216,8595456,7869056,47360,37,9488384,0,0
.long 0,0,0,0,13,4,13,8476672,1559808,4615168,8629376,92160,0,109568,118784,0,4137984,4148224,4158464,4168704,1032,0,0,0,7881472,8606208,7869120,1358080,1061,9513984,0,0
.long 247040,1557760,7878656,8468480,0,0,0,0,0,0,0,0,48,0,0,0,7045120,7065600,7086080,7106560,117760,138240,158720,102400,7880704,0,7878144,56320,44,9437184,0,8660992
.long 252160,1562880,7878784,8468608,0,0,0,0,0,0,0,0,49,0,0,0,7070720,7091200,7111680,7050240,133120,153600,112640,117760,7880960,0,7878208,1367040,1068,9462784,0,8661504
.long 257280,1568000,7878912,8468736,0,0,0,0,0,0,0,0,50,0,0,0,7096320,7116800,7055360,7075840,148480,107520,128000,133120,7881216,1024,7878272,57600,45,9488384,0,8662016
.long 262400,1573120,7879040,8468864,0,0,0,0,0,0,0,0,51,0,0,0,7121920,7060480,7080960,7101440,102400,122880,143360,148480,7881472,1024,7878336,1368320,1069,9513984,0,8662528
.long 0,0,0,0,13,5,13,8470528,1641728,2649344,8567552,73728,0,106496,106496,0,4423680,4433920,4444160,4454400,0,0,0,0,7880704,8595456,7869952,56320,44,9437184,0,0
.long 0,0,0,0,13,5,13,8472576,1723648,3304704,8589056,79872,0,107520,110592,0,4424704,4434944,4445184,4455424,8,0,0,0,7880960,8606208,7870016,1367040,1068,9462784,0,0
.long 0,0,0,0,13,5,13,8474624,1805568,3960064,8610560,86016,0,108544,114688,0,4464640,4474880,4485120,4495360,1024,0,0,0,7881216,8595456,7870080,57600,45,9488384,0,0
.long 0,0,0,0,13,5,13,8476672,1887488,4615424,8632064,92160,0,109568,118784,0,4465664,4475904,4486144,4496384,1032,0,0,0,7881472,8606208,7870144,1368320,1069,9513984,0,0
.long 248320,1559040,7878656,8476672,0,0,0,0,0,0,0,0,48,0,0,0,7372800,7393280,7413760,7434240,117760,138240,158720,102400,7880704,0,7879168,66560,52,9437184,0,8665088
.long 253440,1564160,7878784,8476800,0,0,0,0,0,0,0,0,49,0,0,0,7398400,7418880,7439360,7377920,133120,153600,112640,117760,7880960,0,7879232,1377280,1076,9462784,0,8665600
.long 258560,1569280,7878912,8476928,0,0,0,0,0,0,0,0,50,0,0,0,7424000,7444480,7383040,7403520,148480,107520,128000,133120,7881216,1024,7879296,67840,53,9488384,0,8666112
.long 263680,1574400,7879040,8477056,0,0,0,0,0,0,0,0,51,0,0,0,7449600,7388160,7408640,7429120,102400,122880,143360,148480,7881472,1024,7879360,1378560,1077,9513984,0,8666624
.long 0,0,0,0,13,6,13,8470528,1969408,2649600,8570240,73728,0,106496,106496,0,4751360,4761600,4771840,4782080,0,0,0,0,7880704,8616960,7870976,66560,52,9437184,0,0
.long 0,0,0,0,13,6,13,8472576,2051328,3304960,8591744,79872,0,107520,110592,0,4752384,4762624,4772864,4783104,8,0,0,0,7880960,8627712,7871040,1377280,1076,9462784,0,0
.long 0,0,0,0,13,6,13,8474624,2133248,3960320,8613248,86016,0,108544,114688,0,4792320,4802560,4812800,4823040,1024,0,0,0,7881216,8616960,7871104,67840,53,9488384,0,0
.long 0,0,0,0,13,6,13,8476672,2215168,4615680,8634752,92160,0,109568,118784,0,4793344,4803584,4813824,4824064,1032,0,0,0,7881472,8627712,7871168,1378560,1077,9513984,0,0
.long 249600,1560320,7878656,8484864,0,0,0,0,0,0,0,0,48,0,0,0,7700480,7720960,7741440,7761920,117760,138240,158720,102400,7880704,0,7880192,76800,60,9437184,0,8669184
.long 254720,1565440,7878784,8484992,0,0,0,0,0,0,0,0,49,0,0,0,7726080,7746560,7767040,7705600,133120,153600,112640,117760,7880960,0,7880256,1387520,1084,9462784,0,8669696
.long 259840,1570560,7878912,8485120,0,0,0,0,0,0,0,0,50,0,0,0,7751680,7772160,7710720,7731200,148480,107520,128000,133120,7881216,1024,7880320,78080,61,9488384,0,8670208
.long 264960,1575680,7879040,8485248,0,0,0,0,0,0,0,0,51,0,0,0,7777280,7715840,7736320,7756800,102400,122880,143360,148480,7881472,1024,7880384,1388800,1085,9513984,0,8670720
.long 0,0,0,0,13,7,13,8470528,2297088,2649856,8572928,73728,0,106496,106496,0,5079040,5089280,5099520,5109760,0,0,0,0,7880704,8616960,7872000,76800,60,9437184,0,0
.long 0,0,0,0,13,7,13,8472576,2379008,3305216,8594432,79872,0,107520,110592,0,5080064,5090304,5100544,5110784,8,0,0,0,7880960,8627712,7872064,1387520,1084,9462784,0,0
.long 0,0,0,0,13,7,13,8474624,2460928,3960576,8615936,86016,0,108544,114688,0,5120000,5130240,5140480,5150720,1024,0,0,0,7881216,8616960,7872128,78080,61,9488384,0,0
.long 0,0,0,0,13,7,13,8476672,2542848,4615936,8637440,92160,0,109568,118784,0,5121024,5131264,5141504,5151744,1032,0,0,0,7881472,8627712,7872192,1388800,1085,9513984,0,0
.long 5898240,5900288,8388608,8646656,0,0,0,8486912,0,0,0,0,147456,147456,0,1,2796544,2806784,2817024,2786304,5128,0,0,0,7881728,8563200,7864896,1316000,1028,9539584,80,0
.long 5901312,5900800,8392064,8646784,0,0,0,8491008,0,0,0,0,149760,152064,0,1,2836480,2846720,2856960,2826240,6144,0,0,0,7881984,8552448,7864960,6560,5,9565184,80,0
.long 5980160,5982208,8395520,8646912,0,0,0,8495104,0,0,0,0,152064,147456,0,1,2837504,2847744,2857984,2827264,6152,0,0,0,7882240,8563200,7865024,1317280,1029,9590784,80,0
.long 5983232,5982720,8398976,8647040,0,0,0,8499200,0,0,0,0,154368,152064,0,1,2795520,2805760,2816000,2785280,5120,0,0,0,7882496,8552448,7864832,5280,4,9616384,80,0
.long 8474624,0,0,0,0,0,0,0,8470528,7882752,320,9641984,0,0,0,1,5427200,5447680,5468160,5406720,133120,153600,112640,117760,7881728,5120,7873088,1316000,1028,9539584,80,8640512
.long 8474624,0,0,0,0,0,0,0,8471552,7882752,320,9647104,0,0,0,1,5452800,5473280,5411840,5432320,148480,107520,128000,133120,7881984,6144,7873152,6560,5,9565184,80,8641024
.long 8474624,0,0,0,0,0,0,0,8472576,7882752,320,9652224,0,0,0,1,5478400,5416960,5437440,5457920,102400,122880,143360,148480,7882240,6144,7873216,1317280,1029,9590784,80,8641536
.long 8474624,0,0,0,0,0,0,0,8473600,7882752,320,9652224,0,0,0,1,5422080,5442560,5463040,5483520,117760,138240,158720,102400,7882496,5120,7873024,5280,4,9616384,80,8642048
.long 5903360,5905408,8402432,8647168,0,0,0,8503296,0,0,0,0,147456,147456,0,1,3124224,3134464,3144704,3113984,5128,0,0,0,7881728,8563200,7865920,1326240,1036,9539584,80,0
.long 5906432,5905920,8405888,8647296,0,0,0,8507392,0,0,0,0,149760,152064,0,1,3164160,3174400,3184640,3153920,6144,0,0,0,7881984,8552448,7865984,16800,13,9565184,80,0
.long 5985280,5987328,8409344,8647424,0,0,0,8511488,0,0,0,0,152064,147456,0,1,3165184,3175424,3185664,3154944,6152,0,0,0,7882240,8563200,7866048,1327520,1037,9590784,80,0
.long 5988352,5987840,8412800,8647552,0,0,0,8515584,0,0,0,0,154368,152064,0,1,3123200,3133440,3143680,3112960,5120,0,0,0,7882496,8552448,7865856,15520,12,9616384,80,0
.long 8479744,0,0,0,0,0,0,0,8475648,7882880,102720,9657344,0,0,0,1,5754880,5775360,5795840,5734400,133120,153600,112640,117760,7881728,5120,7874112,1326240,1036,9539584,80,8644608
.long 8479744,0,0,0,0,0,0,0,8476672,7882880,102720,9662464,0,0,0,1,5780480,5800960,5739520,5760000,148480,107520,128000,133120,7881984,6144,7874176,16800,13,9565184,80,8645120
.long 8479744,0,0,0,0,0,0,0,8477696,7882880,102720,9652736,0,0,0,1,5806080,5744640,5765120,5785600,102400,122880,143360,148480,7882240,6144,7874240,1327520,1037,9590784,80,8645632
.long 8479744,0,0,0,0,0,0,0,8478720,7882880,102720,9652736,0,0,0,1,5749760,5770240,5790720,5811200,117760,138240,158720,102400,7882496,5120,7874048,15520,12,9616384,80,8646144
.long 5908480,5910528,8416256,8647680,0,0,0,8519680,0,0,0,0,147456,147456,0,1,3451904,3462144,3472384,3441664,5128,0,0,0,7881728,8584704,7866944,1336480,1044,9539584,80,0
.long 5911552,5911040,8419712,8647808,0,0,0,8523776,0,0,0,0,149760,152064,0,1,3491840,3502080,3512320,3481600,6144,0,0,0,7881984,8573952,7867008,27040,21,9565184,80,0
.long 5990400,5992448,8423168,8647936,0,0,0,8527872,0,0,0,0,152064,147456,0,1,3492864,3503104,3513344,3482624,6152,0,0,0,7882240,8584704,7867072,1337760,1045,9590784,80,0
.long 5993472,5992960,8426624,8648064,0,0,0,8531968,0,0,0,0,154368,152064,0,1,3450880,3461120,3471360,3440640,5120,0,0,0,7882496,8573952,7866880,25760,20,9616384,80,0
.long 8484864,0,0,0,0,0,0,0,8480768,7883008,205120,9667584,0,0,0,1,6082560,6103040,6123520,6062080,133120,153600,112640,117760,7881728,5120,7875136,1336480,1044,9539584,80,8648704
.long 8484864,0,0,0,0,0,0,0,8481792,7883008,205120,9672704,0,0,0,1,6108160,6128640,6067200,6087680,148480,107520,128000,133120,7881984,6144,7875200,27040,21,9565184,80,8649216
.long 8484864,0,0,0,0,0,0,0,8482816,7883008,205120,9677824,0,0,0,1,6133760,6072320,6092800,6113280,102400,122880,143360,148480,7882240,6144,7875264,1337760,1045,9590784,80,8649728
.long 8484864,0,0,0,0,0,0,0,8483840,7883008,205120,9677824,0,0,0,1,6077440,6097920,6118400,6138880,117760,138240,158720,102400,7882496,5120,7875072,25760,20,9616384,80,8650240
.long 5913600,5915648,8430080,8648192,0,0,0,8536064,0,0,0,0,147456,147456,0,1,3779584,3789824,3800064,3769344,5128,0,0,0,7881728,8584704,7867968,1346720,1052,9539584,80,0
.long 5916672,5916160,8433536,8648320,0,0,0,8540160,0,0,0,0,149760,152064,0,1,3819520,3829760,3840000,3809280,6144,0,0,0,7881984,8573952,7868032,37280,29,9565184,80,0
.long 5995520,5997568,8436992,8648448,0,0,0,8544256,0,0,0,0,152064,147456,0,1,3820544,3830784,3841024,3810304,6152,0,0,0,7882240,8584704,7868096,1348000,1053,9590784,80,0
.long 5998592,5998080,8440448,8648576,0,0,0,8548352,0,0,0,0,154368,152064,0,1,3778560,3788800,3799040,3768320,5120,0,0,0,7882496,8573952,7867904,36000,28,9616384,80,0
.long 8489984,0,0,0,0,0,0,0,8485888,7883136,307520,9682944,0,0,0,1,6410240,6430720,6451200,6389760,133120,153600,112640,117760,7881728,5120,7876160,1346720,1052,9539584,80,8652800
.long 8489984,0,0,0,0,0,0,0,8486912,7883136,307520,9688064,0,0,0,1,6435840,6456320,6394880,6415360,148480,107520,128000,133120,7881984,6144,7876224,37280,29,9565184,80,8653312
.long 8489984,0,0,0,0,0,0,0,8487936,7883136,307520,9678336,0,0,0,1,6461440,6400000,6420480,6440960,102400,122880,143360,148480,7882240,6144,7876288,1348000,1053,9590784,80,8653824
.long 8489984,0,0,0,0,0,0,0,8488960,7883136,307520,9678336,0,0,0,1,6405120,6425600,6446080,6466560,117760,138240,158720,102400,7882496,5120,7876096,36000,28,9616384,80,8654336
.long 7208960,7211008,8388608,8663040,0,0,0,8486912,0,0,0,0,147456,147456,0,1,4107264,4117504,4127744,4097024,5128,0,0,0,7881728,8606208,7868992,1356960,1060,9539584,80,0
.long 7212032,7211520,8392064,8663168,0,0,0,8491008,0,0,0,0,149760,152064,0,1,4147200,4157440,4167680,4136960,6144,0,0,0,7881984,8595456,7869056,47520,37,9565184,80,0
.long 7290880,7292928,8395520,8663296,0,0,0,8495104,0,0,0,0,152064,147456,0,1,4148224,4158464,4168704,4137984,6152,0,0,0,7882240,8606208,7869120,1358240,1061,9590784,80,0
.long 7293952,7293440,8398976,8663424,0,0,0,8499200,0,0,0,0,154368,152064,0,1,4106240,4116480,4126720,4096000,5120,0,0,0,7882496,8595456,7868928,46240,36,9616384,80,0
.long 8638464,0,0,0,0,0,0,0,8634368,7886848,960,10051584,0,0,0,1,6737920,6758400,6778880,6717440,133120,153600,112640,117760,7881728,5120,7877184,1356960,1060,9539584,80,8656896
.long 8638464,0,0,0,0,0,0,0,8635392,7886848,960,10056704,0,0,0,1,6763520,6784000,6722560,6743040,148480,107520,128000,133120,7881984,6144,7877248,47520,37,9565184,80,8657408
.long 8638464,0,0,0,0,0,0,0,8636416,7886848,960,10061824,0,0,0,1,6789120,6727680,6748160,6768640,102400,122880,143360,148480,7882240,6144,7877312,1358240,1061,9590784,80,8657920
.long 8638464,0,0,0,0,0,0,0,8637440,7886848,960,10061824,0,0,0,1,6732800,6753280,6773760,6794240,117760,138240,158720,102400,7882496,5120,7877120,46240,36,9616384,80,8658432
.long 7214080,7216128,8402432,8663552,0,0,0,8503296,0,0,0,0,147456,147456,0,1,4434944,4445184,4455424,4424704,5128,0,0,0,7881728,8606208,7870016,1367200,1068,9539584,80,0
.long 7217152,7216640,8405888,8663680,0,0,0,8507392,0,0,0,0,149760,152064,0,1,4474880,4485120,4495360,4464640,6144,0,0,0,7881984,8595456,7870080,57760,45,9565184,80,0
.long 7296000,7298048,8409344,8663808,0,0,0,8511488,0,0,0,0,152064,147456,0,1,4475904,4486144,4496384,4465664,6152,0,0,0,7882240,8606208,7870144,1368480,1069,9590784,80,0
.long 7299072,7298560,8412800,8663936,0,0,0,8515584,0,0,0,0,154368,152064,0,1,4433920,4444160,4454400,4423680,5120,0,0,0,7882496,8595456,7869952,56480,44,9616384,80,0
.long 8643584,0,0,0,0,0,0,0,8639488,7886976,103360,10066944,0,0,0,1,7065600,7086080,7106560,7045120,133120,153600,112640,117760,7881728,5120,7878208,1367200,1068,9539584,80,8660992
.long 8643584,0,0,0,0,0,0,0,8640512,7886976,103360,10072064,0,0,0,1,7091200,7111680,7050240,7070720,148480,107520,128000,133120,7881984,6144,7878272,57760,45,9565184,80,8661504
.long 8643584,0,0,0,0,0,0,0,8641536,7886976,103360,10062336,0,0,0,1,7116800,7055360,7075840,7096320,102400,122880,143360,148480,7882240,6144,7878336,1368480,1069,9590784,80,8662016
.long 8643584,0,0,0,0,0,0,0,8642560,7886976,103360,10062336,0,0,0,1,7060480,7080960,7101440,7121920,117760,138240,158720,102400,7882496,5120,7878144,56480,44,9616384,80,8662528
.long 7219200,7221248,8416256,8664064,0,0,0,8519680,0,0,0,0,147456,147456,0,1,4762624,4772864,4783104,4752384,5128,0,0,0,7881728,8627712,7871040,1377440,1076,9539584,80,0
.long 7222272,7221760,8419712,8664192,0,0,0,8523776,0,0,0,0,149760,152064,0,1,4802560,4812800,4823040,4792320,6144,0,0,0,7881984,8616960,7871104,68000,53,9565184,80,0
.long 7301120,7303168,8423168,8664320,0,0,0,8527872,0,0,0,0,152064,147456,0,1,4803584,4813824,4824064,4793344,6152,0,0,0,7882240,8627712,7871168,1378720,1077,9590784,80,0
.long 7304192,7303680,8426624,8664448,0,0,0,8531968,0,0,0,0,154368,152064,0,1,4761600,4771840,4782080,4751360,5120,0,0,0,7882496,8616960,7870976,66720,52,9616384,80,0
.long 8648704,0,0,0,0,0,0,0,8644608,7887104,205760,10077184,0,0,0,1,7393280,7413760,7434240,7372800,133120,153600,112640,117760,7881728,5120,7879232,1377440,1076,9539584,80,8665088
.long 8648704,0,0,0,0,0,0,0,8645632,7887104,205760,10082304,0,0,0,1,7418880,7439360,7377920,7398400,148480,107520,128000,133120,7881984,6144,7879296,68000,53,9565184,80,8665600
.long 8648704,0,0,0,0,0,0,0,8646656,7887104,205760,10087424,0,0,0,1,7444480,7383040,7403520,7424000,102400,122880,143360,148480,7882240,6144,7879360,1378720,1077,9590784,80,8666112
.long 8648704,0,0,0,0,0,0,0,8647680,7887104,205760,10087424,0,0,0,1,7388160,7408640,7429120,7449600,117760,138240,158720,102400,7882496,5120,7879168,66720,52,9616384,80,8666624
.long 7224320,7226368,8430080,8664576,0,0,0,8536064,0,0,0,0,147456,147456,0,1,5090304,5100544,5110784,5080064,5128,0,0,0,7881728,8627712,7872064,1387680,1084,9539584,80,0
.long 7227392,7226880,8433536,8664704,0,0,0,8540160,0,0,0,0,149760,152064,0,1,5130240,5140480,5150720,5120000,6144,0,0,0,7881984,8616960,7872128,78240,61,9565184,80,0
.long 7306240,7308288,8436992,8664832,0,0,0,8544256,0,0,0,0,152064,147456,0,1,5131264,5141504,5151744,5121024,6152,0,0,0,7882240,8627712,7872192,1388960,1085,9590784,80,0
.long 7309312,7308800,8440448,8664960,0,0,0,8548352,0,0,0,0,154368,152064,0,1,5089280,5099520,5109760,5079040,5120,0,0,0,7882496,8616960,7872000,76960,60,9616384,80,0
.long 8653824,0,0,0,0,0,0,0,8649728,7887232,308160,10092544,0,0,0,1,7720960,7741440,7761920,7700480,133120,153600,112640,117760,7881728,5120,7880256,1387680,1084,9539584,80,8669184
.long 8653824,0,0,0,0,0,0,0,8650752,7887232,308160,10097664,0,0,0,1,7746560,7767040,7705600,7726080,148480,107520,128000,133120,7881984,6144,7880320,78240,61,9565184,80,8669696
.long 8653824,0,0,0,0,0,0,0,8651776,7887232,308160,10087936,0,0,0,1,7772160,7710720,7731200,7751680,102400,122880,143360,148480,7882240,6144,7880384,1388960,1085,9590784,80,8670208
.long 8653824,0,0,0,0,0,0,0,8652800,7887232,308160,10087936,0,0,0,1,7715840,7736320,7756800,7777280,117760,138240,158720,102400,7882496,5120,7880192,76960,60,9616384,80,8670720
.long 8388608,106496,106496,8487424,0,0,0,0,0,0,0,0,0,0,0,2,5447680,5468160,5406720,5427200,148480,107520,128000,133120,7882752,11264,7873152,6720,5,9641984,160,8640512
.long 8390336,126976,110592,8489472,0,0,0,0,0,0,0,0,0,0,0,2,5473280,5411840,5432320,5452800,102400,122880,143360,148480,7883008,11264,7873216,1317440,1029,9667584,160,8641024
.long 8392064,108544,126976,8491520,0,0,0,0,0,0,0,0,0,0,0,2,5416960,5437440,5457920,5478400,117760,138240,158720,102400,7883264,10240,7873024,5440,4,9693184,160,8641536
.long 8393792,129024,131072,8493568,0,0,0,0,0,0,0,0,0,0,0,2,5442560,5463040,5483520,5422080,133120,153600,112640,117760,7883520,10240,7873088,1316160,1028,9718784,160,8642048
.long 0,0,0,0,12,0,12,8470528,3072,2646016,8553984,73728,0,106496,106496,2,2846720,2856960,2826240,2836480,11264,0,0,0,7882752,8552448,7864960,6720,5,9641984,160,0
.long 0,0,0,0,12,0,12,8472576,84992,3301376,8575488,79872,0,107520,110592,2,2847744,2857984,2827264,2837504,11272,0,0,0,7883008,8563200,7865024,1317440,1029,9667584,160,0
.long 0,0,0,0,12,0,12,8474624,166912,3956736,8596992,86016,0,108544,114688,2,2805760,2816000,2785280,2795520,10240,0,0,0,7883264,8552448,7864832,5440,4,9693184,160,0
.long 0,0,0,0,12,0,12,8476672,248832,4612096,8618496,92160,0,109568,118784,2,2806784,2817024,2786304,2796544,10248,0,0,0,7883520,8563200,7864896,1316160,1028,9718784,160,0
.long 8402432,106496,106496,8503808,0,0,0,0,0,0,0,0,0,0,0,2,5775360,5795840,5734400,5754880,148480,107520,128000,133120,7882752,11264,7874176,16960,13,9641984,160,8644608
.long 8404160,126976,110592,8505856,0,0,0,0,0,0,0,0,0,0,0,2,5800960,5739520,5760000,5780480,102400,122880,143360,148480,7883008,11264,7874240,1327680,1037,9667584,160,8645120
.long 8405888,108544,126976,8507904,0,0,0,0,0,0,0,0,0,0,0,2,5744640,5765120,5785600,5806080,117760,138240,158720,102400,7883264,10240,7874048,15680,12,9693184,160,8645632
.long 8407616,129024,131072,8509952,0,0,0,0,0,0,0,0,0,0,0,2,5770240,5790720,5811200,5749760,133120,153600,112640,117760,7883520,10240,7874112,1326400,1036,9718784,160,8646144
.long 0,0,0,0,12,1,12,8470528,330752,2646272,8556672,73728,0,106496,106496,2,3174400,3184640,3153920,3164160,11264,0,0,0,7882752,8552448,7865984,16960,13,9641984,160,0
.long 0,0,0,0,12,1,12,8472576,412672,3301632,8578176,79872,0,107520,110592,2,3175424,3185664,3154944,3165184,11272,0,0,0,7883008,8563200,7866048,1327680,1037,9667584,160,0
.long 0,0,0,0,12,1,12,8474624,494592,3956992,8599680,86016,0,108544,114688,2,3133440,3143680,3112960,3123200,10240,0,0,0,7883264,8552448,7865856,15680,12,9693184,160,0
.long 0,0,0,0,12,1,12,8476672,576512,4612352,8621184,92160,0,109568,118784,2,3134464,3144704,3113984,3124224,10248,0,0,0,7883520,8563200,7865920,1326400,1036,9718784,160,0
.long 8416256,106496,106496,8520192,0,0,0,0,0,0,0,0,0,0,0,2,6103040,6123520,6062080,6082560,148480,107520,128000,133120,7882752,11264,7875200,27200,21,9641984,160,8648704
.long 8417984,126976,110592,8522240,0,0,0,0,0,0,0,0,0,0,0,2,6128640,6067200,6087680,6108160,102400,122880,143360,148480,7883008,11264,7875264,1337920,1045,9667584,160,8649216
.long 8419712,108544,126976,8524288,0,0,0,0,0,0,0,0,0,0,0,2,6072320,6092800,6113280,6133760,117760,138240,158720,102400,7883264,10240,7875072,25920,20,9693184,160,8649728
.long 8421440,129024,131072,8526336,0,0,0,0,0,0,0,0,0,0,0,2,6097920,6118400,6138880,6077440,133120,153600,112640,117760,7883520,10240,7875136,1336640,1044,9718784,160,8650240
.long 0,0,0,0,12,2,12,8470528,658432,2646528,8559360,73728,0,106496,106496,2,3502080,3512320,3481600,3491840,11264,0,0,0,7882752,8573952,7867008,27200,21,9641984,160,0
.long 0,0,0,0,12,2,12,8472576,740352,3301888,8580864,79872,0,107520,110592,2,3503104,3513344,3482624,3492864,11272,0,0,0,7883008,8584704,7867072,1337920,1045,9667584,160,0
.long 0,0,0,0,12,2,12,8474624,822272,3957248,8602368,86016,0,108544,114688,2,3461120,3471360,3440640,3450880,10240,0,0,0,7883264,8573952,7866880,25920,20,9693184,160,0
.long 0,0,0,0,12,2,12,8476672,904192,4612608,8623872,92160,0,109568,118784,2,3462144,3472384,3441664,3451904,10248,0,0,0,7883520,8584704,7866944,1336640,1044,9718784,160,0
.long 8430080,106496,106496,8536576,0,0,0,0,0,0,0,0,0,0,0,2,6430720,6451200,6389760,6410240,148480,107520,128000,133120,7882752,11264,7876224,37440,29,9641984,160,8652800
.long 8431808,126976,110592,8538624,0,0,0,0,0,0,0,0,0,0,0,2,6456320,6394880,6415360,6435840,102400,122880,143360,148480,7883008,11264,7876288,1348160,1053,9667584,160,8653312
.long 8433536,108544,126976,8540672,0,0,0,0,0,0,0,0,0,0,0,2,6400000,6420480,6440960,6461440,117760,138240,158720,102400,7883264,10240,7876096,36160,28,9693184,160,8653824
.long 8435264,129024,131072,8542720,0,0,0,0,0,0,0,0,0,0,0,2,6425600,6446080,6466560,6405120,133120,153600,112640,117760,7883520,10240,7876160,1346880,1052,9718784,160,8654336
.long 0,0,0,0,12,3,12,8470528,986112,2646784,8562048,73728,0,106496,106496,2,3829760,3840000,3809280,3819520,11264,0,0,0,7882752,8573952,7868032,37440,29,9641984,160,0
.long 0,0,0,0,12,3,12,8472576,1068032,3302144,8583552,79872,0,107520,110592,2,3830784,3841024,3810304,3820544,11272,0,0,0,7883008,8584704,7868096,1348160,1053,9667584,160,0
.long 0,0,0,0,12,3,12,8474624,1149952,3957504,8605056,86016,0,108544,114688,2,3788800,3799040,3768320,3778560,10240,0,0,0,7883264,8573952,7867904,36160,28,9693184,160,0
.long 0,0,0,0,12,3,12,8476672,1231872,4612864,8626560,92160,0,109568,118784,2,3789824,3800064,3769344,3779584,10248,0,0,0,7883520,8584704,7867968,1346880,1052,9718784,160,0
.long 8388608,106496,106496,8488448,0,0,0,0,0,0,0,0,0,0,0,2,6758400,6778880,6717440,6737920,148480,107520,128000,133120,7882752,11264,7877248,47680,37,9641984,160,8656896
.long 8390336,126976,110592,8490496,0,0,0,0,0,0,0,0,0,0,0,2,6784000,6722560,6743040,6763520,102400,122880,143360,148480,7883008,11264,7877312,1358400,1061,9667584,160,8657408
.long 8392064,108544,126976,8492544,0,0,0,0,0,0,0,0,0,0,0,2,6727680,6748160,6768640,6789120,117760,138240,158720,102400,7883264,10240,7877120,46400,36,9693184,160,8657920
.long 8393792,129024,131072,8494592,0,0,0,0,0,0,0,0,0,0,0,2,6753280,6773760,6794240,6732800,133120,153600,112640,117760,7883520,10240,7877184,1357120,1060,9718784,160,8658432
.long 0,0,0,0,12,4,12,8470528,1313792,2647040,8564736,73728,0,106496,106496,2,4157440,4167680,4136960,4147200,11264,0,0,0,7882752,8595456,7869056,47680,37,9641984,160,0
.long 0,0,0,0,12,4,12,8472576,1395712,3302400,8586240,79872,0,107520,110592,2,4158464,4168704,4137984,4148224,11272,0,0,0,7883008,8606208,7869120,1358400,1061,9667584,160,0
.long 0,0,0,0,12,4,12,8474624,1477632,3957760,8607744,86016,0,108544,114688,2,4116480,4126720,4096000,4106240,10240,0,0,0,7883264,8595456,7868928,46400,36,9693184,160,0
.long 0,0,0,0,12,4,12,8476672,1559552,4613120,8629248,92160,0,109568,118784,2,4117504,4127744,4097024,4107264,10248,0,0,0,7883520,8606208,7868992,1357120,1060,9718784,160,0
.long 8402432,106496,106496,8504832,0,0,0,0,0,0,0,0,0,0,0,2,7086080,7106560,7045120,7065600,148480,107520,128000,133120,7882752,11264,7878272,57920,45,9641984,160,8660992
.long 8404160,126976,110592,8506880,0,0,0,0,0,0,0,0,0,0,0,2,7111680,7050240,7070720,7091200,102400,122880,143360,148480,7883008,11264,7878336,1368640,1069,9667584,160,8661504
.long 8405888,108544,126976,8508928,0,0,0,0,0,0,0,0,0,0,0,2,7055360,7075840,7096320,7116800,117760,138240,158720,102400,7883264,10240,7878144,56640,44,9693184,160,8662016
.long 8407616,129024,131072,8510976,0,0,0,0,0,0,0,0,0,0,0,2,7080960,7101440,7121920,7060480,133120,153600,112640,117760,7883520,10240,7878208,1367360,1068,9718784,160,8662528
.long 0,0,0,0,12,5,12,8470528,1641472,2647296,8567424,73728,0,106496,106496,2,4485120,4495360,4464640,4474880,11264,0,0,0,7882752,8595456,7870080,57920,45,9641984,160,0
.long 0,0,0,0,12,5,12,8472576,1723392,3302656,8588928,79872,0,107520,110592,2,4486144,4496384,4465664,4475904,11272,0,0,0,7883008,8606208,7870144,1368640,1069,9667584,160,0
.long 0,0,0,0,12,5,12,8474624,1805312,3958016,8610432,86016,0,108544,114688,2,4444160,4454400,4423680,4433920,10240,0,0,0,7883264,8595456,7869952,56640,44,9693184,160,0
.long 0,0,0,0,12,5,12,8476672,1887232,4613376,8631936,92160,0,109568,118784,2,4445184,4455424,4424704,4434944,10248,0,0,0,7883520,8606208,7870016,1367360,1068,9718784,160,0
.long 8416256,106496,106496,8521216,0,0,0,0,0,0,0,0,0,0,0,2,7413760,7434240,7372800,7393280,148480,107520,128000,133120,7882752,11264,7879296,68160,53,9641984,160,8665088
.long 8417984,126976,110592,8523264,0,0,0,0,0,0,0,0,0,0,0,2,7439360,7377920,7398400,7418880,102400,122880,143360,148480,7883008,11264,7879360,1378880,1077,9667584,160,8665600
.long 8419712,108544,126976,8525312,0,0,0,0,0,0,0,0,0,0,0,2,7383040,7403520,7424000,7444480,117760,138240,158720,102400,7883264,10240,7879168,66880,52,9693184,160,8666112
.long 8421440,129024,131072,8527360,0,0,0,0,0,0,0,0,0,0,0,2,7408640,7429120,7449600,7388160,133120,153600,112640,117760,7883520,10240,7879232,1377600,1076,9718784,160,8666624
.long 0,0,0,0,12,6,12,8470528,1969152,2647552,8570112,73728,0,106496,106496,2,4812800,4823040,4792320,4802560,11264,0,0,0,7882752,8616960,7871104,68160,53,9641984,160,0
.long 0,0,0,0,12,6,12,8472576,2051072,3302912,8591616,79872,0,107520,110592,2,4813824,4824064,4793344,4803584,11272,0,0,0,7883008,8627712,7871168,1378880,1077,9667584,160,0
.long 0,0,0,0,12,6,12,8474624,2132992,3958272,8613120,86016,0,108544,114688,2,4771840,4782080,4751360,4761600,10240,0,0,0,7883264,8616960,7870976,66880,52,9693184,160,0
.long 0,0,0,0,12,6,12,8476672,2214912,4613632,8634624,92160,0,109568,118784,2,4772864,4783104,4752384,4762624,10248,0,0,0,7883520,8627712,7871040,1377600,1076,9718784,160,0
.long 8430080,106496,106496,8537600,0,0,0,0,0,0,0,0,0,0,0,2,7741440,7761920,7700480,7720960,148480,107520,128000,133120,7882752,11264,7880320,78400,61,9641984,160,8669184
.long 8431808,126976,110592,8539648,0,0,0,0,0,0,0,0,0,0,0,2,7767040,7705600,7726080,7746560,102400,122880,143360,148480,7883008,11264,7880384,1389120,1085,9667584,160,8669696
.long 8433536,108544,126976,8541696,0,0,0,0,0,0,0,0,0,0,0,2,7710720,7731200,7751680,7772160,117760,138240,158720,102400,7883264,10240,7880192,77120,60,9693184,160,8670208
.long 8435264,129024,131072,8543744,0,0,0,0,0,0,0,0,0,0,0,2,7736320,7756800,7777280,7715840,133120,153600,112640,117760,7883520,10240,7880256,1387840,1084,9718784,160,8670720
.long 0,0,0,0,12,7,12,8470528,2296832,2647808,8572800,73728,0,106496,106496,2,5140480,5150720,5120000,5130240,11264,0,0,0,7882752,8616960,7872128,78400,61,9641984,160,0
.long 0,0,0,0,12,7,12,8472576,2378752,3303168,8594304,79872,0,107520,110592,2,5141504,5151744,5121024,5131264,11272,0,0,0,7883008,8627712,7872192,1389120,1085,9667584,160,0
.long 0,0,0,0,12,7,12,8474624,2460672,3958528,8615808,86016,0,108544,114688,2,5099520,5109760,5079040,5089280,10240,0,0,0,7883264,8616960,7872000,77120,60,9693184,160,0
.long 0,0,0,0,12,7,12,8476672,2542592,4613888,8637312,92160,0,109568,118784,2,5100544,5110784,5080064,5090304,10248,0,0,0,7883520,8627712,7872064,1387840,1084,9718784,160,0
.long 8395520,106496,106496,8495616,0,0,0,0,0,0,0,0,0,0,0,3,5468160,5406720,5427200,5447680,102400,122880,143360,148480,7883776,16384,7873216,1317600,1029,9744384,240,8640512
.long 8397248,126976,110592,8497664,0,0,0,0,0,0,0,0,0,0,0,3,5411840,5432320,5452800,5473280,117760,138240,158720,102400,7884032,15360,7873024,5600,4,9769984,240,8641024
.long 8398976,108544,126976,8499712,0,0,0,0,0,0,0,0,0,0,0,3,5437440,5457920,5478400,5416960,133120,153600,112640,117760,7884288,15360,7873088,1316320,1028,9795584,240,8641536
.long 8400704,129024,131072,8501760,0,0,0,0,0,0,0,0,0,0,0,3,5463040,5483520,5422080,5442560,148480,107520,128000,133120,7884544,16384,7873152,6880,5,9821184,240,8642048
.long 0,0,0,0,14,0,14,8470528,3584,2650112,8554240,73728,0,106496,106496,3,2857984,2827264,2837504,2847744,16392,0,0,0,7883776,8563200,7865024,1317600,1029,9744384,240,0
.long 0,0,0,0,14,0,14,8472576,85504,3305472,8575744,79872,0,107520,110592,3,2816000,2785280,2795520,2805760,15360,0,0,0,7884032,8552448,7864832,5600,4,9769984,240,0
.long 0,0,0,0,14,0,14,8474624,167424,3960832,8597248,86016,0,108544,114688,3,2817024,2786304,2796544,2806784,15368,0,0,0,7884288,8563200,7864896,1316320,1028,9795584,240,0
.long 0,0,0,0,14,0,14,8476672,249344,4616192,8618752,92160,0,109568,118784,3,2856960,2826240,2836480,2846720,16384,0,0,0,7884544,8552448,7864960,6880,5,9821184,240,0
.long 8409344,106496,106496,8512000,0,0,0,0,0,0,0,0,0,0,0,3,5795840,5734400,5754880,5775360,102400,122880,143360,148480,7883776,16384,7874240,1327840,1037,9744384,240,8644608
.long 8411072,126976,110592,8514048,0,0,0,0,0,0,0,0,0,0,0,3,5739520,5760000,5780480,5800960,117760,138240,158720,102400,7884032,15360,7874048,15840,12,9769984,240,8645120
.long 8412800,108544,126976,8516096,0,0,0,0,0,0,0,0,0,0,0,3,5765120,5785600,5806080,5744640,133120,153600,112640,117760,7884288,15360,7874112,1326560,1036,9795584,240,8645632
.long 8414528,129024,131072,8518144,0,0,0,0,0,0,0,0,0,0,0,3,5790720,5811200,5749760,5770240,148480,107520,128000,133120,7884544,16384,7874176,17120,13,9821184,240,8646144
.long 0,0,0,0,14,1,14,8470528,331264,2650368,8556928,73728,0,106496,106496,3,3185664,3154944,3165184,3175424,16392,0,0,0,7883776,8563200,7866048,1327840,1037,9744384,240,0
.long 0,0,0,0,14,1,14,8472576,413184,3305728,8578432,79872,0,107520,110592,3,3143680,3112960,3123200,3133440,15360,0,0,0,7884032,8552448,7865856,15840,12,9769984,240,0
.long 0,0,0,0,14,1,14,8474624,495104,3961088,8599936,86016,0,108544,114688,3,3144704,3113984,3124224,3134464,15368,0,0,0,7884288,8563200,7865920,1326560,1036,9795584,240,0
.long 0,0,0,0,14,1,14,8476672,577024,4616448,8621440,92160,0,109568,118784,3,3184640,3153920,3164160,3174400,16384,0,0,0,7884544,8552448,7865984,17120,13,9821184,240,0
.long 8423168,106496,106496,8528384,0,0,0,0,0,0,0,0,0,0,0,3,6123520,6062080,6082560,6103040,102400,122880,143360,148480,7883776,16384,7875264,1338080,1045,9744384,240,8648704
.long 8424896,126976,110592,8530432,0,0,0,0,0,0,0,0,0,0,0,3,6067200,6087680,6108160,6128640,117760,138240,158720,102400,7884032,15360,7875072,26080,20,9769984,240,8649216
.long 8426624,108544,126976,8532480,0,0,0,0,0,0,0,0,0,0,0,3,6092800,6113280,6133760,6072320,133120,153600,112640,117760,7884288,15360,7875136,1336800,1044,9795584,240,8649728
.long 8428352,129024,131072,8534528,0,0,0,0,0,0,0,0,0,0,0,3,6118400,6138880,6077440,6097920,148480,107520,128000,133120,7884544,16384,7875200,27360,21,9821184,240,8650240
.long 0,0,0,0,14,2,14,8470528,658944,2650624,8559616,73728,0,106496,106496,3,3513344,3482624,3492864,3503104,16392,0,0,0,7883776,8584704,7867072,1338080,1045,9744384,240,0
.long 0,0,0,0,14,2,14,8472576,740864,3305984,8581120,79872,0,107520,110592,3,3471360,3440640,3450880,3461120,15360,0,0,0,7884032,8573952,7866880,26080,20,9769984,240,0
.long 0,0,0,0,14,2,14,8474624,822784,3961344,8602624,86016,0,108544,114688,3,3472384,3441664,3451904,3462144,15368,0,0,0,7884288,8584704,7866944,1336800,1044,9795584,240,0
.long 0,0,0,0,14,2,14,8476672,904704,4616704,8624128,92160,0,109568,118784,3,3512320,3481600,3491840,3502080,16384,0,0,0,7884544,8573952,7867008,27360,21,9821184,240,0
.long 8436992,106496,106496,8544768,0,0,0,0,0,0,0,0,0,0,0,3,6451200,6389760,6410240,6430720,102400,122880,143360,148480,7883776,16384,7876288,1348320,1053,9744384,240,8652800
.long 8438720,126976,110592,8546816,0,0,0,0,0,0,0,0,0,0,0,3,6394880,6415360,6435840,6456320,117760,138240,158720,102400,7884032,15360,7876096,36320,28,9769984,240,8653312
.long 8440448,108544,126976,8548864,0,0,0,0,0,0,0,0,0,0,0,3,6420480,6440960,6461440,6400000,133120,153600,112640,117760,7884288,15360,7876160,1347040,1052,9795584,240,8653824
.long 8442176,129024,131072,8550912,0,0,0,0,0,0,0,0,0,0,0,3,6446080,6466560,6405120,6425600,148480,107520,128000,133120,7884544,16384,7876224,37600,29,9821184,240,8654336
.long 0,0,0,0,14,3,14,8470528,986624,2650880,8562304,73728,0,106496,106496,3,3841024,3810304,3820544,3830784,16392,0,0,0,7883776,8584704,7868096,1348320,1053,9744384,240,0
.long 0,0,0,0,14,3,14,8472576,1068544,3306240,8583808,79872,0,107520,110592,3,3799040,3768320,3778560,3788800,15360,0,0,0,7884032,8573952,7867904,36320,28,9769984,240,0
.long 0,0,0,0,14,3,14,8474624,1150464,3961600,8605312,86016,0,108544,114688,3,3800064,3769344,3779584,3789824,15368,0,0,0,7884288,8584704,7867968,1347040,1052,9795584,240,0
.long 0,0,0,0,14,3,14,8476672,1232384,4616960,8626816,92160,0,109568,118784,3,3840000,3809280,3819520,3829760,16384,0,0,0,7884544,8573952,7868032,37600,29,9821184,240,0
.long 8395520,106496,106496,8496640,0,0,0,0,0,0,0,0,0,0,0,3,6778880,6717440,6737920,6758400,102400,122880,143360,148480,7883776,16384,7877312,1358560,1061,9744384,240,8656896
.long 8397248,126976,110592,8498688,0,0,0,0,0,0,0,0,0,0,0,3,6722560,6743040,6763520,6784000,117760,138240,158720,102400,7884032,15360,7877120,46560,36,9769984,240,8657408
.long 8398976,108544,126976,8500736,0,0,0,0,0,0,0,0,0,0,0,3,6748160,6768640,6789120,6727680,133120,153600,112640,117760,7884288,15360,7877184,1357280,1060,9795584,240,8657920
.long 8400704,129024,131072,8502784,0,0,0,0,0,0,0,0,0,0,0,3,6773760,6794240,6732800,6753280,148480,107520,128000,133120,7884544,16384,7877248,47840,37,9821184,240,8658432
.long 0,0,0,0,14,4,14,8470528,1314304,2651136,8564992,73728,0,106496,106496,3,4168704,4137984,4148224,4158464,16392,0,0,0,7883776,8606208,7869120,1358560,1061,9744384,240,0
.long 0,0,0,0,14,4,14,8472576,1396224,3306496,8586496,79872,0,107520,110592,3,4126720,4096000,4106240,4116480,15360,0,0,0,7884032,8595456,7868928,46560,36,9769984,240,0
.long 0,0,0,0,14,4,14,8474624,1478144,3961856,8608000,86016,0,108544,114688,3,4127744,4097024,4107264,4117504,15368,0,0,0,7884288,8606208,7868992,1357280,1060,9795584,240,0
.long 0,0,0,0,14,4,14,8476672,1560064,4617216,8629504,92160,0,109568,118784,3,4167680,4136960,4147200,4157440,16384,0,0,0,7884544,8595456,7869056,47840,37,9821184,240,0
.long 8409344,106496,106496,8513024,0,0,0,0,0,0,0,0,0,0,0,3,7106560,7045120,7065600,7086080,102400,122880,143360,148480,7883776,16384,7878336,1368800,1069,9744384,240,8660992
.long 8411072,126976,110592,8515072,0,0,0,0,0,0,0,0,0,0,0,3,7050240,7070720,7091200,7111680,117760,138240,158720,102400,7884032,15360,7878144,56800,44,9769984,240,8661504
.long 8412800,108544,126976,8517120,0,0,0,0,0,0,0,0,0,0,0,3,7075840,7096320,7116800,7055360,133120,153600,112640,117760,7884288,15360,7878208,1367520,1068,9795584,240,8662016
.long 8414528,129024,131072,8519168,0,0,0,0,0,0,0,0,0,0,0,3,7101440,7121920,7060480,7080960,148480,107520,128000,133120,7884544,16384,7878272,58080,45,9821184,240,8662528
.long 0,0,0,0,14,5,14,8470528,1641984,2651392,8567680,73728,0,106496,106496,3,4496384,4465664,4475904,4486144,16392,0,0,0,7883776,8606208,7870144,1368800,1069,9744384,240,0
.long 0,0,0,0,14,5,14,8472576,1723904,3306752,8589184,79872,0,107520,110592,3,4454400,4423680,4433920,4444160,15360,0,0,0,7884032,8595456,7869952,56800,44,9769984,240,0
.long 0,0,0,0,14,5,14,8474624,1805824,3962112,8610688,86016,0,108544,114688,3,4455424,4424704,4434944,4445184,15368,0,0,0,7884288,8606208,7870016,1367520,1068,9795584,240,0
.long 0,0,0,0,14,5,14,8476672,1887744,4617472,8632192,92160,0,109568,118784,3,4495360,4464640,4474880,4485120,16384,0,0,0,7884544,8595456,7870080,58080,45,9821184,240,0
.long 8423168,106496,106496,8529408,0,0,0,0,0,0,0,0,0,0,0,3,7434240,7372800,7393280,7413760,102400,122880,143360,148480,7883776,16384,7879360,1379040,1077,9744384,240,8665088
.long 8424896,126976,110592,8531456,0,0,0,0,0,0,0,0,0,0,0,3,7377920,7398400,7418880,7439360,117760,138240,158720,102400,7884032,15360,7879168,67040,52,9769984,240,8665600
.long 8426624,108544,126976,8533504,0,0,0,0,0,0,0,0,0,0,0,3,7403520,7424000,7444480,7383040,133120,153600,112640,117760,7884288,15360,7879232,1377760,1076,9795584,240,8666112
.long 8428352,129024,131072,8535552,0,0,0,0,0,0,0,0,0,0,0,3,7429120,7449600,7388160,7408640,148480,107520,128000,133120,7884544,16384,7879296,68320,53,9821184,240,8666624
.long 0,0,0,0,14,6,14,8470528,1969664,2651648,8570368,73728,0,106496,106496,3,4824064,4793344,4803584,4813824,16392,0,0,0,7883776,8627712,7871168,1379040,1077,9744384,240,0
.long 0,0,0,0,14,6,14,8472576,2051584,3307008,8591872,79872,0,107520,110592,3,4782080,4751360,4761600,4771840,15360,0,0,0,7884032,8616960,7870976,67040,52,9769984,240,0
.long 0,0,0,0,14,6,14,8474624,2133504,3962368,8613376,86016,0,108544,114688,3,4783104,4752384,4762624,4772864,15368,0,0,0,7884288,8627712,7871040,1377760,1076,9795584,240,0
.long 0,0,0,0,14,6,14,8476672,2215424,4617728,8634880,92160,0,109568,118784,3,4823040,4792320,4802560,4812800,16384,0,0,0,7884544,8616960,7871104,68320,53,9821184,240,0
.long 8436992,106496,106496,8545792,0,0,0,0,0,0,0,0,0,0,0,3,7761920,7700480,7720960,7741440,102400,122880,143360,148480,7883776,16384,7880384,1389280,1085,9744384,240,8669184
.long 8438720,126976,110592,8547840,0,0,0,0,0,0,0,0,0,0,0,3,7705600,7726080,7746560,7767040,117760,138240,158720,102400,7884032,15360,7880192,77280,60,9769984,240,8669696
.long 8440448,108544,126976,8549888,0,0,0,0,0,0,0,0,0,0,0,3,7731200,7751680,7772160,7710720,133120,153600,112640,117760,7884288,15360,7880256,1388000,1084,9795584,240,8670208
.long 8442176,129024,131072,8551936,0,0,0,0,0,0,0,0,0,0,0,3,7756800,7777280,7715840,7736320,148480,107520,128000,133120,7884544,16384,7880320,78560,61,9821184,240,8670720
.long 0,0,0,0,14,7,14,8470528,2297344,2651904,8573056,73728,0,106496,106496,3,5151744,5121024,5131264,5141504,16392,0,0,0,7883776,8627712,7872192,1389280,1085,9744384,240,0
.long 0,0,0,0,14,7,14,8472576,2379264,3307264,8594560,79872,0,107520,110592,3,5109760,5079040,5089280,5099520,15360,0,0,0,7884032,8616960,7872000,77280,60,9769984,240,0
.long 0,0,0,0,14,7,14,8474624,2461184,3962624,8616064,86016,0,108544,114688,3,5110784,5080064,5090304,5100544,15368,0,0,0,7884288,8627712,7872064,1388000,1084,9795584,240,0
.long 0,0,0,0,14,7,14,8476672,2543104,4617984,8637568,92160,0,109568,118784,3,5150720,5120000,5130240,5140480,16384,0,0,0,7884544,8616960,7872128,78560,61,9821184,240,0
.long 102400,1413120,7875072,8456704,0,0,0,0,0,0,0,0,20,0,0,4,5406720,5427200,5447680,5468160,117760,138240,158720,102400,7884800,0,7873024,5760,4,9846784,4294966976,8640512
.long 107520,1418240,7875200,8456832,0,0,0,0,0,0,0,0,21,0,0,4,5432320,5452800,5473280,5411840,133120,153600,112640,117760,7885056,0,7873088,1316480,1028,9872384,4294966976,8641024
.long 112640,1423360,7875328,8456960,0,0,0,0,0,0,0,0,22,0,0,4,5457920,5478400,5416960,5437440,148480,107520,128000,133120,7885312,1024,7873152,7040,5,9897984,4294966976,8641536
.long 117760,1428480,7875456,8457088,0,0,0,0,0,0,0,0,23,0,0,4,5483520,5422080,5442560,5463040,102400,122880,143360,148480,7885568,1024,7873216,1317760,1029,9923584,4294966976,8642048
.long 0,0,0,0,16,0,16,8478720,4096,2654208,8554496,73728,0,106496,106496,4,2785280,2795520,2805760,2816000,0,0,0,0,7884800,8552448,7864832,5760,4,9846784,4294966976,0
.long 0,0,0,0,16,0,16,8480768,86016,3309568,8576000,79872,0,107520,110592,4,2786304,2796544,2806784,2817024,8,0,0,0,7885056,8563200,7864896,1316480,1028,9872384,4294966976,0
.long 0,0,0,0,16,0,16,8482816,167936,3964928,8597504,86016,0,108544,114688,4,2826240,2836480,2846720,2856960,1024,0,0,0,7885312,8552448,7864960,7040,5,9897984,4294966976,0
.long 0,0,0,0,16,0,16,8484864,249856,4620288,8619008,92160,0,109568,118784,4,2827264,2837504,2847744,2857984,1032,0,0,0,7885568,8563200,7865024,1317760,1029,9923584,4294966976,0
.long 103680,1414400,7875072,8464896,0,0,0,0,0,0,0,0,20,0,0,4,5734400,5754880,5775360,5795840,117760,138240,158720,102400,7884800,0,7874048,16000,12,9846784,4294966976,8644608
.long 108800,1419520,7875200,8465024,0,0,0,0,0,0,0,0,21,0,0,4,5760000,5780480,5800960,5739520,133120,153600,112640,117760,7885056,0,7874112,1326720,1036,9872384,4294966976,8645120
.long 113920,1424640,7875328,8465152,0,0,0,0,0,0,0,0,22,0,0,4,5785600,5806080,5744640,5765120,148480,107520,128000,133120,7885312,1024,7874176,17280,13,9897984,4294966976,8645632
.long 119040,1429760,7875456,8465280,0,0,0,0,0,0,0,0,23,0,0,4,5811200,5749760,5770240,5790720,102400,122880,143360,148480,7885568,1024,7874240,1328000,1037,9923584,4294966976,8646144
.long 0,0,0,0,16,1,16,8478720,331776,2654464,8557184,73728,0,106496,106496,4,3112960,3123200,3133440,3143680,0,0,0,0,7884800,8552448,7865856,16000,12,9846784,4294966976,0
.long 0,0,0,0,16,1,16,8480768,413696,3309824,8578688,79872,0,107520,110592,4,3113984,3124224,3134464,3144704,8,0,0,0,7885056,8563200,7865920,1326720,1036,9872384,4294966976,0
.long 0,0,0,0,16,1,16,8482816,495616,3965184,8600192,86016,0,108544,114688,4,3153920,3164160,3174400,3184640,1024,0,0,0,7885312,8552448,7865984,17280,13,9897984,4294966976,0
.long 0,0,0,0,16,1,16,8484864,577536,4620544,8621696,92160,0,109568,118784,4,3154944,3165184,3175424,3185664,1032,0,0,0,7885568,8563200,7866048,1328000,1037,9923584,4294966976,0
.long 104960,1415680,7875072,8473088,0,0,0,0,0,0,0,0,20,0,0,4,6062080,6082560,6103040,6123520,117760,138240,158720,102400,7884800,0,7875072,26240,20,9846784,4294966976,8648704
.long 110080,1420800,7875200,8473216,0,0,0,0,0,0,0,0,21,0,0,4,6087680,6108160,6128640,6067200,133120,153600,112640,117760,7885056,0,7875136,1336960,1044,9872384,4294966976,8649216
.long 115200,1425920,7875328,8473344,0,0,0,0,0,0,0,0,22,0,0,4,6113280,6133760,6072320,6092800,148480,107520,128000,133120,7885312,1024,7875200,27520,21,9897984,4294966976,8649728
.long 120320,1431040,7875456,8473472,0,0,0,0,0,0,0,0,23,0,0,4,6138880,6077440,6097920,6118400,102400,122880,143360,148480,7885568,1024,7875264,1338240,1045,9923584,4294966976,8650240
.long 0,0,0,0,16,2,16,8478720,659456,2654720,8559872,73728,0,106496,106496,4,3440640,3450880,3461120,3471360,0,0,0,0,7884800,8573952,7866880,26240,20,9846784,4294966976,0
.long 0,0,0,0,16,2,16,8480768,741376,3310080,8581376,79872,0,107520,110592,4,3441664,3451904,3462144,3472384,8,0,0,0,7885056,8584704,7866944,1336960,1044,9872384,4294966976,0
.long 0,0,0,0,16,2,16,8482816,823296,3965440,8602880,86016,0,108544,114688,4,3481600,3491840,3502080,3512320,1024,0,0,0,7885312,8573952,7867008,27520,21,9897984,4294966976,0
.long 0,0,0,0,16,2,16,8484864,905216,4620800,8624384,92160,0,109568,118784,4,3482624,3492864,3503104,3513344,1032,0,0,0,7885568,8584704,7867072,1338240,1045,9923584,4294966976,0
.long 106240,1416960,7875072,8481280,0,0,0,0,0,0,0,0,20,0,0,4,6389760,6410240,6430720,6451200,117760,138240,158720,102400,7884800,0,7876096,36480,28,9846784,4294966976,8652800
.long 111360,1422080,7875200,8481408,0,0,0,0,0,0,0,0,21,0,0,4,6415360,6435840,6456320,6394880,133120,153600,112640,117760,7885056,0,7876160,1347200,1052,9872384,4294966976,8653312
.long 116480,1427200,7875328,8481536,0,0,0,0,0,0,0,0,22,0,0,4,6440960,6461440,6400000,6420480,148480,107520,128000,133120,7885312,1024,7876224,37760,29,9897984,4294966976,8653824
.long 121600,1432320,7875456,8481664,0,0,0,0,0,0,0,0,23,0,0,4,6466560,6405120,6425600,6446080,102400,122880,143360,148480,7885568,1024,7876288,1348480,1053,9923584,4294966976,8654336
.long 0,0,0,0,16,3,16,8478720,987136,2654976,8562560,73728,0,106496,106496,4,3768320,3778560,3788800,3799040,0,0,0,0,7884800,8573952,7867904,36480,28,9846784,4294966976,0
.long 0,0,0,0,16,3,16,8480768,1069056,3310336,8584064,79872,0,107520,110592,4,3769344,3779584,3789824,3800064,8,0,0,0,7885056,8584704,7867968,1347200,1052,9872384,4294966976,0
.long 0,0,0,0,16,3,16,8482816,1150976,3965696,8605568,86016,0,108544,114688,4,3809280,3819520,3829760,3840000,1024,0,0,0,7885312,8573952,7868032,37760,29,9897984,4294966976,0
.long 0,0,0,0,16,3,16,8484864,1232896,4621056,8627072,92160,0,109568,118784,4,3810304,3820544,3830784,3841024,1032,0,0,0,7885568,8584704,7868096,1348480,1053,9923584,4294966976,0
.long 266240,1576960,7879168,8460800,0,0,0,0,0,0,0,0,52,0,0,4,6717440,6737920,6758400,6778880,117760,138240,158720,102400,7884800,0,7877120,46720,36,9846784,4294966976,8656896
.long 271360,1582080,7879296,8460928,0,0,0,0,0,0,0,0,53,0,0,4,6743040,6763520,6784000,6722560,133120,153600,112640,117760,7885056,0,7877184,1357440,1060,9872384,4294966976,8657408
.long 276480,1587200,7879424,8461056,0,0,0,0,0,0,0,0,54,0,0,4,6768640,6789120,6727680,6748160,148480,107520,128000,133120,7885312,1024,7877248,48000,37,9897984,4294966976,8657920
.long 281600,1592320,7879552,8461184,0,0,0,0,0,0,0,0,55,0,0,4,6794240,6732800,6753280,6773760,102400,122880,143360,148480,7885568,1024,7877312,1358720,1061,9923584,4294966976,8658432
.long 0,0,0,0,16,4,16,8478720,1314816,2655232,8565248,73728,0,106496,106496,4,4096000,4106240,4116480,4126720,0,0,0,0,7884800,8595456,7868928,46720,36,9846784,4294966976,0
.long 0,0,0,0,16,4,16,8480768,1396736,3310592,8586752,79872,0,107520,110592,4,4097024,4107264,4117504,4127744,8,0,0,0,7885056,8606208,7868992,1357440,1060,9872384,4294966976,0
.long 0,0,0,0,16,4,16,8482816,1478656,3965952,8608256,86016,0,108544,114688,4,4136960,4147200,4157440,4167680,1024,0,0,0,7885312,8595456,7869056,48000,37,9897984,4294966976,0
.long 0,0,0,0,16,4,16,8484864,1560576,4621312,8629760,92160,0,109568,118784,4,4137984,4148224,4158464,4168704,1032,0,0,0,7885568,8606208,7869120,1358720,1061,9923584,4294966976,0
.long 267520,1578240,7879168,8468992,0,0,0,0,0,0,0,0,52,0,0,4,7045120,7065600,7086080,7106560,117760,138240,158720,102400,7884800,0,7878144,56960,44,9846784,4294966976,8660992
.long 272640,1583360,7879296,8469120,0,0,0,0,0,0,0,0,53,0,0,4,7070720,7091200,7111680,7050240,133120,153600,112640,117760,7885056,0,7878208,1367680,1068,9872384,4294966976,8661504
.long 277760,1588480,7879424,8469248,0,0,0,0,0,0,0,0,54,0,0,4,7096320,7116800,7055360,7075840,148480,107520,128000,133120,7885312,1024,7878272,58240,45,9897984,4294966976,8662016
.long 282880,1593600,7879552,8469376,0,0,0,0,0,0,0,0,55,0,0,4,7121920,7060480,7080960,7101440,102400,122880,143360,148480,7885568,1024,7878336,1368960,1069,9923584,4294966976,8662528
.long 0,0,0,0,16,5,16,8478720,1642496,2655488,8567936,73728,0,106496,106496,4,4423680,4433920,4444160,4454400,0,0,0,0,7884800,8595456,7869952,56960,44,9846784,4294966976,0
.long 0,0,0,0,16,5,16,8480768,1724416,3310848,8589440,79872,0,107520,110592,4,4424704,4434944,4445184,4455424,8,0,0,0,7885056,8606208,7870016,1367680,1068,9872384,4294966976,0
.long 0,0,0,0,16,5,16,8482816,1806336,3966208,8610944,86016,0,108544,114688,4,4464640,4474880,4485120,4495360,1024,0,0,0,7885312,8595456,7870080,58240,45,9897984,4294966976,0
.long 0,0,0,0,16,5,16,8484864,1888256,4621568,8632448,92160,0,109568,118784,4,4465664,4475904,4486144,4496384,1032,0,0,0,7885568,8606208,7870144,1368960,1069,9923584,4294966976,0
.long 268800,1579520,7879168,8477184,0,0,0,0,0,0,0,0,52,0,0,4,7372800,7393280,7413760,7434240,117760,138240,158720,102400,7884800,0,7879168,67200,52,9846784,4294966976,8665088
.long 273920,1584640,7879296,8477312,0,0,0,0,0,0,0,0,53,0,0,4,7398400,7418880,7439360,7377920,133120,153600,112640,117760,7885056,0,7879232,1377920,1076,9872384,4294966976,8665600
.long 279040,1589760,7879424,8477440,0,0,0,0,0,0,0,0,54,0,0,4,7424000,7444480,7383040,7403520,148480,107520,128000,133120,7885312,1024,7879296,68480,53,9897984,4294966976,8666112
.long 284160,1594880,7879552,8477568,0,0,0,0,0,0,0,0,55,0,0,4,7449600,7388160,7408640,7429120,102400,122880,143360,148480,7885568,1024,7879360,1379200,1077,9923584,4294966976,8666624
.long 0,0,0,0,16,6,16,8478720,1970176,2655744,8570624,73728,0,106496,106496,4,4751360,4761600,4771840,4782080,0,0,0,0,7884800,8616960,7870976,67200,52,9846784,4294966976,0
.long 0,0,0,0,16,6,16,8480768,2052096,3311104,8592128,79872,0,107520,110592,4,4752384,4762624,4772864,4783104,8,0,0,0,7885056,8627712,7871040,1377920,1076,9872384,4294966976,0
.long 0,0,0,0,16,6,16,8482816,2134016,3966464,8613632,86016,0,108544,114688,4,4792320,4802560,4812800,4823040,1024,0,0,0,7885312,8616960,7871104,68480,53,9897984,4294966976,0
.long 0,0,0,0,16,6,16,8484864,2215936,4621824,8635136,92160,0,109568,118784,4,4793344,4803584,4813824,4824064,1032,0,0,0,7885568,8627712,7871168,1379200,1077,9923584,4294966976,0
.long 270080,1580800,7879168,8485376,0,0,0,0,0,0,0,0,52,0,0,4,7700480,7720960,7741440,7761920,117760,138240,158720,102400,7884800,0,7880192,77440,60,9846784,4294966976,8669184
.long 275200,1585920,7879296,8485504,0,0,0,0,0,0,0,0,53,0,0,4,7726080,7746560,7767040,7705600,133120,153600,112640,117760,7885056,0,7880256,1388160,1084,9872384,4294966976,8669696
.long 280320,1591040,7879424,8485632,0,0,0,0,0,0,0,0,54,0,0,4,7751680,7772160,7710720,7731200,148480,107520,128000,133120,7885312,1024,7880320,78720,61,9897984,4294966976,8670208
.long 285440,1596160,7879552,8485760,0,0,0,0,0,0,0,0,55,0,0,4,7777280,7715840,7736320,7756800,102400,122880,143360,148480,7885568,1024,7880384,1389440,1085,9923584,4294966976,8670720
.long 0,0,0,0,16,7,16,8478720,2297856,2656000,8573312,73728,0,106496,106496,4,5079040,5089280,5099520,5109760,0,0,0,0,7884800,8616960,7872000,77440,60,9846784,4294966976,0
.long 0,0,0,0,16,7,16,8480768,2379776,3311360,8594816,79872,0,107520,110592,4,5080064,5090304,5100544,5110784,8,0,0,0,7885056,8627712,7872064,1388160,1084,9872384,4294966976,0
.long 0,0,0,0,16,7,16,8482816,2461696,3966720,8616320,86016,0,108544,114688,4,5120000,5130240,5140480,5150720,1024,0,0,0,7885312,8616960,7872128,78720,61,9897984,4294966976,0
.long 0,0,0,0,16,7,16,8484864,2543616,4622080,8637824,92160,0,109568,118784,4,5121024,5131264,5141504,5151744,1032,0,0,0,7885568,8627712,7872192,1389440,1085,9923584,4294966976,0
.long 6062080,6064128,8388608,8648704,0,0,0,8486912,0,0,0,0,147456,147456,0,5,2796544,2806784,2817024,2786304,5128,0,0,0,7885824,8563200,7864896,1316640,1028,9949184,4294967056,0
.long 6065152,6064640,8392064,8648832,0,0,0,8491008,0,0,0,0,149760,152064,0,5,2836480,2846720,2856960,2826240,6144,0,0,0,7886080,8552448,7864960,7200,5,9974784,4294967056,0
.long 6144000,6146048,8395520,8648960,0,0,0,8495104,0,0,0,0,152064,147456,0,5,2837504,2847744,2857984,2827264,6152,0,0,0,7886336,8563200,7865024,1317920,1029,10000384,4294967056,0
.long 6147072,6146560,8398976,8649088,0,0,0,8499200,0,0,0,0,154368,152064,0,5,2795520,2805760,2816000,2785280,5120,0,0,0,7886592,8552448,7864832,5920,4,10025984,4294967056,0
.long 8495104,0,0,0,0,0,0,0,8491008,7883264,409920,9693184,0,0,0,5,5427200,5447680,5468160,5406720,133120,153600,112640,117760,7885824,5120,7873088,1316640,1028,9949184,4294967056,8640512
.long 8495104,0,0,0,0,0,0,0,8492032,7883264,409920,9698304,0,0,0,5,5452800,5473280,5411840,5432320,148480,107520,128000,133120,7886080,6144,7873152,7200,5,9974784,4294967056,8641024
.long 8495104,0,0,0,0,0,0,0,8493056,7883264,409920,9703424,0,0,0,5,5478400,5416960,5437440,5457920,102400,122880,143360,148480,7886336,6144,7873216,1317920,1029,10000384,4294967056,8641536
.long 8495104,0,0,0,0,0,0,0,8494080,7883264,409920,9703424,0,0,0,5,5422080,5442560,5463040,5483520,117760,138240,158720,102400,7886592,5120,7873024,5920,4,10025984,4294967056,8642048
.long 6067200,6069248,8402432,8649216,0,0,0,8503296,0,0,0,0,147456,147456,0,5,3124224,3134464,3144704,3113984,5128,0,0,0,7885824,8563200,7865920,1326880,1036,9949184,4294967056,0
.long 6070272,6069760,8405888,8649344,0,0,0,8507392,0,0,0,0,149760,152064,0,5,3164160,3174400,3184640,3153920,6144,0,0,0,7886080,8552448,7865984,17440,13,9974784,4294967056,0
.long 6149120,6151168,8409344,8649472,0,0,0,8511488,0,0,0,0,152064,147456,0,5,3165184,3175424,3185664,3154944,6152,0,0,0,7886336,8563200,7866048,1328160,1037,10000384,4294967056,0
.long 6152192,6151680,8412800,8649600,0,0,0,8515584,0,0,0,0,154368,152064,0,5,3123200,3133440,3143680,3112960,5120,0,0,0,7886592,8552448,7865856,16160,12,10025984,4294967056,0
.long 8500224,0,0,0,0,0,0,0,8496128,7883392,512320,9708544,0,0,0,5,5754880,5775360,5795840,5734400,133120,153600,112640,117760,7885824,5120,7874112,1326880,1036,9949184,4294967056,8644608
.long 8500224,0,0,0,0,0,0,0,8497152,7883392,512320,9713664,0,0,0,5,5780480,5800960,5739520,5760000,148480,107520,128000,133120,7886080,6144,7874176,17440,13,9974784,4294967056,8645120
.long 8500224,0,0,0,0,0,0,0,8498176,7883392,512320,9703936,0,0,0,5,5806080,5744640,5765120,5785600,102400,122880,143360,148480,7886336,6144,7874240,1328160,1037,10000384,4294967056,8645632
.long 8500224,0,0,0,0,0,0,0,8499200,7883392,512320,9703936,0,0,0,5,5749760,5770240,5790720,5811200,117760,138240,158720,102400,7886592,5120,7874048,16160,12,10025984,4294967056,8646144
.long 6072320,6074368,8416256,8649728,0,0,0,8519680,0,0,0,0,147456,147456,0,5,3451904,3462144,3472384,3441664,5128,0,0,0,7885824,8584704,7866944,1337120,1044,9949184,4294967056,0
.long 6075392,6074880,8419712,8649856,0,0,0,8523776,0,0,0,0,149760,152064,0,5,3491840,3502080,3512320,3481600,6144,0,0,0,7886080,8573952,7867008,27680,21,9974784,4294967056,0
.long 6154240,6156288,8423168,8649984,0,0,0,8527872,0,0,0,0,152064,147456,0,5,3492864,3503104,3513344,3482624,6152,0,0,0,7886336,8584704,7867072,1338400,1045,10000384,4294967056,0
.long 6157312,6156800,8426624,8650112,0,0,0,8531968,0,0,0,0,154368,152064,0,5,3450880,3461120,3471360,3440640,5120,0,0,0,7886592,8573952,7866880,26400,20,10025984,4294967056,0
.long 8505344,0,0,0,0,0,0,0,8501248,7883520,614720,9718784,0,0,0,5,6082560,6103040,6123520,6062080,133120,153600,112640,117760,7885824,5120,7875136,1337120,1044,9949184,4294967056,8648704
.long 8505344,0,0,0,0,0,0,0,8502272,7883520,614720,9723904,0,0,0,5,6108160,6128640,6067200,6087680,148480,107520,128000,133120,7886080,6144,7875200,27680,21,9974784,4294967056,8649216
.long 8505344,0,0,0,0,0,0,0,8503296,7883520,614720,9729024,0,0,0,5,6133760,6072320,6092800,6113280,102400,122880,143360,148480,7886336,6144,7875264,1338400,1045,10000384,4294967056,8649728
.long 8505344,0,0,0,0,0,0,0,8504320,7883520,614720,9729024,0,0,0,5,6077440,6097920,6118400,6138880,117760,138240,158720,102400,7886592,5120,7875072,26400,20,10025984,4294967056,8650240
.long 6077440,6079488,8430080,8650240,0,0,0,8536064,0,0,0,0,147456,147456,0,5,3779584,3789824,3800064,3769344,5128,0,0,0,7885824,8584704,7867968,1347360,1052,9949184,4294967056,0
.long 6080512,6080000,8433536,8650368,0,0,0,8540160,0,0,0,0,149760,152064,0,5,3819520,3829760,3840000,3809280,6144,0,0,0,7886080,8573952,7868032,37920,29,9974784,4294967056,0
.long 6159360,6161408,8436992,8650496,0,0,0,8544256,0,0,0,0,152064,147456,0,5,3820544,3830784,3841024,3810304,6152,0,0,0,7886336,8584704,7868096,1348640,1053,10000384,4294967056,0
.long 6162432,6161920,8440448,8650624,0,0,0,8548352,0,0,0,0,154368,152064,0,5,3778560,3788800,3799040,3768320,5120,0,0,0,7886592,8573952,7867904,36640,28,10025984,4294967056,0
.long 8510464,0,0,0,0,0,0,0,8506368,7883648,717120,9734144,0,0,0,5,6410240,6430720,6451200,6389760,133120,153600,112640,117760,7885824,5120,7876160,1347360,1052,9949184,4294967056,8652800
.long 8510464,0,0,0,0,0,0,0,8507392,7883648,717120,9739264,0,0,0,5,6435840,6456320,6394880,6415360,148480,107520,128000,133120,7886080,6144,7876224,37920,29,9974784,4294967056,8653312
.long 8510464,0,0,0,0,0,0,0,8508416,7883648,717120,9729536,0,0,0,5,6461440,6400000,6420480,6440960,102400,122880,143360,148480,7886336,6144,7876288,1348640,1053,10000384,4294967056,8653824
.long 8510464,0,0,0,0,0,0,0,8509440,7883648,717120,9729536,0,0,0,5,6405120,6425600,6446080,6466560,117760,138240,158720,102400,7886592,5120,7876096,36640,28,10025984,4294967056,8654336
.long 7372800,7374848,8388608,8665088,0,0,0,8486912,0,0,0,0,147456,147456,0,5,4107264,4117504,4127744,4097024,5128,0,0,0,7885824,8606208,7868992,1357600,1060,9949184,4294967056,0
.long 7375872,7375360,8392064,8665216,0,0,0,8491008,0,0,0,0,149760,152064,0,5,4147200,4157440,4167680,4136960,6144,0,0,0,7886080,8595456,7869056,48160,37,9974784,4294967056,0
.long 7454720,7456768,8395520,8665344,0,0,0,8495104,0,0,0,0,152064,147456,0,5,4148224,4158464,4168704,4137984,6152,0,0,0,7886336,8606208,7869120,1358880,1061,10000384,4294967056,0
.long 7457792,7457280,8398976,8665472,0,0,0,8499200,0,0,0,0,154368,152064,0,5,4106240,4116480,4126720,4096000,5120,0,0,0,7886592,8595456,7868928,46880,36,10025984,4294967056,0
.long 8658944,0,0,0,0,0,0,0,8654848,7887360,410560,10102784,0,0,0,5,6737920,6758400,6778880,6717440,133120,153600,112640,117760,7885824,5120,7877184,1357600,1060,9949184,4294967056,8656896
.long 8658944,0,0,0,0,0,0,0,8655872,7887360,410560,10107904,0,0,0,5,6763520,6784000,6722560,6743040,148480,107520,128000,133120,7886080,6144,7877248,48160,37,9974784,4294967056,8657408
.long 8658944,0,0,0,0,0,0,0,8656896,7887360,410560,10113024,0,0,0,5,6789120,6727680,6748160,6768640,102400,122880,143360,148480,7886336,6144,7877312,1358880,1061,10000384,4294967056,8657920
.long 8658944,0,0,0,0,0,0,0,8657920,7887360,410560,10113024,0,0,0,5,6732800,6753280,6773760,6794240,117760,138240,158720,102400,7886592,5120,7877120,46880,36,10025984,4294967056,8658432
.long 7377920,7379968,8402432,8665600,0,0,0,8503296,0,0,0,0,147456,147456,0,5,4434944,4445184,4455424,4424704,5128,0,0,0,7885824,8606208,7870016,1367840,1068,9949184,4294967056,0
.long 7380992,7380480,8405888,8665728,0,0,0,8507392,0,0,0,0,149760,152064,0,5,4474880,4485120,4495360,4464640,6144,0,0,0,7886080,8595456,7870080,58400,45,9974784,4294967056,0
.long 7459840,7461888,8409344,8665856,0,0,0,8511488,0,0,0,0,152064,147456,0,5,4475904,4486144,4496384,4465664,6152,0,0,0,7886336,8606208,7870144,1369120,1069,10000384,4294967056,0
.long 7462912,7462400,8412800,8665984,0,0,0,8515584,0,0,0,0,154368,152064,0,5,4433920,4444160,4454400,4423680,5120,0,0,0,7886592,8595456,7869952,57120,44,10025984,4294967056,0
.long 8664064,0,0,0,0,0,0,0,8659968,7887488,512960,10118144,0,0,0,5,7065600,7086080,7106560,7045120,133120,153600,112640,117760,7885824,5120,7878208,1367840,1068,9949184,4294967056,8660992
.long 8664064,0,0,0,0,0,0,0,8660992,7887488,512960,10123264,0,0,0,5,7091200,7111680,7050240,7070720,148480,107520,128000,133120,7886080,6144,7878272,58400,45,9974784,4294967056,8661504
.long 8664064,0,0,0,0,0,0,0,8662016,7887488,512960,10113536,0,0,0,5,7116800,7055360,7075840,7096320,102400,122880,143360,148480,7886336,6144,7878336,1369120,1069,10000384,4294967056,8662016
.long 8664064,0,0,0,0,0,0,0,8663040,7887488,512960,10113536,0,0,0,5,7060480,7080960,7101440,7121920,117760,138240,158720,102400,7886592,5120,7878144,57120,44,10025984,4294967056,8662528
.long 7383040,7385088,8416256,8666112,0,0,0,8519680,0,0,0,0,147456,147456,0,5,4762624,4772864,4783104,4752384,5128,0,0,0,7885824,8627712,7871040,1378080,1076,9949184,4294967056,0
.long 7386112,7385600,8419712,8666240,0,0,0,8523776,0,0,0,0,149760,152064,0,5,4802560,4812800,4823040,4792320,6144,0,0,0,7886080,8616960,7871104,68640,53,9974784,4294967056,0
.long 7464960,7467008,8423168,8666368,0,0,0,8527872,0,0,0,0,152064,147456,0,5,4803584,4813824,4824064,4793344,6152,0,0,0,7886336,8627712,7871168,1379360,1077,10000384,4294967056,0
.long 7468032,7467520,8426624,8666496,0,0,0,8531968,0,0,0,0,154368,152064,0,5,4761600,4771840,4782080,4751360,5120,0,0,0,7886592,8616960,7870976,67360,52,10025984,4294967056,0
.long 8669184,0,0,0,0,0,0,0,8665088,7887616,615360,10128384,0,0,0,5,7393280,7413760,7434240,7372800,133120,153600,112640,117760,7885824,5120,7879232,1378080,1076,9949184,4294967056,8665088
.long 8669184,0,0,0,0,0,0,0,8666112,7887616,615360,10133504,0,0,0,5,7418880,7439360,7377920,7398400,148480,107520,128000,133120,7886080,6144,7879296,68640,53,9974784,4294967056,8665600
.long 8669184,0,0,0,0,0,0,0,8667136,7887616,615360,10138624,0,0,0,5,7444480,7383040,7403520,7424000,102400,122880,143360,148480,7886336,6144,7879360,1379360,1077,10000384,4294967056,8666112
.long 8669184,0,0,0,0,0,0,0,8668160,7887616,615360,10138624,0,0,0,5,7388160,7408640,7429120,7449600,117760,138240,158720,102400,7886592,5120,7879168,67360,52,10025984,4294967056,8666624
.long 7388160,7390208,8430080,8666624,0,0,0,8536064,0,0,0,0,147456,147456,0,5,5090304,5100544,5110784,5080064,5128,0,0,0,7885824,8627712,7872064,1388320,1084,9949184,4294967056,0
.long 7391232,7390720,8433536,8666752,0,0,0,8540160,0,0,0,0,149760,152064,0,5,5130240,5140480,5150720,5120000,6144,0,0,0,7886080,8616960,7872128,78880,61,9974784,4294967056,0
.long 7470080,7472128,8436992,8666880,0,0,0,8544256,0,0,0,0,152064,147456,0,5,5131264,5141504,5151744,5121024,6152,0,0,0,7886336,8627712,7872192,1389600,1085,10000384,4294967056,0
.long 7473152,7472640,8440448,8667008,0,0,0,8548352,0,0,0,0,154368,152064,0,5,5089280,5099520,5109760,5079040,5120,0,0,0,7886592,8616960,7872000,77600,60,10025984,4294967056,0
.long 8674304,0,0,0,0,0,0,0,8670208,7887744,717760,10143744,0,0,0,5,7720960,7741440,7761920,7700480,133120,153600,112640,117760,7885824,5120,7880256,1388320,1084,9949184,4294967056,8669184
.long 8674304,0,0,0,0,0,0,0,8671232,7887744,717760,10148864,0,0,0,5,7746560,7767040,7705600,7726080,148480,107520,128000,133120,7886080,6144,7880320,78880,61,9974784,4294967056,8669696
.long 8674304,0,0,0,0,0,0,0,8672256,7887744,717760,10139136,0,0,0,5,7772160,7710720,7731200,7751680,102400,122880,143360,148480,7886336,6144,7880384,1389600,1085,10000384,4294967056,8670208
.long 8674304,0,0,0,0,0,0,0,8673280,7887744,717760,10139136,0,0,0,5,7715840,7736320,7756800,7777280,117760,138240,158720,102400,7886592,5120,7880192,77600,60,10025984,4294967056,8670720
.long 8388608,106496,106496,8487552,0,0,0,0,0,0,0,0,0,0,0,6,5447680,5468160,5406720,5427200,148480,107520,128000,133120,7886848,11264,7873152,7360,5,10051584,4294967136,8640512
.long 8390336,126976,110592,8489600,0,0,0,0,0,0,0,0,0,0,0,6,5473280,5411840,5432320,5452800,102400,122880,143360,148480,7887104,11264,7873216,1318080,1029,10077184,4294967136,8641024
.long 8392064,108544,126976,8491648,0,0,0,0,0,0,0,0,0,0,0,6,5416960,5437440,5457920,5478400,117760,138240,158720,102400,7887360,10240,7873024,6080,4,10102784,4294967136,8641536
.long 8393792,129024,131072,8493696,0,0,0,0,0,0,0,0,0,0,0,6,5442560,5463040,5483520,5422080,133120,153600,112640,117760,7887616,10240,7873088,1316800,1028,10128384,4294967136,8642048
.long 0,0,0,0,15,0,15,8478720,3840,2652160,8554368,73728,0,106496,106496,6,2846720,2856960,2826240,2836480,11264,0,0,0,7886848,8552448,7864960,7360,5,10051584,4294967136,0
.long 0,0,0,0,15,0,15,8480768,85760,3307520,8575872,79872,0,107520,110592,6,2847744,2857984,2827264,2837504,11272,0,0,0,7887104,8563200,7865024,1318080,1029,10077184,4294967136,0
.long 0,0,0,0,15,0,15,8482816,167680,3962880,8597376,86016,0,108544,114688,6,2805760,2816000,2785280,2795520,10240,0,0,0,7887360,8552448,7864832,6080,4,10102784,4294967136,0
.long 0,0,0,0,15,0,15,8484864,249600,4618240,8618880,92160,0,109568,118784,6,2806784,2817024,2786304,2796544,10248,0,0,0,7887616,8563200,7864896,1316800,1028,10128384,4294967136,0
.long 8402432,106496,106496,8503936,0,0,0,0,0,0,0,0,0,0,0,6,5775360,5795840,5734400,5754880,148480,107520,128000,133120,7886848,11264,7874176,17600,13,10051584,4294967136,8644608
.long 8404160,126976,110592,8505984,0,0,0,0,0,0,0,0,0,0,0,6,5800960,5739520,5760000,5780480,102400,122880,143360,148480,7887104,11264,7874240,1328320,1037,10077184,4294967136,8645120
.long 8405888,108544,126976,8508032,0,0,0,0,0,0,0,0,0,0,0,6,5744640,5765120,5785600,5806080,117760,138240,158720,102400,7887360,10240,7874048,16320,12,10102784,4294967136,8645632
.long 8407616,129024,131072,8510080,0,0,0,0,0,0,0,0,0,0,0,6,5770240,5790720,5811200,5749760,133120,153600,112640,117760,7887616,10240,7874112,1327040,1036,10128384,4294967136,8646144
.long 0,0,0,0,15,1,15,8478720,331520,2652416,8557056,73728,0,106496,106496,6,3174400,3184640,3153920,3164160,11264,0,0,0,7886848,8552448,7865984,17600,13,10051584,4294967136,0
.long 0,0,0,0,15,1,15,8480768,413440,3307776,8578560,79872,0,107520,110592,6,3175424,3185664,3154944,3165184,11272,0,0,0,7887104,8563200,7866048,1328320,1037,10077184,4294967136,0
.long 0,0,0,0,15,1,15,8482816,495360,3963136,8600064,86016,0,108544,114688,6,3133440,3143680,3112960,3123200,10240,0,0,0,7887360,8552448,7865856,16320,12,10102784,4294967136,0
.long 0,0,0,0,15,1,15,8484864,577280,4618496,8621568,92160,0,109568,118784,6,3134464,3144704,3113984,3124224,10248,0,0,0,7887616,8563200,7865920,1327040,1036,10128384,4294967136,0
.long 8416256,106496,106496,8520320,0,0,0,0,0,0,0,0,0,0,0,6,6103040,6123520,6062080,6082560,148480,107520,128000,133120,7886848,11264,7875200,27840,21,10051584,4294967136,8648704
.long 8417984,126976,110592,8522368,0,0,0,0,0,0,0,0,0,0,0,6,6128640,6067200,6087680,6108160,102400,122880,143360,148480,7887104,11264,7875264,1338560,1045,10077184,4294967136,8649216
.long 8419712,108544,126976,8524416,0,0,0,0,0,0,0,0,0,0,0,6,6072320,6092800,6113280,6133760,117760,138240,158720,102400,7887360,10240,7875072,26560,20,10102784,4294967136,8649728
.long 8421440,129024,131072,8526464,0,0,0,0,0,0,0,0,0,0,0,6,6097920,6118400,6138880,6077440,133120,153600,112640,117760,7887616,10240,7875136,1337280,1044,10128384,4294967136,8650240
.long 0,0,0,0,15,2,15,8478720,659200,2652672,8559744,73728,0,106496,106496,6,3502080,3512320,3481600,3491840,11264,0,0,0,7886848,8573952,7867008,27840,21,10051584,4294967136,0
.long 0,0,0,0,15,2,15,8480768,741120,3308032,8581248,79872,0,107520,110592,6,3503104,3513344,3482624,3492864,11272,0,0,0,7887104,8584704,7867072,1338560,1045,10077184,4294967136,0
.long 0,0,0,0,15,2,15,8482816,823040,3963392,8602752,86016,0,108544,114688,6,3461120,3471360,3440640,3450880,10240,0,0,0,7887360,8573952,7866880,26560,20,10102784,4294967136,0
.long 0,0,0,0,15,2,15,8484864,904960,4618752,8624256,92160,0,109568,118784,6,3462144,3472384,3441664,3451904,10248,0,0,0,7887616,8584704,7866944,1337280,1044,10128384,4294967136,0
.long 8430080,106496,106496,8536704,0,0,0,0,0,0,0,0,0,0,0,6,6430720,6451200,6389760,6410240,148480,107520,128000,133120,7886848,11264,7876224,38080,29,10051584,4294967136,8652800
.long 8431808,126976,110592,8538752,0,0,0,0,0,0,0,0,0,0,0,6,6456320,6394880,6415360,6435840,102400,122880,143360,148480,7887104,11264,7876288,1348800,1053,10077184,4294967136,8653312
.long 8433536,108544,126976,8540800,0,0,0,0,0,0,0,0,0,0,0,6,6400000,6420480,6440960,6461440,117760,138240,158720,102400,7887360,10240,7876096,36800,28,10102784,4294967136,8653824
.long 8435264,129024,131072,8542848,0,0,0,0,0,0,0,0,0,0,0,6,6425600,6446080,6466560,6405120,133120,153600,112640,117760,7887616,10240,7876160,1347520,1052,10128384,4294967136,8654336
.long 0,0,0,0,15,3,15,8478720,986880,2652928,8562432,73728,0,106496,106496,6,3829760,3840000,3809280,3819520,11264,0,0,0,7886848,8573952,7868032,38080,29,10051584,4294967136,0
.long 0,0,0,0,15,3,15,8480768,1068800,3308288,8583936,79872,0,107520,110592,6,3830784,3841024,3810304,3820544,11272,0,0,0,7887104,8584704,7868096,1348800,1053,10077184,4294967136,0
.long 0,0,0,0,15,3,15,8482816,1150720,3963648,8605440,86016,0,108544,114688,6,3788800,3799040,3768320,3778560,10240,0,0,0,7887360,8573952,7867904,36800,28,10102784,4294967136,0
.long 0,0,0,0,15,3,15,8484864,1232640,4619008,8626944,92160,0,109568,118784,6,3789824,3800064,3769344,3779584,10248,0,0,0,7887616,8584704,7867968,1347520,1052,10128384,4294967136,0
.long 8388608,106496,106496,8488576,0,0,0,0,0,0,0,0,0,0,0,6,6758400,6778880,6717440,6737920,148480,107520,128000,133120,7886848,11264,7877248,48320,37,10051584,4294967136,8656896
.long 8390336,126976,110592,8490624,0,0,0,0,0,0,0,0,0,0,0,6,6784000,6722560,6743040,6763520,102400,122880,143360,148480,7887104,11264,7877312,1359040,1061,10077184,4294967136,8657408
.long 8392064,108544,126976,8492672,0,0,0,0,0,0,0,0,0,0,0,6,6727680,6748160,6768640,6789120,117760,138240,158720,102400,7887360,10240,7877120,47040,36,10102784,4294967136,8657920
.long 8393792,129024,131072,8494720,0,0,0,0,0,0,0,0,0,0,0,6,6753280,6773760,6794240,6732800,133120,153600,112640,117760,7887616,10240,7877184,1357760,1060,10128384,4294967136,8658432
.long 0,0,0,0,15,4,15,8478720,1314560,2653184,8565120,73728,0,106496,106496,6,4157440,4167680,4136960,4147200,11264,0,0,0,7886848,8595456,7869056,48320,37,10051584,4294967136,0
.long 0,0,0,0,15,4,15,8480768,1396480,3308544,8586624,79872,0,107520,110592,6,4158464,4168704,4137984,4148224,11272,0,0,0,7887104,8606208,7869120,1359040,1061,10077184,4294967136,0
.long 0,0,0,0,15,4,15,8482816,1478400,3963904,8608128,86016,0,108544,114688,6,4116480,4126720,4096000,4106240,10240,0,0,0,7887360,8595456,7868928,47040,36,10102784,4294967136,0
.long 0,0,0,0,15,4,15,8484864,1560320,4619264,8629632,92160,0,109568,118784,6,4117504,4127744,4097024,4107264,10248,0,0,0,7887616,8606208,7868992,1357760,1060,10128384,4294967136,0
.long 8402432,106496,106496,8504960,0,0,0,0,0,0,0,0,0,0,0,6,7086080,7106560,7045120,7065600,148480,107520,128000,133120,7886848,11264,7878272,58560,45,10051584,4294967136,8660992
.long 8404160,126976,110592,8507008,0,0,0,0,0,0,0,0,0,0,0,6,7111680,7050240,7070720,7091200,102400,122880,143360,148480,7887104,11264,7878336,1369280,1069,10077184,4294967136,8661504
.long 8405888,108544,126976,8509056,0,0,0,0,0,0,0,0,0,0,0,6,7055360,7075840,7096320,7116800,117760,138240,158720,102400,7887360,10240,7878144,57280,44,10102784,4294967136,8662016
.long 8407616,129024,131072,8511104,0,0,0,0,0,0,0,0,0,0,0,6,7080960,7101440,7121920,7060480,133120,153600,112640,117760,7887616,10240,7878208,1368000,1068,10128384,4294967136,8662528
.long 0,0,0,0,15,5,15,8478720,1642240,2653440,8567808,73728,0,106496,106496,6,4485120,4495360,4464640,4474880,11264,0,0,0,7886848,8595456,7870080,58560,45,10051584,4294967136,0
.long 0,0,0,0,15,5,15,8480768,1724160,3308800,8589312,79872,0,107520,110592,6,4486144,4496384,4465664,4475904,11272,0,0,0,7887104,8606208,7870144,1369280,1069,10077184,4294967136,0
.long 0,0,0,0,15,5,15,8482816,1806080,3964160,8610816,86016,0,108544,114688,6,4444160,4454400,4423680,4433920,10240,0,0,0,7887360,8595456,7869952,57280,44,10102784,4294967136,0
.long 0,0,0,0,15,5,15,8484864,1888000,4619520,8632320,92160,0,109568,118784,6,4445184,4455424,4424704,4434944,10248,0,0,0,7887616,8606208,7870016,1368000,1068,10128384,4294967136,0
.long 8416256,106496,106496,8521344,0,0,0,0,0,0,0,0,0,0,0,6,7413760,7434240,7372800,7393280,148480,107520,128000,133120,7886848,11264,7879296,68800,53,10051584,4294967136,8665088
.long 8417984,126976,110592,8523392,0,0,0,0,0,0,0,0,0,0,0,6,7439360,7377920,7398400,7418880,102400,122880,143360,148480,7887104,11264,7879360,1379520,1077,10077184,4294967136,8665600
.long 8419712,108544,126976,8525440,0,0,0,0,0,0,0,0,0,0,0,6,7383040,7403520,7424000,7444480,117760,138240,158720,102400,7887360,10240,7879168,67520,52,10102784,4294967136,8666112
.long 8421440,129024,131072,8527488,0,0,0,0,0,0,0,0,0,0,0,6,7408640,7429120,7449600,7388160,133120,153600,112640,117760,7887616,10240,7879232,1378240,1076,10128384,4294967136,8666624
.long 0,0,0,0,15,6,15,8478720,1969920,2653696,8570496,73728,0,106496,106496,6,4812800,4823040,4792320,4802560,11264,0,0,0,7886848,8616960,7871104,68800,53,10051584,4294967136,0
.long 0,0,0,0,15,6,15,8480768,2051840,3309056,8592000,79872,0,107520,110592,6,4813824,4824064,4793344,4803584,11272,0,0,0,7887104,8627712,7871168,1379520,1077,10077184,4294967136,0
.long 0,0,0,0,15,6,15,8482816,2133760,3964416,8613504,86016,0,108544,114688,6,4771840,4782080,4751360,4761600,10240,0,0,0,7887360,8616960,7870976,67520,52,10102784,4294967136,0
.long 0,0,0,0,15,6,15,8484864,2215680,4619776,8635008,92160,0,109568,118784,6,4772864,4783104,4752384,4762624,10248,0,0,0,7887616,8627712,7871040,1378240,1076,10128384,4294967136,0
.long 8430080,106496,106496,8537728,0,0,0,0,0,0,0,0,0,0,0,6,7741440,7761920,7700480,7720960,148480,107520,128000,133120,7886848,11264,7880320,79040,61,10051584,4294967136,8669184
.long 8431808,126976,110592,8539776,0,0,0,0,0,0,0,0,0,0,0,6,7767040,7705600,7726080,7746560,102400,122880,143360,148480,7887104,11264,7880384,1389760,1085,10077184,4294967136,8669696
.long 8433536,108544,126976,8541824,0,0,0,0,0,0,0,0,0,0,0,6,7710720,7731200,7751680,7772160,117760,138240,158720,102400,7887360,10240,7880192,77760,60,10102784,4294967136,8670208
.long 8435264,129024,131072,8543872,0,0,0,0,0,0,0,0,0,0,0,6,7736320,7756800,7777280,7715840,133120,153600,112640,117760,7887616,10240,7880256,1388480,1084,10128384,4294967136,8670720
.long 0,0,0,0,15,7,15,8478720,2297600,2653952,8573184,73728,0,106496,106496,6,5140480,5150720,5120000,5130240,11264,0,0,0,7886848,8616960,7872128,79040,61,10051584,4294967136,0
.long 0,0,0,0,15,7,15,8480768,2379520,3309312,8594688,79872,0,107520,110592,6,5141504,5151744,5121024,5131264,11272,0,0,0,7887104,8627712,7872192,1389760,1085,10077184,4294967136,0
.long 0,0,0,0,15,7,15,8482816,2461440,3964672,8616192,86016,0,108544,114688,6,5099520,5109760,5079040,5089280,10240,0,0,0,7887360,8616960,7872000,77760,60,10102784,4294967136,0
.long 0,0,0,0,15,7,15,8484864,2543360,4620032,8637696,92160,0,109568,118784,6,5100544,5110784,5080064,5090304,10248,0,0,0,7887616,8627712,7872064,1388480,1084,10128384,4294967136,0
.long 8395520,106496,106496,8495744,0,0,0,0,0,0,0,0,0,0,0,7,5468160,5406720,5427200,5447680,102400,122880,143360,148480,7887872,16384,7873216,1318240,1029,10153984,4294967216,8640512
.long 8397248,126976,110592,8497792,0,0,0,0,0,0,0,0,0,0,0,7,5411840,5432320,5452800,5473280,117760,138240,158720,102400,7888128,15360,7873024,6240,4,10179584,4294967216,8641024
.long 8398976,108544,126976,8499840,0,0,0,0,0,0,0,0,0,0,0,7,5437440,5457920,5478400,5416960,133120,153600,112640,117760,7888384,15360,7873088,1316960,1028,10205184,4294967216,8641536
.long 8400704,129024,131072,8501888,0,0,0,0,0,0,0,0,0,0,0,7,5463040,5483520,5422080,5442560,148480,107520,128000,133120,7888640,16384,7873152,7520,5,10230784,4294967216,8642048
.long 0,0,0,0,17,0,17,8478720,4352,2656256,8554624,73728,0,106496,106496,7,2857984,2827264,2837504,2847744,16392,0,0,0,7887872,8563200,7865024,1318240,1029,10153984,4294967216,0
.long 0,0,0,0,17,0,17,8480768,86272,3311616,8576128,79872,0,107520,110592,7,2816000,2785280,2795520,2805760,15360,0,0,0,7888128,8552448,7864832,6240,4,10179584,4294967216,0
.long 0,0,0,0,17,0,17,8482816,168192,3966976,8597632,86016,0,108544,114688,7,2817024,2786304,2796544,2806784,15368,0,0,0,7888384,8563200,7864896,1316960,1028,10205184,4294967216,0
.long 0,0,0,0,17,0,17,8484864,250112,4622336,8619136,92160,0,109568,118784,7,2856960,2826240,2836480,2846720,16384,0,0,0,7888640,8552448,7864960,7520,5,10230784,4294967216,0
.long 8409344,106496,106496,8512128,0,0,0,0,0,0,0,0,0,0,0,7,5795840,5734400,5754880,5775360,102400,122880,143360,148480,7887872,16384,7874240,1328480,1037,10153984,4294967216,8644608
.long 8411072,126976,110592,8514176,0,0,0,0,0,0,0,0,0,0,0,7,5739520,5760000,5780480,5800960,117760,138240,158720,102400,7888128,15360,7874048,16480,12,10179584,4294967216,8645120
.long 8412800,108544,126976,8516224,0,0,0,0,0,0,0,0,0,0,0,7,5765120,5785600,5806080,5744640,133120,153600,112640,117760,7888384,15360,7874112,1327200,1036,10205184,4294967216,8645632
.long 8414528,129024,131072,8518272,0,0,0,0,0,0,0,0,0,0,0,7,5790720,5811200,5749760,5770240,148480,107520,128000,133120,7888640,16384,7874176,17760,13,10230784,4294967216,8646144
.long 0,0,0,0,17,1,17,8478720,332032,2656512,8557312,73728,0,106496,106496,7,3185664,3154944,3165184,3175424,16392,0,0,0,7887872,8563200,7866048,1328480,1037,10153984,4294967216,0
.long 0,0,0,0,17,1,17,8480768,413952,3311872,8578816,79872,0,107520,110592,7,3143680,3112960,3123200,3133440,15360,0,0,0,7888128,8552448,7865856,16480,12,10179584,4294967216,0
.long 0,0,0,0,17,1,17,8482816,495872,3967232,8600320,86016,0,108544,114688,7,3144704,3113984,3124224,3134464,15368,0,0,0,7888384,8563200,7865920,1327200,1036,10205184,4294967216,0
.long 0,0,0,0,17,1,17,8484864,577792,4622592,8621824,92160,0,109568,118784,7,3184640,3153920,3164160,3174400,16384,0,0,0,7888640,8552448,7865984,17760,13,10230784,4294967216,0
.long 8423168,106496,106496,8528512,0,0,0,0,0,0,0,0,0,0,0,7,6123520,6062080,6082560,6103040,102400,122880,143360,148480,7887872,16384,7875264,1338720,1045,10153984,4294967216,8648704
.long 8424896,126976,110592,8530560,0,0,0,0,0,0,0,0,0,0,0,7,6067200,6087680,6108160,6128640,117760,138240,158720,102400,7888128,15360,7875072,26720,20,10179584,4294967216,8649216
.long 8426624,108544,126976,8532608,0,0,0,0,0,0,0,0,0,0,0,7,6092800,6113280,6133760,6072320,133120,153600,112640,117760,7888384,15360,7875136,1337440,1044,10205184,4294967216,8649728
.long 8428352,129024,131072,8534656,0,0,0,0,0,0,0,0,0,0,0,7,6118400,6138880,6077440,6097920,148480,107520,128000,133120,7888640,16384,7875200,28000,21,10230784,4294967216,8650240
.long 0,0,0,0,17,2,17,8478720,659712,2656768,8560000,73728,0,106496,106496,7,3513344,3482624,3492864,3503104,16392,0,0,0,7887872,8584704,7867072,1338720,1045,10153984,4294967216,0
.long 0,0,0,0,17,2,17,8480768,741632,3312128,8581504,79872,0,107520,110592,7,3471360,3440640,3450880,3461120,15360,0,0,0,7888128,8573952,7866880,26720,20,10179584,4294967216,0
.long 0,0,0,0,17,2,17,8482816,823552,3967488,8603008,86016,0,108544,114688,7,3472384,3441664,3451904,3462144,15368,0,0,0,7888384,8584704,7866944,1337440,1044,10205184,4294967216,0
.long 0,0,0,0,17,2,17,8484864,905472,4622848,8624512,92160,0,109568,118784,7,3512320,3481600,3491840,3502080,16384,0,0,0,7888640,8573952,7867008,28000,21,10230784,4294967216,0
.long 8436992,106496,106496,8544896,0,0,0,0,0,0,0,0,0,0,0,7,6451200,6389760,6410240,6430720,102400,122880,143360,148480,7887872,16384,7876288,1348960,1053,10153984,4294967216,8652800
.long 8438720,126976,110592,8546944,0,0,0,0,0,0,0,0,0,0,0,7,6394880,6415360,6435840,6456320,117760,138240,158720,102400,7888128,15360,7876096,36960,28,10179584,4294967216,8653312
.long 8440448,108544,126976,8548992,0,0,0,0,0,0,0,0,0,0,0,7,6420480,6440960,6461440,6400000,133120,153600,112640,117760,7888384,15360,7876160,1347680,1052,10205184,4294967216,8653824
.long 8442176,129024,131072,8551040,0,0,0,0,0,0,0,0,0,0,0,7,6446080,6466560,6405120,6425600,148480,107520,128000,133120,7888640,16384,7876224,38240,29,10230784,4294967216,8654336
.long 0,0,0,0,17,3,17,8478720,987392,2657024,8562688,73728,0,106496,106496,7,3841024,3810304,3820544,3830784,16392,0,0,0,7887872,8584704,7868096,1348960,1053,10153984,4294967216,0
.long 0,0,0,0,17,3,17,8480768,1069312,3312384,8584192,79872,0,107520,110592,7,3799040,3768320,3778560,3788800,15360,0,0,0,7888128,8573952,7867904,36960,28,10179584,4294967216,0
.long 0,0,0,0,17,3,17,8482816,1151232,3967744,8605696,86016,0,108544,114688,7,3800064,3769344,3779584,3789824,15368,0,0,0,7888384,8584704,7867968,1347680,1052,10205184,4294967216,0
.long 0,0,0,0,17,3,17,8484864,1233152,4623104,8627200,92160,0,109568,118784,7,3840000,3809280,3819520,3829760,16384,0,0,0,7888640,8573952,7868032,38240,29,10230784,4294967216,0
.long 8395520,106496,106496,8496768,0,0,0,0,0,0,0,0,0,0,0,7,6778880,6717440,6737920,6758400,102400,122880,143360,148480,7887872,16384,7877312,1359200,1061,10153984,4294967216,8656896
.long 8397248,126976,110592,8498816,0,0,0,0,0,0,0,0,0,0,0,7,6722560,6743040,6763520,6784000,117760,138240,158720,102400,7888128,15360,7877120,47200,36,10179584,4294967216,8657408
.long 8398976,108544,126976,8500864,0,0,0,0,0,0,0,0,0,0,0,7,6748160,6768640,6789120,6727680,133120,153600,112640,117760,7888384,15360,7877184,1357920,1060,10205184,4294967216,8657920
.long 8400704,129024,131072,8502912,0,0,0,0,0,0,0,0,0,0,0,7,6773760,6794240,6732800,6753280,148480,107520,128000,133120,7888640,16384,7877248,48480,37,10230784,4294967216,8658432
.long 0,0,0,0,17,4,17,8478720,1315072,2657280,8565376,73728,0,106496,106496,7,4168704,4137984,4148224,4158464,16392,0,0,0,7887872,8606208,7869120,1359200,1061,10153984,4294967216,0
.long 0,0,0,0,17,4,17,8480768,1396992,3312640,8586880,79872,0,107520,110592,7,4126720,4096000,4106240,4116480,15360,0,0,0,7888128,8595456,7868928,47200,36,10179584,4294967216,0
.long 0,0,0,0,17,4,17,8482816,1478912,3968000,8608384,86016,0,108544,114688,7,4127744,4097024,4107264,4117504,15368,0,0,0,7888384,8606208,7868992,1357920,1060,10205184,4294967216,0
.long 0,0,0,0,17,4,17,8484864,1560832,4623360,8629888,92160,0,109568,118784,7,4167680,4136960,4147200,4157440,16384,0,0,0,7888640,8595456,7869056,48480,37,10230784,4294967216,0
.long 8409344,106496,106496,8513152,0,0,0,0,0,0,0,0,0,0,0,7,7106560,7045120,7065600,7086080,102400,122880,143360,148480,7887872,16384,7878336,1369440,1069,10153984,4294967216,8660992
.long 8411072,126976,110592,8515200,0,0,0,0,0,0,0,0,0,0,0,7,7050240,7070720,7091200,7111680,117760,138240,158720,102400,7888128,15360,7878144,57440,44,10179584,4294967216,8661504
.long 8412800,108544,126976,8517248,0,0,0,0,0,0,0,0,0,0,0,7,7075840,7096320,7116800,7055360,133120,153600,112640,117760,7888384,15360,7878208,1368160,1068,10205184,4294967216,8662016
.long 8414528,129024,131072,8519296,0,0,0,0,0,0,0,0,0,0,0,7,7101440,7121920,7060480,7080960,148480,107520,128000,133120,7888640,16384,7878272,58720,45,10230784,4294967216,8662528
.long 0,0,0,0,17,5,17,8478720,1642752,2657536,8568064,73728,0,106496,106496,7,4496384,4465664,4475904,4486144,16392,0,0,0,7887872,8606208,7870144,1369440,1069,10153984,4294967216,0
.long 0,0,0,0,17,5,17,8480768,1724672,3312896,8589568,79872,0,107520,110592,7,4454400,4423680,4433920,4444160,15360,0,0,0,7888128,8595456,7869952,57440,44,10179584,4294967216,0
.long 0,0,0,0,17,5,17,8482816,1806592,3968256,8611072,86016,0,108544,114688,7,4455424,4424704,4434944,4445184,15368,0,0,0,7888384,8606208,7870016,1368160,1068,10205184,4294967216,0
.long 0,0,0,0,17,5,17,8484864,1888512,4623616,8632576,92160,0,109568,118784,7,4495360,4464640,4474880,4485120,16384,0,0,0,7888640,8595456,7870080,58720,45,10230784,4294967216,0
.long 8423168,106496,106496,8529536,0,0,0,0,0,0,0,0,0,0,0,7,7434240,7372800,7393280,7413760,102400,122880,143360,148480,7887872,16384,7879360,1379680,1077,10153984,4294967216,8665088
.long 8424896,126976,110592,8531584,0,0,0,0,0,0,0,0,0,0,0,7,7377920,7398400,7418880,7439360,117760,138240,158720,102400,7888128,15360,7879168,67680,52,10179584,4294967216,8665600
.long 8426624,108544,126976,8533632,0,0,0,0,0,0,0,0,0,0,0,7,7403520,7424000,7444480,7383040,133120,153600,112640,117760,7888384,15360,7879232,1378400,1076,10205184,4294967216,8666112
.long 8428352,129024,131072,8535680,0,0,0,0,0,0,0,0,0,0,0,7,7429120,7449600,7388160,7408640,148480,107520,128000,133120,7888640,16384,7879296,68960,53,10230784,4294967216,8666624
.long 0,0,0,0,17,6,17,8478720,1970432,2657792,8570752,73728,0,106496,106496,7,4824064,4793344,4803584,4813824,16392,0,0,0,7887872,8627712,7871168,1379680,1077,10153984,4294967216,0
.long 0,0,0,0,17,6,17,8480768,2052352,3313152,8592256,79872,0,107520,110592,7,4782080,4751360,4761600,4771840,15360,0,0,0,7888128,8616960,7870976,67680,52,10179584,4294967216,0
.long 0,0,0,0,17,6,17,8482816,2134272,3968512,8613760,86016,0,108544,114688,7,4783104,4752384,4762624,4772864,15368,0,0,0,7888384,8627712,7871040,1378400,1076,10205184,4294967216,0
.long 0,0,0,0,17,6,17,8484864,2216192,4623872,8635264,92160,0,109568,118784,7,4823040,4792320,4802560,4812800,16384,0,0,0,7888640,8616960,7871104,68960,53,10230784,4294967216,0
.long 8436992,106496,106496,8545920,0,0,0,0,0,0,0,0,0,0,0,7,7761920,7700480,7720960,7741440,102400,122880,143360,148480,7887872,16384,7880384,1389920,1085,10153984,4294967216,8669184
.long 8438720,126976,110592,8547968,0,0,0,0,0,0,0,0,0,0,0,7,7705600,7726080,7746560,7767040,117760,138240,158720,102400,7888128,15360,7880192,77920,60,10179584,4294967216,8669696
.long 8440448,108544,126976,8550016,0,0,0,0,0,0,0,0,0,0,0,7,7731200,7751680,7772160,7710720,133120,153600,112640,117760,7888384,15360,7880256,1388640,1084,10205184,4294967216,8670208
.long 8442176,129024,131072,8552064,0,0,0,0,0,0,0,0,0,0,0,7,7756800,7777280,7715840,7736320,148480,107520,128000,133120,7888640,16384,7880320,79200,61,10230784,4294967216,8670720
.long 0,0,0,0,17,7,17,8478720,2298112,2658048,8573440,73728,0,106496,106496,7,5151744,5121024,5131264,5141504,16392,0,0,0,7887872,8627712,7872192,1389920,1085,10153984,4294967216,0
.long 0,0,0,0,17,7,17,8480768,2380032,3313408,8594944,79872,0,107520,110592,7,5109760,5079040,5089280,5099520,15360,0,0,0,7888128,8616960,7872000,77920,60,10179584,4294967216,0
.long 0,0,0,0,17,7,17,8482816,2461952,3968768,8616448,86016,0,108544,114688,7,5110784,5080064,5090304,5100544,15368,0,0,0,7888384,8627712,7872064,1388640,1084,10205184,4294967216,0
.long 0,0,0,0,17,7,17,8484864,2543872,4624128,8637952,92160,0,109568,118784,7,5150720,5120000,5130240,5140480,16384,0,0,0,7888640,8616960,7872128,79200,61,10230784,4294967216,0
.long 122880,1433600,7875584,8457216,0,0,0,0,0,0,0,0,24,0,0,0,5488640,5509120,5529600,5550080,117760,138240,158720,102400,7880704,0,7873280,7680,6,9437184,0,8640768
.long 128000,1438720,7875712,8457344,0,0,0,0,0,0,0,0,25,0,0,0,5514240,5534720,5555200,5493760,133120,153600,112640,117760,7880960,0,7873344,1318400,1030,9462784,0,8641280
.long 133120,1443840,7875840,8457472,0,0,0,0,0,0,0,0,26,0,0,0,5539840,5560320,5498880,5519360,148480,107520,128000,133120,7881216,1024,7873408,8960,7,9488384,0,8641792
.long 138240,1448960,7875968,8457600,0,0,0,0,0,0,0,0,27,0,0,0,5565440,5504000,5524480,5544960,102400,122880,143360,148480,7881472,1024,7873472,1319680,1031,9513984,0,8642304
.long 0,0,0,0,19,0,19,8478720,4864,2660352,8554880,73728,0,106496,106496,0,2867200,2877440,2887680,2897920,0,0,0,0,7880704,8552448,7865088,7680,6,9437184,0,0
.long 0,0,0,0,19,0,19,8480768,86784,3315712,8576384,79872,0,107520,110592,0,2868224,2878464,2888704,2898944,8,0,0,0,7880960,8563200,7865152,1318400,1030,9462784,0,0
.long 0,0,0,0,19,0,19,8482816,168704,3971072,8597888,86016,0,108544,114688,0,2908160,2918400,2928640,2938880,1024,0,0,0,7881216,8552448,7865216,8960,7,9488384,0,0
.long 0,0,0,0,19,0,19,8484864,250624,4626432,8619392,92160,0,109568,118784,0,2909184,2919424,2929664,2939904,1032,0,0,0,7881472,8563200,7865280,1319680,1031,9513984,0,0
.long 124160,1434880,7875584,8465408,0,0,0,0,0,0,0,0,24,0,0,0,5816320,5836800,5857280,5877760,117760,138240,158720,102400,7880704,0,7874304,17920,14,9437184,0,8644864
.long 129280,1440000,7875712,8465536,0,0,0,0,0,0,0,0,25,0,0,0,5841920,5862400,5882880,5821440,133120,153600,112640,117760,7880960,0,7874368,1328640,1038,9462784,0,8645376
.long 134400,1445120,7875840,8465664,0,0,0,0,0,0,0,0,26,0,0,0,5867520,5888000,5826560,5847040,148480,107520,128000,133120,7881216,1024,7874432,19200,15,9488384,0,8645888
.long 139520,1450240,7875968,8465792,0,0,0,0,0,0,0,0,27,0,0,0,5893120,5831680,5852160,5872640,102400,122880,143360,148480,7881472,1024,7874496,1329920,1039,9513984,0,8646400
.long 0,0,0,0,19,1,19,8478720,332544,2660608,8557568,73728,0,106496,106496,0,3194880,3205120,3215360,3225600,0,0,0,0,7880704,8552448,7866112,17920,14,9437184,0,0
.long 0,0,0,0,19,1,19,8480768,414464,3315968,8579072,79872,0,107520,110592,0,3195904,3206144,3216384,3226624,8,0,0,0,7880960,8563200,7866176,1328640,1038,9462784,0,0
.long 0,0,0,0,19,1,19,8482816,496384,3971328,8600576,86016,0,108544,114688,0,3235840,3246080,3256320,3266560,1024,0,0,0,7881216,8552448,7866240,19200,15,9488384,0,0
.long 0,0,0,0,19,1,19,8484864,578304,4626688,8622080,92160,0,109568,118784,0,3236864,3247104,3257344,3267584,1032,0,0,0,7881472,8563200,7866304,1329920,1039,9513984,0,0
.long 125440,1436160,7875584,8473600,0,0,0,0,0,0,0,0,24,0,0,0,6144000,6164480,6184960,6205440,117760,138240,158720,102400,7880704,0,7875328,28160,22,9437184,0,8648960
.long 130560,1441280,7875712,8473728,0,0,0,0,0,0,0,0,25,0,0,0,6169600,6190080,6210560,6149120,133120,153600,112640,117760,7880960,0,7875392,1338880,1046,9462784,0,8649472
.long 135680,1446400,7875840,8473856,0,0,0,0,0,0,0,0,26,0,0,0,6195200,6215680,6154240,6174720,148480,107520,128000,133120,7881216,1024,7875456,29440,23,9488384,0,8649984
.long 140800,1451520,7875968,8473984,0,0,0,0,0,0,0,0,27,0,0,0,6220800,6159360,6179840,6200320,102400,122880,143360,148480,7881472,1024,7875520,1340160,1047,9513984,0,8650496
.long 0,0,0,0,19,2,19,8478720,660224,2660864,8560256,73728,0,106496,106496,0,3522560,3532800,3543040,3553280,0,0,0,0,7880704,8573952,7867136,28160,22,9437184,0,0
.long 0,0,0,0,19,2,19,8480768,742144,3316224,8581760,79872,0,107520,110592,0,3523584,3533824,3544064,3554304,8,0,0,0,7880960,8584704,7867200,1338880,1046,9462784,0,0
.long 0,0,0,0,19,2,19,8482816,824064,3971584,8603264,86016,0,108544,114688,0,3563520,3573760,3584000,3594240,1024,0,0,0,7881216,8573952,7867264,29440,23,9488384,0,0
.long 0,0,0,0,19,2,19,8484864,905984,4626944,8624768,92160,0,109568,118784,0,3564544,3574784,3585024,3595264,1032,0,0,0,7881472,8584704,7867328,1340160,1047,9513984,0,0
.long 126720,1437440,7875584,8481792,0,0,0,0,0,0,0,0,24,0,0,0,6471680,6492160,6512640,6533120,117760,138240,158720,102400,7880704,0,7876352,38400,30,9437184,0,8653056
.long 131840,1442560,7875712,8481920,0,0,0,0,0,0,0,0,25,0,0,0,6497280,6517760,6538240,6476800,133120,153600,112640,117760,7880960,0,7876416,1349120,1054,9462784,0,8653568
.long 136960,1447680,7875840,8482048,0,0,0,0,0,0,0,0,26,0,0,0,6522880,6543360,6481920,6502400,148480,107520,128000,133120,7881216,1024,7876480,39680,31,9488384,0,8654080
.long 142080,1452800,7875968,8482176,0,0,0,0,0,0,0,0,27,0,0,0,6548480,6487040,6507520,6528000,102400,122880,143360,148480,7881472,1024,7876544,1350400,1055,9513984,0,8654592
.long 0,0,0,0,19,3,19,8478720,987904,2661120,8562944,73728,0,106496,106496,0,3850240,3860480,3870720,3880960,0,0,0,0,7880704,8573952,7868160,38400,30,9437184,0,0
.long 0,0,0,0,19,3,19,8480768,1069824,3316480,8584448,79872,0,107520,110592,0,3851264,3861504,3871744,3881984,8,0,0,0,7880960,8584704,7868224,1349120,1054,9462784,0,0
.long 0,0,0,0,19,3,19,8482816,1151744,3971840,8605952,86016,0,108544,114688,0,3891200,3901440,3911680,3921920,1024,0,0,0,7881216,8573952,7868288,39680,31,9488384,0,0
.long 0,0,0,0,19,3,19,8484864,1233664,4627200,8627456,92160,0,109568,118784,0,3892224,3902464,3912704,3922944,1032,0,0,0,7881472,8584704,7868352,1350400,1055,9513984,0,0
.long 286720,1597440,7879680,8461312,0,0,0,0,0,0,0,0,56,0,0,0,6799360,6819840,6840320,6860800,117760,138240,158720,102400,7880704,0,7877376,48640,38,9437184,0,8657152
.long 291840,1602560,7879808,8461440,0,0,0,0,0,0,0,0,57,0,0,0,6824960,6845440,6865920,6804480,133120,153600,112640,117760,7880960,0,7877440,1359360,1062,9462784,0,8657664
.long 296960,1607680,7879936,8461568,0,0,0,0,0,0,0,0,58,0,0,0,6850560,6871040,6809600,6830080,148480,107520,128000,133120,7881216,1024,7877504,49920,39,9488384,0,8658176
.long 302080,1612800,7880064,8461696,0,0,0,0,0,0,0,0,59,0,0,0,6876160,6814720,6835200,6855680,102400,122880,143360,148480,7881472,1024,7877568,1360640,1063,9513984,0,8658688
.long 0,0,0,0,19,4,19,8478720,1315584,2661376,8565632,73728,0,106496,106496,0,4177920,4188160,4198400,4208640,0,0,0,0,7880704,8595456,7869184,48640,38,9437184,0,0
.long 0,0,0,0,19,4,19,8480768,1397504,3316736,8587136,79872,0,107520,110592,0,4178944,4189184,4199424,4209664,8,0,0,0,7880960,8606208,7869248,1359360,1062,9462784,0,0
.long 0,0,0,0,19,4,19,8482816,1479424,3972096,8608640,86016,0,108544,114688,0,4218880,4229120,4239360,4249600,1024,0,0,0,7881216,8595456,7869312,49920,39,9488384,0,0
.long 0,0,0,0,19,4,19,8484864,1561344,4627456,8630144,92160,0,109568,118784,0,4219904,4230144,4240384,4250624,1032,0,0,0,7881472,8606208,7869376,1360640,1063,9513984,0,0
.long 288000,1598720,7879680,8469504,0,0,0,0,0,0,0,0,56,0,0,0,7127040,7147520,7168000,7188480,117760,138240,158720,102400,7880704,0,7878400,58880,46,9437184,0,8661248
.long 293120,1603840,7879808,8469632,0,0,0,0,0,0,0,0,57,0,0,0,7152640,7173120,7193600,7132160,133120,153600,112640,117760,7880960,0,7878464,1369600,1070,9462784,0,8661760
.long 298240,1608960,7879936,8469760,0,0,0,0,0,0,0,0,58,0,0,0,7178240,7198720,7137280,7157760,148480,107520,128000,133120,7881216,1024,7878528,60160,47,9488384,0,8662272
.long 303360,1614080,7880064,8469888,0,0,0,0,0,0,0,0,59,0,0,0,7203840,7142400,7162880,7183360,102400,122880,143360,148480,7881472,1024,7878592,1370880,1071,9513984,0,8662784
.long 0,0,0,0,19,5,19,8478720,1643264,2661632,8568320,73728,0,106496,106496,0,4505600,4515840,4526080,4536320,0,0,0,0,7880704,8595456,7870208,58880,46,9437184,0,0
.long 0,0,0,0,19,5,19,8480768,1725184,3316992,8589824,79872,0,107520,110592,0,4506624,4516864,4527104,4537344,8,0,0,0,7880960,8606208,7870272,1369600,1070,9462784,0,0
.long 0,0,0,0,19,5,19,8482816,1807104,3972352,8611328,86016,0,108544,114688,0,4546560,4556800,4567040,4577280,1024,0,0,0,7881216,8595456,7870336,60160,47,9488384,0,0
.long 0,0,0,0,19,5,19,8484864,1889024,4627712,8632832,92160,0,109568,118784,0,4547584,4557824,4568064,4578304,1032,0,0,0,7881472,8606208,7870400,1370880,1071,9513984,0,0
.long 289280,1600000,7879680,8477696,0,0,0,0,0,0,0,0,56,0,0,0,7454720,7475200,7495680,7516160,117760,138240,158720,102400,7880704,0,7879424,69120,54,9437184,0,8665344
.long 294400,1605120,7879808,8477824,0,0,0,0,0,0,0,0,57,0,0,0,7480320,7500800,7521280,7459840,133120,153600,112640,117760,7880960,0,7879488,1379840,1078,9462784,0,8665856
.long 299520,1610240,7879936,8477952,0,0,0,0,0,0,0,0,58,0,0,0,7505920,7526400,7464960,7485440,148480,107520,128000,133120,7881216,1024,7879552,70400,55,9488384,0,8666368
.long 304640,1615360,7880064,8478080,0,0,0,0,0,0,0,0,59,0,0,0,7531520,7470080,7490560,7511040,102400,122880,143360,148480,7881472,1024,7879616,1381120,1079,9513984,0,8666880
.long 0,0,0,0,19,6,19,8478720,1970944,2661888,8571008,73728,0,106496,106496,0,4833280,4843520,4853760,4864000,0,0,0,0,7880704,8616960,7871232,69120,54,9437184,0,0
.long 0,0,0,0,19,6,19,8480768,2052864,3317248,8592512,79872,0,107520,110592,0,4834304,4844544,4854784,4865024,8,0,0,0,7880960,8627712,7871296,1379840,1078,9462784,0,0
.long 0,0,0,0,19,6,19,8482816,2134784,3972608,8614016,86016,0,108544,114688,0,4874240,4884480,4894720,4904960,1024,0,0,0,7881216,8616960,7871360,70400,55,9488384,0,0
.long 0,0,0,0,19,6,19,8484864,2216704,4627968,8635520,92160,0,109568,118784,0,4875264,4885504,4895744,4905984,1032,0,0,0,7881472,8627712,7871424,1381120,1079,9513984,0,0
.long 290560,1601280,7879680,8485888,0,0,0,0,0,0,0,0,56,0,0,0,7782400,7802880,7823360,7843840,117760,138240,158720,102400,7880704,0,7880448,79360,62,9437184,0,8669440
.long 295680,1606400,7879808,8486016,0,0,0,0,0,0,0,0,57,0,0,0,7808000,7828480,7848960,7787520,133120,153600,112640,117760,7880960,0,7880512,1390080,1086,9462784,0,8669952
.long 300800,1611520,7879936,8486144,0,0,0,0,0,0,0,0,58,0,0,0,7833600,7854080,7792640,7813120,148480,107520,128000,133120,7881216,1024,7880576,80640,63,9488384,0,8670464
.long 305920,1616640,7880064,8486272,0,0,0,0,0,0,0,0,59,0,0,0,7859200,7797760,7818240,7838720,102400,122880,143360,148480,7881472,1024,7880640,1391360,1087,9513984,0,8670976
.long 0,0,0,0,19,7,19,8478720,2298624,2662144,8573696,73728,0,106496,106496,0,5160960,5171200,5181440,5191680,0,0,0,0,7880704,8616960,7872256,79360,62,9437184,0,0
.long 0,0,0,0,19,7,19,8480768,2380544,3317504,8595200,79872,0,107520,110592,0,5161984,5172224,5182464,5192704,8,0,0,0,7880960,8627712,7872320,1390080,1086,9462784,0,0
.long 0,0,0,0,19,7,19,8482816,2462464,3972864,8616704,86016,0,108544,114688,0,5201920,5212160,5222400,5232640,1024,0,0,0,7881216,8616960,7872384,80640,63,9488384,0,0
.long 0,0,0,0,19,7,19,8484864,2544384,4628224,8638208,92160,0,109568,118784,0,5202944,5213184,5223424,5233664,1032,0,0,0,7881472,8627712,7872448,1391360,1087,9513984,0,0
.long 6225920,6227968,8388608,8650752,0,0,0,8486912,0,0,0,0,147456,147456,0,1,2878464,2888704,2898944,2868224,5128,0,0,0,7881728,8563200,7865152,1318560,1030,9539584,80,0
.long 6228992,6228480,8392064,8650880,0,0,0,8491008,0,0,0,0,149760,152064,0,1,2918400,2928640,2938880,2908160,6144,0,0,0,7881984,8552448,7865216,9120,7,9565184,80,0
.long 6307840,6309888,8395520,8651008,0,0,0,8495104,0,0,0,0,152064,147456,0,1,2919424,2929664,2939904,2909184,6152,0,0,0,7882240,8563200,7865280,1319840,1031,9590784,80,0
.long 6310912,6310400,8398976,8651136,0,0,0,8499200,0,0,0,0,154368,152064,0,1,2877440,2887680,2897920,2867200,5120,0,0,0,7882496,8552448,7865088,7840,6,9616384,80,0
.long 8515584,0,0,0,0,0,0,0,8511488,7883776,480,9744384,0,0,0,1,5509120,5529600,5550080,5488640,133120,153600,112640,117760,7881728,5120,7873344,1318560,1030,9539584,80,8640768
.long 8515584,0,0,0,0,0,0,0,8512512,7883776,480,9749504,0,0,0,1,5534720,5555200,5493760,5514240,148480,107520,128000,133120,7881984,6144,7873408,9120,7,9565184,80,8641280
.long 8515584,0,0,0,0,0,0,0,8513536,7883776,480,9754624,0,0,0,1,5560320,5498880,5519360,5539840,102400,122880,143360,148480,7882240,6144,7873472,1319840,1031,9590784,80,8641792
.long 8515584,0,0,0,0,0,0,0,8514560,7883776,480,9754624,0,0,0,1,5504000,5524480,5544960,5565440,117760,138240,158720,102400,7882496,5120,7873280,7840,6,9616384,80,8642304
.long 6231040,6233088,8402432,8651264,0,0,0,8503296,0,0,0,0,147456,147456,0,1,3206144,3216384,3226624,3195904,5128,0,0,0,7881728,8563200,7866176,1328800,1038,9539584,80,0
.long 6234112,6233600,8405888,8651392,0,0,0,8507392,0,0,0,0,149760,152064,0,1,3246080,3256320,3266560,3235840,6144,0,0,0,7881984,8552448,7866240,19360,15,9565184,80,0
.long 6312960,6315008,8409344,8651520,0,0,0,8511488,0,0,0,0,152064,147456,0,1,3247104,3257344,3267584,3236864,6152,0,0,0,7882240,8563200,7866304,1330080,1039,9590784,80,0
.long 6316032,6315520,8412800,8651648,0,0,0,8515584,0,0,0,0,154368,152064,0,1,3205120,3215360,3225600,3194880,5120,0,0,0,7882496,8552448,7866112,18080,14,9616384,80,0
.long 8520704,0,0,0,0,0,0,0,8516608,7883904,102880,9759744,0,0,0,1,5836800,5857280,5877760,5816320,133120,153600,112640,117760,7881728,5120,7874368,1328800,1038,9539584,80,8644864
.long 8520704,0,0,0,0,0,0,0,8517632,7883904,102880,9764864,0,0,0,1,5862400,5882880,5821440,5841920,148480,107520,128000,133120,7881984,6144,7874432,19360,15,9565184,80,8645376
.long 8520704,0,0,0,0,0,0,0,8518656,7883904,102880,9755136,0,0,0,1,5888000,5826560,5847040,5867520,102400,122880,143360,148480,7882240,6144,7874496,1330080,1039,9590784,80,8645888
.long 8520704,0,0,0,0,0,0,0,8519680,7883904,102880,9755136,0,0,0,1,5831680,5852160,5872640,5893120,117760,138240,158720,102400,7882496,5120,7874304,18080,14,9616384,80,8646400
.long 6236160,6238208,8416256,8651776,0,0,0,8519680,0,0,0,0,147456,147456,0,1,3533824,3544064,3554304,3523584,5128,0,0,0,7881728,8584704,7867200,1339040,1046,9539584,80,0
.long 6239232,6238720,8419712,8651904,0,0,0,8523776,0,0,0,0,149760,152064,0,1,3573760,3584000,3594240,3563520,6144,0,0,0,7881984,8573952,7867264,29600,23,9565184,80,0
.long 6318080,6320128,8423168,8652032,0,0,0,8527872,0,0,0,0,152064,147456,0,1,3574784,3585024,3595264,3564544,6152,0,0,0,7882240,8584704,7867328,1340320,1047,9590784,80,0
.long 6321152,6320640,8426624,8652160,0,0,0,8531968,0,0,0,0,154368,152064,0,1,3532800,3543040,3553280,3522560,5120,0,0,0,7882496,8573952,7867136,28320,22,9616384,80,0
.long 8525824,0,0,0,0,0,0,0,8521728,7884032,205280,9769984,0,0,0,1,6164480,6184960,6205440,6144000,133120,153600,112640,117760,7881728,5120,7875392,1339040,1046,9539584,80,8648960
.long 8525824,0,0,0,0,0,0,0,8522752,7884032,205280,9775104,0,0,0,1,6190080,6210560,6149120,6169600,148480,107520,128000,133120,7881984,6144,7875456,29600,23,9565184,80,8649472
.long 8525824,0,0,0,0,0,0,0,8523776,7884032,205280,9780224,0,0,0,1,6215680,6154240,6174720,6195200,102400,122880,143360,148480,7882240,6144,7875520,1340320,1047,9590784,80,8649984
.long 8525824,0,0,0,0,0,0,0,8524800,7884032,205280,9780224,0,0,0,1,6159360,6179840,6200320,6220800,117760,138240,158720,102400,7882496,5120,7875328,28320,22,9616384,80,8650496
.long 6241280,6243328,8430080,8652288,0,0,0,8536064,0,0,0,0,147456,147456,0,1,3861504,3871744,3881984,3851264,5128,0,0,0,7881728,8584704,7868224,1349280,1054,9539584,80,0
.long 6244352,6243840,8433536,8652416,0,0,0,8540160,0,0,0,0,149760,152064,0,1,3901440,3911680,3921920,3891200,6144,0,0,0,7881984,8573952,7868288,39840,31,9565184,80,0
.long 6323200,6325248,8436992,8652544,0,0,0,8544256,0,0,0,0,152064,147456,0,1,3902464,3912704,3922944,3892224,6152,0,0,0,7882240,8584704,7868352,1350560,1055,9590784,80,0
.long 6326272,6325760,8440448,8652672,0,0,0,8548352,0,0,0,0,154368,152064,0,1,3860480,3870720,3880960,3850240,5120,0,0,0,7882496,8573952,7868160,38560,30,9616384,80,0
.long 8530944,0,0,0,0,0,0,0,8526848,7884160,307680,9785344,0,0,0,1,6492160,6512640,6533120,6471680,133120,153600,112640,117760,7881728,5120,7876416,1349280,1054,9539584,80,8653056
.long 8530944,0,0,0,0,0,0,0,8527872,7884160,307680,9790464,0,0,0,1,6517760,6538240,6476800,6497280,148480,107520,128000,133120,7881984,6144,7876480,39840,31,9565184,80,8653568
.long 8530944,0,0,0,0,0,0,0,8528896,7884160,307680,9780736,0,0,0,1,6543360,6481920,6502400,6522880,102400,122880,143360,148480,7882240,6144,7876544,1350560,1055,9590784,80,8654080
.long 8530944,0,0,0,0,0,0,0,8529920,7884160,307680,9780736,0,0,0,1,6487040,6507520,6528000,6548480,117760,138240,158720,102400,7882496,5120,7876352,38560,30,9616384,80,8654592
.long 7536640,7538688,8388608,8667136,0,0,0,8486912,0,0,0,0,147456,147456,0,1,4189184,4199424,4209664,4178944,5128,0,0,0,7881728,8606208,7869248,1359520,1062,9539584,80,0
.long 7539712,7539200,8392064,8667264,0,0,0,8491008,0,0,0,0,149760,152064,0,1,4229120,4239360,4249600,4218880,6144,0,0,0,7881984,8595456,7869312,50080,39,9565184,80,0
.long 7618560,7620608,8395520,8667392,0,0,0,8495104,0,0,0,0,152064,147456,0,1,4230144,4240384,4250624,4219904,6152,0,0,0,7882240,8606208,7869376,1360800,1063,9590784,80,0
.long 7621632,7621120,8398976,8667520,0,0,0,8499200,0,0,0,0,154368,152064,0,1,4188160,4198400,4208640,4177920,5120,0,0,0,7882496,8595456,7869184,48800,38,9616384,80,0
.long 8679424,0,0,0,0,0,0,0,8675328,7887872,1120,10153984,0,0,0,1,6819840,6840320,6860800,6799360,133120,153600,112640,117760,7881728,5120,7877440,1359520,1062,9539584,80,8657152
.long 8679424,0,0,0,0,0,0,0,8676352,7887872,1120,10159104,0,0,0,1,6845440,6865920,6804480,6824960,148480,107520,128000,133120,7881984,6144,7877504,50080,39,9565184,80,8657664
.long 8679424,0,0,0,0,0,0,0,8677376,7887872,1120,10164224,0,0,0,1,6871040,6809600,6830080,6850560,102400,122880,143360,148480,7882240,6144,7877568,1360800,1063,9590784,80,8658176
.long 8679424,0,0,0,0,0,0,0,8678400,7887872,1120,10164224,0,0,0,1,6814720,6835200,6855680,6876160,117760,138240,158720,102400,7882496,5120,7877376,48800,38,9616384,80,8658688
.long 7541760,7543808,8402432,8667648,0,0,0,8503296,0,0,0,0,147456,147456,0,1,4516864,4527104,4537344,4506624,5128,0,0,0,7881728,8606208,7870272,1369760,1070,9539584,80,0
.long 7544832,7544320,8405888,8667776,0,0,0,8507392,0,0,0,0,149760,152064,0,1,4556800,4567040,4577280,4546560,6144,0,0,0,7881984,8595456,7870336,60320,47,9565184,80,0
.long 7623680,7625728,8409344,8667904,0,0,0,8511488,0,0,0,0,152064,147456,0,1,4557824,4568064,4578304,4547584,6152,0,0,0,7882240,8606208,7870400,1371040,1071,9590784,80,0
.long 7626752,7626240,8412800,8668032,0,0,0,8515584,0,0,0,0,154368,152064,0,1,4515840,4526080,4536320,4505600,5120,0,0,0,7882496,8595456,7870208,59040,46,9616384,80,0
.long 8684544,0,0,0,0,0,0,0,8680448,7888000,103520,10169344,0,0,0,1,7147520,7168000,7188480,7127040,133120,153600,112640,117760,7881728,5120,7878464,1369760,1070,9539584,80,8661248
.long 8684544,0,0,0,0,0,0,0,8681472,7888000,103520,10174464,0,0,0,1,7173120,7193600,7132160,7152640,148480,107520,128000,133120,7881984,6144,7878528,60320,47,9565184,80,8661760
.long 8684544,0,0,0,0,0,0,0,8682496,7888000,103520,10164736,0,0,0,1,7198720,7137280,7157760,7178240,102400,122880,143360,148480,7882240,6144,7878592,1371040,1071,9590784,80,8662272
.long 8684544,0,0,0,0,0,0,0,8683520,7888000,103520,10164736,0,0,0,1,7142400,7162880,7183360,7203840,117760,138240,158720,102400,7882496,5120,7878400,59040,46,9616384,80,8662784
.long 7546880,7548928,8416256,8668160,0,0,0,8519680,0,0,0,0,147456,147456,0,1,4844544,4854784,4865024,4834304,5128,0,0,0,7881728,8627712,7871296,1380000,1078,9539584,80,0
.long 7549952,7549440,8419712,8668288,0,0,0,8523776,0,0,0,0,149760,152064,0,1,4884480,4894720,4904960,4874240,6144,0,0,0,7881984,8616960,7871360,70560,55,9565184,80,0
.long 7628800,7630848,8423168,8668416,0,0,0,8527872,0,0,0,0,152064,147456,0,1,4885504,4895744,4905984,4875264,6152,0,0,0,7882240,8627712,7871424,1381280,1079,9590784,80,0
.long 7631872,7631360,8426624,8668544,0,0,0,8531968,0,0,0,0,154368,152064,0,1,4843520,4853760,4864000,4833280,5120,0,0,0,7882496,8616960,7871232,69280,54,9616384,80,0
.long 8689664,0,0,0,0,0,0,0,8685568,7888128,205920,10179584,0,0,0,1,7475200,7495680,7516160,7454720,133120,153600,112640,117760,7881728,5120,7879488,1380000,1078,9539584,80,8665344
.long 8689664,0,0,0,0,0,0,0,8686592,7888128,205920,10184704,0,0,0,1,7500800,7521280,7459840,7480320,148480,107520,128000,133120,7881984,6144,7879552,70560,55,9565184,80,8665856
.long 8689664,0,0,0,0,0,0,0,8687616,7888128,205920,10189824,0,0,0,1,7526400,7464960,7485440,7505920,102400,122880,143360,148480,7882240,6144,7879616,1381280,1079,9590784,80,8666368
.long 8689664,0,0,0,0,0,0,0,8688640,7888128,205920,10189824,0,0,0,1,7470080,7490560,7511040,7531520,117760,138240,158720,102400,7882496,5120,7879424,69280,54,9616384,80,8666880
.long 7552000,7554048,8430080,8668672,0,0,0,8536064,0,0,0,0,147456,147456,0,1,5172224,5182464,5192704,5161984,5128,0,0,0,7881728,8627712,7872320,1390240,1086,9539584,80,0
.long 7555072,7554560,8433536,8668800,0,0,0,8540160,0,0,0,0,149760,152064,0,1,5212160,5222400,5232640,5201920,6144,0,0,0,7881984,8616960,7872384,80800,63,9565184,80,0
.long 7633920,7635968,8436992,8668928,0,0,0,8544256,0,0,0,0,152064,147456,0,1,5213184,5223424,5233664,5202944,6152,0,0,0,7882240,8627712,7872448,1391520,1087,9590784,80,0
.long 7636992,7636480,8440448,8669056,0,0,0,8548352,0,0,0,0,154368,152064,0,1,5171200,5181440,5191680,5160960,5120,0,0,0,7882496,8616960,7872256,79520,62,9616384,80,0
.long 8694784,0,0,0,0,0,0,0,8690688,7888256,308320,10194944,0,0,0,1,7802880,7823360,7843840,7782400,133120,153600,112640,117760,7881728,5120,7880512,1390240,1086,9539584,80,8669440
.long 8694784,0,0,0,0,0,0,0,8691712,7888256,308320,10200064,0,0,0,1,7828480,7848960,7787520,7808000,148480,107520,128000,133120,7881984,6144,7880576,80800,63,9565184,80,8669952
.long 8694784,0,0,0,0,0,0,0,8692736,7888256,308320,10190336,0,0,0,1,7854080,7792640,7813120,7833600,102400,122880,143360,148480,7882240,6144,7880640,1391520,1087,9590784,80,8670464
.long 8694784,0,0,0,0,0,0,0,8693760,7888256,308320,10190336,0,0,0,1,7797760,7818240,7838720,7859200,117760,138240,158720,102400,7882496,5120,7880448,79520,62,9616384,80,8670976
.long 8388608,106496,106496,8487680,0,0,0,0,0,0,0,0,0,0,0,2,5529600,5550080,5488640,5509120,148480,107520,128000,133120,7882752,11264,7873408,9280,7,9641984,160,8640768
.long 8390336,126976,110592,8489728,0,0,0,0,0,0,0,0,0,0,0,2,5555200,5493760,5514240,5534720,102400,122880,143360,148480,7883008,11264,7873472,1320000,1031,9667584,160,8641280
.long 8392064,108544,126976,8491776,0,0,0,0,0,0,0,0,0,0,0,2,5498880,5519360,5539840,5560320,117760,138240,158720,102400,7883264,10240,7873280,8000,6,9693184,160,8641792
.long 8393792,129024,131072,8493824,0,0,0,0,0,0,0,0,0,0,0,2,5524480,5544960,5565440,5504000,133120,153600,112640,117760,7883520,10240,7873344,1318720,1030,9718784,160,8642304
.long 0,0,0,0,18,0,18,8478720,4608,2658304,8554752,73728,0,106496,106496,2,2928640,2938880,2908160,2918400,11264,0,0,0,7882752,8552448,7865216,9280,7,9641984,160,0
.long 0,0,0,0,18,0,18,8480768,86528,3313664,8576256,79872,0,107520,110592,2,2929664,2939904,2909184,2919424,11272,0,0,0,7883008,8563200,7865280,1320000,1031,9667584,160,0
.long 0,0,0,0,18,0,18,8482816,168448,3969024,8597760,86016,0,108544,114688,2,2887680,2897920,2867200,2877440,10240,0,0,0,7883264,8552448,7865088,8000,6,9693184,160,0
.long 0,0,0,0,18,0,18,8484864,250368,4624384,8619264,92160,0,109568,118784,2,2888704,2898944,2868224,2878464,10248,0,0,0,7883520,8563200,7865152,1318720,1030,9718784,160,0
.long 8402432,106496,106496,8504064,0,0,0,0,0,0,0,0,0,0,0,2,5857280,5877760,5816320,5836800,148480,107520,128000,133120,7882752,11264,7874432,19520,15,9641984,160,8644864
.long 8404160,126976,110592,8506112,0,0,0,0,0,0,0,0,0,0,0,2,5882880,5821440,5841920,5862400,102400,122880,143360,148480,7883008,11264,7874496,1330240,1039,9667584,160,8645376
.long 8405888,108544,126976,8508160,0,0,0,0,0,0,0,0,0,0,0,2,5826560,5847040,5867520,5888000,117760,138240,158720,102400,7883264,10240,7874304,18240,14,9693184,160,8645888
.long 8407616,129024,131072,8510208,0,0,0,0,0,0,0,0,0,0,0,2,5852160,5872640,5893120,5831680,133120,153600,112640,117760,7883520,10240,7874368,1328960,1038,9718784,160,8646400
.long 0,0,0,0,18,1,18,8478720,332288,2658560,8557440,73728,0,106496,106496,2,3256320,3266560,3235840,3246080,11264,0,0,0,7882752,8552448,7866240,19520,15,9641984,160,0
.long 0,0,0,0,18,1,18,8480768,414208,3313920,8578944,79872,0,107520,110592,2,3257344,3267584,3236864,3247104,11272,0,0,0,7883008,8563200,7866304,1330240,1039,9667584,160,0
.long 0,0,0,0,18,1,18,8482816,496128,3969280,8600448,86016,0,108544,114688,2,3215360,3225600,3194880,3205120,10240,0,0,0,7883264,8552448,7866112,18240,14,9693184,160,0
.long 0,0,0,0,18,1,18,8484864,578048,4624640,8621952,92160,0,109568,118784,2,3216384,3226624,3195904,3206144,10248,0,0,0,7883520,8563200,7866176,1328960,1038,9718784,160,0
.long 8416256,106496,106496,8520448,0,0,0,0,0,0,0,0,0,0,0,2,6184960,6205440,6144000,6164480,148480,107520,128000,133120,7882752,11264,7875456,29760,23,9641984,160,8648960
.long 8417984,126976,110592,8522496,0,0,0,0,0,0,0,0,0,0,0,2,6210560,6149120,6169600,6190080,102400,122880,143360,148480,7883008,11264,7875520,1340480,1047,9667584,160,8649472
.long 8419712,108544,126976,8524544,0,0,0,0,0,0,0,0,0,0,0,2,6154240,6174720,6195200,6215680,117760,138240,158720,102400,7883264,10240,7875328,28480,22,9693184,160,8649984
.long 8421440,129024,131072,8526592,0,0,0,0,0,0,0,0,0,0,0,2,6179840,6200320,6220800,6159360,133120,153600,112640,117760,7883520,10240,7875392,1339200,1046,9718784,160,8650496
.long 0,0,0,0,18,2,18,8478720,659968,2658816,8560128,73728,0,106496,106496,2,3584000,3594240,3563520,3573760,11264,0,0,0,7882752,8573952,7867264,29760,23,9641984,160,0
.long 0,0,0,0,18,2,18,8480768,741888,3314176,8581632,79872,0,107520,110592,2,3585024,3595264,3564544,3574784,11272,0,0,0,7883008,8584704,7867328,1340480,1047,9667584,160,0
.long 0,0,0,0,18,2,18,8482816,823808,3969536,8603136,86016,0,108544,114688,2,3543040,3553280,3522560,3532800,10240,0,0,0,7883264,8573952,7867136,28480,22,9693184,160,0
.long 0,0,0,0,18,2,18,8484864,905728,4624896,8624640,92160,0,109568,118784,2,3544064,3554304,3523584,3533824,10248,0,0,0,7883520,8584704,7867200,1339200,1046,9718784,160,0
.long 8430080,106496,106496,8536832,0,0,0,0,0,0,0,0,0,0,0,2,6512640,6533120,6471680,6492160,148480,107520,128000,133120,7882752,11264,7876480,40000,31,9641984,160,8653056
.long 8431808,126976,110592,8538880,0,0,0,0,0,0,0,0,0,0,0,2,6538240,6476800,6497280,6517760,102400,122880,143360,148480,7883008,11264,7876544,1350720,1055,9667584,160,8653568
.long 8433536,108544,126976,8540928,0,0,0,0,0,0,0,0,0,0,0,2,6481920,6502400,6522880,6543360,117760,138240,158720,102400,7883264,10240,7876352,38720,30,9693184,160,8654080
.long 8435264,129024,131072,8542976,0,0,0,0,0,0,0,0,0,0,0,2,6507520,6528000,6548480,6487040,133120,153600,112640,117760,7883520,10240,7876416,1349440,1054,9718784,160,8654592
.long 0,0,0,0,18,3,18,8478720,987648,2659072,8562816,73728,0,106496,106496,2,3911680,3921920,3891200,3901440,11264,0,0,0,7882752,8573952,7868288,40000,31,9641984,160,0
.long 0,0,0,0,18,3,18,8480768,1069568,3314432,8584320,79872,0,107520,110592,2,3912704,3922944,3892224,3902464,11272,0,0,0,7883008,8584704,7868352,1350720,1055,9667584,160,0
.long 0,0,0,0,18,3,18,8482816,1151488,3969792,8605824,86016,0,108544,114688,2,3870720,3880960,3850240,3860480,10240,0,0,0,7883264,8573952,7868160,38720,30,9693184,160,0
.long 0,0,0,0,18,3,18,8484864,1233408,4625152,8627328,92160,0,109568,118784,2,3871744,3881984,3851264,3861504,10248,0,0,0,7883520,8584704,7868224,1349440,1054,9718784,160,0
.long 8388608,106496,106496,8488704,0,0,0,0,0,0,0,0,0,0,0,2,6840320,6860800,6799360,6819840,148480,107520,128000,133120,7882752,11264,7877504,50240,39,9641984,160,8657152
.long 8390336,126976,110592,8490752,0,0,0,0,0,0,0,0,0,0,0,2,6865920,6804480,6824960,6845440,102400,122880,143360,148480,7883008,11264,7877568,1360960,1063,9667584,160,8657664
.long 8392064,108544,126976,8492800,0,0,0,0,0,0,0,0,0,0,0,2,6809600,6830080,6850560,6871040,117760,138240,158720,102400,7883264,10240,7877376,48960,38,9693184,160,8658176
.long 8393792,129024,131072,8494848,0,0,0,0,0,0,0,0,0,0,0,2,6835200,6855680,6876160,6814720,133120,153600,112640,117760,7883520,10240,7877440,1359680,1062,9718784,160,8658688
.long 0,0,0,0,18,4,18,8478720,1315328,2659328,8565504,73728,0,106496,106496,2,4239360,4249600,4218880,4229120,11264,0,0,0,7882752,8595456,7869312,50240,39,9641984,160,0
.long 0,0,0,0,18,4,18,8480768,1397248,3314688,8587008,79872,0,107520,110592,2,4240384,4250624,4219904,4230144,11272,0,0,0,7883008,8606208,7869376,1360960,1063,9667584,160,0
.long 0,0,0,0,18,4,18,8482816,1479168,3970048,8608512,86016,0,108544,114688,2,4198400,4208640,4177920,4188160,10240,0,0,0,7883264,8595456,7869184,48960,38,9693184,160,0
.long 0,0,0,0,18,4,18,8484864,1561088,4625408,8630016,92160,0,109568,118784,2,4199424,4209664,4178944,4189184,10248,0,0,0,7883520,8606208,7869248,1359680,1062,9718784,160,0
.long 8402432,106496,106496,8505088,0,0,0,0,0,0,0,0,0,0,0,2,7168000,7188480,7127040,7147520,148480,107520,128000,133120,7882752,11264,7878528,60480,47,9641984,160,8661248
.long 8404160,126976,110592,8507136,0,0,0,0,0,0,0,0,0,0,0,2,7193600,7132160,7152640,7173120,102400,122880,143360,148480,7883008,11264,7878592,1371200,1071,9667584,160,8661760
.long 8405888,108544,126976,8509184,0,0,0,0,0,0,0,0,0,0,0,2,7137280,7157760,7178240,7198720,117760,138240,158720,102400,7883264,10240,7878400,59200,46,9693184,160,8662272
.long 8407616,129024,131072,8511232,0,0,0,0,0,0,0,0,0,0,0,2,7162880,7183360,7203840,7142400,133120,153600,112640,117760,7883520,10240,7878464,1369920,1070,9718784,160,8662784
.long 0,0,0,0,18,5,18,8478720,1643008,2659584,8568192,73728,0,106496,106496,2,4567040,4577280,4546560,4556800,11264,0,0,0,7882752,8595456,7870336,60480,47,9641984,160,0
.long 0,0,0,0,18,5,18,8480768,1724928,3314944,8589696,79872,0,107520,110592,2,4568064,4578304,4547584,4557824,11272,0,0,0,7883008,8606208,7870400,1371200,1071,9667584,160,0
.long 0,0,0,0,18,5,18,8482816,1806848,3970304,8611200,86016,0,108544,114688,2,4526080,4536320,4505600,4515840,10240,0,0,0,7883264,8595456,7870208,59200,46,9693184,160,0
.long 0,0,0,0,18,5,18,8484864,1888768,4625664,8632704,92160,0,109568,118784,2,4527104,4537344,4506624,4516864,10248,0,0,0,7883520,8606208,7870272,1369920,1070,9718784,160,0
.long 8416256,106496,106496,8521472,0,0,0,0,0,0,0,0,0,0,0,2,7495680,7516160,7454720,7475200,148480,107520,128000,133120,7882752,11264,7879552,70720,55,9641984,160,8665344
.long 8417984,126976,110592,8523520,0,0,0,0,0,0,0,0,0,0,0,2,7521280,7459840,7480320,7500800,102400,122880,143360,148480,7883008,11264,7879616,1381440,1079,9667584,160,8665856
.long 8419712,108544,126976,8525568,0,0,0,0,0,0,0,0,0,0,0,2,7464960,7485440,7505920,7526400,117760,138240,158720,102400,7883264,10240,7879424,69440,54,9693184,160,8666368
.long 8421440,129024,131072,8527616,0,0,0,0,0,0,0,0,0,0,0,2,7490560,7511040,7531520,7470080,133120,153600,112640,117760,7883520,10240,7879488,1380160,1078,9718784,160,8666880
.long 0,0,0,0,18,6,18,8478720,1970688,2659840,8570880,73728,0,106496,106496,2,4894720,4904960,4874240,4884480,11264,0,0,0,7882752,8616960,7871360,70720,55,9641984,160,0
.long 0,0,0,0,18,6,18,8480768,2052608,3315200,8592384,79872,0,107520,110592,2,4895744,4905984,4875264,4885504,11272,0,0,0,7883008,8627712,7871424,1381440,1079,9667584,160,0
.long 0,0,0,0,18,6,18,8482816,2134528,3970560,8613888,86016,0,108544,114688,2,4853760,4864000,4833280,4843520,10240,0,0,0,7883264,8616960,7871232,69440,54,9693184,160,0
.long 0,0,0,0,18,6,18,8484864,2216448,4625920,8635392,92160,0,109568,118784,2,4854784,4865024,4834304,4844544,10248,0,0,0,7883520,8627712,7871296,1380160,1078,9718784,160,0
.long 8430080,106496,106496,8537856,0,0,0,0,0,0,0,0,0,0,0,2,7823360,7843840,7782400,7802880,148480,107520,128000,133120,7882752,11264,7880576,80960,63,9641984,160,8669440
.long 8431808,126976,110592,8539904,0,0,0,0,0,0,0,0,0,0,0,2,7848960,7787520,7808000,7828480,102400,122880,143360,148480,7883008,11264,7880640,1391680,1087,9667584,160,8669952
.long 8433536,108544,126976,8541952,0,0,0,0,0,0,0,0,0,0,0,2,7792640,7813120,7833600,7854080,117760,138240,158720,102400,7883264,10240,7880448,79680,62,9693184,160,8670464
.long 8435264,129024,131072,8544000,0,0,0,0,0,0,0,0,0,0,0,2,7818240,7838720,7859200,7797760,133120,153600,112640,117760,7883520,10240,7880512,1390400,1086,9718784,160,8670976
.long 0,0,0,0,18,7,18,8478720,2298368,2660096,8573568,73728,0,106496,106496,2,5222400,5232640,5201920,5212160,11264,0,0,0,7882752,8616960,7872384,80960,63,9641984,160,0
.long 0,0,0,0,18,7,18,8480768,2380288,3315456,8595072,79872,0,107520,110592,2,5223424,5233664,5202944,5213184,11272,0,0,0,7883008,8627712,7872448,1391680,1087,9667584,160,0
.long 0,0,0,0,18,7,18,8482816,2462208,3970816,8616576,86016,0,108544,114688,2,5181440,5191680,5160960,5171200,10240,0,0,0,7883264,8616960,7872256,79680,62,9693184,160,0
.long 0,0,0,0,18,7,18,8484864,2544128,4626176,8638080,92160,0,109568,118784,2,5182464,5192704,5161984,5172224,10248,0,0,0,7883520,8627712,7872320,1390400,1086,9718784,160,0
.long 8395520,106496,106496,8495872,0,0,0,0,0,0,0,0,0,0,0,3,5550080,5488640,5509120,5529600,102400,122880,143360,148480,7883776,16384,7873472,1320160,1031,9744384,240,8640768
.long 8397248,126976,110592,8497920,0,0,0,0,0,0,0,0,0,0,0,3,5493760,5514240,5534720,5555200,117760,138240,158720,102400,7884032,15360,7873280,8160,6,9769984,240,8641280
.long 8398976,108544,126976,8499968,0,0,0,0,0,0,0,0,0,0,0,3,5519360,5539840,5560320,5498880,133120,153600,112640,117760,7884288,15360,7873344,1318880,1030,9795584,240,8641792
.long 8400704,129024,131072,8502016,0,0,0,0,0,0,0,0,0,0,0,3,5544960,5565440,5504000,5524480,148480,107520,128000,133120,7884544,16384,7873408,9440,7,9821184,240,8642304
.long 0,0,0,0,24,0,20,8454144,0,7864320,8555008,73728,0,106496,106496,3,2939904,2909184,2919424,2929664,16392,0,0,0,7883776,8563200,7865280,1320160,1031,9744384,240,0
.long 0,0,0,0,24,0,20,8456192,81920,7866368,8576512,79872,0,107520,110592,3,2897920,2867200,2877440,2887680,15360,0,0,0,7884032,8552448,7865088,8160,6,9769984,240,0
.long 0,0,0,0,24,0,20,8458240,163840,7868416,8598016,86016,0,108544,114688,3,2898944,2868224,2878464,2888704,15368,0,0,0,7884288,8563200,7865152,1318880,1030,9795584,240,0
.long 0,0,0,0,24,0,20,8460288,245760,7870464,8619520,92160,0,109568,118784,3,2938880,2908160,2918400,2928640,16384,0,0,0,7884544,8552448,7865216,9440,7,9821184,240,0
.long 8409344,106496,106496,8512256,0,0,0,0,0,0,0,0,0,0,0,3,5877760,5816320,5836800,5857280,102400,122880,143360,148480,7883776,16384,7874496,1330400,1039,9744384,240,8644864
.long 8411072,126976,110592,8514304,0,0,0,0,0,0,0,0,0,0,0,3,5821440,5841920,5862400,5882880,117760,138240,158720,102400,7884032,15360,7874304,18400,14,9769984,240,8645376
.long 8412800,108544,126976,8516352,0,0,0,0,0,0,0,0,0,0,0,3,5847040,5867520,5888000,5826560,133120,153600,112640,117760,7884288,15360,7874368,1329120,1038,9795584,240,8645888
.long 8414528,129024,131072,8518400,0,0,0,0,0,0,0,0,0,0,0,3,5872640,5893120,5831680,5852160,148480,107520,128000,133120,7884544,16384,7874432,19680,15,9821184,240,8646400
.long 0,0,0,0,24,1,20,8454144,327680,7864336,8557696,73728,0,106496,106496,3,3267584,3236864,3247104,3257344,16392,0,0,0,7883776,8563200,7866304,1330400,1039,9744384,240,0
.long 0,0,0,0,24,1,20,8456192,409600,7866384,8579200,79872,0,107520,110592,3,3225600,3194880,3205120,3215360,15360,0,0,0,7884032,8552448,7866112,18400,14,9769984,240,0
.long 0,0,0,0,24,1,20,8458240,491520,7868432,8600704,86016,0,108544,114688,3,3226624,3195904,3206144,3216384,15368,0,0,0,7884288,8563200,7866176,1329120,1038,9795584,240,0
.long 0,0,0,0,24,1,20,8460288,573440,7870480,8622208,92160,0,109568,118784,3,3266560,3235840,3246080,3256320,16384,0,0,0,7884544,8552448,7866240,19680,15,9821184,240,0
.long 8423168,106496,106496,8528640,0,0,0,0,0,0,0,0,0,0,0,3,6205440,6144000,6164480,6184960,102400,122880,143360,148480,7883776,16384,7875520,1340640,1047,9744384,240,8648960
.long 8424896,126976,110592,8530688,0,0,0,0,0,0,0,0,0,0,0,3,6149120,6169600,6190080,6210560,117760,138240,158720,102400,7884032,15360,7875328,28640,22,9769984,240,8649472
.long 8426624,108544,126976,8532736,0,0,0,0,0,0,0,0,0,0,0,3,6174720,6195200,6215680,6154240,133120,153600,112640,117760,7884288,15360,7875392,1339360,1046,9795584,240,8649984
.long 8428352,129024,131072,8534784,0,0,0,0,0,0,0,0,0,0,0,3,6200320,6220800,6159360,6179840,148480,107520,128000,133120,7884544,16384,7875456,29920,23,9821184,240,8650496
.long 0,0,0,0,24,2,20,8454144,655360,7864352,8560384,73728,0,106496,106496,3,3595264,3564544,3574784,3585024,16392,0,0,0,7883776,8584704,7867328,1340640,1047,9744384,240,0
.long 0,0,0,0,24,2,20,8456192,737280,7866400,8581888,79872,0,107520,110592,3,3553280,3522560,3532800,3543040,15360,0,0,0,7884032,8573952,7867136,28640,22,9769984,240,0
.long 0,0,0,0,24,2,20,8458240,819200,7868448,8603392,86016,0,108544,114688,3,3554304,3523584,3533824,3544064,15368,0,0,0,7884288,8584704,7867200,1339360,1046,9795584,240,0
.long 0,0,0,0,24,2,20,8460288,901120,7870496,8624896,92160,0,109568,118784,3,3594240,3563520,3573760,3584000,16384,0,0,0,7884544,8573952,7867264,29920,23,9821184,240,0
.long 8436992,106496,106496,8545024,0,0,0,0,0,0,0,0,0,0,0,3,6533120,6471680,6492160,6512640,102400,122880,143360,148480,7883776,16384,7876544,1350880,1055,9744384,240,8653056
.long 8438720,126976,110592,8547072,0,0,0,0,0,0,0,0,0,0,0,3,6476800,6497280,6517760,6538240,117760,138240,158720,102400,7884032,15360,7876352,38880,30,9769984,240,8653568
.long 8440448,108544,126976,8549120,0,0,0,0,0,0,0,0,0,0,0,3,6502400,6522880,6543360,6481920,133120,153600,112640,117760,7884288,15360,7876416,1349600,1054,9795584,240,8654080
.long 8442176,129024,131072,8551168,0,0,0,0,0,0,0,0,0,0,0,3,6528000,6548480,6487040,6507520,148480,107520,128000,133120,7884544,16384,7876480,40160,31,9821184,240,8654592
.long 0,0,0,0,24,3,20,8454144,983040,7864368,8563072,73728,0,106496,106496,3,3922944,3892224,3902464,3912704,16392,0,0,0,7883776,8584704,7868352,1350880,1055,9744384,240,0
.long 0,0,0,0,24,3,20,8456192,1064960,7866416,8584576,79872,0,107520,110592,3,3880960,3850240,3860480,3870720,15360,0,0,0,7884032,8573952,7868160,38880,30,9769984,240,0
.long 0,0,0,0,24,3,20,8458240,1146880,7868464,8606080,86016,0,108544,114688,3,3881984,3851264,3861504,3871744,15368,0,0,0,7884288,8584704,7868224,1349600,1054,9795584,240,0
.long 0,0,0,0,24,3,20,8460288,1228800,7870512,8627584,92160,0,109568,118784,3,3921920,3891200,3901440,3911680,16384,0,0,0,7884544,8573952,7868288,40160,31,9821184,240,0
.long 8395520,106496,106496,8496896,0,0,0,0,0,0,0,0,0,0,0,3,6860800,6799360,6819840,6840320,102400,122880,143360,148480,7883776,16384,7877568,1361120,1063,9744384,240,8657152
.long 8397248,126976,110592,8498944,0,0,0,0,0,0,0,0,0,0,0,3,6804480,6824960,6845440,6865920,117760,138240,158720,102400,7884032,15360,7877376,49120,38,9769984,240,8657664
.long 8398976,108544,126976,8500992,0,0,0,0,0,0,0,0,0,0,0,3,6830080,6850560,6871040,6809600,133120,153600,112640,117760,7884288,15360,7877440,1359840,1062,9795584,240,8658176
.long 8400704,129024,131072,8503040,0,0,0,0,0,0,0,0,0,0,0,3,6855680,6876160,6814720,6835200,148480,107520,128000,133120,7884544,16384,7877504,50400,39,9821184,240,8658688
.long 0,0,0,0,24,4,20,8454144,1310720,7864384,8565760,73728,0,106496,106496,3,4250624,4219904,4230144,4240384,16392,0,0,0,7883776,8606208,7869376,1361120,1063,9744384,240,0
.long 0,0,0,0,24,4,20,8456192,1392640,7866432,8587264,79872,0,107520,110592,3,4208640,4177920,4188160,4198400,15360,0,0,0,7884032,8595456,7869184,49120,38,9769984,240,0
.long 0,0,0,0,24,4,20,8458240,1474560,7868480,8608768,86016,0,108544,114688,3,4209664,4178944,4189184,4199424,15368,0,0,0,7884288,8606208,7869248,1359840,1062,9795584,240,0
.long 0,0,0,0,24,4,20,8460288,1556480,7870528,8630272,92160,0,109568,118784,3,4249600,4218880,4229120,4239360,16384,0,0,0,7884544,8595456,7869312,50400,39,9821184,240,0
.long 8409344,106496,106496,8513280,0,0,0,0,0,0,0,0,0,0,0,3,7188480,7127040,7147520,7168000,102400,122880,143360,148480,7883776,16384,7878592,1371360,1071,9744384,240,8661248
.long 8411072,126976,110592,8515328,0,0,0,0,0,0,0,0,0,0,0,3,7132160,7152640,7173120,7193600,117760,138240,158720,102400,7884032,15360,7878400,59360,46,9769984,240,8661760
.long 8412800,108544,126976,8517376,0,0,0,0,0,0,0,0,0,0,0,3,7157760,7178240,7198720,7137280,133120,153600,112640,117760,7884288,15360,7878464,1370080,1070,9795584,240,8662272
.long 8414528,129024,131072,8519424,0,0,0,0,0,0,0,0,0,0,0,3,7183360,7203840,7142400,7162880,148480,107520,128000,133120,7884544,16384,7878528,60640,47,9821184,240,8662784
.long 0,0,0,0,24,5,20,8454144,1638400,7864400,8568448,73728,0,106496,106496,3,4578304,4547584,4557824,4568064,16392,0,0,0,7883776,8606208,7870400,1371360,1071,9744384,240,0
.long 0,0,0,0,24,5,20,8456192,1720320,7866448,8589952,79872,0,107520,110592,3,4536320,4505600,4515840,4526080,15360,0,0,0,7884032,8595456,7870208,59360,46,9769984,240,0
.long 0,0,0,0,24,5,20,8458240,1802240,7868496,8611456,86016,0,108544,114688,3,4537344,4506624,4516864,4527104,15368,0,0,0,7884288,8606208,7870272,1370080,1070,9795584,240,0
.long 0,0,0,0,24,5,20,8460288,1884160,7870544,8632960,92160,0,109568,118784,3,4577280,4546560,4556800,4567040,16384,0,0,0,7884544,8595456,7870336,60640,47,9821184,240,0
.long 8423168,106496,106496,8529664,0,0,0,0,0,0,0,0,0,0,0,3,7516160,7454720,7475200,7495680,102400,122880,143360,148480,7883776,16384,7879616,1381600,1079,9744384,240,8665344
.long 8424896,126976,110592,8531712,0,0,0,0,0,0,0,0,0,0,0,3,7459840,7480320,7500800,7521280,117760,138240,158720,102400,7884032,15360,7879424,69600,54,9769984,240,8665856
.long 8426624,108544,126976,8533760,0,0,0,0,0,0,0,0,0,0,0,3,7485440,7505920,7526400,7464960,133120,153600,112640,117760,7884288,15360,7879488,1380320,1078,9795584,240,8666368
.long 8428352,129024,131072,8535808,0,0,0,0,0,0,0,0,0,0,0,3,7511040,7531520,7470080,7490560,148480,107520,128000,133120,7884544,16384,7879552,70880,55,9821184,240,8666880
.long 0,0,0,0,24,6,20,8454144,1966080,7864416,8571136,73728,0,106496,106496,3,4905984,4875264,4885504,4895744,16392,0,0,0,7883776,8627712,7871424,1381600,1079,9744384,240,0
.long 0,0,0,0,24,6,20,8456192,2048000,7866464,8592640,79872,0,107520,110592,3,4864000,4833280,4843520,4853760,15360,0,0,0,7884032,8616960,7871232,69600,54,9769984,240,0
.long 0,0,0,0,24,6,20,8458240,2129920,7868512,8614144,86016,0,108544,114688,3,4865024,4834304,4844544,4854784,15368,0,0,0,7884288,8627712,7871296,1380320,1078,9795584,240,0
.long 0,0,0,0,24,6,20,8460288,2211840,7870560,8635648,92160,0,109568,118784,3,4904960,4874240,4884480,4894720,16384,0,0,0,7884544,8616960,7871360,70880,55,9821184,240,0
.long 8436992,106496,106496,8546048,0,0,0,0,0,0,0,0,0,0,0,3,7843840,7782400,7802880,7823360,102400,122880,143360,148480,7883776,16384,7880640,1391840,1087,9744384,240,8669440
.long 8438720,126976,110592,8548096,0,0,0,0,0,0,0,0,0,0,0,3,7787520,7808000,7828480,7848960,117760,138240,158720,102400,7884032,15360,7880448,79840,62,9769984,240,8669952
.long 8440448,108544,126976,8550144,0,0,0,0,0,0,0,0,0,0,0,3,7813120,7833600,7854080,7792640,133120,153600,112640,117760,7884288,15360,7880512,1390560,1086,9795584,240,8670464
.long 8442176,129024,131072,8552192,0,0,0,0,0,0,0,0,0,0,0,3,7838720,7859200,7797760,7818240,148480,107520,128000,133120,7884544,16384,7880576,81120,63,9821184,240,8670976
.long 0,0,0,0,24,7,20,8454144,2293760,7864432,8573824,73728,0,106496,106496,3,5233664,5202944,5213184,5223424,16392,0,0,0,7883776,8627712,7872448,1391840,1087,9744384,240,0
.long 0,0,0,0,24,7,20,8456192,2375680,7866480,8595328,79872,0,107520,110592,3,5191680,5160960,5171200,5181440,15360,0,0,0,7884032,8616960,7872256,79840,62,9769984,240,0
.long 0,0,0,0,24,7,20,8458240,2457600,7868528,8616832,86016,0,108544,114688,3,5192704,5161984,5172224,5182464,15368,0,0,0,7884288,8627712,7872320,1390560,1086,9795584,240,0
.long 0,0,0,0,24,7,20,8460288,2539520,7870576,8638336,92160,0,109568,118784,3,5232640,5201920,5212160,5222400,16384,0,0,0,7884544,8616960,7872384,81120,63,9821184,240,0
.long 143360,1454080,7876096,8457728,0,0,0,0,0,0,0,0,28,0,0,4,5488640,5509120,5529600,5550080,117760,138240,158720,102400,7884800,0,7873280,8320,6,9846784,4294966976,8640768
.long 148480,1459200,7876224,8457856,0,0,0,0,0,0,0,0,29,0,0,4,5514240,5534720,5555200,5493760,133120,153600,112640,117760,7885056,0,7873344,1319040,1030,9872384,4294966976,8641280
.long 153600,1464320,7876352,8457984,0,0,0,0,0,0,0,0,30,0,0,4,5539840,5560320,5498880,5519360,148480,107520,128000,133120,7885312,1024,7873408,9600,7,9897984,4294966976,8641792
.long 158720,1469440,7876480,8458112,0,0,0,0,0,0,0,0,31,0,0,4,5565440,5504000,5524480,5544960,102400,122880,143360,148480,7885568,1024,7873472,1320320,1031,9923584,4294966976,8642304
.long 0,0,0,0,20,0,20,8454144,0,7864320,8555008,73728,0,106496,106496,4,2867200,2877440,2887680,2897920,0,0,0,0,7884800,8552448,7865088,8320,6,9846784,4294966976,0
.long 0,0,0,0,20,0,20,8456192,81920,7866368,8576512,79872,0,107520,110592,4,2868224,2878464,2888704,2898944,8,0,0,0,7885056,8563200,7865152,1319040,1030,9872384,4294966976,0
.long 0,0,0,0,20,0,20,8458240,163840,7868416,8598016,86016,0,108544,114688,4,2908160,2918400,2928640,2938880,1024,0,0,0,7885312,8552448,7865216,9600,7,9897984,4294966976,0
.long 0,0,0,0,20,0,20,8460288,245760,7870464,8619520,92160,0,109568,118784,4,2909184,2919424,2929664,2939904,1032,0,0,0,7885568,8563200,7865280,1320320,1031,9923584,4294966976,0
.long 144640,1455360,7876096,8465920,0,0,0,0,0,0,0,0,28,0,0,4,5816320,5836800,5857280,5877760,117760,138240,158720,102400,7884800,0,7874304,18560,14,9846784,4294966976,8644864
.long 149760,1460480,7876224,8466048,0,0,0,0,0,0,0,0,29,0,0,4,5841920,5862400,5882880,5821440,133120,153600,112640,117760,7885056,0,7874368,1329280,1038,9872384,4294966976,8645376
.long 154880,1465600,7876352,8466176,0,0,0,0,0,0,0,0,30,0,0,4,5867520,5888000,5826560,5847040,148480,107520,128000,133120,7885312,1024,7874432,19840,15,9897984,4294966976,8645888
.long 160000,1470720,7876480,8466304,0,0,0,0,0,0,0,0,31,0,0,4,5893120,5831680,5852160,5872640,102400,122880,143360,148480,7885568,1024,7874496,1330560,1039,9923584,4294966976,8646400
.long 0,0,0,0,20,1,20,8454144,327680,7864336,8557696,73728,0,106496,106496,4,3194880,3205120,3215360,3225600,0,0,0,0,7884800,8552448,7866112,18560,14,9846784,4294966976,0
.long 0,0,0,0,20,1,20,8456192,409600,7866384,8579200,79872,0,107520,110592,4,3195904,3206144,3216384,3226624,8,0,0,0,7885056,8563200,7866176,1329280,1038,9872384,4294966976,0
.long 0,0,0,0,20,1,20,8458240,491520,7868432,8600704,86016,0,108544,114688,4,3235840,3246080,3256320,3266560,1024,0,0,0,7885312,8552448,7866240,19840,15,9897984,4294966976,0
.long 0,0,0,0,20,1,20,8460288,573440,7870480,8622208,92160,0,109568,118784,4,3236864,3247104,3257344,3267584,1032,0,0,0,7885568,8563200,7866304,1330560,1039,9923584,4294966976,0
.long 145920,1456640,7876096,8474112,0,0,0,0,0,0,0,0,28,0,0,4,6144000,6164480,6184960,6205440,117760,138240,158720,102400,7884800,0,7875328,28800,22,9846784,4294966976,8648960
.long 151040,1461760,7876224,8474240,0,0,0,0,0,0,0,0,29,0,0,4,6169600,6190080,6210560,6149120,133120,153600,112640,117760,7885056,0,7875392,1339520,1046,9872384,4294966976,8649472
.long 156160,1466880,7876352,8474368,0,0,0,0,0,0,0,0,30,0,0,4,6195200,6215680,6154240,6174720,148480,107520,128000,133120,7885312,1024,7875456,30080,23,9897984,4294966976,8649984
.long 161280,1472000,7876480,8474496,0,0,0,0,0,0,0,0,31,0,0,4,6220800,6159360,6179840,6200320,102400,122880,143360,148480,7885568,1024,7875520,1340800,1047,9923584,4294966976,8650496
.long 0,0,0,0,20,2,20,8454144,655360,7864352,8560384,73728,0,106496,106496,4,3522560,3532800,3543040,3553280,0,0,0,0,7884800,8573952,7867136,28800,22,9846784,4294966976,0
.long 0,0,0,0,20,2,20,8456192,737280,7866400,8581888,79872,0,107520,110592,4,3523584,3533824,3544064,3554304,8,0,0,0,7885056,8584704,7867200,1339520,1046,9872384,4294966976,0
.long 0,0,0,0,20,2,20,8458240,819200,7868448,8603392,86016,0,108544,114688,4,3563520,3573760,3584000,3594240,1024,0,0,0,7885312,8573952,7867264,30080,23,9897984,4294966976,0
.long 0,0,0,0,20,2,20,8460288,901120,7870496,8624896,92160,0,109568,118784,4,3564544,3574784,3585024,3595264,1032,0,0,0,7885568,8584704,7867328,1340800,1047,9923584,4294966976,0
.long 147200,1457920,7876096,8482304,0,0,0,0,0,0,0,0,28,0,0,4,6471680,6492160,6512640,6533120,117760,138240,158720,102400,7884800,0,7876352,39040,30,9846784,4294966976,8653056
.long 152320,1463040,7876224,8482432,0,0,0,0,0,0,0,0,29,0,0,4,6497280,6517760,6538240,6476800,133120,153600,112640,117760,7885056,0,7876416,1349760,1054,9872384,4294966976,8653568
.long 157440,1468160,7876352,8482560,0,0,0,0,0,0,0,0,30,0,0,4,6522880,6543360,6481920,6502400,148480,107520,128000,133120,7885312,1024,7876480,40320,31,9897984,4294966976,8654080
.long 162560,1473280,7876480,8482688,0,0,0,0,0,0,0,0,31,0,0,4,6548480,6487040,6507520,6528000,102400,122880,143360,148480,7885568,1024,7876544,1351040,1055,9923584,4294966976,8654592
.long 0,0,0,0,20,3,20,8454144,983040,7864368,8563072,73728,0,106496,106496,4,3850240,3860480,3870720,3880960,0,0,0,0,7884800,8573952,7868160,39040,30,9846784,4294966976,0
.long 0,0,0,0,20,3,20,8456192,1064960,7866416,8584576,79872,0,107520,110592,4,3851264,3861504,3871744,3881984,8,0,0,0,7885056,8584704,7868224,1349760,1054,9872384,4294966976,0
.long 0,0,0,0,20,3,20,8458240,1146880,7868464,8606080,86016,0,108544,114688,4,3891200,3901440,3911680,3921920,1024,0,0,0,7885312,8573952,7868288,40320,31,9897984,4294966976,0
.long 0,0,0,0,20,3,20,8460288,1228800,7870512,8627584,92160,0,109568,118784,4,3892224,3902464,3912704,3922944,1032,0,0,0,7885568,8584704,7868352,1351040,1055,9923584,4294966976,0
.long 307200,1617920,7880192,8461824,0,0,0,0,0,0,0,0,60,0,0,4,6799360,6819840,6840320,6860800,117760,138240,158720,102400,7884800,0,7877376,49280,38,9846784,4294966976,8657152
.long 312320,1623040,7880320,8461952,0,0,0,0,0,0,0,0,61,0,0,4,6824960,6845440,6865920,6804480,133120,153600,112640,117760,7885056,0,7877440,1360000,1062,9872384,4294966976,8657664
.long 317440,1628160,7880448,8462080,0,0,0,0,0,0,0,0,62,0,0,4,6850560,6871040,6809600,6830080,148480,107520,128000,133120,7885312,1024,7877504,50560,39,9897984,4294966976,8658176
.long 322560,1633280,7880576,8462208,0,0,0,0,0,0,0,0,63,0,0,4,6876160,6814720,6835200,6855680,102400,122880,143360,148480,7885568,1024,7877568,1361280,1063,9923584,4294966976,8658688
.long 0,0,0,0,20,4,20,8454144,1310720,7864384,8565760,73728,0,106496,106496,4,4177920,4188160,4198400,4208640,0,0,0,0,7884800,8595456,7869184,49280,38,9846784,4294966976,0
.long 0,0,0,0,20,4,20,8456192,1392640,7866432,8587264,79872,0,107520,110592,4,4178944,4189184,4199424,4209664,8,0,0,0,7885056,8606208,7869248,1360000,1062,9872384,4294966976,0
.long 0,0,0,0,20,4,20,8458240,1474560,7868480,8608768,86016,0,108544,114688,4,4218880,4229120,4239360,4249600,1024,0,0,0,7885312,8595456,7869312,50560,39,9897984,4294966976,0
.long 0,0,0,0,20,4,20,8460288,1556480,7870528,8630272,92160,0,109568,118784,4,4219904,4230144,4240384,4250624,1032,0,0,0,7885568,8606208,7869376,1361280,1063,9923584,4294966976,0
.long 308480,1619200,7880192,8470016,0,0,0,0,0,0,0,0,60,0,0,4,7127040,7147520,7168000,7188480,117760,138240,158720,102400,7884800,0,7878400,59520,46,9846784,4294966976,8661248
.long 313600,1624320,7880320,8470144,0,0,0,0,0,0,0,0,61,0,0,4,7152640,7173120,7193600,7132160,133120,153600,112640,117760,7885056,0,7878464,1370240,1070,9872384,4294966976,8661760
.long 318720,1629440,7880448,8470272,0,0,0,0,0,0,0,0,62,0,0,4,7178240,7198720,7137280,7157760,148480,107520,128000,133120,7885312,1024,7878528,60800,47,9897984,4294966976,8662272
.long 323840,1634560,7880576,8470400,0,0,0,0,0,0,0,0,63,0,0,4,7203840,7142400,7162880,7183360,102400,122880,143360,148480,7885568,1024,7878592,1371520,1071,9923584,4294966976,8662784
.long 0,0,0,0,20,5,20,8454144,1638400,7864400,8568448,73728,0,106496,106496,4,4505600,4515840,4526080,4536320,0,0,0,0,7884800,8595456,7870208,59520,46,9846784,4294966976,0
.long 0,0,0,0,20,5,20,8456192,1720320,7866448,8589952,79872,0,107520,110592,4,4506624,4516864,4527104,4537344,8,0,0,0,7885056,8606208,7870272,1370240,1070,9872384,4294966976,0
.long 0,0,0,0,20,5,20,8458240,1802240,7868496,8611456,86016,0,108544,114688,4,4546560,4556800,4567040,4577280,1024,0,0,0,7885312,8595456,7870336,60800,47,9897984,4294966976,0
.long 0,0,0,0,20,5,20,8460288,1884160,7870544,8632960,92160,0,109568,118784,4,4547584,4557824,4568064,4578304,1032,0,0,0,7885568,8606208,7870400,1371520,1071,9923584,4294966976,0
.long 309760,1620480,7880192,8478208,0,0,0,0,0,0,0,0,60,0,0,4,7454720,7475200,7495680,7516160,117760,138240,158720,102400,7884800,0,7879424,69760,54,9846784,4294966976,8665344
.long 314880,1625600,7880320,8478336,0,0,0,0,0,0,0,0,61,0,0,4,7480320,7500800,7521280,7459840,133120,153600,112640,117760,7885056,0,7879488,1380480,1078,9872384,4294966976,8665856
.long 320000,1630720,7880448,8478464,0,0,0,0,0,0,0,0,62,0,0,4,7505920,7526400,7464960,7485440,148480,107520,128000,133120,7885312,1024,7879552,71040,55,9897984,4294966976,8666368
.long 325120,1635840,7880576,8478592,0,0,0,0,0,0,0,0,63,0,0,4,7531520,7470080,7490560,7511040,102400,122880,143360,148480,7885568,1024,7879616,1381760,1079,9923584,4294966976,8666880
.long 0,0,0,0,20,6,20,8454144,1966080,7864416,8571136,73728,0,106496,106496,4,4833280,4843520,4853760,4864000,0,0,0,0,7884800,8616960,7871232,69760,54,9846784,4294966976,0
.long 0,0,0,0,20,6,20,8456192,2048000,7866464,8592640,79872,0,107520,110592,4,4834304,4844544,4854784,4865024,8,0,0,0,7885056,8627712,7871296,1380480,1078,9872384,4294966976,0
.long 0,0,0,0,20,6,20,8458240,2129920,7868512,8614144,86016,0,108544,114688,4,4874240,4884480,4894720,4904960,1024,0,0,0,7885312,8616960,7871360,71040,55,9897984,4294966976,0
.long 0,0,0,0,20,6,20,8460288,2211840,7870560,8635648,92160,0,109568,118784,4,4875264,4885504,4895744,4905984,1032,0,0,0,7885568,8627712,7871424,1381760,1079,9923584,4294966976,0
.long 311040,1621760,7880192,8486400,0,0,0,0,0,0,0,0,60,0,0,4,7782400,7802880,7823360,7843840,117760,138240,158720,102400,7884800,0,7880448,80000,62,9846784,4294966976,8669440
.long 316160,1626880,7880320,8486528,0,0,0,0,0,0,0,0,61,0,0,4,7808000,7828480,7848960,7787520,133120,153600,112640,117760,7885056,0,7880512,1390720,1086,9872384,4294966976,8669952
.long 321280,1632000,7880448,8486656,0,0,0,0,0,0,0,0,62,0,0,4,7833600,7854080,7792640,7813120,148480,107520,128000,133120,7885312,1024,7880576,81280,63,9897984,4294966976,8670464
.long 326400,1637120,7880576,8486784,0,0,0,0,0,0,0,0,63,0,0,4,7859200,7797760,7818240,7838720,102400,122880,143360,148480,7885568,1024,7880640,1392000,1087,9923584,4294966976,8670976
.long 0,0,0,0,20,7,20,8454144,2293760,7864432,8573824,73728,0,106496,106496,4,5160960,5171200,5181440,5191680,0,0,0,0,7884800,8616960,7872256,80000,62,9846784,4294966976,0
.long 0,0,0,0,20,7,20,8456192,2375680,7866480,8595328,79872,0,107520,110592,4,5161984,5172224,5182464,5192704,8,0,0,0,7885056,8627712,7872320,1390720,1086,9872384,4294966976,0
.long 0,0,0,0,20,7,20,8458240,2457600,7868528,8616832,86016,0,108544,114688,4,5201920,5212160,5222400,5232640,1024,0,0,0,7885312,8616960,7872384,81280,63,9897984,4294966976,0
.long 0,0,0,0,20,7,20,8460288,2539520,7870576,8638336,92160,0,109568,118784,4,5202944,5213184,5223424,5233664,1032,0,0,0,7885568,8627712,7872448,1392000,1087,9923584,4294966976,0
.long 6389760,6391808,8388608,8652800,0,0,0,8486912,0,0,0,0,147456,147456,0,5,2878464,2888704,2898944,2868224,5128,0,0,0,7885824,8563200,7865152,1319200,1030,9949184,4294967056,0
.long 6392832,6392320,8392064,8652928,0,0,0,8491008,0,0,0,0,149760,152064,0,5,2918400,2928640,2938880,2908160,6144,0,0,0,7886080,8552448,7865216,9760,7,9974784,4294967056,0
.long 6471680,6473728,8395520,8653056,0,0,0,8495104,0,0,0,0,152064,147456,0,5,2919424,2929664,2939904,2909184,6152,0,0,0,7886336,8563200,7865280,1320480,1031,10000384,4294967056,0
.long 6474752,6474240,8398976,8653184,0,0,0,8499200,0,0,0,0,154368,152064,0,5,2877440,2887680,2897920,2867200,5120,0,0,0,7886592,8552448,7865088,8480,6,10025984,4294967056,0
.long 8536064,0,0,0,0,0,0,0,8531968,7884288,410080,9795584,0,0,0,5,5509120,5529600,5550080,5488640,133120,153600,112640,117760,7885824,5120,7873344,1319200,1030,9949184,4294967056,8640768
.long 8536064,0,0,0,0,0,0,0,8532992,7884288,410080,9800704,0,0,0,5,5534720,5555200,5493760,5514240,148480,107520,128000,133120,7886080,6144,7873408,9760,7,9974784,4294967056,8641280
.long 8536064,0,0,0,0,0,0,0,8534016,7884288,410080,9805824,0,0,0,5,5560320,5498880,5519360,5539840,102400,122880,143360,148480,7886336,6144,7873472,1320480,1031,10000384,4294967056,8641792
.long 8536064,0,0,0,0,0,0,0,8535040,7884288,410080,9805824,0,0,0,5,5504000,5524480,5544960,5565440,117760,138240,158720,102400,7886592,5120,7873280,8480,6,10025984,4294967056,8642304
.long 6394880,6396928,8402432,8653312,0,0,0,8503296,0,0,0,0,147456,147456,0,5,3206144,3216384,3226624,3195904,5128,0,0,0,7885824,8563200,7866176,1329440,1038,9949184,4294967056,0
.long 6397952,6397440,8405888,8653440,0,0,0,8507392,0,0,0,0,149760,152064,0,5,3246080,3256320,3266560,3235840,6144,0,0,0,7886080,8552448,7866240,20000,15,9974784,4294967056,0
.long 6476800,6478848,8409344,8653568,0,0,0,8511488,0,0,0,0,152064,147456,0,5,3247104,3257344,3267584,3236864,6152,0,0,0,7886336,8563200,7866304,1330720,1039,10000384,4294967056,0
.long 6479872,6479360,8412800,8653696,0,0,0,8515584,0,0,0,0,154368,152064,0,5,3205120,3215360,3225600,3194880,5120,0,0,0,7886592,8552448,7866112,18720,14,10025984,4294967056,0
.long 8541184,0,0,0,0,0,0,0,8537088,7884416,512480,9810944,0,0,0,5,5836800,5857280,5877760,5816320,133120,153600,112640,117760,7885824,5120,7874368,1329440,1038,9949184,4294967056,8644864
.long 8541184,0,0,0,0,0,0,0,8538112,7884416,512480,9816064,0,0,0,5,5862400,5882880,5821440,5841920,148480,107520,128000,133120,7886080,6144,7874432,20000,15,9974784,4294967056,8645376
.long 8541184,0,0,0,0,0,0,0,8539136,7884416,512480,9806336,0,0,0,5,5888000,5826560,5847040,5867520,102400,122880,143360,148480,7886336,6144,7874496,1330720,1039,10000384,4294967056,8645888
.long 8541184,0,0,0,0,0,0,0,8540160,7884416,512480,9806336,0,0,0,5,5831680,5852160,5872640,5893120,117760,138240,158720,102400,7886592,5120,7874304,18720,14,10025984,4294967056,8646400
.long 6400000,6402048,8416256,8653824,0,0,0,8519680,0,0,0,0,147456,147456,0,5,3533824,3544064,3554304,3523584,5128,0,0,0,7885824,8584704,7867200,1339680,1046,9949184,4294967056,0
.long 6403072,6402560,8419712,8653952,0,0,0,8523776,0,0,0,0,149760,152064,0,5,3573760,3584000,3594240,3563520,6144,0,0,0,7886080,8573952,7867264,30240,23,9974784,4294967056,0
.long 6481920,6483968,8423168,8654080,0,0,0,8527872,0,0,0,0,152064,147456,0,5,3574784,3585024,3595264,3564544,6152,0,0,0,7886336,8584704,7867328,1340960,1047,10000384,4294967056,0
.long 6484992,6484480,8426624,8654208,0,0,0,8531968,0,0,0,0,154368,152064,0,5,3532800,3543040,3553280,3522560,5120,0,0,0,7886592,8573952,7867136,28960,22,10025984,4294967056,0
.long 8546304,0,0,0,0,0,0,0,8542208,7884544,614880,9821184,0,0,0,5,6164480,6184960,6205440,6144000,133120,153600,112640,117760,7885824,5120,7875392,1339680,1046,9949184,4294967056,8648960
.long 8546304,0,0,0,0,0,0,0,8543232,7884544,614880,9826304,0,0,0,5,6190080,6210560,6149120,6169600,148480,107520,128000,133120,7886080,6144,7875456,30240,23,9974784,4294967056,8649472
.long 8546304,0,0,0,0,0,0,0,8544256,7884544,614880,9831424,0,0,0,5,6215680,6154240,6174720,6195200,102400,122880,143360,148480,7886336,6144,7875520,1340960,1047,10000384,4294967056,8649984
.long 8546304,0,0,0,0,0,0,0,8545280,7884544,614880,9831424,0,0,0,5,6159360,6179840,6200320,6220800,117760,138240,158720,102400,7886592,5120,7875328,28960,22,10025984,4294967056,8650496
.long 6405120,6407168,8430080,8654336,0,0,0,8536064,0,0,0,0,147456,147456,0,5,3861504,3871744,3881984,3851264,5128,0,0,0,7885824,8584704,7868224,1349920,1054,9949184,4294967056,0
.long 6408192,6407680,8433536,8654464,0,0,0,8540160,0,0,0,0,149760,152064,0,5,3901440,3911680,3921920,3891200,6144,0,0,0,7886080,8573952,7868288,40480,31,9974784,4294967056,0
.long 6487040,6489088,8436992,8654592,0,0,0,8544256,0,0,0,0,152064,147456,0,5,3902464,3912704,3922944,3892224,6152,0,0,0,7886336,8584704,7868352,1351200,1055,10000384,4294967056,0
.long 6490112,6489600,8440448,8654720,0,0,0,8548352,0,0,0,0,154368,152064,0,5,3860480,3870720,3880960,3850240,5120,0,0,0,7886592,8573952,7868160,39200,30,10025984,4294967056,0
.long 8551424,0,0,0,0,0,0,0,8547328,7884672,717280,9836544,0,0,0,5,6492160,6512640,6533120,6471680,133120,153600,112640,117760,7885824,5120,7876416,1349920,1054,9949184,4294967056,8653056
.long 8551424,0,0,0,0,0,0,0,8548352,7884672,717280,9841664,0,0,0,5,6517760,6538240,6476800,6497280,148480,107520,128000,133120,7886080,6144,7876480,40480,31,9974784,4294967056,8653568
.long 8551424,0,0,0,0,0,0,0,8549376,7884672,717280,9831936,0,0,0,5,6543360,6481920,6502400,6522880,102400,122880,143360,148480,7886336,6144,7876544,1351200,1055,10000384,4294967056,8654080
.long 8551424,0,0,0,0,0,0,0,8550400,7884672,717280,9831936,0,0,0,5,6487040,6507520,6528000,6548480,117760,138240,158720,102400,7886592,5120,7876352,39200,30,10025984,4294967056,8654592
.long 7700480,7702528,8388608,8669184,0,0,0,8486912,0,0,0,0,147456,147456,0,5,4189184,4199424,4209664,4178944,5128,0,0,0,7885824,8606208,7869248,1360160,1062,9949184,4294967056,0
.long 7703552,7703040,8392064,8669312,0,0,0,8491008,0,0,0,0,149760,152064,0,5,4229120,4239360,4249600,4218880,6144,0,0,0,7886080,8595456,7869312,50720,39,9974784,4294967056,0
.long 7782400,7784448,8395520,8669440,0,0,0,8495104,0,0,0,0,152064,147456,0,5,4230144,4240384,4250624,4219904,6152,0,0,0,7886336,8606208,7869376,1361440,1063,10000384,4294967056,0
.long 7785472,7784960,8398976,8669568,0,0,0,8499200,0,0,0,0,154368,152064,0,5,4188160,4198400,4208640,4177920,5120,0,0,0,7886592,8595456,7869184,49440,38,10025984,4294967056,0
.long 8699904,0,0,0,0,0,0,0,8695808,7888384,410720,10205184,0,0,0,5,6819840,6840320,6860800,6799360,133120,153600,112640,117760,7885824,5120,7877440,1360160,1062,9949184,4294967056,8657152
.long 8699904,0,0,0,0,0,0,0,8696832,7888384,410720,10210304,0,0,0,5,6845440,6865920,6804480,6824960,148480,107520,128000,133120,7886080,6144,7877504,50720,39,9974784,4294967056,8657664
.long 8699904,0,0,0,0,0,0,0,8697856,7888384,410720,10215424,0,0,0,5,6871040,6809600,6830080,6850560,102400,122880,143360,148480,7886336,6144,7877568,1361440,1063,10000384,4294967056,8658176
.long 8699904,0,0,0,0,0,0,0,8698880,7888384,410720,10215424,0,0,0,5,6814720,6835200,6855680,6876160,117760,138240,158720,102400,7886592,5120,7877376,49440,38,10025984,4294967056,8658688
.long 7705600,7707648,8402432,8669696,0,0,0,8503296,0,0,0,0,147456,147456,0,5,4516864,4527104,4537344,4506624,5128,0,0,0,7885824,8606208,7870272,1370400,1070,9949184,4294967056,0
.long 7708672,7708160,8405888,8669824,0,0,0,8507392,0,0,0,0,149760,152064,0,5,4556800,4567040,4577280,4546560,6144,0,0,0,7886080,8595456,7870336,60960,47,9974784,4294967056,0
.long 7787520,7789568,8409344,8669952,0,0,0,8511488,0,0,0,0,152064,147456,0,5,4557824,4568064,4578304,4547584,6152,0,0,0,7886336,8606208,7870400,1371680,1071,10000384,4294967056,0
.long 7790592,7790080,8412800,8670080,0,0,0,8515584,0,0,0,0,154368,152064,0,5,4515840,4526080,4536320,4505600,5120,0,0,0,7886592,8595456,7870208,59680,46,10025984,4294967056,0
.long 8705024,0,0,0,0,0,0,0,8700928,7888512,513120,10220544,0,0,0,5,7147520,7168000,7188480,7127040,133120,153600,112640,117760,7885824,5120,7878464,1370400,1070,9949184,4294967056,8661248
.long 8705024,0,0,0,0,0,0,0,8701952,7888512,513120,10225664,0,0,0,5,7173120,7193600,7132160,7152640,148480,107520,128000,133120,7886080,6144,7878528,60960,47,9974784,4294967056,8661760
.long 8705024,0,0,0,0,0,0,0,8702976,7888512,513120,10215936,0,0,0,5,7198720,7137280,7157760,7178240,102400,122880,143360,148480,7886336,6144,7878592,1371680,1071,10000384,4294967056,8662272
.long 8705024,0,0,0,0,0,0,0,8704000,7888512,513120,10215936,0,0,0,5,7142400,7162880,7183360,7203840,117760,138240,158720,102400,7886592,5120,7878400,59680,46,10025984,4294967056,8662784
.long 7710720,7712768,8416256,8670208,0,0,0,8519680,0,0,0,0,147456,147456,0,5,4844544,4854784,4865024,4834304,5128,0,0,0,7885824,8627712,7871296,1380640,1078,9949184,4294967056,0
.long 7713792,7713280,8419712,8670336,0,0,0,8523776,0,0,0,0,149760,152064,0,5,4884480,4894720,4904960,4874240,6144,0,0,0,7886080,8616960,7871360,71200,55,9974784,4294967056,0
.long 7792640,7794688,8423168,8670464,0,0,0,8527872,0,0,0,0,152064,147456,0,5,4885504,4895744,4905984,4875264,6152,0,0,0,7886336,8627712,7871424,1381920,1079,10000384,4294967056,0
.long 7795712,7795200,8426624,8670592,0,0,0,8531968,0,0,0,0,154368,152064,0,5,4843520,4853760,4864000,4833280,5120,0,0,0,7886592,8616960,7871232,69920,54,10025984,4294967056,0
.long 8710144,0,0,0,0,0,0,0,8706048,7888640,615520,10230784,0,0,0,5,7475200,7495680,7516160,7454720,133120,153600,112640,117760,7885824,5120,7879488,1380640,1078,9949184,4294967056,8665344
.long 8710144,0,0,0,0,0,0,0,8707072,7888640,615520,10235904,0,0,0,5,7500800,7521280,7459840,7480320,148480,107520,128000,133120,7886080,6144,7879552,71200,55,9974784,4294967056,8665856
.long 8710144,0,0,0,0,0,0,0,8708096,7888640,615520,10241024,0,0,0,5,7526400,7464960,7485440,7505920,102400,122880,143360,148480,7886336,6144,7879616,1381920,1079,10000384,4294967056,8666368
.long 8710144,0,0,0,0,0,0,0,8709120,7888640,615520,10241024,0,0,0,5,7470080,7490560,7511040,7531520,117760,138240,158720,102400,7886592,5120,7879424,69920,54,10025984,4294967056,8666880
.long 7715840,7717888,8430080,8670720,0,0,0,8536064,0,0,0,0,147456,147456,0,5,5172224,5182464,5192704,5161984,5128,0,0,0,7885824,8627712,7872320,1390880,1086,9949184,4294967056,0
.long 7718912,7718400,8433536,8670848,0,0,0,8540160,0,0,0,0,149760,152064,0,5,5212160,5222400,5232640,5201920,6144,0,0,0,7886080,8616960,7872384,81440,63,9974784,4294967056,0
.long 7797760,7799808,8436992,8670976,0,0,0,8544256,0,0,0,0,152064,147456,0,5,5213184,5223424,5233664,5202944,6152,0,0,0,7886336,8627712,7872448,1392160,1087,10000384,4294967056,0
.long 7800832,7800320,8440448,8671104,0,0,0,8548352,0,0,0,0,154368,152064,0,5,5171200,5181440,5191680,5160960,5120,0,0,0,7886592,8616960,7872256,80160,62,10025984,4294967056,0
.long 8715264,0,0,0,0,0,0,0,8711168,7888768,717920,10246144,0,0,0,5,7802880,7823360,7843840,7782400,133120,153600,112640,117760,7885824,5120,7880512,1390880,1086,9949184,4294967056,8669440
.long 8715264,0,0,0,0,0,0,0,8712192,7888768,717920,10251264,0,0,0,5,7828480,7848960,7787520,7808000,148480,107520,128000,133120,7886080,6144,7880576,81440,63,9974784,4294967056,8669952
.long 8715264,0,0,0,0,0,0,0,8713216,7888768,717920,10241536,0,0,0,5,7854080,7792640,7813120,7833600,102400,122880,143360,148480,7886336,6144,7880640,1392160,1087,10000384,4294967056,8670464
.long 8715264,0,0,0,0,0,0,0,8714240,7888768,717920,10241536,0,0,0,5,7797760,7818240,7838720,7859200,117760,138240,158720,102400,7886592,5120,7880448,80160,62,10025984,4294967056,8670976
.long 8388608,106496,106496,8487808,0,0,0,0,0,0,0,0,0,0,0,6,5529600,5550080,5488640,5509120,148480,107520,128000,133120,7886848,11264,7873408,9920,7,10051584,4294967136,8640768
.long 8390336,126976,110592,8489856,0,0,0,0,0,0,0,0,0,0,0,6,5555200,5493760,5514240,5534720,102400,122880,143360,148480,7887104,11264,7873472,1320640,1031,10077184,4294967136,8641280
.long 8392064,108544,126976,8491904,0,0,0,0,0,0,0,0,0,0,0,6,5498880,5519360,5539840,5560320,117760,138240,158720,102400,7887360,10240,7873280,8640,6,10102784,4294967136,8641792
.long 8393792,129024,131072,8493952,0,0,0,0,0,0,0,0,0,0,0,6,5524480,5544960,5565440,5504000,133120,153600,112640,117760,7887616,10240,7873344,1319360,1030,10128384,4294967136,8642304
.long 0,0,0,0,21,0,20,8454144,0,7864320,8555008,73728,0,106496,106496,6,2928640,2938880,2908160,2918400,11264,0,0,0,7886848,8552448,7865216,9920,7,10051584,4294967136,0
.long 0,0,0,0,21,0,20,8456192,81920,7866368,8576512,79872,0,107520,110592,6,2929664,2939904,2909184,2919424,11272,0,0,0,7887104,8563200,7865280,1320640,1031,10077184,4294967136,0
.long 0,0,0,0,21,0,20,8458240,163840,7868416,8598016,86016,0,108544,114688,6,2887680,2897920,2867200,2877440,10240,0,0,0,7887360,8552448,7865088,8640,6,10102784,4294967136,0
.long 0,0,0,0,21,0,20,8460288,245760,7870464,8619520,92160,0,109568,118784,6,2888704,2898944,2868224,2878464,10248,0,0,0,7887616,8563200,7865152,1319360,1030,10128384,4294967136,0
.long 8402432,106496,106496,8504192,0,0,0,0,0,0,0,0,0,0,0,6,5857280,5877760,5816320,5836800,148480,107520,128000,133120,7886848,11264,7874432,20160,15,10051584,4294967136,8644864
.long 8404160,126976,110592,8506240,0,0,0,0,0,0,0,0,0,0,0,6,5882880,5821440,5841920,5862400,102400,122880,143360,148480,7887104,11264,7874496,1330880,1039,10077184,4294967136,8645376
.long 8405888,108544,126976,8508288,0,0,0,0,0,0,0,0,0,0,0,6,5826560,5847040,5867520,5888000,117760,138240,158720,102400,7887360,10240,7874304,18880,14,10102784,4294967136,8645888
.long 8407616,129024,131072,8510336,0,0,0,0,0,0,0,0,0,0,0,6,5852160,5872640,5893120,5831680,133120,153600,112640,117760,7887616,10240,7874368,1329600,1038,10128384,4294967136,8646400
.long 0,0,0,0,21,1,20,8454144,327680,7864336,8557696,73728,0,106496,106496,6,3256320,3266560,3235840,3246080,11264,0,0,0,7886848,8552448,7866240,20160,15,10051584,4294967136,0
.long 0,0,0,0,21,1,20,8456192,409600,7866384,8579200,79872,0,107520,110592,6,3257344,3267584,3236864,3247104,11272,0,0,0,7887104,8563200,7866304,1330880,1039,10077184,4294967136,0
.long 0,0,0,0,21,1,20,8458240,491520,7868432,8600704,86016,0,108544,114688,6,3215360,3225600,3194880,3205120,10240,0,0,0,7887360,8552448,7866112,18880,14,10102784,4294967136,0
.long 0,0,0,0,21,1,20,8460288,573440,7870480,8622208,92160,0,109568,118784,6,3216384,3226624,3195904,3206144,10248,0,0,0,7887616,8563200,7866176,1329600,1038,10128384,4294967136,0
.long 8416256,106496,106496,8520576,0,0,0,0,0,0,0,0,0,0,0,6,6184960,6205440,6144000,6164480,148480,107520,128000,133120,7886848,11264,7875456,30400,23,10051584,4294967136,8648960
.long 8417984,126976,110592,8522624,0,0,0,0,0,0,0,0,0,0,0,6,6210560,6149120,6169600,6190080,102400,122880,143360,148480,7887104,11264,7875520,1341120,1047,10077184,4294967136,8649472
.long 8419712,108544,126976,8524672,0,0,0,0,0,0,0,0,0,0,0,6,6154240,6174720,6195200,6215680,117760,138240,158720,102400,7887360,10240,7875328,29120,22,10102784,4294967136,8649984
.long 8421440,129024,131072,8526720,0,0,0,0,0,0,0,0,0,0,0,6,6179840,6200320,6220800,6159360,133120,153600,112640,117760,7887616,10240,7875392,1339840,1046,10128384,4294967136,8650496
.long 0,0,0,0,21,2,20,8454144,655360,7864352,8560384,73728,0,106496,106496,6,3584000,3594240,3563520,3573760,11264,0,0,0,7886848,8573952,7867264,30400,23,10051584,4294967136,0
.long 0,0,0,0,21,2,20,8456192,737280,7866400,8581888,79872,0,107520,110592,6,3585024,3595264,3564544,3574784,11272,0,0,0,7887104,8584704,7867328,1341120,1047,10077184,4294967136,0
.long 0,0,0,0,21,2,20,8458240,819200,7868448,8603392,86016,0,108544,114688,6,3543040,3553280,3522560,3532800,10240,0,0,0,7887360,8573952,7867136,29120,22,10102784,4294967136,0
.long 0,0,0,0,21,2,20,8460288,901120,7870496,8624896,92160,0,109568,118784,6,3544064,3554304,3523584,3533824,10248,0,0,0,7887616,8584704,7867200,1339840,1046,10128384,4294967136,0
.long 8430080,106496,106496,8536960,0,0,0,0,0,0,0,0,0,0,0,6,6512640,6533120,6471680,6492160,148480,107520,128000,133120,7886848,11264,7876480,40640,31,10051584,4294967136,8653056
.long 8431808,126976,110592,8539008,0,0,0,0,0,0,0,0,0,0,0,6,6538240,6476800,6497280,6517760,102400,122880,143360,148480,7887104,11264,7876544,1351360,1055,10077184,4294967136,8653568
.long 8433536,108544,126976,8541056,0,0,0,0,0,0,0,0,0,0,0,6,6481920,6502400,6522880,6543360,117760,138240,158720,102400,7887360,10240,7876352,39360,30,10102784,4294967136,8654080
.long 8435264,129024,131072,8543104,0,0,0,0,0,0,0,0,0,0,0,6,6507520,6528000,6548480,6487040,133120,153600,112640,117760,7887616,10240,7876416,1350080,1054,10128384,4294967136,8654592
.long 0,0,0,0,21,3,20,8454144,983040,7864368,8563072,73728,0,106496,106496,6,3911680,3921920,3891200,3901440,11264,0,0,0,7886848,8573952,7868288,40640,31,10051584,4294967136,0
.long 0,0,0,0,21,3,20,8456192,1064960,7866416,8584576,79872,0,107520,110592,6,3912704,3922944,3892224,3902464,11272,0,0,0,7887104,8584704,7868352,1351360,1055,10077184,4294967136,0
.long 0,0,0,0,21,3,20,8458240,1146880,7868464,8606080,86016,0,108544,114688,6,3870720,3880960,3850240,3860480,10240,0,0,0,7887360,8573952,7868160,39360,30,10102784,4294967136,0
.long 0,0,0,0,21,3,20,8460288,1228800,7870512,8627584,92160,0,109568,118784,6,3871744,3881984,3851264,3861504,10248,0,0,0,7887616,8584704,7868224,1350080,1054,10128384,4294967136,0
.long 8388608,106496,106496,8488832,0,0,0,0,0,0,0,0,0,0,0,6,6840320,6860800,6799360,6819840,148480,107520,128000,133120,7886848,11264,7877504,50880,39,10051584,4294967136,8657152
.long 8390336,126976,110592,8490880,0,0,0,0,0,0,0,0,0,0,0,6,6865920,6804480,6824960,6845440,102400,122880,143360,148480,7887104,11264,7877568,1361600,1063,10077184,4294967136,8657664
.long 8392064,108544,126976,8492928,0,0,0,0,0,0,0,0,0,0,0,6,6809600,6830080,6850560,6871040,117760,138240,158720,102400,7887360,10240,7877376,49600,38,10102784,4294967136,8658176
.long 8393792,129024,131072,8494976,0,0,0,0,0,0,0,0,0,0,0,6,6835200,6855680,6876160,6814720,133120,153600,112640,117760,7887616,10240,7877440,1360320,1062,10128384,4294967136,8658688
.long 0,0,0,0,21,4,20,8454144,1310720,7864384,8565760,73728,0,106496,106496,6,4239360,4249600,4218880,4229120,11264,0,0,0,7886848,8595456,7869312,50880,39,10051584,4294967136,0
.long 0,0,0,0,21,4,20,8456192,1392640,7866432,8587264,79872,0,107520,110592,6,4240384,4250624,4219904,4230144,11272,0,0,0,7887104,8606208,7869376,1361600,1063,10077184,4294967136,0
.long 0,0,0,0,21,4,20,8458240,1474560,7868480,8608768,86016,0,108544,114688,6,4198400,4208640,4177920,4188160,10240,0,0,0,7887360,8595456,7869184,49600,38,10102784,4294967136,0
.long 0,0,0,0,21,4,20,8460288,1556480,7870528,8630272,92160,0,109568,118784,6,4199424,4209664,4178944,4189184,10248,0,0,0,7887616,8606208,7869248,1360320,1062,10128384,4294967136,0
.long 8402432,106496,106496,8505216,0,0,0,0,0,0,0,0,0,0,0,6,7168000,7188480,7127040,7147520,148480,107520,128000,133120,7886848,11264,7878528,61120,47,10051584,4294967136,8661248
.long 8404160,126976,110592,8507264,0,0,0,0,0,0,0,0,0,0,0,6,7193600,7132160,7152640,7173120,102400,122880,143360,148480,7887104,11264,7878592,1371840,1071,10077184,4294967136,8661760
.long 8405888,108544,126976,8509312,0,0,0,0,0,0,0,0,0,0,0,6,7137280,7157760,7178240,7198720,117760,138240,158720,102400,7887360,10240,7878400,59840,46,10102784,4294967136,8662272
.long 8407616,129024,131072,8511360,0,0,0,0,0,0,0,0,0,0,0,6,7162880,7183360,7203840,7142400,133120,153600,112640,117760,7887616,10240,7878464,1370560,1070,10128384,4294967136,8662784
.long 0,0,0,0,21,5,20,8454144,1638400,7864400,8568448,73728,0,106496,106496,6,4567040,4577280,4546560,4556800,11264,0,0,0,7886848,8595456,7870336,61120,47,10051584,4294967136,0
.long 0,0,0,0,21,5,20,8456192,1720320,7866448,8589952,79872,0,107520,110592,6,4568064,4578304,4547584,4557824,11272,0,0,0,7887104,8606208,7870400,1371840,1071,10077184,4294967136,0
.long 0,0,0,0,21,5,20,8458240,1802240,7868496,8611456,86016,0,108544,114688,6,4526080,4536320,4505600,4515840,10240,0,0,0,7887360,8595456,7870208,59840,46,10102784,4294967136,0
.long 0,0,0,0,21,5,20,8460288,1884160,7870544,8632960,92160,0,109568,118784,6,4527104,4537344,4506624,4516864,10248,0,0,0,7887616,8606208,7870272,1370560,1070,10128384,4294967136,0
.long 8416256,106496,106496,8521600,0,0,0,0,0,0,0,0,0,0,0,6,7495680,7516160,7454720,7475200,148480,107520,128000,133120,7886848,11264,7879552,71360,55,10051584,4294967136,8665344
.long 8417984,126976,110592,8523648,0,0,0,0,0,0,0,0,0,0,0,6,7521280,7459840,7480320,7500800,102400,122880,143360,148480,7887104,11264,7879616,1382080,1079,10077184,4294967136,8665856
.long 8419712,108544,126976,8525696,0,0,0,0,0,0,0,0,0,0,0,6,7464960,7485440,7505920,7526400,117760,138240,158720,102400,7887360,10240,7879424,70080,54,10102784,4294967136,8666368
.long 8421440,129024,131072,8527744,0,0,0,0,0,0,0,0,0,0,0,6,7490560,7511040,7531520,7470080,133120,153600,112640,117760,7887616,10240,7879488,1380800,1078,10128384,4294967136,8666880
.long 0,0,0,0,21,6,20,8454144,1966080,7864416,8571136,73728,0,106496,106496,6,4894720,4904960,4874240,4884480,11264,0,0,0,7886848,8616960,7871360,71360,55,10051584,4294967136,0
.long 0,0,0,0,21,6,20,8456192,2048000,7866464,8592640,79872,0,107520,110592,6,4895744,4905984,4875264,4885504,11272,0,0,0,7887104,8627712,7871424,1382080,1079,10077184,4294967136,0
.long 0,0,0,0,21,6,20,8458240,2129920,7868512,8614144,86016,0,108544,114688,6,4853760,4864000,4833280,4843520,10240,0,0,0,7887360,8616960,7871232,70080,54,10102784,4294967136,0
.long 0,0,0,0,21,6,20,8460288,2211840,7870560,8635648,92160,0,109568,118784,6,4854784,4865024,4834304,4844544,10248,0,0,0,7887616,8627712,7871296,1380800,1078,10128384,4294967136,0
.long 8430080,106496,106496,8537984,0,0,0,0,0,0,0,0,0,0,0,6,7823360,7843840,7782400,7802880,148480,107520,128000,133120,7886848,11264,7880576,81600,63,10051584,4294967136,8669440
.long 8431808,126976,110592,8540032,0,0,0,0,0,0,0,0,0,0,0,6,7848960,7787520,7808000,7828480,102400,122880,143360,148480,7887104,11264,7880640,1392320,1087,10077184,4294967136,8669952
.long 8433536,108544,126976,8542080,0,0,0,0,0,0,0,0,0,0,0,6,7792640,7813120,7833600,7854080,117760,138240,158720,102400,7887360,10240,7880448,80320,62,10102784,4294967136,8670464
.long 8435264,129024,131072,8544128,0,0,0,0,0,0,0,0,0,0,0,6,7818240,7838720,7859200,7797760,133120,153600,112640,117760,7887616,10240,7880512,1391040,1086,10128384,4294967136,8670976
.long 0,0,0,0,21,7,20,8454144,2293760,7864432,8573824,73728,0,106496,106496,6,5222400,5232640,5201920,5212160,11264,0,0,0,7886848,8616960,7872384,81600,63,10051584,4294967136,0
.long 0,0,0,0,21,7,20,8456192,2375680,7866480,8595328,79872,0,107520,110592,6,5223424,5233664,5202944,5213184,11272,0,0,0,7887104,8627712,7872448,1392320,1087,10077184,4294967136,0
.long 0,0,0,0,21,7,20,8458240,2457600,7868528,8616832,86016,0,108544,114688,6,5181440,5191680,5160960,5171200,10240,0,0,0,7887360,8616960,7872256,80320,62,10102784,4294967136,0
.long 0,0,0,0,21,7,20,8460288,2539520,7870576,8638336,92160,0,109568,118784,6,5182464,5192704,5161984,5172224,10248,0,0,0,7887616,8627712,7872320,1391040,1086,10128384,4294967136,0
.long 8395520,106496,106496,8496000,0,0,0,0,0,0,0,0,0,0,0,7,5550080,5488640,5509120,5529600,102400,122880,143360,148480,7887872,16384,7873472,1320800,1031,10153984,4294967216,8640768
.long 8397248,126976,110592,8498048,0,0,0,0,0,0,0,0,0,0,0,7,5493760,5514240,5534720,5555200,117760,138240,158720,102400,7888128,15360,7873280,8800,6,10179584,4294967216,8641280
.long 8398976,108544,126976,8500096,0,0,0,0,0,0,0,0,0,0,0,7,5519360,5539840,5560320,5498880,133120,153600,112640,117760,7888384,15360,7873344,1319520,1030,10205184,4294967216,8641792
.long 8400704,129024,131072,8502144,0,0,0,0,0,0,0,0,0,0,0,7,5544960,5565440,5504000,5524480,148480,107520,128000,133120,7888640,16384,7873408,10080,7,10230784,4294967216,8642304
.long 0,0,0,0,23,0,20,8454144,0,7864320,8555008,73728,0,106496,106496,7,2939904,2909184,2919424,2929664,16392,0,0,0,7887872,8563200,7865280,1320800,1031,10153984,4294967216,0
.long 0,0,0,0,23,0,20,8456192,81920,7866368,8576512,79872,0,107520,110592,7,2897920,2867200,2877440,2887680,15360,0,0,0,7888128,8552448,7865088,8800,6,10179584,4294967216,0
.long 0,0,0,0,23,0,20,8458240,163840,7868416,8598016,86016,0,108544,114688,7,2898944,2868224,2878464,2888704,15368,0,0,0,7888384,8563200,7865152,1319520,1030,10205184,4294967216,0
.long 0,0,0,0,23,0,20,8460288,245760,7870464,8619520,92160,0,109568,118784,7,2938880,2908160,2918400,2928640,16384,0,0,0,7888640,8552448,7865216,10080,7,10230784,4294967216,0
.long 8409344,106496,106496,8512384,0,0,0,0,0,0,0,0,0,0,0,7,5877760,5816320,5836800,5857280,102400,122880,143360,148480,7887872,16384,7874496,1331040,1039,10153984,4294967216,8644864
.long 8411072,126976,110592,8514432,0,0,0,0,0,0,0,0,0,0,0,7,5821440,5841920,5862400,5882880,117760,138240,158720,102400,7888128,15360,7874304,19040,14,10179584,4294967216,8645376
.long 8412800,108544,126976,8516480,0,0,0,0,0,0,0,0,0,0,0,7,5847040,5867520,5888000,5826560,133120,153600,112640,117760,7888384,15360,7874368,1329760,1038,10205184,4294967216,8645888
.long 8414528,129024,131072,8518528,0,0,0,0,0,0,0,0,0,0,0,7,5872640,5893120,5831680,5852160,148480,107520,128000,133120,7888640,16384,7874432,20320,15,10230784,4294967216,8646400
.long 0,0,0,0,23,1,20,8454144,327680,7864336,8557696,73728,0,106496,106496,7,3267584,3236864,3247104,3257344,16392,0,0,0,7887872,8563200,7866304,1331040,1039,10153984,4294967216,0
.long 0,0,0,0,23,1,20,8456192,409600,7866384,8579200,79872,0,107520,110592,7,3225600,3194880,3205120,3215360,15360,0,0,0,7888128,8552448,7866112,19040,14,10179584,4294967216,0
.long 0,0,0,0,23,1,20,8458240,491520,7868432,8600704,86016,0,108544,114688,7,3226624,3195904,3206144,3216384,15368,0,0,0,7888384,8563200,7866176,1329760,1038,10205184,4294967216,0
.long 0,0,0,0,23,1,20,8460288,573440,7870480,8622208,92160,0,109568,118784,7,3266560,3235840,3246080,3256320,16384,0,0,0,7888640,8552448,7866240,20320,15,10230784,4294967216,0
.long 8423168,106496,106496,8528768,0,0,0,0,0,0,0,0,0,0,0,7,6205440,6144000,6164480,6184960,102400,122880,143360,148480,7887872,16384,7875520,1341280,1047,10153984,4294967216,8648960
.long 8424896,126976,110592,8530816,0,0,0,0,0,0,0,0,0,0,0,7,6149120,6169600,6190080,6210560,117760,138240,158720,102400,7888128,15360,7875328,29280,22,10179584,4294967216,8649472
.long 8426624,108544,126976,8532864,0,0,0,0,0,0,0,0,0,0,0,7,6174720,6195200,6215680,6154240,133120,153600,112640,117760,7888384,15360,7875392,1340000,1046,10205184,4294967216,8649984
.long 8428352,129024,131072,8534912,0,0,0,0,0,0,0,0,0,0,0,7,6200320,6220800,6159360,6179840,148480,107520,128000,133120,7888640,16384,7875456,30560,23,10230784,4294967216,8650496
.long 0,0,0,0,23,2,20,8454144,655360,7864352,8560384,73728,0,106496,106496,7,3595264,3564544,3574784,3585024,16392,0,0,0,7887872,8584704,7867328,1341280,1047,10153984,4294967216,0
.long 0,0,0,0,23,2,20,8456192,737280,7866400,8581888,79872,0,107520,110592,7,3553280,3522560,3532800,3543040,15360,0,0,0,7888128,8573952,7867136,29280,22,10179584,4294967216,0
.long 0,0,0,0,23,2,20,8458240,819200,7868448,8603392,86016,0,108544,114688,7,3554304,3523584,3533824,3544064,15368,0,0,0,7888384,8584704,7867200,1340000,1046,10205184,4294967216,0
.long 0,0,0,0,23,2,20,8460288,901120,7870496,8624896,92160,0,109568,118784,7,3594240,3563520,3573760,3584000,16384,0,0,0,7888640,8573952,7867264,30560,23,10230784,4294967216,0
.long 8436992,106496,106496,8545152,0,0,0,0,0,0,0,0,0,0,0,7,6533120,6471680,6492160,6512640,102400,122880,143360,148480,7887872,16384,7876544,1351520,1055,10153984,4294967216,8653056
.long 8438720,126976,110592,8547200,0,0,0,0,0,0,0,0,0,0,0,7,6476800,6497280,6517760,6538240,117760,138240,158720,102400,7888128,15360,7876352,39520,30,10179584,4294967216,8653568
.long 8440448,108544,126976,8549248,0,0,0,0,0,0,0,0,0,0,0,7,6502400,6522880,6543360,6481920,133120,153600,112640,117760,7888384,15360,7876416,1350240,1054,10205184,4294967216,8654080
.long 8442176,129024,131072,8551296,0,0,0,0,0,0,0,0,0,0,0,7,6528000,6548480,6487040,6507520,148480,107520,128000,133120,7888640,16384,7876480,40800,31,10230784,4294967216,8654592
.long 0,0,0,0,23,3,20,8454144,983040,7864368,8563072,73728,0,106496,106496,7,3922944,3892224,3902464,3912704,16392,0,0,0,7887872,8584704,7868352,1351520,1055,10153984,4294967216,0
.long 0,0,0,0,23,3,20,8456192,1064960,7866416,8584576,79872,0,107520,110592,7,3880960,3850240,3860480,3870720,15360,0,0,0,7888128,8573952,7868160,39520,30,10179584,4294967216,0
.long 0,0,0,0,23,3,20,8458240,1146880,7868464,8606080,86016,0,108544,114688,7,3881984,3851264,3861504,3871744,15368,0,0,0,7888384,8584704,7868224,1350240,1054,10205184,4294967216,0
.long 0,0,0,0,23,3,20,8460288,1228800,7870512,8627584,92160,0,109568,118784,7,3921920,3891200,3901440,3911680,16384,0,0,0,7888640,8573952,7868288,40800,31,10230784,4294967216,0
.long 8395520,106496,106496,8497024,0,0,0,0,0,0,0,0,0,0,0,7,6860800,6799360,6819840,6840320,102400,122880,143360,148480,7887872,16384,7877568,1361760,1063,10153984,4294967216,8657152
.long 8397248,126976,110592,8499072,0,0,0,0,0,0,0,0,0,0,0,7,6804480,6824960,6845440,6865920,117760,138240,158720,102400,7888128,15360,7877376,49760,38,10179584,4294967216,8657664
.long 8398976,108544,126976,8501120,0,0,0,0,0,0,0,0,0,0,0,7,6830080,6850560,6871040,6809600,133120,153600,112640,117760,7888384,15360,7877440,1360480,1062,10205184,4294967216,8658176
.long 8400704,129024,131072,8503168,0,0,0,0,0,0,0,0,0,0,0,7,6855680,6876160,6814720,6835200,148480,107520,128000,133120,7888640,16384,7877504,51040,39,10230784,4294967216,8658688
.long 0,0,0,0,23,4,20,8454144,1310720,7864384,8565760,73728,0,106496,106496,7,4250624,4219904,4230144,4240384,16392,0,0,0,7887872,8606208,7869376,1361760,1063,10153984,4294967216,0
.long 0,0,0,0,23,4,20,8456192,1392640,7866432,8587264,79872,0,107520,110592,7,4208640,4177920,4188160,4198400,15360,0,0,0,7888128,8595456,7869184,49760,38,10179584,4294967216,0
.long 0,0,0,0,23,4,20,8458240,1474560,7868480,8608768,86016,0,108544,114688,7,4209664,4178944,4189184,4199424,15368,0,0,0,7888384,8606208,7869248,1360480,1062,10205184,4294967216,0
.long 0,0,0,0,23,4,20,8460288,1556480,7870528,8630272,92160,0,109568,118784,7,4249600,4218880,4229120,4239360,16384,0,0,0,7888640,8595456,7869312,51040,39,10230784,4294967216,0
.long 8409344,106496,106496,8513408,0,0,0,0,0,0,0,0,0,0,0,7,7188480,7127040,7147520,7168000,102400,122880,143360,148480,7887872,16384,7878592,1372000,1071,10153984,4294967216,8661248
.long 8411072,126976,110592,8515456,0,0,0,0,0,0,0,0,0,0,0,7,7132160,7152640,7173120,7193600,117760,138240,158720,102400,7888128,15360,7878400,60000,46,10179584,4294967216,8661760
.long 8412800,108544,126976,8517504,0,0,0,0,0,0,0,0,0,0,0,7,7157760,7178240,7198720,7137280,133120,153600,112640,117760,7888384,15360,7878464,1370720,1070,10205184,4294967216,8662272
.long 8414528,129024,131072,8519552,0,0,0,0,0,0,0,0,0,0,0,7,7183360,7203840,7142400,7162880,148480,107520,128000,133120,7888640,16384,7878528,61280,47,10230784,4294967216,8662784
.long 0,0,0,0,23,5,20,8454144,1638400,7864400,8568448,73728,0,106496,106496,7,4578304,4547584,4557824,4568064,16392,0,0,0,7887872,8606208,7870400,1372000,1071,10153984,4294967216,0
.long 0,0,0,0,23,5,20,8456192,1720320,7866448,8589952,79872,0,107520,110592,7,4536320,4505600,4515840,4526080,15360,0,0,0,7888128,8595456,7870208,60000,46,10179584,4294967216,0
.long 0,0,0,0,23,5,20,8458240,1802240,7868496,8611456,86016,0,108544,114688,7,4537344,4506624,4516864,4527104,15368,0,0,0,7888384,8606208,7870272,1370720,1070,10205184,4294967216,0
.long 0,0,0,0,23,5,20,8460288,1884160,7870544,8632960,92160,0,109568,118784,7,4577280,4546560,4556800,4567040,16384,0,0,0,7888640,8595456,7870336,61280,47,10230784,4294967216,0
.long 8423168,106496,106496,8529792,0,0,0,0,0,0,0,0,0,0,0,7,7516160,7454720,7475200,7495680,102400,122880,143360,148480,7887872,16384,7879616,1382240,1079,10153984,4294967216,8665344
.long 8424896,126976,110592,8531840,0,0,0,0,0,0,0,0,0,0,0,7,7459840,7480320,7500800,7521280,117760,138240,158720,102400,7888128,15360,7879424,70240,54,10179584,4294967216,8665856
.long 8426624,108544,126976,8533888,0,0,0,0,0,0,0,0,0,0,0,7,7485440,7505920,7526400,7464960,133120,153600,112640,117760,7888384,15360,7879488,1380960,1078,10205184,4294967216,8666368
.long 8428352,129024,131072,8535936,0,0,0,0,0,0,0,0,0,0,0,7,7511040,7531520,7470080,7490560,148480,107520,128000,133120,7888640,16384,7879552,71520,55,10230784,4294967216,8666880
.long 0,0,0,0,23,6,20,8454144,1966080,7864416,8571136,73728,0,106496,106496,7,4905984,4875264,4885504,4895744,16392,0,0,0,7887872,8627712,7871424,1382240,1079,10153984,4294967216,0
.long 0,0,0,0,23,6,20,8456192,2048000,7866464,8592640,79872,0,107520,110592,7,4864000,4833280,4843520,4853760,15360,0,0,0,7888128,8616960,7871232,70240,54,10179584,4294967216,0
.long 0,0,0,0,23,6,20,8458240,2129920,7868512,8614144,86016,0,108544,114688,7,4865024,4834304,4844544,4854784,15368,0,0,0,7888384,8627712,7871296,1380960,1078,10205184,4294967216,0
.long 0,0,0,0,23,6,20,8460288,2211840,7870560,8635648,92160,0,109568,118784,7,4904960,4874240,4884480,4894720,16384,0,0,0,7888640,8616960,7871360,71520,55,10230784,4294967216,0
.long 8436992,106496,106496,8546176,0,0,0,0,0,0,0,0,0,0,0,7,7843840,7782400,7802880,7823360,102400,122880,143360,148480,7887872,16384,7880640,1392480,1087,10153984,4294967216,8669440
.long 8438720,126976,110592,8548224,0,0,0,0,0,0,0,0,0,0,0,7,7787520,7808000,7828480,7848960,117760,138240,158720,102400,7888128,15360,7880448,80480,62,10179584,4294967216,8669952
.long 8440448,108544,126976,8550272,0,0,0,0,0,0,0,0,0,0,0,7,7813120,7833600,7854080,7792640,133120,153600,112640,117760,7888384,15360,7880512,1391200,1086,10205184,4294967216,8670464
.long 8442176,129024,131072,8552320,0,0,0,0,0,0,0,0,0,0,0,7,7838720,7859200,7797760,7818240,148480,107520,128000,133120,7888640,16384,7880576,81760,63,10230784,4294967216,8670976
.long 0,0,0,0,23,7,20,8454144,2293760,7864432,8573824,73728,0,106496,106496,7,5233664,5202944,5213184,5223424,16392,0,0,0,7887872,8627712,7872448,1392480,1087,10153984,4294967216,0
.long 0,0,0,0,23,7,20,8456192,2375680,7866480,8595328,79872,0,107520,110592,7,5191680,5160960,5171200,5181440,15360,0,0,0,7888128,8616960,7872256,80480,62,10179584,4294967216,0
.long 0,0,0,0,23,7,20,8458240,2457600,7868528,8616832,86016,0,108544,114688,7,5192704,5161984,5172224,5182464,15368,0,0,0,7888384,8627712,7872320,1391200,1086,10205184,4294967216,0
.long 0,0,0,0,23,7,20,8460288,2539520,7870576,8638336,92160,0,109568,118784,7,5232640,5201920,5212160,5222400,16384,0,0,0,7888640,8616960,7872384,81760,63,10230784,4294967216,0
.size stab, 262144
.p2align 8
.type ftab,@object
.altmacro
.set c0, 0x3f80
.set c1, 0x3f80
.set c2, 0x3f80
.set c3, 0x3f80
.set c4, 0x3f80
.set c5, 0x3f80
.set c6, 0x3f80
.set c7, 0x3f7f
.set c8, 0x3f7f
.set c9, 0x3f7f
.set c10, 0x3f7f
.set c11, 0x3f7f
.set c12, 0x3f7e
.set c13, 0x3f7e
.set c14, 0x3f7e
.set c15, 0x3f7d
.set c16, 0x3f7d
.set c17, 0x3f7c
.set c18, 0x3f7c
.set c19, 0x3f7c
.set c20, 0x3f7b
.set c21, 0x3f7b
.set c22, 0x3f7a
.set c23, 0x3f7a
.set c24, 0x3f79
.set c25, 0x3f78
.set c26, 0x3f78
.set c27, 0x3f77
.set c28, 0x3f76
.set c29, 0x3f76
.set c30, 0x3f75
.set c31, 0x3f74
.set c32, 0x3f73
.set c33, 0x3f73
.set c34, 0x3f72
.set c35, 0x3f71
.set c36, 0x3f70
.set c37, 0x3f6f
.set c38, 0x3f6e
.set c39, 0x3f6d
.set c40, 0x3f6d
.set c41, 0x3f6c
.set c42, 0x3f6b
.set c43, 0x3f6a
.set c44, 0x3f68
.set c45, 0x3f67
.set c46, 0x3f66
.set c47, 0x3f65
.set c48, 0x3f64
.set c49, 0x3f63
.set c50, 0x3f62
.set c51, 0x3f61
.set c52, 0x3f5f
.set c53, 0x3f5e
.set c54, 0x3f5d
.set c55, 0x3f5c
.set c56, 0x3f5a
.set c57, 0x3f59
.set c58, 0x3f58
.set c59, 0x3f56
.set c60, 0x3f55
.set c61, 0x3f53
.set c62, 0x3f52
.set c63, 0x3f51
.set c64, 0x3f4f
.set c65, 0x3f4e
.set c66, 0x3f4c
.set c67, 0x3f4b
.set c68, 0x3f49
.set c69, 0x3f47
.set c70, 0x3f46
.set c71, 0x3f44
.set c72, 0x3f43
.set c73, 0x3f41
.set c74, 0x3f3f
.set c75, 0x3f3e
.set c76, 0x3f3c
.set c77, 0x3f3a
.set c78, 0x3f39
.set c79, 0x3f37
.set c80, 0x3f35
.set c81, 0x3f33
.set c82, 0x3f31
.set c83, 0x3f30
.set c84, 0x3f2e
.set c85, 0x3f2c
.set c86, 0x3f2a
.set c87, 0x3f28
.set c88, 0x3f26
.set c89, 0x3f24
.set c90, 0x3f22
.set c91, 0x3f20
.set c92, 0x3f1e
.set c93, 0x3f1d
.set c94, 0x3f1b
.set c95, 0x3f18
.set c96, 0x3f16
.set c97, 0x3f14
.set c98, 0x3f12
.set c99, 0x3f10
.set c100, 0x3f0e
.set c101, 0x3f0c
.set c102, 0x3f0a
.set c103, 0x3f08
.set c104, 0x3f06
.set c105, 0x3f04
.set c106, 0x3f01
.set c107, 0x3eff
.set c108, 0x3efa
.set c109, 0x3ef6
.set c110, 0x3ef1
.set c111, 0x3eed
.set c112, 0x3ee8
.set c113, 0x3ee4
.set c114, 0x3edf
.set c115, 0x3edb
.set c116, 0x3ed6
.set c117, 0x3ed2
.set c118, 0x3ecd
.set c119, 0x3ec9
.set c120, 0x3ec4
.set c121, 0x3ebf
.set c122, 0x3ebb
.set c123, 0x3eb6
.set c124, 0x3eb1
.set c125, 0x3eac
.set c126, 0x3ea8
.set c127, 0x3ea3
.set c128, 0x3e9e
.set c129, 0x3e99
.set c130, 0x3e95
.set c131, 0x3e90
.set c132, 0x3e8b
.set c133, 0x3e86
.set c134, 0x3e81
.set c135, 0x3e79
.set c136, 0x3e6f
.set c137, 0x3e65
.set c138, 0x3e5b
.set c139, 0x3e52
.set c140, 0x3e48
.set c141, 0x3e3e
.set c142, 0x3e34
.set c143, 0x3e2a
.set c144, 0x3e20
.set c145, 0x3e16
.set c146, 0x3e0c
.set c147, 0x3e02
.set c148, 0x3df1
.set c149, 0x3ddd
.set c150, 0x3dc9
.set c151, 0x3db5
.set c152, 0x3da1
.set c153, 0x3d8d
.set c154, 0x3d71
.set c155, 0x3d49
.set c156, 0x3d21
.set c157, 0x3cf1
.set c158, 0x3ca1
.set c159, 0x3c21
.set c160, 0x0
.set c161, 0xbc21
.set c162, 0xbca1
.set c163, 0xbcf1
.set c164, 0xbd21
.set c165, 0xbd49
.set c166, 0xbd71
.set c167, 0xbd8d
.set c168, 0xbda1
.set c169, 0xbdb5
.set c170, 0xbdc9
.set c171, 0xbddd
.set c172, 0xbdf1
.set c173, 0xbe02
.set c174, 0xbe0c
.set c175, 0xbe16
.set c176, 0xbe20
.set c177, 0xbe2a
.set c178, 0xbe34
.set c179, 0xbe3e
.set c180, 0xbe48
.set c181, 0xbe52
.set c182, 0xbe5b
.set c183, 0xbe65
.set c184, 0xbe6f
.set c185, 0xbe79
.set c186, 0xbe81
.set c187, 0xbe86
.set c188, 0xbe8b
.set c189, 0xbe90
.set c190, 0xbe95
.set c191, 0xbe99
.set c192, 0xbe9e
.set c193, 0xbea3
.set c194, 0xbea8
.set c195, 0xbeac
.set c196, 0xbeb1
.set c197, 0xbeb6
.set c198, 0xbebb
.set c199, 0xbebf
.set c200, 0xbec4
.set c201, 0xbec9
.set c202, 0xbecd
.set c203, 0xbed2
.set c204, 0xbed6
.set c205, 0xbedb
.set c206, 0xbedf
.set c207, 0xbee4
.set c208, 0xbee8
.set c209, 0xbeed
.set c210, 0xbef1
.set c211, 0xbef6
.set c212, 0xbefa
.set c213, 0xbeff
.set c214, 0xbf01
.set c215, 0xbf04
.set c216, 0xbf06
.set c217, 0xbf08
.set c218, 0xbf0a
.set c219, 0xbf0c
.set c220, 0xbf0e
.set c221, 0xbf10
.set c222, 0xbf12
.set c223, 0xbf14
.set c224, 0xbf16
.set c225, 0xbf18
.set c226, 0xbf1b
.set c227, 0xbf1d
.set c228, 0xbf1e
.set c229, 0xbf20
.set c230, 0xbf22
.set c231, 0xbf24
.set c232, 0xbf26
.set c233, 0xbf28
.set c234, 0xbf2a
.set c235, 0xbf2c
.set c236, 0xbf2e
.set c237, 0xbf30
.set c238, 0xbf31
.set c239, 0xbf33
.set c240, 0xbf35
.set c241, 0xbf37
.set c242, 0xbf39
.set c243, 0xbf3a
.set c244, 0xbf3c
.set c245, 0xbf3e
.set c246, 0xbf3f
.set c247, 0xbf41
.set c248, 0xbf43
.set c249, 0xbf44
.set c250, 0xbf46
.set c251, 0xbf47
.set c252, 0xbf49
.set c253, 0xbf4b
.set c254, 0xbf4c
.set c255, 0xbf4e
.set c256, 0xbf4f
.set c257, 0xbf51
.set c258, 0xbf52
.set c259, 0xbf53
.set c260, 0xbf55
.set c261, 0xbf56
.set c262, 0xbf58
.set c263, 0xbf59
.set c264, 0xbf5a
.set c265, 0xbf5c
.set c266, 0xbf5d
.set c267, 0xbf5e
.set c268, 0xbf5f
.set c269, 0xbf61
.set c270, 0xbf62
.set c271, 0xbf63
.set c272, 0xbf64
.set c273, 0xbf65
.set c274, 0xbf66
.set c275, 0xbf67
.set c276, 0xbf68
.set c277, 0xbf6a
.set c278, 0xbf6b
.set c279, 0xbf6c
.set c280, 0xbf6d
.set c281, 0xbf6d
.set c282, 0xbf6e
.set c283, 0xbf6f
.set c284, 0xbf70
.set c285, 0xbf71
.set c286, 0xbf72
.set c287, 0xbf73
.set c288, 0xbf73
.set c289, 0xbf74
.set c290, 0xbf75
.set c291, 0xbf76
.set c292, 0xbf76
.set c293, 0xbf77
.set c294, 0xbf78
.set c295, 0xbf78
.set c296, 0xbf79
.set c297, 0xbf7a
.set c298, 0xbf7a
.set c299, 0xbf7b
.set c300, 0xbf7b
.set c301, 0xbf7c
.set c302, 0xbf7c
.set c303, 0xbf7c
.set c304, 0xbf7d
.set c305, 0xbf7d
.set c306, 0xbf7e
.set c307, 0xbf7e
.set c308, 0xbf7e
.set c309, 0xbf7f
.set c310, 0xbf7f
.set c311, 0xbf7f
.set c312, 0xbf7f
.set c313, 0xbf7f
.set c314, 0xbf80
.set c315, 0xbf80
.set c316, 0xbf80
.set c317, 0xbf80
.set c318, 0xbf80
.set c319, 0xbf80
.set c320, 0xbf80
.set c321, 0xbf80
.set c322, 0xbf80
.set c323, 0xbf80
.set c324, 0xbf80
.set c325, 0xbf80
.set c326, 0xbf80
.set c327, 0xbf7f
.set c328, 0xbf7f
.set c329, 0xbf7f
.set c330, 0xbf7f
.set c331, 0xbf7f
.set c332, 0xbf7e
.set c333, 0xbf7e
.set c334, 0xbf7e
.set c335, 0xbf7d
.set c336, 0xbf7d
.set c337, 0xbf7c
.set c338, 0xbf7c
.set c339, 0xbf7c
.set c340, 0xbf7b
.set c341, 0xbf7b
.set c342, 0xbf7a
.set c343, 0xbf7a
.set c344, 0xbf79
.set c345, 0xbf78
.set c346, 0xbf78
.set c347, 0xbf77
.set c348, 0xbf76
.set c349, 0xbf76
.set c350, 0xbf75
.set c351, 0xbf74
.set c352, 0xbf73
.set c353, 0xbf73
.set c354, 0xbf72
.set c355, 0xbf71
.set c356, 0xbf70
.set c357, 0xbf6f
.set c358, 0xbf6e
.set c359, 0xbf6d
.set c360, 0xbf6d
.set c361, 0xbf6c
.set c362, 0xbf6b
.set c363, 0xbf6a
.set c364, 0xbf68
.set c365, 0xbf67
.set c366, 0xbf66
.set c367, 0xbf65
.set c368, 0xbf64
.set c369, 0xbf63
.set c370, 0xbf62
.set c371, 0xbf61
.set c372, 0xbf5f
.set c373, 0xbf5e
.set c374, 0xbf5d
.set c375, 0xbf5c
.set c376, 0xbf5a
.set c377, 0xbf59
.set c378, 0xbf58
.set c379, 0xbf56
.set c380, 0xbf55
.set c381, 0xbf53
.set c382, 0xbf52
.set c383, 0xbf51
.set c384, 0xbf4f
.set c385, 0xbf4e
.set c386, 0xbf4c
.set c387, 0xbf4b
.set c388, 0xbf49
.set c389, 0xbf47
.set c390, 0xbf46
.set c391, 0xbf44
.set c392, 0xbf43
.set c393, 0xbf41
.set c394, 0xbf3f
.set c395, 0xbf3e
.set c396, 0xbf3c
.set c397, 0xbf3a
.set c398, 0xbf39
.set c399, 0xbf37
.set c400, 0xbf35
.set c401, 0xbf33
.set c402, 0xbf31
.set c403, 0xbf30
.set c404, 0xbf2e
.set c405, 0xbf2c
.set c406, 0xbf2a
.set c407, 0xbf28
.set c408, 0xbf26
.set c409, 0xbf24
.set c410, 0xbf22
.set c411, 0xbf20
.set c412, 0xbf1e
.set c413, 0xbf1d
.set c414, 0xbf1b
.set c415, 0xbf18
.set c416, 0xbf16
.set c417, 0xbf14
.set c418, 0xbf12
.set c419, 0xbf10
.set c420, 0xbf0e
.set c421, 0xbf0c
.set c422, 0xbf0a
.set c423, 0xbf08
.set c424, 0xbf06
.set c425, 0xbf04
.set c426, 0xbf01
.set c427, 0xbeff
.set c428, 0xbefa
.set c429, 0xbef6
.set c430, 0xbef1
.set c431, 0xbeed
.set c432, 0xbee8
.set c433, 0xbee4
.set c434, 0xbedf
.set c435, 0xbedb
.set c436, 0xbed6
.set c437, 0xbed2
.set c438, 0xbecd
.set c439, 0xbec9
.set c440, 0xbec4
.set c441, 0xbebf
.set c442, 0xbebb
.set c443, 0xbeb6
.set c444, 0xbeb1
.set c445, 0xbeac
.set c446, 0xbea8
.set c447, 0xbea3
.set c448, 0xbe9e
.set c449, 0xbe99
.set c450, 0xbe95
.set c451, 0xbe90
.set c452, 0xbe8b
.set c453, 0xbe86
.set c454, 0xbe81
.set c455, 0xbe79
.set c456, 0xbe6f
.set c457, 0xbe65
.set c458, 0xbe5b
.set c459, 0xbe52
.set c460, 0xbe48
.set c461, 0xbe3e
.set c462, 0xbe34
.set c463, 0xbe2a
.set c464, 0xbe20
.set c465, 0xbe16
.set c466, 0xbe0c
.set c467, 0xbe02
.set c468, 0xbdf1
.set c469, 0xbddd
.set c470, 0xbdc9
.set c471, 0xbdb5
.set c472, 0xbda1
.set c473, 0xbd8d
.set c474, 0xbd71
.set c475, 0xbd49
.set c476, 0xbd21
.set c477, 0xbcf1
.set c478, 0xbca1
.set c479, 0xbc21
.set c480, 0x0
.set c481, 0x3c21
.set c482, 0x3ca1
.set c483, 0x3cf1
.set c484, 0x3d21
.set c485, 0x3d49
.set c486, 0x3d71
.set c487, 0x3d8d
.set c488, 0x3da1
.set c489, 0x3db5
.set c490, 0x3dc9
.set c491, 0x3ddd
.set c492, 0x3df1
.set c493, 0x3e02
.set c494, 0x3e0c
.set c495, 0x3e16
.set c496, 0x3e20
.set c497, 0x3e2a
.set c498, 0x3e34
.set c499, 0x3e3e
.set c500, 0x3e48
.set c501, 0x3e52
.set c502, 0x3e5b
.set c503, 0x3e65
.set c504, 0x3e6f
.set c505, 0x3e79
.set c506, 0x3e81
.set c507, 0x3e86
.set c508, 0x3e8b
.set c509, 0x3e90
.set c510, 0x3e95
.set c511, 0x3e99
.set c512, 0x3e9e
.set c513, 0x3ea3
.set c514, 0x3ea8
.set c515, 0x3eac
.set c516, 0x3eb1
.set c517, 0x3eb6
.set c518, 0x3ebb
.set c519, 0x3ebf
.set c520, 0x3ec4
.set c521, 0x3ec9
.set c522, 0x3ecd
.set c523, 0x3ed2
.set c524, 0x3ed6
.set c525, 0x3edb
.set c526, 0x3edf
.set c527, 0x3ee4
.set c528, 0x3ee8
.set c529, 0x3eed
.set c530, 0x3ef1
.set c531, 0x3ef6
.set c532, 0x3efa
.set c533, 0x3eff
.set c534, 0x3f01
.set c535, 0x3f04
.set c536, 0x3f06
.set c537, 0x3f08
.set c538, 0x3f0a
.set c539, 0x3f0c
.set c540, 0x3f0e
.set c541, 0x3f10
.set c542, 0x3f12
.set c543, 0x3f14
.set c544, 0x3f16
.set c545, 0x3f18
.set c546, 0x3f1b
.set c547, 0x3f1d
.set c548, 0x3f1e
.set c549, 0x3f20
.set c550, 0x3f22
.set c551, 0x3f24
.set c552, 0x3f26
.set c553, 0x3f28
.set c554, 0x3f2a
.set c555, 0x3f2c
.set c556, 0x3f2e
.set c557, 0x3f30
.set c558, 0x3f31
.set c559, 0x3f33
.set c560, 0x3f35
.set c561, 0x3f37
.set c562, 0x3f39
.set c563, 0x3f3a
.set c564, 0x3f3c
.set c565, 0x3f3e
.set c566, 0x3f3f
.set c567, 0x3f41
.set c568, 0x3f43
.set c569, 0x3f44
.set c570, 0x3f46
.set c571, 0x3f47
.set c572, 0x3f49
.set c573, 0x3f4b
.set c574, 0x3f4c
.set c575, 0x3f4e
.set c576, 0x3f4f
.set c577, 0x3f51
.set c578, 0x3f52
.set c579, 0x3f53
.set c580, 0x3f55
.set c581, 0x3f56
.set c582, 0x3f58
.set c583, 0x3f59
.set c584, 0x3f5a
.set c585, 0x3f5c
.set c586, 0x3f5d
.set c587, 0x3f5e
.set c588, 0x3f5f
.set c589, 0x3f61
.set c590, 0x3f62
.set c591, 0x3f63
.set c592, 0x3f64
.set c593, 0x3f65
.set c594, 0x3f66
.set c595, 0x3f67
.set c596, 0x3f68
.set c597, 0x3f6a
.set c598, 0x3f6b
.set c599, 0x3f6c
.set c600, 0x3f6d
.set c601, 0x3f6d
.set c602, 0x3f6e
.set c603, 0x3f6f
.set c604, 0x3f70
.set c605, 0x3f71
.set c606, 0x3f72
.set c607, 0x3f73
.set c608, 0x3f73
.set c609, 0x3f74
.set c610, 0x3f75
.set c611, 0x3f76
.set c612, 0x3f76
.set c613, 0x3f77
.set c614, 0x3f78
.set c615, 0x3f78
.set c616, 0x3f79
.set c617, 0x3f7a
.set c618, 0x3f7a
.set c619, 0x3f7b
.set c620, 0x3f7b
.set c621, 0x3f7c
.set c622, 0x3f7c
.set c623, 0x3f7c
.set c624, 0x3f7d
.set c625, 0x3f7d
.set c626, 0x3f7e
.set c627, 0x3f7e
.set c628, 0x3f7e
.set c629, 0x3f7f
.set c630, 0x3f7f
.set c631, 0x3f7f
.set c632, 0x3f7f
.set c633, 0x3f7f
.set c634, 0x3f80
.set c635, 0x3f80
.set c636, 0x3f80
.set c637, 0x3f80
.set c638, 0x3f80
.set c639, 0x3f80
.macro e8 i0,i1,i2,i3,i4,i5,i6,i7
.short c\i0,c\i1,c\i2,c\i3,c\i4,c\i5,c\i6,c\i7
.endm
ftab:
.set tn, 0
.rept 4
.set tc, 0
.rept 20
.set tt, 0
.rept 10
.set tq, 0
.rept 4
.set td, 32*tc+8*tq
.set tk, 80*tn+16*(tt/2)
.rept 16
.set tz, (tk==0)*(tt&1)
.set tm, tk-320*tz
.set tp, 160*(tt&1)+160*tz
e8 %(((td+0)*tm+tp)%640),%(((td+1)*tm+tp)%640),%(((td+2)*tm+tp)%640),%(((td+3)*tm+tp)%640),%(((td+4)*tm+tp)%640),%(((td+5)*tm+tp)%640),%(((td+6)*tm+tp)%640),%(((td+7)*tm+tp)%640)
.set tk, tk+1
.endr
.set tq, tq+1
.endr
.set tt, tt+1
.endr
.set tc, tc+1
.endr
.set tn, tn+1
.endr
.size ftab, 819200
```
